```python
import torch

def _softmax(x, axis=-1):
    return torch.softmax(x, dim=axis)

def _gelu(x):
    return torch.nn.functional.gelu(x, approximate='tanh')

def _silu(x):
    return torch.nn.functional.silu(x)

def _sigmoid(x):
    return torch.sigmoid(x)

def _layernorm(x, axis=-1, eps=1e-05):
    m = x.mean(dim=axis, keepdim=True)
    v = x.var(dim=axis, keepdim=True, unbiased=False)
    return (x - m) / torch.sqrt(v + eps)

def _scatter_add(tgt, idx, src, axis=0):
    return tgt.clone().index_add_(axis, idx, src)

def _segment_sum(src, seg, n):
    out = torch.zeros((n,) + src.shape[1:], dtype=src.dtype)
    return out.index_add_(0, seg, src)

def _pad(x, pw):
    flat = tuple((v for pair in reversed(pw) for v in pair))
    return torch.nn.functional.pad(x, flat)
kernel_name = 'adaLN_cond__gqa_block_cached__glu_gated_reglu__prompt'

def setup_inputs():

    _w = lambda a: (lambda t: t.to(torch.bfloat16) if t.is_floating_point() else t)(torch.as_tensor(a))

    def _A_setup():
        B, Sq, D = (1, 2048, 512)
        Hq, Hkv, Sk, Dh = (32, 8, 2048, 128)
        assert Hq % Hkv == 0, (Hq, Hkv)
        return {'x': _w((lambda *s: torch.randn(*s, dtype=torch.bfloat16) * 0.1)(B, Sq, D)), 'k_cache': _w((lambda *s: torch.randn(*s, dtype=torch.bfloat16) * 0.8)(B, Hkv, Sk, Dh)), 'v_cache': _w((lambda *s: torch.randn(*s, dtype=torch.bfloat16) * 3.2)(B, Hkv, Sk, Dh)), 'wq': _w((lambda *s: torch.randn(*s, dtype=torch.bfloat16) * 0.8)(D, Hq * Dh) * D ** (-0.5)), 'wo': _w((lambda *s: torch.randn(*s, dtype=torch.bfloat16) * 3.2)(Hq * Dh, D) * (Hq * Dh) ** (-0.5))}
    _A_in = _A_setup()

    def _B_setup():
        B, S, D, F = (1, 2048, 512, 1792)
        return {'x': _w((lambda *s: torch.randn(*s, dtype=torch.bfloat16) * 0.1)(B, S, D)), 'W_gate': _w((lambda *s: torch.randn(*s, dtype=torch.bfloat16) * 3.2)(D, F) * (2.0 / D) ** 0.5), 'W_up': _w((lambda *s: torch.randn(*s, dtype=torch.bfloat16) * 3.2)(D, F) * (2.0 / D) ** 0.5), 'W_down': _w((lambda *s: torch.randn(*s, dtype=torch.bfloat16) * 3.2)(F, D) * (1.0 / F) ** 0.5)}
    _B_in = _B_setup()
    return {'A_x': _A_in['x'], 'A_k_cache': _A_in['k_cache'], 'A_v_cache': _A_in['v_cache'], 'A_wq': _A_in['wq'], 'A_wo': _A_in['wo'], 'B_x': _B_in['x'], 'B_W_gate': _B_in['W_gate'], 'B_W_up': _B_in['W_up'], 'B_W_down': _B_in['W_down'], 'c': _w((lambda *s: torch.randn(*s, dtype=torch.bfloat16) * 0.2)(1, 512) * 8.0), 'w_mod': _w((lambda *s: torch.randn(*s, dtype=torch.bfloat16) * 0.2)(512, 6 * 512) * 512 ** (-0.5) * 8.0)}

def reference(A_x, A_k_cache, A_v_cache, A_wq, A_wo, B_x, B_W_gate, B_W_up, B_W_down, c, w_mod):

    def _A_ref(x, k_cache, v_cache, wq, wo):
        B, Sq, D = x.shape
        Hq, Dh = (32, 128)
        Hkv = k_cache.shape[1]
        rep = Hq // Hkv
        q = (lambda x, *d: x.permute(*d))((x @ wq).reshape(B, Sq, Hq, Dh), 0, 2, 1, 3)
        k = (lambda x, n, axis: torch.repeat_interleave(x, n, dim=axis))(k_cache, rep, axis=1)
        v = (lambda x, n, axis: torch.repeat_interleave(x, n, dim=axis))(v_cache, rep, axis=1)
        scores = torch.einsum('bhqd,bhkd->bhqk', q, k) * Dh ** (-0.5)
        p = _softmax(scores, axis=-1)
        o = torch.einsum('bhqk,bhkd->bhqd', p, v)
        return (lambda x, *d: x.permute(*d))(o, 0, 2, 1, 3).reshape(B, Sq, Hq * Dh) @ wo

    def _B_ref(x, W_gate, W_up, W_down):
        gate = torch.einsum('bsd,df->bsf', x, W_gate)
        up = torch.einsum('bsd,df->bsf', x, W_up)
        gate = gate * (lambda x, dt: x.to(dt))(gate > 0, gate.dtype)
        h = gate * up
        return torch.einsum('bsf,fd->bsd', h, W_down)
    x = A_x
    mod = (_silu(c) @ w_mod).reshape(c.shape[0], 6, 1, -1)
    sa, ca, ga, sb, cb, gb = (mod[:, 0].clone(), mod[:, 1].clone(), mod[:, 2].clone(), mod[:, 3].clone(), mod[:, 4].clone(), mod[:, 5].clone())
    h = _layernorm(x, axis=-1) * (1 + ca) + sa
    x = x + ga * _A_ref(h, A_k_cache, A_v_cache, A_wq, A_wo)
    h = _layernorm(x, axis=-1) * (1 + cb) + sb
    x = x + gb * _B_ref(h, B_W_gate, B_W_up, B_W_down)
    return x
```

```asm
; @launch grid=(256,1,1) block=(256,1,1) lds=163840
.amdgcn_target "amdgcn-amd-amdhsa--gfx950"
.text
.p2align 12
.text
.globl adaLN_cond__gqa_block_cached__glu_gated_reglu__prompt_kernel
.p2align 8
.type adaLN_cond__gqa_block_cached__glu_gated_reglu__prompt_kernel,@function
adaLN_cond__gqa_block_cached__glu_gated_reglu__prompt_kernel:
    s_cmp_ge_u32 s2, 256
    s_cbranch_scc1 L_main_done
    s_load_dwordx8 s[56:63], s[0:1], 64
    s_load_dwordx8 s[40:47], s[0:1], 0
    s_load_dwordx4 s[64:67], s[0:1], 96
    s_load_dwordx4 s[48:51], s[0:1], 48
    s_load_dwordx2 s[52:53], s[0:1], 32
    v_lshrrev_b32 v2, 6, v0
    v_mov_b32 v5, v0
    v_readfirstlane_b32 s3, v2
    v_and_b32 v0, 63, v0
    s_and_b32 s4, s2, 7
    s_lshr_b32 s5, s2, 3
    v_lshlrev_b32 v1, 4, v0
    s_getpc_b64 s[86:87]
L_pc:
    s_lshr_b32 s88, s2, 1
    s_and_b32 s88, s88, 0xfc
    s_add_u32 s88, s88, s3
    s_and_b32 s88, s88, 15
    s_lshl_b32 s88, s88, 13
    v_lshl_add_u32 v8, v0, 7, s88
    v_min_u32 v8, L_code_end-L_pc-4, v8
    v_mov_b32 v9, s87
    v_add_co_u32 v8, vcc, s86, v8
    s_nop 1
    v_addc_co_u32 v9, vcc, 0, v9, vcc
    global_load_dword a17, v[8:9], off
    s_lshl_b32 s80, s5, 16
    s_lshr_b32 s87, s4, 1
    s_add_u32 s87, s87, s3
    s_add_u32 s87, s87, 1
    s_and_b32 s87, s87, 3
    s_lshl_b32 s87, s87, 14
    s_add_u32 s80, s80, s87
    s_add_u32 s81, s80, 4096
    s_add_u32 s82, s80, 8192
    s_add_u32 s83, s80, 12288
    s_cmp_lt_u32 s2, 64
    s_waitcnt lgkmcnt(0)
    s_cbranch_scc1 L_mod_first
L_mod_first_ret:
    s_lshr_b32 s86, s2, 6
    s_cmp_eq_u32 s86, 1
    s_cbranch_scc0 L_no_p2
    s_mov_b32 s24, s58
    s_and_b32 s25, s59, 0xffff
    s_mov_b32 s26, 0x400
    s_mov_b32 s27, 0x20000
    s_mov_b32 s28, s60
    s_and_b32 s29, s61, 0xffff
    s_mov_b32 s30, 0x300000
    s_mov_b32 s31, 0x20000
    s_and_b32 s84, s2, 7
    s_lshl_b32 s84, s84, 1
    s_bfe_u32 s86, s2, 0x10003
    s_add_u32 s84, s84, s86
    s_and_b32 s86, s2, 0x30
    s_add_u32 s84, s84, s86
    s_add_u32 s84, s84, 32
    s_lshl_b32 s68, s84, 6
    s_add_u32 s69, s68, 6144
    s_add_u32 s70, s68, 12288
    s_add_u32 s71, s68, 18432
    s_add_u32 s72, s68, 24576
    s_add_u32 s73, s68, 30720
    s_add_u32 s74, s68, 36864
    s_add_u32 s75, s68, 43008
    v_lshrrev_b32 v8, 2, v0
    s_lshl_b32 s86, s3, 4
    v_add_u32 v8, s86, v8
    v_and_b32 v7, 3, v0
    v_mul_u32_u24 v6, 49152, v8
    v_lshl_add_u32 v6, v7, 4, v6
    v_lshlrev_b32 v8, 4, v8
    buffer_load_dwordx4 v[96:99], v8, s[24:27], 0 offen
    buffer_load_dwordx4 v[64:67], v6, s[28:31], s68 offen
    buffer_load_dwordx4 v[68:71], v6, s[28:31], s69 offen
    buffer_load_dwordx4 v[72:75], v6, s[28:31], s70 offen
    buffer_load_dwordx4 v[76:79], v6, s[28:31], s71 offen
    buffer_load_dwordx4 v[80:83], v6, s[28:31], s72 offen
    buffer_load_dwordx4 v[84:87], v6, s[28:31], s73 offen
    buffer_load_dwordx4 v[88:91], v6, s[28:31], s74 offen
    buffer_load_dwordx4 v[92:95], v6, s[28:31], s75 offen
L_no_p2:
    s_mov_b32 s8, s40
    s_and_b32 s9, s41, 0xffff
    s_mov_b32 s10, 0x200000
    s_mov_b32 s11, 0x20000
    buffer_load_dwordx4 v[132:135], v1, s[8:11], s80 offen offset:0
    buffer_load_dwordx4 v[140:143], v1, s[8:11], s80 offen offset:1024
    buffer_load_dwordx4 v[148:151], v1, s[8:11], s80 offen offset:2048
    buffer_load_dwordx4 v[156:159], v1, s[8:11], s80 offen offset:3072
    buffer_load_dwordx4 v[164:167], v1, s[8:11], s81 offen offset:0
    buffer_load_dwordx4 v[172:175], v1, s[8:11], s81 offen offset:1024
    buffer_load_dwordx4 v[180:183], v1, s[8:11], s81 offen offset:2048
    buffer_load_dwordx4 v[188:191], v1, s[8:11], s81 offen offset:3072
    buffer_load_dwordx4 v[196:199], v1, s[8:11], s82 offen offset:0
    buffer_load_dwordx4 v[204:207], v1, s[8:11], s82 offen offset:1024
    buffer_load_dwordx4 v[212:215], v1, s[8:11], s82 offen offset:2048
    buffer_load_dwordx4 v[220:223], v1, s[8:11], s82 offen offset:3072
    buffer_load_dwordx4 v[228:231], v1, s[8:11], s83 offen offset:0
    buffer_load_dwordx4 v[236:239], v1, s[8:11], s83 offen offset:1024
    buffer_load_dwordx4 v[244:247], v1, s[8:11], s83 offen offset:2048
    buffer_load_dwordx4 v[252:255], v1, s[8:11], s83 offen offset:3072
    v_and_b32 v2, 15, v0
    v_lshrrev_b32 v3, 4, v0
    s_mov_b32 s36, s46
    s_and_b32 s37, s47, 0xffff
    s_mov_b32 s38, 0x400000
    s_mov_b32 s39, 0x20000
    v_lshlrev_b32 v5, 13, v3
    v_lshl_add_u32 v5, v2, 6, v5
    s_sub_u32 s86, 31, s5
    s_lshl_b32 s86, s86, 17
    s_lshl_b32 s87, s3, 15
    s_add_u32 s86, s86, s87
    s_lshl_b32 s87, s4, 10
    s_add_u32 s86, s86, s87
    buffer_load_dword a16, v5, s[36:39], s86 offen
    s_lshl_b32 s91, s3, 12
    v_lshlrev_b32 v9, 1, v3
    v_xor_b32 v9, v9, v2
    v_lshlrev_b32 v9, 4, v9
    v_lshl_add_u32 v9, v3, 13, v9
    v_mov_b32 v56, v9
    v_xor_b32 v57, 128, v9
    v_add_u32 v57, 64512, v57
    v_mov_b32 v58, v9
    v_add_u32 v58, 129024, v58
    v_xor_b32 v59, 128, v9
    v_add_u32 v59, 193536, v59
    s_lshl_b32 s92, s4, 10
    s_lshl_b32 s86, s3, 8
    s_add_u32 s92, s92, s86
    s_mov_b32 s85, 0
    s_mov_b32 s96, 0x05040100
    s_mov_b32 s97, 0x07060302
    s_add_u32 s12, s66, 0x0
    s_addc_u32 s13, s67, 0
    s_and_b32 s13, s13, 0xffff
    s_mov_b32 s14, 0x7000
    s_mov_b32 s15, 0x20000
    s_mov_b32 s76, s64
    s_and_b32 s77, s65, 0xffff
    s_mov_b32 s78, 0x100
    s_mov_b32 s79, 0x20000
    s_add_u32 s32, s66, 0x10000
    s_addc_u32 s33, s67, 0
    s_and_b32 s33, s33, 0xffff
    s_mov_b32 s34, 0x60000
    s_mov_b32 s35, 0x20000
    s_mov_b64 s[94:95], s[62:63]
    s_mul_i32 s86, s4, 1212416
    s_add_u32 s86, s86, 0x3000000
    s_add_u32 s16, s66, s86
    s_addc_u32 s17, s67, 0
    s_and_b32 s17, s17, 0xffff
    s_mov_b32 s18, 0x128000
    s_mov_b32 s19, 0x20000
    s_lshl_b32 s86, s4, 19
    s_sub_u32 s42, s42, 2880
    s_subb_u32 s43, s43, 0
    s_sub_u32 s44, s44, 2880
    s_subb_u32 s45, s45, 0
    s_add_u32 s20, s42, s86
    s_addc_u32 s21, s43, 0
    s_and_b32 s21, s21, 0xffff
    s_mov_b32 s22, 0x80b40
    s_mov_b32 s23, 0x20000
    s_add_u32 s24, s44, s86
    s_addc_u32 s25, s45, 0
    s_and_b32 s25, s25, 0xffff
    s_mov_b32 s26, 0x80b40
    s_mov_b32 s27, 0x20000
    s_mov_b32 s88, 0x3f803f80
    s_lshr_b32 s86, s2, 6
    s_cmp_eq_u32 s86, 1
    s_cbranch_scc1 L_mod_rest
L_mod_end:
    v_bfe_u32 v5, v0, 2, 2
    v_and_b32 v6, 1, v3
    v_lshl_add_u32 v6, v6, 2, v5
    v_lshlrev_b32 v6, 5, v6
    v_lshl_add_u32 v6, v5, 8, v6
    v_lshl_add_u32 v6, v3, 10, v6
    v_and_b32 v5, 3, v0
    v_lshlrev_b32 v5, 4, v5
    v_xor_b32 v6, v6, v5
    v_add_u32 v6, s91, v6
    v_xor_b32 v64, 0, v6
    v_add_u32 v72, 0x20000, v64
    v_xor_b32 v65, 8, v6
    v_add_u32 v73, 0x20000, v65
    v_xor_b32 v66, 64, v6
    v_add_u32 v74, 0x20000, v66
    v_xor_b32 v67, 72, v6
    v_add_u32 v75, 0x20000, v67
    v_xor_b32 v68, 128, v6
    v_add_u32 v76, 0x20000, v68
    v_xor_b32 v69, 136, v6
    v_add_u32 v77, 0x20000, v69
    v_xor_b32 v70, 192, v6
    v_add_u32 v78, 0x20000, v70
    v_xor_b32 v71, 200, v6
    v_add_u32 v79, 0x20000, v71
    v_xor_b32 v5, v2, v3
    v_lshlrev_b32 v5, 4, v5
    v_lshl_add_u32 v20, v3, 8, v5
    v_add_u32 v20, 65536, v20
    v_xor_b32 v21, 64, v20
    v_add_u32 v21, 1024, v21
    v_and_b32 v2, 7, v0
    v_lshlrev_b32 v5, 4, v2
    v_lshl_add_u32 v22, v0, 8, v5
    s_lshl_b32 s86, s3, 14
    s_add_u32 s86, s86, 65536
    v_add_u32 v22, s86, v22
    s_lshl_b32 s86, s3, 14
    s_add_u32 s86, s86, 73728
    v_lshl_add_u32 v4, v0, 5, s86
    v_and_b32 v61, 3, v0
    v_mul_u32_u24 v61, 64, v61
    v_add_u32 v61, 4, v61
    s_lshl_b32 s86, s3, 10
    v_add_u32 v62, s86, v1
    v_add_u32 v63, 73728, v62
    s_mov_b32 s80, 12288
    s_mov_b32 s81, 16384
    s_mov_b32 s82, 20480
    s_mov_b32 s83, 24576
    s_cmp_ge_u32 s3, 2
    s_cselect_b32 s93, 1.0, 0
    s_lshl_b32 s89, s5, 12
L_pads_a:
    s_cmp_lg_u32 s3, 0
    s_cbranch_scc1 L_pc_1_0
    s_call_b64 s[86:87], L_pad1
    s_call_b64 s[86:87], L_pad5
    s_call_b64 s[86:87], L_pad9
    s_call_b64 s[86:87], L_pad13
L_pc_1_0:
    s_cmp_lg_u32 s3, 1
    s_cbranch_scc1 L_pc_1_1
    s_call_b64 s[86:87], L_pad2
    s_call_b64 s[86:87], L_pad6
    s_call_b64 s[86:87], L_pad10
L_pc_1_1:
    s_cmp_lg_u32 s3, 2
    s_cbranch_scc1 L_pc_1_2
    s_call_b64 s[86:87], L_pad3
    s_call_b64 s[86:87], L_pad7
    s_call_b64 s[86:87], L_pad11
L_pc_1_2:
    s_cmp_lg_u32 s3, 3
    s_cbranch_scc1 L_pc_1_3
    s_call_b64 s[86:87], L_pad4
    s_call_b64 s[86:87], L_pad8
    s_call_b64 s[86:87], L_pad12
L_pc_1_3:
    s_waitcnt vmcnt(16)
    v_dot2_f32_bf16 v40, v132, s88, 0
    v_dot2_f32_bf16 v48, v132, v132, 0
    v_dot2_f32_bf16 v40, v133, s88, v40
    v_dot2_f32_bf16 v48, v133, v133, v48
    v_dot2_f32_bf16 v40, v134, s88, v40
    v_dot2_f32_bf16 v48, v134, v134, v48
    v_dot2_f32_bf16 v40, v135, s88, v40
    v_dot2_f32_bf16 v48, v135, v135, v48
    s_waitcnt vmcnt(15)
    v_dot2_f32_bf16 v41, v140, s88, 0
    v_dot2_f32_bf16 v49, v140, v140, 0
    v_dot2_f32_bf16 v41, v141, s88, v41
    v_dot2_f32_bf16 v49, v141, v141, v49
    v_dot2_f32_bf16 v41, v142, s88, v41
    v_dot2_f32_bf16 v49, v142, v142, v49
    v_dot2_f32_bf16 v41, v143, s88, v41
    v_dot2_f32_bf16 v49, v143, v143, v49
    s_waitcnt vmcnt(14)
    v_dot2_f32_bf16 v42, v148, s88, 0
    v_dot2_f32_bf16 v50, v148, v148, 0
    v_dot2_f32_bf16 v42, v149, s88, v42
    v_dot2_f32_bf16 v50, v149, v149, v50
    v_dot2_f32_bf16 v42, v150, s88, v42
    v_dot2_f32_bf16 v50, v150, v150, v50
    v_dot2_f32_bf16 v42, v151, s88, v42
    v_dot2_f32_bf16 v50, v151, v151, v50
    s_waitcnt vmcnt(13)
    v_dot2_f32_bf16 v43, v156, s88, 0
    v_dot2_f32_bf16 v51, v156, v156, 0
    v_dot2_f32_bf16 v43, v157, s88, v43
    v_dot2_f32_bf16 v51, v157, v157, v51
    v_dot2_f32_bf16 v43, v158, s88, v43
    v_dot2_f32_bf16 v51, v158, v158, v51
    v_dot2_f32_bf16 v43, v159, s88, v43
    v_dot2_f32_bf16 v51, v159, v159, v51
    s_waitcnt vmcnt(12)
    v_dot2_f32_bf16 v44, v164, s88, 0
    v_dot2_f32_bf16 v52, v164, v164, 0
    v_dot2_f32_bf16 v44, v165, s88, v44
    v_dot2_f32_bf16 v52, v165, v165, v52
    v_dot2_f32_bf16 v44, v166, s88, v44
    v_dot2_f32_bf16 v52, v166, v166, v52
    v_dot2_f32_bf16 v44, v167, s88, v44
    v_dot2_f32_bf16 v52, v167, v167, v52
    s_waitcnt vmcnt(11)
    v_dot2_f32_bf16 v45, v172, s88, 0
    v_dot2_f32_bf16 v53, v172, v172, 0
    v_dot2_f32_bf16 v45, v173, s88, v45
    v_dot2_f32_bf16 v53, v173, v173, v53
    v_dot2_f32_bf16 v45, v174, s88, v45
    v_dot2_f32_bf16 v53, v174, v174, v53
    v_dot2_f32_bf16 v45, v175, s88, v45
    v_dot2_f32_bf16 v53, v175, v175, v53
    s_waitcnt vmcnt(10)
    v_dot2_f32_bf16 v46, v180, s88, 0
    v_dot2_f32_bf16 v54, v180, v180, 0
    v_dot2_f32_bf16 v46, v181, s88, v46
    v_dot2_f32_bf16 v54, v181, v181, v54
    v_dot2_f32_bf16 v46, v182, s88, v46
    v_dot2_f32_bf16 v54, v182, v182, v54
    v_dot2_f32_bf16 v46, v183, s88, v46
    v_dot2_f32_bf16 v54, v183, v183, v54
    s_waitcnt vmcnt(9)
    v_dot2_f32_bf16 v47, v188, s88, 0
    v_dot2_f32_bf16 v55, v188, v188, 0
    v_dot2_f32_bf16 v47, v189, s88, v47
    v_dot2_f32_bf16 v55, v189, v189, v55
    v_dot2_f32_bf16 v47, v190, s88, v47
    v_dot2_f32_bf16 v55, v190, v190, v55
    v_dot2_f32_bf16 v47, v191, s88, v47
    v_dot2_f32_bf16 v55, v191, v191, v55
    s_nop 2
    v_permlane32_swap_b32 v40, v44
    v_permlane32_swap_b32 v41, v45
    v_permlane32_swap_b32 v42, v46
    v_permlane32_swap_b32 v43, v47
    v_permlane32_swap_b32 v48, v52
    v_permlane32_swap_b32 v49, v53
    v_permlane32_swap_b32 v50, v54
    v_permlane32_swap_b32 v51, v55
    s_nop 0
    v_add_f32 v40, v40, v44
    v_add_f32 v41, v41, v45
    v_add_f32 v42, v42, v46
    v_add_f32 v43, v43, v47
    v_add_f32 v48, v48, v52
    v_add_f32 v49, v49, v53
    v_add_f32 v50, v50, v54
    v_add_f32 v51, v51, v55
    s_nop 0
    v_permlane16_swap_b32 v40, v42
    v_permlane16_swap_b32 v41, v43
    v_permlane16_swap_b32 v48, v50
    v_permlane16_swap_b32 v49, v51
    s_nop 0
    v_add_f32 v40, v40, v42
    v_add_f32 v41, v41, v43
    v_add_f32 v48, v48, v50
    v_add_f32 v49, v49, v51
    s_nop 0
    v_add_f32_dpp v40, v40, v40 row_ror:8 row_mask:0xf bank_mask:0xf
    v_add_f32_dpp v41, v41, v41 row_ror:8 row_mask:0xf bank_mask:0xf
    v_add_f32_dpp v48, v48, v48 row_ror:8 row_mask:0xf bank_mask:0xf
    v_add_f32_dpp v49, v49, v49 row_ror:8 row_mask:0xf bank_mask:0xf
    v_add_f32_dpp v40, v40, v40 row_ror:4 row_mask:0xf bank_mask:0xf
    v_add_f32_dpp v41, v41, v41 row_ror:4 row_mask:0xf bank_mask:0xf
    v_add_f32_dpp v48, v48, v48 row_ror:4 row_mask:0xf bank_mask:0xf
    v_add_f32_dpp v49, v49, v49 row_ror:4 row_mask:0xf bank_mask:0xf
    v_add_f32_dpp v40, v40, v40 row_ror:2 row_mask:0xf bank_mask:0xf
    v_add_f32_dpp v41, v41, v41 row_ror:2 row_mask:0xf bank_mask:0xf
    v_add_f32_dpp v48, v48, v48 row_ror:2 row_mask:0xf bank_mask:0xf
    v_add_f32_dpp v49, v49, v49 row_ror:2 row_mask:0xf bank_mask:0xf
    v_add_f32_dpp v40, v40, v40 row_ror:1 row_mask:0xf bank_mask:0xf
    v_add_f32_dpp v41, v41, v41 row_ror:1 row_mask:0xf bank_mask:0xf
    v_add_f32_dpp v48, v48, v48 row_ror:1 row_mask:0xf bank_mask:0xf
    v_add_f32_dpp v49, v49, v49 row_ror:1 row_mask:0xf bank_mask:0xf
    v_mul_f32 v40, 0x3b000000, v40
    v_mul_f32 v48, 0x3b000000, v48
    v_mul_f32 v41, 0x3b000000, v41
    v_mul_f32 v49, 0x3b000000, v49
    v_fma_f32 v48, -v40, v40, v48
    v_fma_f32 v49, -v41, v41, v49
    v_max_f32 v48, 0, v48
    v_max_f32 v49, 0, v49
    v_add_f32 v48, 0x3727c5ac, v48
    v_add_f32 v49, 0x3727c5ac, v49
    v_rsq_f32 v48, v48
    v_rsq_f32 v49, v49
    v_lshlrev_b32 v128, 16, v132
    v_mul_f32 v40, -v40, v48
    v_mul_f32 v41, -v41, v49
    v_and_b32 v129, 0xffff0000, v132
    v_readlane_b32 s40, v48, 0
    v_readlane_b32 s41, v40, 0
    v_readlane_b32 s42, v49, 0
    v_readlane_b32 s43, v41, 0
    v_readlane_b32 s44, v48, 16
    v_readlane_b32 s45, v40, 16
    v_readlane_b32 s46, v49, 16
    v_readlane_b32 s47, v41, 16
    v_readlane_b32 s68, v48, 32
    v_readlane_b32 s69, v40, 32
    v_readlane_b32 s70, v49, 32
    v_readlane_b32 s71, v41, 32
    v_readlane_b32 s72, v48, 48
    v_readlane_b32 s73, v40, 48
    v_readlane_b32 s74, v49, 48
    v_readlane_b32 s75, v41, 48
    v_lshlrev_b32 v130, 16, v133
    v_and_b32 v131, 0xffff0000, v133
    v_lshlrev_b32 v132, 16, v134
    v_and_b32 v133, 0xffff0000, v134
    v_lshlrev_b32 v134, 16, v135
    v_and_b32 v135, 0xffff0000, v135
    v_lshlrev_b32 v136, 16, v140
    v_and_b32 v137, 0xffff0000, v140
    v_lshlrev_b32 v138, 16, v141
    v_and_b32 v139, 0xffff0000, v141
    v_lshlrev_b32 v140, 16, v142
    v_and_b32 v141, 0xffff0000, v142
    v_lshlrev_b32 v142, 16, v143
    v_and_b32 v143, 0xffff0000, v143
    v_lshlrev_b32 v144, 16, v148
    v_and_b32 v145, 0xffff0000, v148
    v_lshlrev_b32 v146, 16, v149
    v_and_b32 v147, 0xffff0000, v149
    v_lshlrev_b32 v148, 16, v150
    v_and_b32 v149, 0xffff0000, v150
    v_lshlrev_b32 v150, 16, v151
    v_and_b32 v151, 0xffff0000, v151
    v_lshlrev_b32 v152, 16, v156
    v_and_b32 v153, 0xffff0000, v156
    v_lshlrev_b32 v154, 16, v157
    v_and_b32 v155, 0xffff0000, v157
    v_lshlrev_b32 v156, 16, v158
    v_and_b32 v157, 0xffff0000, v158
    v_lshlrev_b32 v158, 16, v159
    v_and_b32 v159, 0xffff0000, v159
    v_lshlrev_b32 v160, 16, v164
    v_and_b32 v161, 0xffff0000, v164
    v_lshlrev_b32 v162, 16, v165
    v_and_b32 v163, 0xffff0000, v165
    v_lshlrev_b32 v164, 16, v166
    v_and_b32 v165, 0xffff0000, v166
    v_lshlrev_b32 v166, 16, v167
    v_and_b32 v167, 0xffff0000, v167
    v_lshlrev_b32 v168, 16, v172
    v_and_b32 v169, 0xffff0000, v172
    v_lshlrev_b32 v170, 16, v173
    v_and_b32 v171, 0xffff0000, v173
    v_lshlrev_b32 v172, 16, v174
    v_and_b32 v173, 0xffff0000, v174
    v_lshlrev_b32 v174, 16, v175
    v_and_b32 v175, 0xffff0000, v175
    v_lshlrev_b32 v176, 16, v180
    v_and_b32 v177, 0xffff0000, v180
    v_lshlrev_b32 v178, 16, v181
    v_and_b32 v179, 0xffff0000, v181
    v_lshlrev_b32 v180, 16, v182
    v_and_b32 v181, 0xffff0000, v182
    v_lshlrev_b32 v182, 16, v183
    v_and_b32 v183, 0xffff0000, v183
    v_lshlrev_b32 v184, 16, v188
    v_and_b32 v185, 0xffff0000, v188
    v_lshlrev_b32 v186, 16, v189
    v_and_b32 v187, 0xffff0000, v189
    v_lshlrev_b32 v188, 16, v190
    v_and_b32 v189, 0xffff0000, v190
    v_lshlrev_b32 v190, 16, v191
    v_and_b32 v191, 0xffff0000, v191
    v_pk_fma_f32 v[128:129], v[128:129], s[40:41], s[40:41] op_sel:[0,0,1] op_sel_hi:[1,0,1]
    v_pk_fma_f32 v[130:131], v[130:131], s[40:41], s[40:41] op_sel:[0,0,1] op_sel_hi:[1,0,1]
    v_pk_fma_f32 v[132:133], v[132:133], s[40:41], s[40:41] op_sel:[0,0,1] op_sel_hi:[1,0,1]
    v_pk_fma_f32 v[134:135], v[134:135], s[40:41], s[40:41] op_sel:[0,0,1] op_sel_hi:[1,0,1]
    v_pk_fma_f32 v[136:137], v[136:137], s[42:43], s[42:43] op_sel:[0,0,1] op_sel_hi:[1,0,1]
    v_pk_fma_f32 v[138:139], v[138:139], s[42:43], s[42:43] op_sel:[0,0,1] op_sel_hi:[1,0,1]
    v_pk_fma_f32 v[140:141], v[140:141], s[42:43], s[42:43] op_sel:[0,0,1] op_sel_hi:[1,0,1]
    v_pk_fma_f32 v[142:143], v[142:143], s[42:43], s[42:43] op_sel:[0,0,1] op_sel_hi:[1,0,1]
    v_pk_fma_f32 v[144:145], v[144:145], s[44:45], s[44:45] op_sel:[0,0,1] op_sel_hi:[1,0,1]
    v_pk_fma_f32 v[146:147], v[146:147], s[44:45], s[44:45] op_sel:[0,0,1] op_sel_hi:[1,0,1]
    v_pk_fma_f32 v[148:149], v[148:149], s[44:45], s[44:45] op_sel:[0,0,1] op_sel_hi:[1,0,1]
    v_pk_fma_f32 v[150:151], v[150:151], s[44:45], s[44:45] op_sel:[0,0,1] op_sel_hi:[1,0,1]
    v_pk_fma_f32 v[152:153], v[152:153], s[46:47], s[46:47] op_sel:[0,0,1] op_sel_hi:[1,0,1]
    v_pk_fma_f32 v[154:155], v[154:155], s[46:47], s[46:47] op_sel:[0,0,1] op_sel_hi:[1,0,1]
    v_pk_fma_f32 v[156:157], v[156:157], s[46:47], s[46:47] op_sel:[0,0,1] op_sel_hi:[1,0,1]
    v_pk_fma_f32 v[158:159], v[158:159], s[46:47], s[46:47] op_sel:[0,0,1] op_sel_hi:[1,0,1]
    v_pk_fma_f32 v[160:161], v[160:161], s[68:69], s[68:69] op_sel:[0,0,1] op_sel_hi:[1,0,1]
    v_pk_fma_f32 v[162:163], v[162:163], s[68:69], s[68:69] op_sel:[0,0,1] op_sel_hi:[1,0,1]
    v_pk_fma_f32 v[164:165], v[164:165], s[68:69], s[68:69] op_sel:[0,0,1] op_sel_hi:[1,0,1]
    v_pk_fma_f32 v[166:167], v[166:167], s[68:69], s[68:69] op_sel:[0,0,1] op_sel_hi:[1,0,1]
    v_pk_fma_f32 v[168:169], v[168:169], s[70:71], s[70:71] op_sel:[0,0,1] op_sel_hi:[1,0,1]
    v_pk_fma_f32 v[170:171], v[170:171], s[70:71], s[70:71] op_sel:[0,0,1] op_sel_hi:[1,0,1]
    v_pk_fma_f32 v[172:173], v[172:173], s[70:71], s[70:71] op_sel:[0,0,1] op_sel_hi:[1,0,1]
    v_pk_fma_f32 v[174:175], v[174:175], s[70:71], s[70:71] op_sel:[0,0,1] op_sel_hi:[1,0,1]
    v_pk_fma_f32 v[176:177], v[176:177], s[72:73], s[72:73] op_sel:[0,0,1] op_sel_hi:[1,0,1]
    v_pk_fma_f32 v[178:179], v[178:179], s[72:73], s[72:73] op_sel:[0,0,1] op_sel_hi:[1,0,1]
    v_pk_fma_f32 v[180:181], v[180:181], s[72:73], s[72:73] op_sel:[0,0,1] op_sel_hi:[1,0,1]
    v_pk_fma_f32 v[182:183], v[182:183], s[72:73], s[72:73] op_sel:[0,0,1] op_sel_hi:[1,0,1]
    v_pk_fma_f32 v[184:185], v[184:185], s[74:75], s[74:75] op_sel:[0,0,1] op_sel_hi:[1,0,1]
    v_pk_fma_f32 v[186:187], v[186:187], s[74:75], s[74:75] op_sel:[0,0,1] op_sel_hi:[1,0,1]
    v_pk_fma_f32 v[188:189], v[188:189], s[74:75], s[74:75] op_sel:[0,0,1] op_sel_hi:[1,0,1]
    v_pk_fma_f32 v[190:191], v[190:191], s[74:75], s[74:75] op_sel:[0,0,1] op_sel_hi:[1,0,1]
    s_waitcnt vmcnt(8)
    s_add_u32 m0, s91, 131072
    s_nop 0
    buffer_load_dwordx4 v56, s[36:39], s92 offen offset:0 lds
    buffer_load_dwordx4 v57, s[36:39], s92 offen offset:1024 lds
    v_dot2_f32_bf16 v40, v196, s88, 0
    v_dot2_f32_bf16 v48, v196, v196, 0
    v_dot2_f32_bf16 v40, v197, s88, v40
    v_dot2_f32_bf16 v48, v197, v197, v48
    v_dot2_f32_bf16 v40, v198, s88, v40
    v_dot2_f32_bf16 v48, v198, v198, v48
    v_dot2_f32_bf16 v40, v199, s88, v40
    v_dot2_f32_bf16 v48, v199, v199, v48
    s_waitcnt vmcnt(9)
    buffer_load_dwordx4 v58, s[36:39], s92 offen offset:2048 lds
    buffer_load_dwordx4 v59, s[36:39], s92 offen offset:3072 lds
    s_add_u32 s92, s92, 32768
    v_dot2_f32_bf16 v41, v204, s88, 0
    v_dot2_f32_bf16 v49, v204, v204, 0
    v_dot2_f32_bf16 v41, v205, s88, v41
    v_dot2_f32_bf16 v49, v205, v205, v49
    v_dot2_f32_bf16 v41, v206, s88, v41
    v_dot2_f32_bf16 v49, v206, v206, v49
    v_dot2_f32_bf16 v41, v207, s88, v41
    v_dot2_f32_bf16 v49, v207, v207, v49
    s_waitcnt vmcnt(10)
    s_add_u32 m0, s91, 147456
    s_nop 0
    buffer_load_dwordx4 v56, s[36:39], s92 offen offset:0 lds
    buffer_load_dwordx4 v57, s[36:39], s92 offen offset:1024 lds
    s_branch L_ov1
L_pad1:
    s_setpc_b64 s[86:87]
L_ov1:
    v_dot2_f32_bf16 v42, v212, s88, 0
    v_dot2_f32_bf16 v50, v212, v212, 0
    v_dot2_f32_bf16 v42, v213, s88, v42
    v_dot2_f32_bf16 v50, v213, v213, v50
    v_dot2_f32_bf16 v42, v214, s88, v42
    v_dot2_f32_bf16 v50, v214, v214, v50
    v_dot2_f32_bf16 v42, v215, s88, v42
    v_dot2_f32_bf16 v50, v215, v215, v50
    s_waitcnt vmcnt(11)
    buffer_load_dwordx4 v58, s[36:39], s92 offen offset:2048 lds
    buffer_load_dwordx4 v59, s[36:39], s92 offen offset:3072 lds
    s_add_u32 s92, s92, 229376
    v_dot2_f32_bf16 v43, v220, s88, 0
    v_dot2_f32_bf16 v51, v220, v220, 0
    v_dot2_f32_bf16 v43, v221, s88, v43
    v_dot2_f32_bf16 v51, v221, v221, v51
    v_dot2_f32_bf16 v43, v222, s88, v43
    v_dot2_f32_bf16 v51, v222, v222, v51
    v_dot2_f32_bf16 v43, v223, s88, v43
    v_dot2_f32_bf16 v51, v223, v223, v51
    s_waitcnt vmcnt(12)
    s_add_u32 m0, s91, 0
    s_nop 0
    buffer_load_dwordx4 v56, s[36:39], s92 offen offset:0 lds
    buffer_load_dwordx4 v57, s[36:39], s92 offen offset:1024 lds
    v_dot2_f32_bf16 v44, v228, s88, 0
    v_dot2_f32_bf16 v52, v228, v228, 0
    v_dot2_f32_bf16 v44, v229, s88, v44
    v_dot2_f32_bf16 v52, v229, v229, v52
    v_dot2_f32_bf16 v44, v230, s88, v44
    v_dot2_f32_bf16 v52, v230, v230, v52
    v_dot2_f32_bf16 v44, v231, s88, v44
    v_dot2_f32_bf16 v52, v231, v231, v52
    s_waitcnt vmcnt(13)
    buffer_load_dwordx4 v58, s[36:39], s92 offen offset:2048 lds
    buffer_load_dwordx4 v59, s[36:39], s92 offen offset:3072 lds
    s_add_u32 s92, s92, 32768
    v_dot2_f32_bf16 v45, v236, s88, 0
    v_dot2_f32_bf16 v53, v236, v236, 0
    v_dot2_f32_bf16 v45, v237, s88, v45
    v_dot2_f32_bf16 v53, v237, v237, v53
    v_dot2_f32_bf16 v45, v238, s88, v45
    v_dot2_f32_bf16 v53, v238, v238, v53
    v_dot2_f32_bf16 v45, v239, s88, v45
    v_dot2_f32_bf16 v53, v239, v239, v53
    s_waitcnt vmcnt(14)
    s_add_u32 m0, s91, 16384
    s_nop 0
    buffer_load_dwordx4 v56, s[36:39], s92 offen offset:0 lds
    buffer_load_dwordx4 v57, s[36:39], s92 offen offset:1024 lds
    v_dot2_f32_bf16 v46, v244, s88, 0
    v_dot2_f32_bf16 v54, v244, v244, 0
    v_dot2_f32_bf16 v46, v245, s88, v46
    v_dot2_f32_bf16 v54, v245, v245, v54
    v_dot2_f32_bf16 v46, v246, s88, v46
    v_dot2_f32_bf16 v54, v246, v246, v54
    v_dot2_f32_bf16 v46, v247, s88, v46
    v_dot2_f32_bf16 v54, v247, v247, v54
    s_waitcnt vmcnt(15)
    buffer_load_dwordx4 v58, s[36:39], s92 offen offset:2048 lds
    buffer_load_dwordx4 v59, s[36:39], s92 offen offset:3072 lds
    s_add_u32 s92, s92, 229376
    v_dot2_f32_bf16 v47, v252, s88, 0
    v_dot2_f32_bf16 v55, v252, v252, 0
    v_dot2_f32_bf16 v47, v253, s88, v47
    v_dot2_f32_bf16 v55, v253, v253, v55
    v_dot2_f32_bf16 v47, v254, s88, v47
    v_dot2_f32_bf16 v55, v254, v254, v55
    v_dot2_f32_bf16 v47, v255, s88, v47
    v_dot2_f32_bf16 v55, v255, v255, v55
    s_nop 2
    v_permlane32_swap_b32 v40, v44
    v_permlane32_swap_b32 v41, v45
    v_permlane32_swap_b32 v42, v46
    v_permlane32_swap_b32 v43, v47
    v_permlane32_swap_b32 v48, v52
    v_permlane32_swap_b32 v49, v53
    v_permlane32_swap_b32 v50, v54
    s_add_u32 m0, s91, 32768
    s_nop 0
    buffer_load_dwordx4 v56, s[36:39], s92 offen offset:0 lds
    v_permlane32_swap_b32 v51, v55
    s_nop 0
    v_add_f32 v40, v40, v44
    v_add_f32 v41, v41, v45
    v_add_f32 v42, v42, v46
    v_add_f32 v43, v43, v47
    v_add_f32 v48, v48, v52
    v_add_f32 v49, v49, v53
    buffer_load_dwordx4 v57, s[36:39], s92 offen offset:1024 lds
    v_add_f32 v50, v50, v54
    v_add_f32 v51, v51, v55
    s_nop 0
    v_permlane16_swap_b32 v40, v42
    v_permlane16_swap_b32 v41, v43
    v_permlane16_swap_b32 v48, v50
    v_permlane16_swap_b32 v49, v51
    s_nop 0
    buffer_load_dwordx4 v58, s[36:39], s92 offen offset:2048 lds
    v_add_f32 v40, v40, v42
    v_add_f32 v41, v41, v43
    v_add_f32 v48, v48, v50
    v_add_f32 v49, v49, v51
    s_nop 0
    v_add_f32_dpp v40, v40, v40 row_ror:8 row_mask:0xf bank_mask:0xf
    v_add_f32_dpp v41, v41, v41 row_ror:8 row_mask:0xf bank_mask:0xf
    v_add_f32_dpp v48, v48, v48 row_ror:8 row_mask:0xf bank_mask:0xf
    buffer_load_dwordx4 v59, s[36:39], s92 offen offset:3072 lds
    s_add_u32 s92, s92, 32768
    v_add_f32_dpp v49, v49, v49 row_ror:8 row_mask:0xf bank_mask:0xf
    v_add_f32_dpp v40, v40, v40 row_ror:4 row_mask:0xf bank_mask:0xf
    v_add_f32_dpp v41, v41, v41 row_ror:4 row_mask:0xf bank_mask:0xf
    v_add_f32_dpp v48, v48, v48 row_ror:4 row_mask:0xf bank_mask:0xf
    v_add_f32_dpp v49, v49, v49 row_ror:4 row_mask:0xf bank_mask:0xf
    v_add_f32_dpp v40, v40, v40 row_ror:2 row_mask:0xf bank_mask:0xf
    v_add_f32_dpp v41, v41, v41 row_ror:2 row_mask:0xf bank_mask:0xf
    v_add_f32_dpp v48, v48, v48 row_ror:2 row_mask:0xf bank_mask:0xf
    s_add_u32 m0, s91, 49152
    s_nop 0
    buffer_load_dwordx4 v56, s[36:39], s92 offen offset:0 lds
    v_add_f32_dpp v49, v49, v49 row_ror:2 row_mask:0xf bank_mask:0xf
    v_add_f32_dpp v40, v40, v40 row_ror:1 row_mask:0xf bank_mask:0xf
    v_add_f32_dpp v41, v41, v41 row_ror:1 row_mask:0xf bank_mask:0xf
    v_add_f32_dpp v48, v48, v48 row_ror:1 row_mask:0xf bank_mask:0xf
    v_add_f32_dpp v49, v49, v49 row_ror:1 row_mask:0xf bank_mask:0xf
    v_mul_f32 v40, 0x3b000000, v40
    v_mul_f32 v48, 0x3b000000, v48
    v_mul_f32 v41, 0x3b000000, v41
    buffer_load_dwordx4 v57, s[36:39], s92 offen offset:1024 lds
    v_mul_f32 v49, 0x3b000000, v49
    v_fma_f32 v48, -v40, v40, v48
    v_fma_f32 v49, -v41, v41, v49
    v_max_f32 v48, 0, v48
    v_max_f32 v49, 0, v49
    v_add_f32 v48, 0x3727c5ac, v48
    v_add_f32 v49, 0x3727c5ac, v49
    v_rsq_f32 v48, v48
    buffer_load_dwordx4 v58, s[36:39], s92 offen offset:2048 lds
    v_rsq_f32 v49, v49
    v_lshlrev_b32 v192, 16, v196
    v_mul_f32 v40, -v40, v48
    v_mul_f32 v41, -v41, v49
    v_and_b32 v193, 0xffff0000, v196
    v_readlane_b32 s40, v48, 0
    v_readlane_b32 s41, v40, 0
    v_readlane_b32 s42, v49, 0
    buffer_load_dwordx4 v59, s[36:39], s92 offen offset:3072 lds
    s_add_u32 s92, s92, 229376
    v_readlane_b32 s43, v41, 0
    v_readlane_b32 s44, v48, 16
    v_readlane_b32 s45, v40, 16
    v_readlane_b32 s46, v49, 16
    v_readlane_b32 s47, v41, 16
    v_readlane_b32 s68, v48, 32
    v_readlane_b32 s69, v40, 32
    v_readlane_b32 s70, v49, 32
    v_readlane_b32 s71, v41, 32
    v_readlane_b32 s72, v48, 48
    v_readlane_b32 s73, v40, 48
    v_readlane_b32 s74, v49, 48
    v_readlane_b32 s75, v41, 48
    v_lshlrev_b32 v194, 16, v197
    v_and_b32 v195, 0xffff0000, v197
    v_lshlrev_b32 v196, 16, v198
    v_and_b32 v197, 0xffff0000, v198
    v_lshlrev_b32 v198, 16, v199
    v_and_b32 v199, 0xffff0000, v199
    v_lshlrev_b32 v200, 16, v204
    v_and_b32 v201, 0xffff0000, v204
    v_lshlrev_b32 v202, 16, v205
    v_and_b32 v203, 0xffff0000, v205
    v_lshlrev_b32 v204, 16, v206
    v_and_b32 v205, 0xffff0000, v206
    v_lshlrev_b32 v206, 16, v207
    v_and_b32 v207, 0xffff0000, v207
    v_lshlrev_b32 v208, 16, v212
    v_and_b32 v209, 0xffff0000, v212
    v_lshlrev_b32 v210, 16, v213
    v_and_b32 v211, 0xffff0000, v213
    v_lshlrev_b32 v212, 16, v214
    v_and_b32 v213, 0xffff0000, v214
    v_lshlrev_b32 v214, 16, v215
    v_and_b32 v215, 0xffff0000, v215
    v_lshlrev_b32 v216, 16, v220
    v_and_b32 v217, 0xffff0000, v220
    v_lshlrev_b32 v218, 16, v221
    v_and_b32 v219, 0xffff0000, v221
    v_lshlrev_b32 v220, 16, v222
    v_and_b32 v221, 0xffff0000, v222
    v_lshlrev_b32 v222, 16, v223
    v_and_b32 v223, 0xffff0000, v223
    v_lshlrev_b32 v224, 16, v228
    v_and_b32 v225, 0xffff0000, v228
    v_lshlrev_b32 v226, 16, v229
    v_and_b32 v227, 0xffff0000, v229
    buffer_load_dword v2, v61, s[76:79], 0 offen sc1
    v_lshlrev_b32 v228, 16, v230
    v_and_b32 v229, 0xffff0000, v230
    v_lshlrev_b32 v230, 16, v231
    v_and_b32 v231, 0xffff0000, v231
    v_lshlrev_b32 v232, 16, v236
    v_and_b32 v233, 0xffff0000, v236
    v_lshlrev_b32 v234, 16, v237
    v_and_b32 v235, 0xffff0000, v237
    v_lshlrev_b32 v236, 16, v238
    v_and_b32 v237, 0xffff0000, v238
    v_lshlrev_b32 v238, 16, v239
    v_and_b32 v239, 0xffff0000, v239
    v_lshlrev_b32 v240, 16, v244
    v_and_b32 v241, 0xffff0000, v244
    v_lshlrev_b32 v242, 16, v245
    v_and_b32 v243, 0xffff0000, v245
    v_lshlrev_b32 v244, 16, v246
    v_and_b32 v245, 0xffff0000, v246
    v_lshlrev_b32 v246, 16, v247
    v_and_b32 v247, 0xffff0000, v247
    v_lshlrev_b32 v248, 16, v252
    v_and_b32 v249, 0xffff0000, v252
    v_lshlrev_b32 v250, 16, v253
    v_and_b32 v251, 0xffff0000, v253
    v_lshlrev_b32 v252, 16, v254
    v_and_b32 v253, 0xffff0000, v254
    v_lshlrev_b32 v254, 16, v255
    v_and_b32 v255, 0xffff0000, v255
    v_pk_fma_f32 v[192:193], v[192:193], s[40:41], s[40:41] op_sel:[0,0,1] op_sel_hi:[1,0,1]
    v_pk_fma_f32 v[194:195], v[194:195], s[40:41], s[40:41] op_sel:[0,0,1] op_sel_hi:[1,0,1]
    v_pk_fma_f32 v[196:197], v[196:197], s[40:41], s[40:41] op_sel:[0,0,1] op_sel_hi:[1,0,1]
    v_pk_fma_f32 v[198:199], v[198:199], s[40:41], s[40:41] op_sel:[0,0,1] op_sel_hi:[1,0,1]
    v_pk_fma_f32 v[200:201], v[200:201], s[42:43], s[42:43] op_sel:[0,0,1] op_sel_hi:[1,0,1]
    v_pk_fma_f32 v[202:203], v[202:203], s[42:43], s[42:43] op_sel:[0,0,1] op_sel_hi:[1,0,1]
    v_pk_fma_f32 v[204:205], v[204:205], s[42:43], s[42:43] op_sel:[0,0,1] op_sel_hi:[1,0,1]
    v_pk_fma_f32 v[206:207], v[206:207], s[42:43], s[42:43] op_sel:[0,0,1] op_sel_hi:[1,0,1]
    v_pk_fma_f32 v[208:209], v[208:209], s[44:45], s[44:45] op_sel:[0,0,1] op_sel_hi:[1,0,1]
    v_pk_fma_f32 v[210:211], v[210:211], s[44:45], s[44:45] op_sel:[0,0,1] op_sel_hi:[1,0,1]
    v_pk_fma_f32 v[212:213], v[212:213], s[44:45], s[44:45] op_sel:[0,0,1] op_sel_hi:[1,0,1]
    v_pk_fma_f32 v[214:215], v[214:215], s[44:45], s[44:45] op_sel:[0,0,1] op_sel_hi:[1,0,1]
    v_pk_fma_f32 v[216:217], v[216:217], s[46:47], s[46:47] op_sel:[0,0,1] op_sel_hi:[1,0,1]
    v_pk_fma_f32 v[218:219], v[218:219], s[46:47], s[46:47] op_sel:[0,0,1] op_sel_hi:[1,0,1]
    v_pk_fma_f32 v[220:221], v[220:221], s[46:47], s[46:47] op_sel:[0,0,1] op_sel_hi:[1,0,1]
    v_pk_fma_f32 v[222:223], v[222:223], s[46:47], s[46:47] op_sel:[0,0,1] op_sel_hi:[1,0,1]
    v_pk_fma_f32 v[224:225], v[224:225], s[68:69], s[68:69] op_sel:[0,0,1] op_sel_hi:[1,0,1]
    v_pk_fma_f32 v[226:227], v[226:227], s[68:69], s[68:69] op_sel:[0,0,1] op_sel_hi:[1,0,1]
    v_pk_fma_f32 v[228:229], v[228:229], s[68:69], s[68:69] op_sel:[0,0,1] op_sel_hi:[1,0,1]
    v_pk_fma_f32 v[230:231], v[230:231], s[68:69], s[68:69] op_sel:[0,0,1] op_sel_hi:[1,0,1]
    v_pk_fma_f32 v[232:233], v[232:233], s[70:71], s[70:71] op_sel:[0,0,1] op_sel_hi:[1,0,1]
    v_pk_fma_f32 v[234:235], v[234:235], s[70:71], s[70:71] op_sel:[0,0,1] op_sel_hi:[1,0,1]
    v_pk_fma_f32 v[236:237], v[236:237], s[70:71], s[70:71] op_sel:[0,0,1] op_sel_hi:[1,0,1]
    v_pk_fma_f32 v[238:239], v[238:239], s[70:71], s[70:71] op_sel:[0,0,1] op_sel_hi:[1,0,1]
    v_pk_fma_f32 v[240:241], v[240:241], s[72:73], s[72:73] op_sel:[0,0,1] op_sel_hi:[1,0,1]
    v_pk_fma_f32 v[242:243], v[242:243], s[72:73], s[72:73] op_sel:[0,0,1] op_sel_hi:[1,0,1]
    v_pk_fma_f32 v[244:245], v[244:245], s[72:73], s[72:73] op_sel:[0,0,1] op_sel_hi:[1,0,1]
    v_pk_fma_f32 v[246:247], v[246:247], s[72:73], s[72:73] op_sel:[0,0,1] op_sel_hi:[1,0,1]
    v_pk_fma_f32 v[248:249], v[248:249], s[74:75], s[74:75] op_sel:[0,0,1] op_sel_hi:[1,0,1]
    v_pk_fma_f32 v[250:251], v[250:251], s[74:75], s[74:75] op_sel:[0,0,1] op_sel_hi:[1,0,1]
    v_pk_fma_f32 v[252:253], v[252:253], s[74:75], s[74:75] op_sel:[0,0,1] op_sel_hi:[1,0,1]
    v_pk_fma_f32 v[254:255], v[254:255], s[74:75], s[74:75] op_sel:[0,0,1] op_sel_hi:[1,0,1]
    s_waitcnt vmcnt(0)
    v_cmp_gt_u32 vcc, 16, v2
    s_nop 1
    s_cbranch_vccz L_urgx
    s_mov_b32 s90, 0x40000
L_urg:
    s_sleep 24
    buffer_load_dword v2, v61, s[76:79], 0 offen sc1
    s_sub_u32 s90, s90, 1
    s_cbranch_scc1 L_urgx
    s_waitcnt vmcnt(0)
    v_cmp_gt_u32 vcc, 0x10, v2
    s_nop 1
    s_cbranch_vccnz L_urg
L_urgx:
    buffer_load_dwordx4 v[40:43], v62, s[12:15], s80 offen sc1
    buffer_load_dwordx4 v[44:47], v62, s[12:15], s81 offen sc1
    buffer_load_dwordx4 v[48:51], v62, s[12:15], s82 offen sc1
    buffer_load_dwordx4 v[52:55], v62, s[12:15], s83 offen sc1
    ds_read_b64_tr_b16 a[128:129], v72 offset:0
    ds_read_b64_tr_b16 a[132:133], v73 offset:0
    ds_read_b64_tr_b16 a[136:137], v74 offset:0
    ds_read_b64_tr_b16 a[140:141], v75 offset:0
    ds_read_b64_tr_b16 a[144:145], v76 offset:0
    ds_read_b64_tr_b16 a[148:149], v77 offset:0
    ds_read_b64_tr_b16 a[152:153], v78 offset:0
    ds_read_b64_tr_b16 a[156:157], v79 offset:0
    ds_read_b64_tr_b16 a[130:131], v72 offset:16384
    ds_read_b64_tr_b16 a[134:135], v73 offset:16384
    ds_read_b64_tr_b16 a[138:139], v74 offset:16384
    ds_read_b64_tr_b16 a[142:143], v75 offset:16384
    ds_read_b64_tr_b16 a[146:147], v76 offset:16384
    ds_read_b64_tr_b16 a[150:151], v77 offset:16384
    ds_read_b64_tr_b16 a[154:155], v78 offset:16384
    ds_read_b64_tr_b16 a[158:159], v79 offset:16384
    ds_read_b64_tr_b16 a[192:193], v64 offset:0
    ds_read_b64_tr_b16 a[196:197], v65 offset:0
    ds_read_b64_tr_b16 a[200:201], v66 offset:0
    ds_read_b64_tr_b16 a[204:205], v67 offset:0
    ds_read_b64_tr_b16 a[208:209], v68 offset:0
    ds_read_b64_tr_b16 a[212:213], v69 offset:0
    ds_read_b64_tr_b16 a[216:217], v70 offset:0
    ds_read_b64_tr_b16 a[220:221], v71 offset:0
    ds_read_b64_tr_b16 a[194:195], v64 offset:16384
    ds_read_b64_tr_b16 a[198:199], v65 offset:16384
    ds_read_b64_tr_b16 a[202:203], v66 offset:16384
    ds_read_b64_tr_b16 a[206:207], v67 offset:16384
    ds_read_b64_tr_b16 a[210:211], v68 offset:16384
    ds_read_b64_tr_b16 a[214:215], v69 offset:16384
    ds_read_b64_tr_b16 a[218:219], v70 offset:16384
    ds_read_b64_tr_b16 a[222:223], v71 offset:16384
    s_waitcnt lgkmcnt(15)
    s_add_u32 m0, s91, 131072
    s_nop 0
    buffer_load_dwordx4 v56, s[36:39], s92 offen offset:0 lds
    buffer_load_dwordx4 v57, s[36:39], s92 offen offset:1024 lds
    buffer_load_dwordx4 v58, s[36:39], s92 offen offset:2048 lds
    buffer_load_dwordx4 v59, s[36:39], s92 offen offset:3072 lds
    s_add_u32 s92, s92, 32768
    ds_read_b64_tr_b16 a[160:161], v64 offset:32768
    ds_read_b64_tr_b16 a[164:165], v65 offset:32768
    ds_read_b64_tr_b16 a[168:169], v66 offset:32768
    ds_read_b64_tr_b16 a[172:173], v67 offset:32768
    ds_read_b64_tr_b16 a[176:177], v68 offset:32768
    ds_read_b64_tr_b16 a[180:181], v69 offset:32768
    ds_read_b64_tr_b16 a[184:185], v70 offset:32768
    ds_read_b64_tr_b16 a[188:189], v71 offset:32768
    ds_read_b64_tr_b16 a[162:163], v64 offset:49152
    ds_read_b64_tr_b16 a[166:167], v65 offset:49152
    ds_read_b64_tr_b16 a[170:171], v66 offset:49152
    ds_read_b64_tr_b16 a[174:175], v67 offset:49152
    ds_read_b64_tr_b16 a[178:179], v68 offset:49152
    ds_read_b64_tr_b16 a[182:183], v69 offset:49152
    ds_read_b64_tr_b16 a[186:187], v70 offset:49152
    ds_read_b64_tr_b16 a[190:191], v71 offset:49152
    s_waitcnt vmcnt(4)
    v_pk_add_f32 v[40:41], v[40:41], v[44:45]
    v_pk_add_f32 v[42:43], v[42:43], v[46:47]
    v_pk_add_f32 v[48:49], v[48:49], v[52:53]
    v_pk_add_f32 v[50:51], v[50:51], v[54:55]
    v_pk_add_f32 v[40:41], v[40:41], v[48:49]
    v_pk_add_f32 v[42:43], v[42:43], v[50:51]
    v_cvt_pk_bf16_f32 v44, v40, v41
    v_cvt_pk_bf16_f32 v45, v42, v43
    v_lshlrev_b32 v40, 16, v44
    v_and_b32 v41, 0xffff0000, v44
    v_lshlrev_b32 v42, 16, v45
    v_and_b32 v43, 0xffff0000, v45
    v_add_f32 v40, s93, v40
    v_add_f32 v41, s93, v41
    v_add_f32 v42, s93, v42
    v_add_f32 v43, s93, v43
    v_cvt_pk_bf16_f32 v44, v40, v41
    v_cvt_pk_bf16_f32 v45, v42, v43
    v_lshlrev_b32 v40, 16, v44
    v_and_b32 v41, 0xffff0000, v44
    v_lshlrev_b32 v42, 16, v45
    v_and_b32 v43, 0xffff0000, v45
    v_mul_f32 v40, 0x3e0293ee, v40
    v_mul_f32 v41, 0x3e0293ee, v41
    v_mul_f32 v42, 0x3e0293ee, v42
    v_mul_f32 v43, 0x3e0293ee, v43
    ds_write_b128 v63, v[40:43] offset:0
    ds_write_b128 v63, v[40:43] offset:16384
    ds_write_b128 v63, v[40:43] offset:32768
    ds_write_b128 v63, v[40:43] offset:49152
    s_waitcnt lgkmcnt(0)
    s_add_u32 m0, s91, 147456
    s_nop 0
    buffer_load_dwordx4 v56, s[36:39], s92 offen offset:0 lds
    buffer_load_dwordx4 v57, s[36:39], s92 offen offset:1024 lds
    buffer_load_dwordx4 v58, s[36:39], s92 offen offset:2048 lds
    buffer_load_dwordx4 v59, s[36:39], s92 offen offset:3072 lds
    s_add_u32 s92, s92, 229376
    s_barrier
    ds_read_b128 v[32:35], v4 offset:0
    ds_read_b128 v[24:27], v4 offset:2048
    ds_read_b128 v[36:39], v4 offset:16
    ds_read_b128 v[28:31], v4 offset:2064
    s_add_u32 m0, s91, 0
    s_nop 0
    buffer_load_dwordx4 v56, s[36:39], s92 offen offset:0 lds
    buffer_load_dwordx4 v57, s[36:39], s92 offen offset:1024 lds
    buffer_load_dwordx4 v58, s[36:39], s92 offen offset:2048 lds
    buffer_load_dwordx4 v59, s[36:39], s92 offen offset:3072 lds
    s_add_u32 s92, s92, 32768
    s_waitcnt lgkmcnt(0)
    v_pk_fma_f32 v[128:129], v[128:129], v[24:25], v[32:33]
    v_pk_fma_f32 v[130:131], v[130:131], v[26:27], v[34:35]
    v_pk_fma_f32 v[132:133], v[132:133], v[28:29], v[36:37]
    v_pk_fma_f32 v[134:135], v[134:135], v[30:31], v[38:39]
    v_cvt_pk_bf16_f32 v128, v128, v129
    v_cvt_pk_bf16_f32 v129, v130, v131
    v_cvt_pk_bf16_f32 v130, v132, v133
    v_cvt_pk_bf16_f32 v131, v134, v135
    ds_write_b128 v22, v[128:131] offset:0
    v_pk_fma_f32 v[192:193], v[192:193], v[24:25], v[32:33]
    v_pk_fma_f32 v[194:195], v[194:195], v[26:27], v[34:35]
    v_pk_fma_f32 v[196:197], v[196:197], v[28:29], v[36:37]
    v_pk_fma_f32 v[198:199], v[198:199], v[30:31], v[38:39]
    v_cvt_pk_bf16_f32 v192, v192, v193
    v_cvt_pk_bf16_f32 v193, v194, v195
    v_cvt_pk_bf16_f32 v194, v196, v197
    v_cvt_pk_bf16_f32 v195, v198, v199
    ds_write_b128 v22, v[192:195] offset:128
    s_add_u32 m0, s91, 16384
    s_nop 0
    buffer_load_dwordx4 v56, s[36:39], s92 offen offset:0 lds
    v_xor_b32 v23, 16, v22
    v_pk_fma_f32 v[136:137], v[136:137], v[24:25], v[32:33]
    v_pk_fma_f32 v[138:139], v[138:139], v[26:27], v[34:35]
    v_pk_fma_f32 v[140:141], v[140:141], v[28:29], v[36:37]
    v_pk_fma_f32 v[142:143], v[142:143], v[30:31], v[38:39]
    v_cvt_pk_bf16_f32 v136, v136, v137
    v_cvt_pk_bf16_f32 v137, v138, v139
    v_cvt_pk_bf16_f32 v138, v140, v141
    v_cvt_pk_bf16_f32 v139, v142, v143
    ds_write_b128 v23, v[136:139] offset:0
    v_pk_fma_f32 v[200:201], v[200:201], v[24:25], v[32:33]
    v_pk_fma_f32 v[202:203], v[202:203], v[26:27], v[34:35]
    v_pk_fma_f32 v[204:205], v[204:205], v[28:29], v[36:37]
    v_pk_fma_f32 v[206:207], v[206:207], v[30:31], v[38:39]
    v_cvt_pk_bf16_f32 v200, v200, v201
    v_cvt_pk_bf16_f32 v201, v202, v203
    v_cvt_pk_bf16_f32 v202, v204, v205
    v_cvt_pk_bf16_f32 v203, v206, v207
    ds_write_b128 v23, v[200:203] offset:128
    buffer_load_dwordx4 v57, s[36:39], s92 offen offset:1024 lds
    v_xor_b32 v23, 32, v22
    v_pk_fma_f32 v[144:145], v[144:145], v[24:25], v[32:33]
    v_pk_fma_f32 v[146:147], v[146:147], v[26:27], v[34:35]
    v_pk_fma_f32 v[148:149], v[148:149], v[28:29], v[36:37]
    v_pk_fma_f32 v[150:151], v[150:151], v[30:31], v[38:39]
    v_cvt_pk_bf16_f32 v144, v144, v145
    v_cvt_pk_bf16_f32 v145, v146, v147
    v_cvt_pk_bf16_f32 v146, v148, v149
    v_cvt_pk_bf16_f32 v147, v150, v151
    ds_write_b128 v23, v[144:147] offset:0
    v_pk_fma_f32 v[208:209], v[208:209], v[24:25], v[32:33]
    v_pk_fma_f32 v[210:211], v[210:211], v[26:27], v[34:35]
    v_pk_fma_f32 v[212:213], v[212:213], v[28:29], v[36:37]
    v_pk_fma_f32 v[214:215], v[214:215], v[30:31], v[38:39]
    v_cvt_pk_bf16_f32 v208, v208, v209
    v_cvt_pk_bf16_f32 v209, v210, v211
    v_cvt_pk_bf16_f32 v210, v212, v213
    v_cvt_pk_bf16_f32 v211, v214, v215
    ds_write_b128 v23, v[208:211] offset:128
    buffer_load_dwordx4 v58, s[36:39], s92 offen offset:2048 lds
    v_xor_b32 v23, 48, v22
    v_pk_fma_f32 v[152:153], v[152:153], v[24:25], v[32:33]
    v_pk_fma_f32 v[154:155], v[154:155], v[26:27], v[34:35]
    v_pk_fma_f32 v[156:157], v[156:157], v[28:29], v[36:37]
    v_pk_fma_f32 v[158:159], v[158:159], v[30:31], v[38:39]
    v_cvt_pk_bf16_f32 v152, v152, v153
    v_cvt_pk_bf16_f32 v153, v154, v155
    v_cvt_pk_bf16_f32 v154, v156, v157
    v_cvt_pk_bf16_f32 v155, v158, v159
    ds_write_b128 v23, v[152:155] offset:0
    v_pk_fma_f32 v[216:217], v[216:217], v[24:25], v[32:33]
    v_pk_fma_f32 v[218:219], v[218:219], v[26:27], v[34:35]
    v_pk_fma_f32 v[220:221], v[220:221], v[28:29], v[36:37]
    v_pk_fma_f32 v[222:223], v[222:223], v[30:31], v[38:39]
    v_cvt_pk_bf16_f32 v216, v216, v217
    v_cvt_pk_bf16_f32 v217, v218, v219
    v_cvt_pk_bf16_f32 v218, v220, v221
    v_cvt_pk_bf16_f32 v219, v222, v223
    ds_write_b128 v23, v[216:219] offset:128
    buffer_load_dwordx4 v59, s[36:39], s92 offen offset:3072 lds
    s_add_u32 s92, s92, 229376
    v_xor_b32 v23, 64, v22
    v_pk_fma_f32 v[160:161], v[160:161], v[24:25], v[32:33]
    v_pk_fma_f32 v[162:163], v[162:163], v[26:27], v[34:35]
    v_pk_fma_f32 v[164:165], v[164:165], v[28:29], v[36:37]
    v_pk_fma_f32 v[166:167], v[166:167], v[30:31], v[38:39]
    v_cvt_pk_bf16_f32 v160, v160, v161
    v_cvt_pk_bf16_f32 v161, v162, v163
    v_cvt_pk_bf16_f32 v162, v164, v165
    v_cvt_pk_bf16_f32 v163, v166, v167
    ds_write_b128 v23, v[160:163] offset:0
    v_pk_fma_f32 v[224:225], v[224:225], v[24:25], v[32:33]
    v_pk_fma_f32 v[226:227], v[226:227], v[26:27], v[34:35]
    v_pk_fma_f32 v[228:229], v[228:229], v[28:29], v[36:37]
    v_pk_fma_f32 v[230:231], v[230:231], v[30:31], v[38:39]
    v_cvt_pk_bf16_f32 v224, v224, v225
    v_cvt_pk_bf16_f32 v225, v226, v227
    v_cvt_pk_bf16_f32 v226, v228, v229
    v_cvt_pk_bf16_f32 v227, v230, v231
    ds_write_b128 v23, v[224:227] offset:128
    s_add_u32 m0, s91, 32768
    s_nop 0
    buffer_load_dwordx4 v56, s[36:39], s92 offen offset:0 lds
    v_xor_b32 v23, 80, v22
    v_pk_fma_f32 v[168:169], v[168:169], v[24:25], v[32:33]
    v_pk_fma_f32 v[170:171], v[170:171], v[26:27], v[34:35]
    v_pk_fma_f32 v[172:173], v[172:173], v[28:29], v[36:37]
    v_pk_fma_f32 v[174:175], v[174:175], v[30:31], v[38:39]
    v_cvt_pk_bf16_f32 v168, v168, v169
    v_cvt_pk_bf16_f32 v169, v170, v171
    v_cvt_pk_bf16_f32 v170, v172, v173
    v_cvt_pk_bf16_f32 v171, v174, v175
    ds_write_b128 v23, v[168:171] offset:0
    v_pk_fma_f32 v[232:233], v[232:233], v[24:25], v[32:33]
    v_pk_fma_f32 v[234:235], v[234:235], v[26:27], v[34:35]
    v_pk_fma_f32 v[236:237], v[236:237], v[28:29], v[36:37]
    v_pk_fma_f32 v[238:239], v[238:239], v[30:31], v[38:39]
    v_cvt_pk_bf16_f32 v232, v232, v233
    v_cvt_pk_bf16_f32 v233, v234, v235
    v_cvt_pk_bf16_f32 v234, v236, v237
    v_cvt_pk_bf16_f32 v235, v238, v239
    ds_write_b128 v23, v[232:235] offset:128
    buffer_load_dwordx4 v57, s[36:39], s92 offen offset:1024 lds
    v_xor_b32 v23, 96, v22
    v_pk_fma_f32 v[176:177], v[176:177], v[24:25], v[32:33]
    v_pk_fma_f32 v[178:179], v[178:179], v[26:27], v[34:35]
    v_pk_fma_f32 v[180:181], v[180:181], v[28:29], v[36:37]
    v_pk_fma_f32 v[182:183], v[182:183], v[30:31], v[38:39]
    v_cvt_pk_bf16_f32 v176, v176, v177
    v_cvt_pk_bf16_f32 v177, v178, v179
    v_cvt_pk_bf16_f32 v178, v180, v181
    v_cvt_pk_bf16_f32 v179, v182, v183
    ds_write_b128 v23, v[176:179] offset:0
    v_pk_fma_f32 v[240:241], v[240:241], v[24:25], v[32:33]
    v_pk_fma_f32 v[242:243], v[242:243], v[26:27], v[34:35]
    v_pk_fma_f32 v[244:245], v[244:245], v[28:29], v[36:37]
    v_pk_fma_f32 v[246:247], v[246:247], v[30:31], v[38:39]
    v_cvt_pk_bf16_f32 v240, v240, v241
    v_cvt_pk_bf16_f32 v241, v242, v243
    v_cvt_pk_bf16_f32 v242, v244, v245
    v_cvt_pk_bf16_f32 v243, v246, v247
    ds_write_b128 v23, v[240:243] offset:128
    buffer_load_dwordx4 v58, s[36:39], s92 offen offset:2048 lds
    v_xor_b32 v23, 112, v22
    v_pk_fma_f32 v[184:185], v[184:185], v[24:25], v[32:33]
    v_pk_fma_f32 v[186:187], v[186:187], v[26:27], v[34:35]
    v_pk_fma_f32 v[188:189], v[188:189], v[28:29], v[36:37]
    v_pk_fma_f32 v[190:191], v[190:191], v[30:31], v[38:39]
    v_cvt_pk_bf16_f32 v184, v184, v185
    v_cvt_pk_bf16_f32 v185, v186, v187
    v_cvt_pk_bf16_f32 v186, v188, v189
    v_cvt_pk_bf16_f32 v187, v190, v191
    ds_write_b128 v23, v[184:187] offset:0
    v_pk_fma_f32 v[248:249], v[248:249], v[24:25], v[32:33]
    v_pk_fma_f32 v[250:251], v[250:251], v[26:27], v[34:35]
    v_pk_fma_f32 v[252:253], v[252:253], v[28:29], v[36:37]
    v_pk_fma_f32 v[254:255], v[254:255], v[30:31], v[38:39]
    v_cvt_pk_bf16_f32 v248, v248, v249
    v_cvt_pk_bf16_f32 v249, v250, v251
    v_cvt_pk_bf16_f32 v250, v252, v253
    v_cvt_pk_bf16_f32 v251, v254, v255
    ds_write_b128 v23, v[248:251] offset:128
    buffer_load_dwordx4 v59, s[36:39], s92 offen offset:3072 lds
    s_add_u32 s92, s92, 32768
    s_waitcnt lgkmcnt(0)
    s_barrier
    ds_read_b128 v[80:83], v20 offset:0
    ds_read_b128 v[84:87], v21 offset:0
    ds_read_b128 v[88:91], v20 offset:16384
    ds_read_b128 v[92:95], v21 offset:16384
    ds_read_b128 v[96:99], v20 offset:32768
    ds_read_b128 v[100:103], v21 offset:32768
    ds_read_b128 v[104:107], v20 offset:49152
    ds_read_b128 v[108:111], v21 offset:49152
    s_waitcnt vmcnt(16)
    s_waitcnt lgkmcnt(0)
    v_mfma_f32_16x16x32_bf16 v[128:131], a[128:131], v[80:83], 0
    s_add_u32 m0, s91, 49152
    ds_read_b64_tr_b16 a[224:225], v72 offset:0
    v_mfma_f32_16x16x32_bf16 v[128:131], a[192:195], v[84:87], v[128:131]
    buffer_load_dwordx4 v56, s[36:39], s92 offen offset:0 lds
    v_mfma_f32_16x16x32_bf16 v[132:135], a[128:131], v[88:91], 0
    s_branch L_ov2
L_pad2:
    s_setpc_b64 s[86:87]
L_ov2:
    ds_read_b64_tr_b16 a[228:229], v73 offset:0
    v_and_b32 v2, 15, v0
    v_mfma_f32_16x16x32_bf16 v[132:135], a[192:195], v[92:95], v[132:135]
    ds_read_b128 v[24:27], v20 offset:2048
    v_lshlrev_b32 v4, 3, v2
    v_mfma_f32_16x16x32_bf16 v[136:139], a[128:131], v[96:99], 0
    ds_read_b64_tr_b16 a[232:233], v74 offset:0
    v_mfma_f32_16x16x32_bf16 v[136:139], a[192:195], v[100:103], v[136:139]
    buffer_load_dwordx4 v57, s[36:39], s92 offen offset:1024 lds
    v_mfma_f32_16x16x32_bf16 v[140:143], a[128:131], v[104:107], 0
    ds_read_b64_tr_b16 a[236:237], v75 offset:0
    v_and_b32 v5, 3, v0
    v_mfma_f32_16x16x32_bf16 v[140:143], a[192:195], v[108:111], v[140:143]
    ds_read_b128 v[28:31], v21 offset:2048
    v_lshrrev_b32 v61, 1, v3
    v_mfma_f32_16x16x32_bf16 v[156:159], a[132:135], v[104:107], 0
    ds_read_b64_tr_b16 a[240:241], v76 offset:0
    v_mfma_f32_16x16x32_bf16 v[156:159], a[196:199], v[108:111], v[156:159]
    buffer_load_dwordx4 v58, s[36:39], s92 offen offset:2048 lds
    v_mfma_f32_16x16x32_bf16 v[152:155], a[132:135], v[96:99], 0
    ds_read_b64_tr_b16 a[244:245], v77 offset:0
    v_xor_b32 v6, v61, v3
    v_mfma_f32_16x16x32_bf16 v[152:155], a[196:199], v[100:103], v[152:155]
    ds_read_b128 v[32:35], v20 offset:18432
    v_and_b32 v6, 1, v6
    v_mfma_f32_16x16x32_bf16 v[148:151], a[132:135], v[88:91], 0
    ds_read_b64_tr_b16 a[248:249], v78 offset:0
    v_mfma_f32_16x16x32_bf16 v[148:151], a[196:199], v[92:95], v[148:151]
    buffer_load_dwordx4 v59, s[36:39], s92 offen offset:3072 lds
    v_mfma_f32_16x16x32_bf16 v[144:147], a[132:135], v[80:83], 0
    s_add_u32 s92, s92, 229376
    ds_read_b64_tr_b16 a[252:253], v79 offset:0
    v_lshl_add_u32 v61, v6, 1, v61
    v_mfma_f32_16x16x32_bf16 v[144:147], a[196:199], v[84:87], v[144:147]
    s_waitcnt vmcnt(16)
    ds_read_b128 v[36:39], v21 offset:18432
    v_xor_b32 v6, v5, v61
    v_mfma_f32_16x16x32_bf16 v[160:163], a[136:139], v[80:83], 0
    ds_read_b64_tr_b16 a[226:227], v72 offset:16384
    v_mfma_f32_16x16x32_bf16 v[160:163], a[200:203], v[84:87], v[160:163]
    v_mfma_f32_16x16x32_bf16 v[164:167], a[136:139], v[88:91], 0
    ds_read_b64_tr_b16 a[230:231], v73 offset:16384
    v_lshlrev_b32 v6, 4, v6
    v_mfma_f32_16x16x32_bf16 v[164:167], a[200:203], v[92:95], v[164:167]
    ds_read_b128 v[40:43], v20 offset:34816
    v_lshrrev_b32 v62, 2, v0
    v_mfma_f32_16x16x32_bf16 v[168:171], a[136:139], v[96:99], 0
    s_waitcnt lgkmcnt(4)
    s_add_u32 m0, s91, 131072
    ds_read_b64_tr_b16 a[234:235], v74 offset:16384
    v_mfma_f32_16x16x32_bf16 v[168:171], a[200:203], v[100:103], v[168:171]
    buffer_load_dwordx4 v56, s[36:39], s92 offen offset:0 lds
    v_mfma_f32_16x16x32_bf16 v[172:175], a[136:139], v[104:107], 0
    ds_read_b64_tr_b16 a[238:239], v75 offset:16384
    v_lshl_add_u32 v15, v62, 8, v6
    v_mfma_f32_16x16x32_bf16 v[172:175], a[200:203], v[108:111], v[172:175]
    ds_read_b128 v[44:47], v21 offset:34816
    v_lshrrev_b32 v6, 1, v5
    v_mfma_f32_16x16x32_bf16 v[188:191], a[140:143], v[104:107], 0
    ds_read_b64_tr_b16 a[242:243], v76 offset:16384
    v_mfma_f32_16x16x32_bf16 v[188:191], a[204:207], v[108:111], v[188:191]
    buffer_load_dwordx4 v57, s[36:39], s92 offen offset:1024 lds
    v_mfma_f32_16x16x32_bf16 v[184:187], a[140:143], v[96:99], 0
    ds_read_b64_tr_b16 a[246:247], v77 offset:16384
    v_xor_b32 v6, v6, v61
    v_mfma_f32_16x16x32_bf16 v[184:187], a[204:207], v[100:103], v[184:187]
    ds_read_b128 v[48:51], v20 offset:51200
    v_lshlrev_b32 v6, 4, v6
    v_mfma_f32_16x16x32_bf16 v[180:183], a[140:143], v[88:91], 0
    ds_read_b64_tr_b16 a[250:251], v78 offset:16384
    v_mfma_f32_16x16x32_bf16 v[180:183], a[204:207], v[92:95], v[180:183]
    buffer_load_dwordx4 v58, s[36:39], s92 offen offset:2048 lds
    v_mfma_f32_16x16x32_bf16 v[176:179], a[140:143], v[80:83], 0
    ds_read_b64_tr_b16 a[254:255], v79 offset:16384
    v_lshl_add_u32 v14, v62, 6, v6
    v_mfma_f32_16x16x32_bf16 v[176:179], a[204:207], v[84:87], v[176:179]
    s_waitcnt vmcnt(15)
    ds_read_b128 v[52:55], v21 offset:51200
    v_and_b32 v6, 1, v0
    v_mfma_f32_16x16x32_bf16 v[192:195], a[144:147], v[80:83], 0
    ds_read_b64_tr_b16 a[64:65], v64 offset:0
    v_mfma_f32_16x16x32_bf16 v[192:195], a[208:211], v[84:87], v[192:195]
    buffer_load_dwordx4 v59, s[36:39], s92 offen offset:3072 lds
    v_mfma_f32_16x16x32_bf16 v[196:199], a[144:147], v[88:91], 0
    s_add_u32 s92, s92, 32768
    ds_read_b64_tr_b16 a[68:69], v65 offset:0
    v_lshl_add_u32 v14, v6, 3, v14
    v_mfma_f32_16x16x32_bf16 v[196:199], a[208:211], v[92:95], v[196:199]
    v_lshrrev_b32 v62, 2, v2
    v_mfma_f32_16x16x32_bf16 v[200:203], a[144:147], v[96:99], 0
    s_waitcnt lgkmcnt(3)
    s_add_u32 m0, s91, 147456
    ds_read_b64_tr_b16 a[72:73], v66 offset:0
    v_mfma_f32_16x16x32_bf16 v[200:203], a[208:211], v[100:103], v[200:203]
    buffer_load_dwordx4 v56, s[36:39], s92 offen offset:0 lds
    v_mfma_f32_16x16x32_bf16 v[204:207], a[144:147], v[104:107], 0
    ds_read_b64_tr_b16 a[76:77], v67 offset:0
    v_lshrrev_b32 v61, 1, v62
    v_mfma_f32_16x16x32_bf16 v[204:207], a[208:211], v[108:111], v[204:207]
    v_xor_b32 v6, v61, v62
    v_mfma_f32_16x16x32_bf16 v[220:223], a[148:151], v[104:107], 0
    ds_read_b64_tr_b16 a[80:81], v68 offset:0
    v_mfma_f32_16x16x32_bf16 v[220:223], a[212:215], v[108:111], v[220:223]
    buffer_load_dwordx4 v57, s[36:39], s92 offen offset:1024 lds
    v_mfma_f32_16x16x32_bf16 v[216:219], a[148:151], v[96:99], 0
    ds_read_b64_tr_b16 a[84:85], v69 offset:0
    v_and_b32 v6, 1, v6
    v_mfma_f32_16x16x32_bf16 v[216:219], a[212:215], v[100:103], v[216:219]
    v_lshl_add_u32 v61, v6, 1, v61
    v_mfma_f32_16x16x32_bf16 v[212:215], a[148:151], v[88:91], 0
    ds_read_b64_tr_b16 a[88:89], v70 offset:0
    v_mfma_f32_16x16x32_bf16 v[212:215], a[212:215], v[92:95], v[212:215]
    buffer_load_dwordx4 v58, s[36:39], s92 offen offset:2048 lds
    v_mfma_f32_16x16x32_bf16 v[208:211], a[148:151], v[80:83], 0
    ds_read_b64_tr_b16 a[92:93], v71 offset:0
    v_xor_b32 v6, v3, v61
    v_mfma_f32_16x16x32_bf16 v[208:211], a[212:215], v[84:87], v[208:211]
    s_waitcnt vmcnt(15)
    v_lshlrev_b32 v6, 4, v6
    v_mfma_f32_16x16x32_bf16 v[224:227], a[152:155], v[80:83], 0
    ds_read_b64_tr_b16 a[66:67], v64 offset:16384
    v_mfma_f32_16x16x32_bf16 v[224:227], a[216:219], v[84:87], v[224:227]
    buffer_load_dwordx4 v59, s[36:39], s92 offen offset:3072 lds
    v_mfma_f32_16x16x32_bf16 v[228:231], a[152:155], v[88:91], 0
    s_add_u32 s92, s92, 229376
    ds_read_b64_tr_b16 a[70:71], v65 offset:16384
    v_lshl_add_u32 v13, v2, 6, v6
    v_mfma_f32_16x16x32_bf16 v[228:231], a[216:219], v[92:95], v[228:231]
    v_mov_b32 v10, v13
    v_mfma_f32_16x16x32_bf16 v[232:235], a[152:155], v[96:99], 0
    s_waitcnt lgkmcnt(2)
    s_add_u32 m0, s91, 0
    ds_read_b64_tr_b16 a[74:75], v66 offset:16384
    v_mfma_f32_16x16x32_bf16 v[232:235], a[216:219], v[100:103], v[232:235]
    buffer_load_dwordx4 v56, s[36:39], s92 offen offset:0 lds
    v_mfma_f32_16x16x32_bf16 v[236:239], a[152:155], v[104:107], 0
    ds_read_b64_tr_b16 a[78:79], v67 offset:16384
    v_mov_b32 v19, v14
    v_mfma_f32_16x16x32_bf16 v[236:239], a[216:219], v[108:111], v[236:239]
    v_xor_b32 v12, 32, v14
    v_mfma_f32_16x16x32_bf16 v[252:255], a[156:159], v[104:107], 0
    s_sub_u32 s82, s91, 32768
    ds_read_b64_tr_b16 a[82:83], v68 offset:16384
    v_mfma_f32_16x16x32_bf16 v[252:255], a[220:223], v[108:111], v[252:255]
    buffer_load_dwordx4 v57, s[36:39], s92 offen offset:1024 lds
    v_mfma_f32_16x16x32_bf16 v[248:251], a[156:159], v[96:99], 0
    s_and_b32 s81, s5, 0
    ds_read_b64_tr_b16 a[86:87], v69 offset:16384
    v_mfma_f32_16x16x32_bf16 v[248:251], a[220:223], v[100:103], v[248:251]
    s_lshl_b32 s81, s81, 14
    v_mfma_f32_16x16x32_bf16 v[244:247], a[156:159], v[88:91], 0
    s_add_u32 s81, s81, s91
    ds_read_b64_tr_b16 a[90:91], v70 offset:16384
    v_mfma_f32_16x16x32_bf16 v[244:247], a[220:223], v[92:95], v[244:247]
    buffer_load_dwordx4 v58, s[36:39], s92 offen offset:2048 lds
    v_mfma_f32_16x16x32_bf16 v[240:243], a[156:159], v[80:83], 0
    s_sub_u32 s81, s81, 16384
    ds_read_b64_tr_b16 a[94:95], v71 offset:16384
    v_mfma_f32_16x16x32_bf16 v[240:243], a[220:223], v[84:87], v[240:243]
    s_waitcnt vmcnt(15) lgkmcnt(5)
    v_mfma_f32_16x16x32_bf16 v[128:131], a[160:163], v[24:27], v[128:131]
    s_mov_b32 s83, 0
    ds_read_b64_tr_b16 a[32:33], v64 offset:32768
    v_mfma_f32_16x16x32_bf16 v[128:131], a[224:227], v[28:31], v[128:131]
    buffer_load_dwordx4 v59, s[36:39], s92 offen offset:3072 lds
    v_mfma_f32_16x16x32_bf16 v[132:135], a[160:163], v[32:35], v[132:135]
    s_add_u32 s92, s92, 32768
    ds_read_b64_tr_b16 a[36:37], v65 offset:32768
    v_mfma_f32_16x16x32_bf16 v[132:135], a[224:227], v[36:39], v[132:135]
    s_mul_i32 s80, s3, 303104
    ds_read_b128 v[80:83], v20 offset:4096
    v_mfma_f32_16x16x32_bf16 v[136:139], a[160:163], v[40:43], v[136:139]
    s_waitcnt lgkmcnt(3)
    s_add_u32 m0, s91, 16384
    ds_read_b64_tr_b16 a[40:41], v66 offset:32768
    v_mfma_f32_16x16x32_bf16 v[136:139], a[224:227], v[44:47], v[136:139]
    buffer_load_dwordx4 v56, s[36:39], s92 offen offset:0 lds
    v_mfma_f32_16x16x32_bf16 v[140:143], a[160:163], v[48:51], v[140:143]
    s_lshl_b32 s86, s4, 19
    ds_read_b64_tr_b16 a[44:45], v67 offset:32768
    v_mfma_f32_16x16x32_bf16 v[140:143], a[224:227], v[52:55], v[140:143]
    s_add_u32 s28, s52, s86
    s_addc_u32 s29, s53, 0
    ds_read_b128 v[84:87], v21 offset:4096
    v_mfma_f32_16x16x32_bf16 v[156:159], a[164:167], v[48:51], v[156:159]
    s_and_b32 s29, s29, 0xffff
    ds_read_b64_tr_b16 a[48:49], v68 offset:32768
    v_mfma_f32_16x16x32_bf16 v[156:159], a[228:231], v[52:55], v[156:159]
    buffer_load_dwordx4 v57, s[36:39], s92 offen offset:1024 lds
    v_mfma_f32_16x16x32_bf16 v[152:155], a[164:167], v[40:43], v[152:155]
    s_mov_b32 s30, 0x80000
    ds_read_b64_tr_b16 a[52:53], v69 offset:32768
    v_mfma_f32_16x16x32_bf16 v[152:155], a[228:231], v[44:47], v[152:155]
    s_mov_b32 s31, 0x20000
    ds_read_b128 v[88:91], v20 offset:20480
    v_mfma_f32_16x16x32_bf16 v[148:151], a[164:167], v[32:35], v[148:151]
    s_mov_b32 s40, s56
    ds_read_b64_tr_b16 a[56:57], v70 offset:32768
    v_mfma_f32_16x16x32_bf16 v[148:151], a[228:231], v[36:39], v[148:151]
    buffer_load_dwordx4 v58, s[36:39], s92 offen offset:2048 lds
    v_mfma_f32_16x16x32_bf16 v[144:147], a[164:167], v[24:27], v[144:147]
    s_and_b32 s41, s57, 0xffff
    ds_read_b64_tr_b16 a[60:61], v71 offset:32768
    v_mfma_f32_16x16x32_bf16 v[144:147], a[228:231], v[28:31], v[144:147]
    s_waitcnt vmcnt(15)
    ds_read_b128 v[92:95], v21 offset:20480
    v_mfma_f32_16x16x32_bf16 v[160:163], a[168:171], v[24:27], v[160:163]
    s_mov_b32 s42, 0x1c0000
    ds_read_b64_tr_b16 a[34:35], v64 offset:49152
    v_mfma_f32_16x16x32_bf16 v[160:163], a[232:235], v[28:31], v[160:163]
    buffer_load_dwordx4 v59, s[36:39], s92 offen offset:3072 lds
    v_mfma_f32_16x16x32_bf16 v[164:167], a[168:171], v[32:35], v[164:167]
    s_add_u32 s92, s92, 229376
    ds_read_b64_tr_b16 a[38:39], v65 offset:49152
    v_mfma_f32_16x16x32_bf16 v[164:167], a[232:235], v[36:39], v[164:167]
    s_mov_b32 s43, 0x20000
    ds_read_b128 v[96:99], v20 offset:36864
    v_mfma_f32_16x16x32_bf16 v[168:171], a[168:171], v[40:43], v[168:171]
    s_waitcnt lgkmcnt(4)
    s_add_u32 m0, s91, 32768
    ds_read_b64_tr_b16 a[42:43], v66 offset:49152
    v_mfma_f32_16x16x32_bf16 v[168:171], a[232:235], v[44:47], v[168:171]
    buffer_load_dwordx4 v56, s[36:39], s92 offen offset:0 lds
    v_mfma_f32_16x16x32_bf16 v[172:175], a[168:171], v[48:51], v[172:175]
    s_mov_b32 s44, s48
    ds_read_b64_tr_b16 a[46:47], v67 offset:49152
    v_mfma_f32_16x16x32_bf16 v[172:175], a[232:235], v[52:55], v[172:175]
    s_and_b32 s45, s49, 0xffff
    ds_read_b128 v[100:103], v21 offset:36864
    v_mfma_f32_16x16x32_bf16 v[188:191], a[172:175], v[48:51], v[188:191]
    s_mov_b32 s46, 0x1c0000
    ds_read_b64_tr_b16 a[50:51], v68 offset:49152
    v_mfma_f32_16x16x32_bf16 v[188:191], a[236:239], v[52:55], v[188:191]
    buffer_load_dwordx4 v57, s[36:39], s92 offen offset:1024 lds
    v_mfma_f32_16x16x32_bf16 v[184:187], a[172:175], v[40:43], v[184:187]
    s_mov_b32 s47, 0x20000
    ds_read_b64_tr_b16 a[54:55], v69 offset:49152
    v_mfma_f32_16x16x32_bf16 v[184:187], a[236:239], v[44:47], v[184:187]
    s_mov_b32 s48, s50
    ds_read_b128 v[104:107], v20 offset:53248
    v_mfma_f32_16x16x32_bf16 v[180:183], a[172:175], v[32:35], v[180:183]
    s_and_b32 s49, s51, 0xffff
    ds_read_b64_tr_b16 a[58:59], v70 offset:49152
    v_mfma_f32_16x16x32_bf16 v[180:183], a[236:239], v[36:39], v[180:183]
    buffer_load_dwordx4 v58, s[36:39], s92 offen offset:2048 lds
    v_mfma_f32_16x16x32_bf16 v[176:179], a[172:175], v[24:27], v[176:179]
    s_mov_b32 s50, 0x1c0000
    ds_read_b64_tr_b16 a[62:63], v71 offset:49152
    v_mfma_f32_16x16x32_bf16 v[176:179], a[236:239], v[28:31], v[176:179]
    s_mov_b32 s51, 0x20000
    ds_read_b128 v[108:111], v21 offset:53248
    v_mfma_f32_16x16x32_bf16 v[192:195], a[176:179], v[24:27], v[192:195]
    s_mov_b32 s56, 0x33333333
    v_mfma_f32_16x16x32_bf16 v[192:195], a[240:243], v[28:31], v[192:195]
    buffer_load_dwordx4 v59, s[36:39], s92 offen offset:3072 lds
    v_mfma_f32_16x16x32_bf16 v[196:199], a[176:179], v[32:35], v[196:199]
    s_add_u32 s92, s92, 32768
    v_mfma_f32_16x16x32_bf16 v[196:199], a[240:243], v[36:39], v[196:199]
    s_mov_b32 s57, 0x33333333
    v_mfma_f32_16x16x32_bf16 v[200:203], a[176:179], v[40:43], v[200:203]
    s_waitcnt lgkmcnt(1)
    s_add_u32 m0, s91, 49152
    v_mfma_f32_16x16x32_bf16 v[200:203], a[240:243], v[44:47], v[200:203]
    buffer_load_dwordx4 v56, s[36:39], s92 offen offset:0 lds
    v_mfma_f32_16x16x32_bf16 v[204:207], a[176:179], v[48:51], v[204:207]
    s_not_b64 s[58:59], s[56:57]
    v_and_b32 v2, 7, v0
    v_mfma_f32_16x16x32_bf16 v[204:207], a[240:243], v[52:55], v[204:207]
    v_bfe_u32 v3, v0, 3, 1
    v_mfma_f32_16x16x32_bf16 v[220:223], a[180:183], v[48:51], v[220:223]
    v_mfma_f32_16x16x32_bf16 v[220:223], a[244:247], v[52:55], v[220:223]
    buffer_load_dwordx4 v57, s[36:39], s92 offen offset:1024 lds
    v_mfma_f32_16x16x32_bf16 v[216:219], a[180:183], v[40:43], v[216:219]
    v_lshrrev_b32 v5, 4, v0
    v_mfma_f32_16x16x32_bf16 v[216:219], a[244:247], v[44:47], v[216:219]
    v_lshlrev_b32 v11, 10, v3
    v_mfma_f32_16x16x32_bf16 v[212:215], a[180:183], v[32:35], v[212:215]
    v_mfma_f32_16x16x32_bf16 v[212:215], a[244:247], v[36:39], v[212:215]
    buffer_load_dwordx4 v58, s[36:39], s92 offen offset:2048 lds
    v_mfma_f32_16x16x32_bf16 v[208:211], a[180:183], v[24:27], v[208:211]
    v_lshl_add_u32 v11, v5, 8, v11
    v_mfma_f32_16x16x32_bf16 v[208:211], a[244:247], v[28:31], v[208:211]
    s_waitcnt vmcnt(19)
    v_lshl_add_u32 v11, v2, 4, v11
    v_mfma_f32_16x16x32_bf16 v[224:227], a[184:187], v[24:27], v[224:227]
    s_lshr_b32 s86, s4, 1
    ds_read_b64_tr_b16 a[128:129], v72 offset:0
    v_mfma_f32_16x16x32_bf16 v[224:227], a[248:251], v[28:31], v[224:227]
    buffer_load_dwordx4 v59, s[36:39], s92 offen offset:3072 lds
    v_mfma_f32_16x16x32_bf16 v[228:231], a[184:187], v[32:35], v[228:231]
    s_add_u32 s92, s92, 229376
    ds_read_b64_tr_b16 a[132:133], v73 offset:0
    v_mfma_f32_16x16x32_bf16 v[228:231], a[248:251], v[36:39], v[228:231]
    s_lshl_b32 s86, s86, 14
    v_mfma_f32_16x16x32_bf16 v[232:235], a[184:187], v[40:43], v[232:235]
    s_and_b32 s87, s4, 1
    ds_read_b64_tr_b16 a[136:137], v74 offset:0
    v_mfma_f32_16x16x32_bf16 v[232:235], a[248:251], v[44:47], v[232:235]
    v_mfma_f32_16x16x32_bf16 v[236:239], a[184:187], v[48:51], v[236:239]
    s_lshl_b32 s87, s87, 7
    ds_read_b64_tr_b16 a[140:141], v75 offset:0
    v_mfma_f32_16x16x32_bf16 v[236:239], a[248:251], v[52:55], v[236:239]
    s_add_u32 s86, s86, s87
    v_mfma_f32_16x16x32_bf16 v[252:255], a[188:191], v[48:51], v[252:255]
    s_lshl_b32 s87, s3, 12
    ds_read_b64_tr_b16 a[144:145], v76 offset:0
    v_mfma_f32_16x16x32_bf16 v[252:255], a[252:255], v[52:55], v[252:255]
    v_mfma_f32_16x16x32_bf16 v[248:251], a[188:191], v[40:43], v[248:251]
    s_add_u32 s86, s86, s87
    ds_read_b64_tr_b16 a[148:149], v77 offset:0
    v_add_u32 v11, s86, v11
    v_mfma_f32_16x16x32_bf16 v[248:251], a[252:255], v[44:47], v[248:251]
    v_lshrrev_b32 v3, 3, v0
    v_mfma_f32_16x16x32_bf16 v[244:247], a[188:191], v[32:35], v[244:247]
    s_lshl_b32 s86, s3, 4
    ds_read_b64_tr_b16 a[152:153], v78 offset:0
    v_mfma_f32_16x16x32_bf16 v[244:247], a[252:255], v[36:39], v[244:247]
    v_mfma_f32_16x16x32_bf16 v[240:243], a[188:191], v[24:27], v[240:243]
    ds_read_b64_tr_b16 a[156:157], v79 offset:0
    v_add_u32 v3, s86, v3
    v_mfma_f32_16x16x32_bf16 v[240:243], a[252:255], v[28:31], v[240:243]
    s_waitcnt vmcnt(16) lgkmcnt(5)
    v_lshlrev_b32 v18, 10, v2
    v_mfma_f32_16x16x32_bf16 v[128:131], a[64:67], v[80:83], v[128:131]
    ds_read_b64_tr_b16 a[130:131], v72 offset:16384
    v_mfma_f32_16x16x32_bf16 v[128:131], a[32:35], v[84:87], v[128:131]
    v_mfma_f32_16x16x32_bf16 v[132:135], a[64:67], v[88:91], v[132:135]
    ds_read_b64_tr_b16 a[134:135], v73 offset:16384
    v_lshl_add_u32 v18, v3, 4, v18
    v_mfma_f32_16x16x32_bf16 v[132:135], a[32:35], v[92:95], v[132:135]
    s_lshl_b32 s86, s5, 3
    ds_read_b128 v[24:27], v20 offset:6144
    v_mfma_f32_16x16x32_bf16 v[136:139], a[64:67], v[96:99], v[136:139]
    s_waitcnt lgkmcnt(3)
    s_add_u32 m0, s91, 131072
    ds_read_b64_tr_b16 a[138:139], v74 offset:16384
    v_mfma_f32_16x16x32_bf16 v[136:139], a[32:35], v[100:103], v[136:139]
    buffer_load_dwordx4 v56, s[36:39], s92 offen offset:0 lds
    v_mfma_f32_16x16x32_bf16 v[140:143], a[64:67], v[104:107], v[140:143]
    s_add_u32 s86, s86, s4
    ds_read_b64_tr_b16 a[142:143], v75 offset:16384
    v_mfma_f32_16x16x32_bf16 v[140:143], a[32:35], v[108:111], v[140:143]
    s_lshl_b32 s86, s86, 13
    ds_read_b128 v[28:31], v21 offset:6144
    v_add_u32 v18, s86, v18
    v_mfma_f32_16x16x32_bf16 v[156:159], a[68:71], v[104:107], v[156:159]
    s_lshl_b32 s86, s4, 9
    ds_read_b64_tr_b16 a[146:147], v76 offset:16384
    v_mfma_f32_16x16x32_bf16 v[156:159], a[36:39], v[108:111], v[156:159]
    buffer_load_dwordx4 v57, s[36:39], s92 offen offset:1024 lds
    v_mfma_f32_16x16x32_bf16 v[152:155], a[68:71], v[96:99], v[152:155]
    s_lshl_b32 s87, s3, 7
    ds_read_b64_tr_b16 a[150:151], v77 offset:16384
    v_mfma_f32_16x16x32_bf16 v[152:155], a[36:39], v[100:103], v[152:155]
    s_add_u32 s93, s86, s87
    ds_read_b128 v[32:35], v20 offset:22528
    v_mfma_f32_16x16x32_bf16 v[148:151], a[68:71], v[88:91], v[148:151]
    s_add_u32 s86, s93, s89
    ds_read_b64_tr_b16 a[154:155], v78 offset:16384
    v_mfma_f32_16x16x32_bf16 v[148:151], a[36:39], v[92:95], v[148:151]
    buffer_load_dwordx4 v58, s[36:39], s92 offen offset:2048 lds
    v_mfma_f32_16x16x32_bf16 v[144:147], a[68:71], v[80:83], v[144:147]
    ds_read_b64_tr_b16 a[158:159], v79 offset:16384
    v_mov_b32 v3, 0
    v_mfma_f32_16x16x32_bf16 v[144:147], a[36:39], v[84:87], v[144:147]
    s_waitcnt vmcnt(15)
    ds_read_b128 v[36:39], v21 offset:22528
    v_lshlrev_b32 v5, 17, v0
    v_mfma_f32_16x16x32_bf16 v[160:163], a[72:75], v[80:83], v[160:163]
    ds_read_b64_tr_b16 a[192:193], v64 offset:0
    v_mfma_f32_16x16x32_bf16 v[160:163], a[40:43], v[84:87], v[160:163]
    buffer_load_dwordx4 v59, s[36:39], s92 offen offset:3072 lds
    v_mfma_f32_16x16x32_bf16 v[164:167], a[72:75], v[88:91], v[164:167]
    s_add_u32 s92, s92, 32768
    ds_read_b64_tr_b16 a[196:197], v65 offset:0
    v_mfma_f32_16x16x32_bf16 v[164:167], a[40:43], v[92:95], v[164:167]
    ds_read_b128 v[40:43], v20 offset:38912
    v_mfma_f32_16x16x32_bf16 v[168:171], a[72:75], v[96:99], v[168:171]
    s_waitcnt lgkmcnt(4)
    s_add_u32 m0, s91, 147456
    ds_read_b64_tr_b16 a[200:201], v66 offset:0
    v_mfma_f32_16x16x32_bf16 v[168:171], a[40:43], v[100:103], v[168:171]
    buffer_load_dwordx4 v56, s[36:39], s92 offen offset:0 lds
    v_mfma_f32_16x16x32_bf16 v[172:175], a[72:75], v[104:107], v[172:175]
    ds_read_b64_tr_b16 a[204:205], v67 offset:0
    v_mfma_f32_16x16x32_bf16 v[172:175], a[40:43], v[108:111], v[172:175]
    ds_read_b128 v[44:47], v21 offset:38912
    v_mfma_f32_16x16x32_bf16 v[188:191], a[76:79], v[104:107], v[188:191]
    ds_read_b64_tr_b16 a[208:209], v68 offset:0
    v_mfma_f32_16x16x32_bf16 v[188:191], a[44:47], v[108:111], v[188:191]
    buffer_load_dwordx4 v57, s[36:39], s92 offen offset:1024 lds
    v_mfma_f32_16x16x32_bf16 v[184:187], a[76:79], v[96:99], v[184:187]
    ds_read_b64_tr_b16 a[212:213], v69 offset:0
    v_mfma_f32_16x16x32_bf16 v[184:187], a[44:47], v[100:103], v[184:187]
    ds_read_b128 v[48:51], v20 offset:55296
    v_mfma_f32_16x16x32_bf16 v[180:183], a[76:79], v[88:91], v[180:183]
    ds_read_b64_tr_b16 a[216:217], v70 offset:0
    v_mfma_f32_16x16x32_bf16 v[180:183], a[44:47], v[92:95], v[180:183]
    buffer_load_dwordx4 v58, s[36:39], s92 offen offset:2048 lds
    v_mfma_f32_16x16x32_bf16 v[176:179], a[76:79], v[80:83], v[176:179]
    ds_read_b64_tr_b16 a[220:221], v71 offset:0
    v_mfma_f32_16x16x32_bf16 v[176:179], a[44:47], v[84:87], v[176:179]
    s_waitcnt vmcnt(15)
    ds_read_b128 v[52:55], v21 offset:55296
    v_mfma_f32_16x16x32_bf16 v[192:195], a[80:83], v[80:83], v[192:195]
    ds_read_b64_tr_b16 a[194:195], v64 offset:16384
    v_mfma_f32_16x16x32_bf16 v[192:195], a[48:51], v[84:87], v[192:195]
    buffer_load_dwordx4 v59, s[36:39], s92 offen offset:3072 lds
    v_mfma_f32_16x16x32_bf16 v[196:199], a[80:83], v[88:91], v[196:199]
    s_add_u32 s92, s92, 229376
    ds_read_b64_tr_b16 a[198:199], v65 offset:16384
    v_mfma_f32_16x16x32_bf16 v[196:199], a[48:51], v[92:95], v[196:199]
    v_mfma_f32_16x16x32_bf16 v[200:203], a[80:83], v[96:99], v[200:203]
    s_waitcnt lgkmcnt(3)
    s_add_u32 m0, s91, 0
    ds_read_b64_tr_b16 a[202:203], v66 offset:16384
    v_mfma_f32_16x16x32_bf16 v[200:203], a[48:51], v[100:103], v[200:203]
    buffer_load_dwordx4 v56, s[36:39], s92 offen offset:0 lds
    v_mfma_f32_16x16x32_bf16 v[204:207], a[80:83], v[104:107], v[204:207]
    ds_read_b64_tr_b16 a[206:207], v67 offset:16384
    v_mfma_f32_16x16x32_bf16 v[204:207], a[48:51], v[108:111], v[204:207]
    v_mfma_f32_16x16x32_bf16 v[220:223], a[84:87], v[104:107], v[220:223]
    ds_read_b64_tr_b16 a[210:211], v68 offset:16384
    v_mfma_f32_16x16x32_bf16 v[220:223], a[52:55], v[108:111], v[220:223]
    buffer_load_dwordx4 v57, s[36:39], s92 offen offset:1024 lds
    v_mfma_f32_16x16x32_bf16 v[216:219], a[84:87], v[96:99], v[216:219]
    ds_read_b64_tr_b16 a[214:215], v69 offset:16384
    v_mfma_f32_16x16x32_bf16 v[216:219], a[52:55], v[100:103], v[216:219]
    v_mfma_f32_16x16x32_bf16 v[212:215], a[84:87], v[88:91], v[212:215]
    ds_read_b64_tr_b16 a[218:219], v70 offset:16384
    v_mfma_f32_16x16x32_bf16 v[212:215], a[52:55], v[92:95], v[212:215]
    buffer_load_dwordx4 v58, s[36:39], s92 offen offset:2048 lds
    v_mfma_f32_16x16x32_bf16 v[208:211], a[84:87], v[80:83], v[208:211]
    ds_read_b64_tr_b16 a[222:223], v71 offset:16384
    v_mfma_f32_16x16x32_bf16 v[208:211], a[52:55], v[84:87], v[208:211]
    s_waitcnt vmcnt(15)
    v_mfma_f32_16x16x32_bf16 v[224:227], a[88:91], v[80:83], v[224:227]
    ds_read_b64_tr_b16 a[160:161], v64 offset:32768
    v_mfma_f32_16x16x32_bf16 v[224:227], a[56:59], v[84:87], v[224:227]
    buffer_load_dwordx4 v59, s[36:39], s92 offen offset:3072 lds
    v_mfma_f32_16x16x32_bf16 v[228:231], a[88:91], v[88:91], v[228:231]
    s_add_u32 s92, s92, 32768
    ds_read_b64_tr_b16 a[164:165], v65 offset:32768
    v_mfma_f32_16x16x32_bf16 v[228:231], a[56:59], v[92:95], v[228:231]
    v_mfma_f32_16x16x32_bf16 v[232:235], a[88:91], v[96:99], v[232:235]
    s_waitcnt lgkmcnt(2)
    s_add_u32 m0, s91, 16384
    ds_read_b64_tr_b16 a[168:169], v66 offset:32768
    v_mfma_f32_16x16x32_bf16 v[232:235], a[56:59], v[100:103], v[232:235]
    buffer_load_dwordx4 v56, s[36:39], s92 offen offset:0 lds
    v_mfma_f32_16x16x32_bf16 v[236:239], a[88:91], v[104:107], v[236:239]
    ds_read_b64_tr_b16 a[172:173], v67 offset:32768
    v_mfma_f32_16x16x32_bf16 v[236:239], a[56:59], v[108:111], v[236:239]
    v_mfma_f32_16x16x32_bf16 v[252:255], a[92:95], v[104:107], v[252:255]
    ds_read_b64_tr_b16 a[176:177], v68 offset:32768
    v_mfma_f32_16x16x32_bf16 v[252:255], a[60:63], v[108:111], v[252:255]
    buffer_load_dwordx4 v57, s[36:39], s92 offen offset:1024 lds
    v_mfma_f32_16x16x32_bf16 v[248:251], a[92:95], v[96:99], v[248:251]
    ds_read_b64_tr_b16 a[180:181], v69 offset:32768
    v_mfma_f32_16x16x32_bf16 v[248:251], a[60:63], v[100:103], v[248:251]
    v_mfma_f32_16x16x32_bf16 v[244:247], a[92:95], v[88:91], v[244:247]
    ds_read_b64_tr_b16 a[184:185], v70 offset:32768
    v_mfma_f32_16x16x32_bf16 v[244:247], a[60:63], v[92:95], v[244:247]
    buffer_load_dwordx4 v58, s[36:39], s92 offen offset:2048 lds
    v_mfma_f32_16x16x32_bf16 v[240:243], a[92:95], v[80:83], v[240:243]
    ds_read_b64_tr_b16 a[188:189], v71 offset:32768
    v_mfma_f32_16x16x32_bf16 v[240:243], a[60:63], v[84:87], v[240:243]
    s_waitcnt vmcnt(15) lgkmcnt(5)
    v_mfma_f32_16x16x32_bf16 v[128:131], a[128:131], v[24:27], v[128:131]
    ds_read_b64_tr_b16 a[162:163], v64 offset:49152
    v_mfma_f32_16x16x32_bf16 v[128:131], a[192:195], v[28:31], v[128:131]
    buffer_load_dwordx4 v59, s[36:39], s92 offen offset:3072 lds
    v_mfma_f32_16x16x32_bf16 v[132:135], a[128:131], v[32:35], v[132:135]
    s_add_u32 s92, s92, 229376
    ds_read_b64_tr_b16 a[166:167], v65 offset:49152
    v_mfma_f32_16x16x32_bf16 v[132:135], a[192:195], v[36:39], v[132:135]
    ds_read_b128 v[80:83], v20 offset:8192
    v_mfma_f32_16x16x32_bf16 v[136:139], a[128:131], v[40:43], v[136:139]
    s_waitcnt lgkmcnt(3)
    s_add_u32 m0, s91, 32768
    ds_read_b64_tr_b16 a[170:171], v66 offset:49152
    v_mfma_f32_16x16x32_bf16 v[136:139], a[192:195], v[44:47], v[136:139]
    buffer_load_dwordx4 v56, s[36:39], s92 offen offset:0 lds
    v_mfma_f32_16x16x32_bf16 v[140:143], a[128:131], v[48:51], v[140:143]
    ds_read_b64_tr_b16 a[174:175], v67 offset:49152
    v_mfma_f32_16x16x32_bf16 v[140:143], a[192:195], v[52:55], v[140:143]
    ds_read_b128 v[84:87], v21 offset:8192
    v_mfma_f32_16x16x32_bf16 v[156:159], a[132:135], v[48:51], v[156:159]
    ds_read_b64_tr_b16 a[178:179], v68 offset:49152
    v_mfma_f32_16x16x32_bf16 v[156:159], a[196:199], v[52:55], v[156:159]
    buffer_load_dwordx4 v57, s[36:39], s92 offen offset:1024 lds
    v_mfma_f32_16x16x32_bf16 v[152:155], a[132:135], v[40:43], v[152:155]
    ds_read_b64_tr_b16 a[182:183], v69 offset:49152
    v_mfma_f32_16x16x32_bf16 v[152:155], a[196:199], v[44:47], v[152:155]
    ds_read_b128 v[88:91], v20 offset:24576
    v_mfma_f32_16x16x32_bf16 v[148:151], a[132:135], v[32:35], v[148:151]
    ds_read_b64_tr_b16 a[186:187], v70 offset:49152
    v_mfma_f32_16x16x32_bf16 v[148:151], a[196:199], v[36:39], v[148:151]
    buffer_load_dwordx4 v58, s[36:39], s92 offen offset:2048 lds
    v_mfma_f32_16x16x32_bf16 v[144:147], a[132:135], v[24:27], v[144:147]
    ds_read_b64_tr_b16 a[190:191], v71 offset:49152
    v_mfma_f32_16x16x32_bf16 v[144:147], a[196:199], v[28:31], v[144:147]
    s_waitcnt vmcnt(15)
    ds_read_b128 v[92:95], v21 offset:24576
    v_mfma_f32_16x16x32_bf16 v[160:163], a[136:139], v[24:27], v[160:163]
    ds_read_b64_tr_b16 a[224:225], v72 offset:0
    v_mfma_f32_16x16x32_bf16 v[160:163], a[200:203], v[28:31], v[160:163]
    buffer_load_dwordx4 v59, s[36:39], s92 offen offset:3072 lds
    v_mfma_f32_16x16x32_bf16 v[164:167], a[136:139], v[32:35], v[164:167]
    s_add_u32 s92, s92, 32768
    ds_read_b64_tr_b16 a[228:229], v73 offset:0
    v_mfma_f32_16x16x32_bf16 v[164:167], a[200:203], v[36:39], v[164:167]
    ds_read_b128 v[96:99], v20 offset:40960
    v_mfma_f32_16x16x32_bf16 v[168:171], a[136:139], v[40:43], v[168:171]
    s_waitcnt lgkmcnt(4)
    s_add_u32 m0, s91, 49152
    ds_read_b64_tr_b16 a[232:233], v74 offset:0
    v_mfma_f32_16x16x32_bf16 v[168:171], a[200:203], v[44:47], v[168:171]
    buffer_load_dwordx4 v56, s[36:39], s92 offen offset:0 lds
    v_mfma_f32_16x16x32_bf16 v[172:175], a[136:139], v[48:51], v[172:175]
    ds_read_b64_tr_b16 a[236:237], v75 offset:0
    v_mfma_f32_16x16x32_bf16 v[172:175], a[200:203], v[52:55], v[172:175]
    ds_read_b128 v[100:103], v21 offset:40960
    v_mfma_f32_16x16x32_bf16 v[188:191], a[140:143], v[48:51], v[188:191]
    ds_read_b64_tr_b16 a[240:241], v76 offset:0
    v_mfma_f32_16x16x32_bf16 v[188:191], a[204:207], v[52:55], v[188:191]
    buffer_load_dwordx4 v57, s[36:39], s92 offen offset:1024 lds
    v_mfma_f32_16x16x32_bf16 v[184:187], a[140:143], v[40:43], v[184:187]
    ds_read_b64_tr_b16 a[244:245], v77 offset:0
    v_mfma_f32_16x16x32_bf16 v[184:187], a[204:207], v[44:47], v[184:187]
    ds_read_b128 v[104:107], v20 offset:57344
    v_mfma_f32_16x16x32_bf16 v[180:183], a[140:143], v[32:35], v[180:183]
    ds_read_b64_tr_b16 a[248:249], v78 offset:0
    v_mfma_f32_16x16x32_bf16 v[180:183], a[204:207], v[36:39], v[180:183]
    buffer_load_dwordx4 v58, s[36:39], s92 offen offset:2048 lds
    v_mfma_f32_16x16x32_bf16 v[176:179], a[140:143], v[24:27], v[176:179]
    ds_read_b64_tr_b16 a[252:253], v79 offset:0
    v_mfma_f32_16x16x32_bf16 v[176:179], a[204:207], v[28:31], v[176:179]
    s_waitcnt vmcnt(15)
    ds_read_b128 v[108:111], v21 offset:57344
    v_mfma_f32_16x16x32_bf16 v[192:195], a[144:147], v[24:27], v[192:195]
    ds_read_b64_tr_b16 a[226:227], v72 offset:16384
    v_mfma_f32_16x16x32_bf16 v[192:195], a[208:211], v[28:31], v[192:195]
    buffer_load_dwordx4 v59, s[36:39], s92 offen offset:3072 lds
    v_mfma_f32_16x16x32_bf16 v[196:199], a[144:147], v[32:35], v[196:199]
    s_add_u32 s92, s92, 229376
    ds_read_b64_tr_b16 a[230:231], v73 offset:16384
    v_mfma_f32_16x16x32_bf16 v[196:199], a[208:211], v[36:39], v[196:199]
    v_mfma_f32_16x16x32_bf16 v[200:203], a[144:147], v[40:43], v[200:203]
    s_waitcnt lgkmcnt(3)
    s_add_u32 m0, s91, 131072
    ds_read_b64_tr_b16 a[234:235], v74 offset:16384
    v_mfma_f32_16x16x32_bf16 v[200:203], a[208:211], v[44:47], v[200:203]
    s_branch L_ov3
L_pad3:
    s_setpc_b64 s[86:87]
L_ov3:
    buffer_load_dwordx4 v56, s[36:39], s92 offen offset:0 lds
    v_mfma_f32_16x16x32_bf16 v[204:207], a[144:147], v[48:51], v[204:207]
    ds_read_b64_tr_b16 a[238:239], v75 offset:16384
    v_mfma_f32_16x16x32_bf16 v[204:207], a[208:211], v[52:55], v[204:207]
    v_mfma_f32_16x16x32_bf16 v[220:223], a[148:151], v[48:51], v[220:223]
    ds_read_b64_tr_b16 a[242:243], v76 offset:16384
    v_mfma_f32_16x16x32_bf16 v[220:223], a[212:215], v[52:55], v[220:223]
    buffer_load_dwordx4 v57, s[36:39], s92 offen offset:1024 lds
    v_mfma_f32_16x16x32_bf16 v[216:219], a[148:151], v[40:43], v[216:219]
    ds_read_b64_tr_b16 a[246:247], v77 offset:16384
    v_mfma_f32_16x16x32_bf16 v[216:219], a[212:215], v[44:47], v[216:219]
    v_mfma_f32_16x16x32_bf16 v[212:215], a[148:151], v[32:35], v[212:215]
    ds_read_b64_tr_b16 a[250:251], v78 offset:16384
    v_mfma_f32_16x16x32_bf16 v[212:215], a[212:215], v[36:39], v[212:215]
    buffer_load_dwordx4 v58, s[36:39], s92 offen offset:2048 lds
    v_mfma_f32_16x16x32_bf16 v[208:211], a[148:151], v[24:27], v[208:211]
    ds_read_b64_tr_b16 a[254:255], v79 offset:16384
    v_mfma_f32_16x16x32_bf16 v[208:211], a[212:215], v[28:31], v[208:211]
    s_waitcnt vmcnt(15)
    v_mfma_f32_16x16x32_bf16 v[224:227], a[152:155], v[24:27], v[224:227]
    ds_read_b64_tr_b16 a[64:65], v64 offset:0
    v_mfma_f32_16x16x32_bf16 v[224:227], a[216:219], v[28:31], v[224:227]
    buffer_load_dwordx4 v59, s[36:39], s92 offen offset:3072 lds
    v_mfma_f32_16x16x32_bf16 v[228:231], a[152:155], v[32:35], v[228:231]
    s_add_u32 s92, s92, 32768
    ds_read_b64_tr_b16 a[68:69], v65 offset:0
    v_mfma_f32_16x16x32_bf16 v[228:231], a[216:219], v[36:39], v[228:231]
    v_mfma_f32_16x16x32_bf16 v[232:235], a[152:155], v[40:43], v[232:235]
    s_waitcnt lgkmcnt(2)
    s_add_u32 m0, s91, 147456
    ds_read_b64_tr_b16 a[72:73], v66 offset:0
    v_mfma_f32_16x16x32_bf16 v[232:235], a[216:219], v[44:47], v[232:235]
    buffer_load_dwordx4 v56, s[36:39], s92 offen offset:0 lds
    v_mfma_f32_16x16x32_bf16 v[236:239], a[152:155], v[48:51], v[236:239]
    ds_read_b64_tr_b16 a[76:77], v67 offset:0
    v_mfma_f32_16x16x32_bf16 v[236:239], a[216:219], v[52:55], v[236:239]
    v_mfma_f32_16x16x32_bf16 v[252:255], a[156:159], v[48:51], v[252:255]
    ds_read_b64_tr_b16 a[80:81], v68 offset:0
    v_mfma_f32_16x16x32_bf16 v[252:255], a[220:223], v[52:55], v[252:255]
    buffer_load_dwordx4 v57, s[36:39], s92 offen offset:1024 lds
    v_mfma_f32_16x16x32_bf16 v[248:251], a[156:159], v[40:43], v[248:251]
    ds_read_b64_tr_b16 a[84:85], v69 offset:0
    v_mfma_f32_16x16x32_bf16 v[248:251], a[220:223], v[44:47], v[248:251]
    v_mfma_f32_16x16x32_bf16 v[244:247], a[156:159], v[32:35], v[244:247]
    ds_read_b64_tr_b16 a[88:89], v70 offset:0
    v_mfma_f32_16x16x32_bf16 v[244:247], a[220:223], v[36:39], v[244:247]
    buffer_load_dwordx4 v58, s[36:39], s92 offen offset:2048 lds
    v_mfma_f32_16x16x32_bf16 v[240:243], a[156:159], v[24:27], v[240:243]
    ds_read_b64_tr_b16 a[92:93], v71 offset:0
    v_mfma_f32_16x16x32_bf16 v[240:243], a[220:223], v[28:31], v[240:243]
    s_waitcnt lgkmcnt(5)
    v_mfma_f32_16x16x32_bf16 v[128:131], a[160:163], v[80:83], v[128:131]
    v_mfma_f32_16x16x32_bf16 v[128:131], a[224:227], v[84:87], v[128:131]
    buffer_load_dwordx4 v59, s[36:39], s92 offen offset:3072 lds
    v_mfma_f32_16x16x32_bf16 v[132:135], a[160:163], v[88:91], v[132:135]
    s_add_u32 s92, s92, 229376
    v_mfma_f32_16x16x32_bf16 v[132:135], a[224:227], v[92:95], v[132:135]
    ds_read_b128 v[24:27], v20 offset:10240
    v_mfma_f32_16x16x32_bf16 v[136:139], a[160:163], v[96:99], v[136:139]
    s_waitcnt lgkmcnt(1)
    s_add_u32 m0, s91, 0
    v_mfma_f32_16x16x32_bf16 v[136:139], a[224:227], v[100:103], v[136:139]
    buffer_load_dwordx4 v56, s[36:39], s92 offen offset:0 lds
    v_mfma_f32_16x16x32_bf16 v[140:143], a[160:163], v[104:107], v[140:143]
    v_mfma_f32_16x16x32_bf16 v[140:143], a[224:227], v[108:111], v[140:143]
    ds_read_b128 v[28:31], v21 offset:10240
    v_mfma_f32_16x16x32_bf16 v[156:159], a[164:167], v[104:107], v[156:159]
    v_mfma_f32_16x16x32_bf16 v[156:159], a[228:231], v[108:111], v[156:159]
    buffer_load_dwordx4 v57, s[36:39], s92 offen offset:1024 lds
    v_mfma_f32_16x16x32_bf16 v[152:155], a[164:167], v[96:99], v[152:155]
    v_mfma_f32_16x16x32_bf16 v[152:155], a[228:231], v[100:103], v[152:155]
    ds_read_b128 v[32:35], v20 offset:26624
    v_mfma_f32_16x16x32_bf16 v[148:151], a[164:167], v[88:91], v[148:151]
    v_mfma_f32_16x16x32_bf16 v[148:151], a[228:231], v[92:95], v[148:151]
    buffer_load_dwordx4 v58, s[36:39], s92 offen offset:2048 lds
    v_mfma_f32_16x16x32_bf16 v[144:147], a[164:167], v[80:83], v[144:147]
    v_mfma_f32_16x16x32_bf16 v[144:147], a[228:231], v[84:87], v[144:147]
    s_waitcnt vmcnt(19)
    ds_read_b128 v[36:39], v21 offset:26624
    v_mfma_f32_16x16x32_bf16 v[160:163], a[168:171], v[80:83], v[160:163]
    ds_read_b64_tr_b16 a[66:67], v64 offset:16384
    v_mfma_f32_16x16x32_bf16 v[160:163], a[232:235], v[84:87], v[160:163]
    buffer_load_dwordx4 v59, s[36:39], s92 offen offset:3072 lds
    v_mfma_f32_16x16x32_bf16 v[164:167], a[168:171], v[88:91], v[164:167]
    s_add_u32 s92, s92, 32768
    ds_read_b64_tr_b16 a[70:71], v65 offset:16384
    v_mfma_f32_16x16x32_bf16 v[164:167], a[232:235], v[92:95], v[164:167]
    ds_read_b128 v[40:43], v20 offset:43008
    v_mfma_f32_16x16x32_bf16 v[168:171], a[168:171], v[96:99], v[168:171]
    ds_read_b64_tr_b16 a[74:75], v66 offset:16384
    v_mfma_f32_16x16x32_bf16 v[168:171], a[232:235], v[100:103], v[168:171]
    v_mfma_f32_16x16x32_bf16 v[172:175], a[168:171], v[104:107], v[172:175]
    ds_read_b64_tr_b16 a[78:79], v67 offset:16384
    v_mfma_f32_16x16x32_bf16 v[172:175], a[232:235], v[108:111], v[172:175]
    ds_read_b128 v[44:47], v21 offset:43008
    v_mfma_f32_16x16x32_bf16 v[188:191], a[172:175], v[104:107], v[188:191]
    ds_read_b64_tr_b16 a[82:83], v68 offset:16384
    v_mfma_f32_16x16x32_bf16 v[188:191], a[236:239], v[108:111], v[188:191]
    v_mfma_f32_16x16x32_bf16 v[184:187], a[172:175], v[96:99], v[184:187]
    ds_read_b64_tr_b16 a[86:87], v69 offset:16384
    v_mfma_f32_16x16x32_bf16 v[184:187], a[236:239], v[100:103], v[184:187]
    ds_read_b128 v[48:51], v20 offset:59392
    v_mfma_f32_16x16x32_bf16 v[180:183], a[172:175], v[88:91], v[180:183]
    ds_read_b64_tr_b16 a[90:91], v70 offset:16384
    v_mfma_f32_16x16x32_bf16 v[180:183], a[236:239], v[92:95], v[180:183]
    v_mfma_f32_16x16x32_bf16 v[176:179], a[172:175], v[80:83], v[176:179]
    ds_read_b64_tr_b16 a[94:95], v71 offset:16384
    v_mfma_f32_16x16x32_bf16 v[176:179], a[236:239], v[84:87], v[176:179]
    s_waitcnt vmcnt(16)
    ds_read_b128 v[52:55], v21 offset:59392
    v_mfma_f32_16x16x32_bf16 v[192:195], a[176:179], v[80:83], v[192:195]
    ds_read_b64_tr_b16 a[32:33], v64 offset:32768
    v_mfma_f32_16x16x32_bf16 v[192:195], a[240:243], v[84:87], v[192:195]
    v_mfma_f32_16x16x32_bf16 v[196:199], a[176:179], v[88:91], v[196:199]
    ds_read_b64_tr_b16 a[36:37], v65 offset:32768
    v_mfma_f32_16x16x32_bf16 v[196:199], a[240:243], v[92:95], v[196:199]
    v_mfma_f32_16x16x32_bf16 v[200:203], a[176:179], v[96:99], v[200:203]
    s_waitcnt lgkmcnt(3)
    s_add_u32 m0, s91, 16384
    ds_read_b64_tr_b16 a[40:41], v66 offset:32768
    v_mfma_f32_16x16x32_bf16 v[200:203], a[240:243], v[100:103], v[200:203]
    buffer_load_dwordx4 v56, s[36:39], s92 offen offset:0 lds
    v_mfma_f32_16x16x32_bf16 v[204:207], a[176:179], v[104:107], v[204:207]
    ds_read_b64_tr_b16 a[44:45], v67 offset:32768
    v_mfma_f32_16x16x32_bf16 v[204:207], a[240:243], v[108:111], v[204:207]
    v_mfma_f32_16x16x32_bf16 v[220:223], a[180:183], v[104:107], v[220:223]
    ds_read_b64_tr_b16 a[48:49], v68 offset:32768
    v_mfma_f32_16x16x32_bf16 v[220:223], a[244:247], v[108:111], v[220:223]
    buffer_load_dwordx4 v57, s[36:39], s92 offen offset:1024 lds
    v_mfma_f32_16x16x32_bf16 v[216:219], a[180:183], v[96:99], v[216:219]
    ds_read_b64_tr_b16 a[52:53], v69 offset:32768
    v_mfma_f32_16x16x32_bf16 v[216:219], a[244:247], v[100:103], v[216:219]
    v_mfma_f32_16x16x32_bf16 v[212:215], a[180:183], v[88:91], v[212:215]
    ds_read_b64_tr_b16 a[56:57], v70 offset:32768
    v_mfma_f32_16x16x32_bf16 v[212:215], a[244:247], v[92:95], v[212:215]
    buffer_load_dwordx4 v58, s[36:39], s92 offen offset:2048 lds
    v_mfma_f32_16x16x32_bf16 v[208:211], a[180:183], v[80:83], v[208:211]
    ds_read_b64_tr_b16 a[60:61], v71 offset:32768
    v_mfma_f32_16x16x32_bf16 v[208:211], a[244:247], v[84:87], v[208:211]
    s_waitcnt vmcnt(15)
    v_mfma_f32_16x16x32_bf16 v[224:227], a[184:187], v[80:83], v[224:227]
    ds_read_b64_tr_b16 a[34:35], v64 offset:49152
    v_mfma_f32_16x16x32_bf16 v[224:227], a[248:251], v[84:87], v[224:227]
    buffer_load_dwordx4 v59, s[36:39], s92 offen offset:3072 lds
    v_mfma_f32_16x16x32_bf16 v[228:231], a[184:187], v[88:91], v[228:231]
    s_add_u32 s92, s92, 229376
    ds_read_b64_tr_b16 a[38:39], v65 offset:49152
    v_mfma_f32_16x16x32_bf16 v[228:231], a[248:251], v[92:95], v[228:231]
    v_mfma_f32_16x16x32_bf16 v[232:235], a[184:187], v[96:99], v[232:235]
    s_waitcnt lgkmcnt(2)
    s_add_u32 m0, s91, 32768
    ds_read_b64_tr_b16 a[42:43], v66 offset:49152
    v_mfma_f32_16x16x32_bf16 v[232:235], a[248:251], v[100:103], v[232:235]
    buffer_load_dwordx4 v56, s[36:39], s92 offen offset:0 lds
    v_mfma_f32_16x16x32_bf16 v[236:239], a[184:187], v[104:107], v[236:239]
    ds_read_b64_tr_b16 a[46:47], v67 offset:49152
    v_mfma_f32_16x16x32_bf16 v[236:239], a[248:251], v[108:111], v[236:239]
    v_mfma_f32_16x16x32_bf16 v[252:255], a[188:191], v[104:107], v[252:255]
    ds_read_b64_tr_b16 a[50:51], v68 offset:49152
    v_mfma_f32_16x16x32_bf16 v[252:255], a[252:255], v[108:111], v[252:255]
    buffer_load_dwordx4 v57, s[36:39], s92 offen offset:1024 lds
    v_mfma_f32_16x16x32_bf16 v[248:251], a[188:191], v[96:99], v[248:251]
    ds_read_b64_tr_b16 a[54:55], v69 offset:49152
    v_mfma_f32_16x16x32_bf16 v[248:251], a[252:255], v[100:103], v[248:251]
    v_mfma_f32_16x16x32_bf16 v[244:247], a[188:191], v[88:91], v[244:247]
    ds_read_b64_tr_b16 a[58:59], v70 offset:49152
    v_mfma_f32_16x16x32_bf16 v[244:247], a[252:255], v[92:95], v[244:247]
    buffer_load_dwordx4 v58, s[36:39], s92 offen offset:2048 lds
    v_mfma_f32_16x16x32_bf16 v[240:243], a[188:191], v[80:83], v[240:243]
    ds_read_b64_tr_b16 a[62:63], v71 offset:49152
    v_mfma_f32_16x16x32_bf16 v[240:243], a[252:255], v[84:87], v[240:243]
    s_waitcnt vmcnt(15) lgkmcnt(5)
    v_mfma_f32_16x16x32_bf16 v[128:131], a[64:67], v[24:27], v[128:131]
    ds_read_b64_tr_b16 a[128:129], v72 offset:0
    v_mfma_f32_16x16x32_bf16 v[128:131], a[32:35], v[28:31], v[128:131]
    buffer_load_dwordx4 v59, s[36:39], s92 offen offset:3072 lds
    v_mfma_f32_16x16x32_bf16 v[132:135], a[64:67], v[32:35], v[132:135]
    s_add_u32 s92, s92, 32768
    ds_read_b64_tr_b16 a[132:133], v73 offset:0
    v_mfma_f32_16x16x32_bf16 v[132:135], a[32:35], v[36:39], v[132:135]
    ds_read_b128 v[80:83], v20 offset:12288
    v_mfma_f32_16x16x32_bf16 v[136:139], a[64:67], v[40:43], v[136:139]
    s_waitcnt lgkmcnt(3)
    s_add_u32 m0, s91, 49152
    ds_read_b64_tr_b16 a[136:137], v74 offset:0
    v_mfma_f32_16x16x32_bf16 v[136:139], a[32:35], v[44:47], v[136:139]
    buffer_load_dwordx4 v56, s[36:39], s92 offen offset:0 lds
    v_mfma_f32_16x16x32_bf16 v[140:143], a[64:67], v[48:51], v[140:143]
    ds_read_b64_tr_b16 a[140:141], v75 offset:0
    v_mfma_f32_16x16x32_bf16 v[140:143], a[32:35], v[52:55], v[140:143]
    ds_read_b128 v[84:87], v21 offset:12288
    v_mfma_f32_16x16x32_bf16 v[156:159], a[68:71], v[48:51], v[156:159]
    ds_read_b64_tr_b16 a[144:145], v76 offset:0
    v_mfma_f32_16x16x32_bf16 v[156:159], a[36:39], v[52:55], v[156:159]
    buffer_load_dwordx4 v57, s[36:39], s92 offen offset:1024 lds
    v_mfma_f32_16x16x32_bf16 v[152:155], a[68:71], v[40:43], v[152:155]
    ds_read_b64_tr_b16 a[148:149], v77 offset:0
    v_mfma_f32_16x16x32_bf16 v[152:155], a[36:39], v[44:47], v[152:155]
    ds_read_b128 v[88:91], v20 offset:28672
    v_mfma_f32_16x16x32_bf16 v[148:151], a[68:71], v[32:35], v[148:151]
    ds_read_b64_tr_b16 a[152:153], v78 offset:0
    v_mfma_f32_16x16x32_bf16 v[148:151], a[36:39], v[36:39], v[148:151]
    buffer_load_dwordx4 v58, s[36:39], s92 offen offset:2048 lds
    v_mfma_f32_16x16x32_bf16 v[144:147], a[68:71], v[24:27], v[144:147]
    ds_read_b64_tr_b16 a[156:157], v79 offset:0
    v_mfma_f32_16x16x32_bf16 v[144:147], a[36:39], v[28:31], v[144:147]
    s_waitcnt vmcnt(15)
    ds_read_b128 v[92:95], v21 offset:28672
    v_mfma_f32_16x16x32_bf16 v[160:163], a[72:75], v[24:27], v[160:163]
    ds_read_b64_tr_b16 a[130:131], v72 offset:16384
    v_mfma_f32_16x16x32_bf16 v[160:163], a[40:43], v[28:31], v[160:163]
    buffer_load_dwordx4 v59, s[36:39], s92 offen offset:3072 lds
    v_mfma_f32_16x16x32_bf16 v[164:167], a[72:75], v[32:35], v[164:167]
    s_add_u32 s92, s92, 229376
    ds_read_b64_tr_b16 a[134:135], v73 offset:16384
    v_mfma_f32_16x16x32_bf16 v[164:167], a[40:43], v[36:39], v[164:167]
    ds_read_b128 v[96:99], v20 offset:45056
    v_mfma_f32_16x16x32_bf16 v[168:171], a[72:75], v[40:43], v[168:171]
    s_waitcnt lgkmcnt(4)
    s_add_u32 m0, s91, 131072
    ds_read_b64_tr_b16 a[138:139], v74 offset:16384
    v_mfma_f32_16x16x32_bf16 v[168:171], a[40:43], v[44:47], v[168:171]
    buffer_load_dwordx4 v56, s[36:39], s92 offen offset:0 lds
    v_mfma_f32_16x16x32_bf16 v[172:175], a[72:75], v[48:51], v[172:175]
    ds_read_b64_tr_b16 a[142:143], v75 offset:16384
    v_mfma_f32_16x16x32_bf16 v[172:175], a[40:43], v[52:55], v[172:175]
    ds_read_b128 v[100:103], v21 offset:45056
    v_mfma_f32_16x16x32_bf16 v[188:191], a[76:79], v[48:51], v[188:191]
    ds_read_b64_tr_b16 a[146:147], v76 offset:16384
    v_mfma_f32_16x16x32_bf16 v[188:191], a[44:47], v[52:55], v[188:191]
    buffer_load_dwordx4 v57, s[36:39], s92 offen offset:1024 lds
    v_mfma_f32_16x16x32_bf16 v[184:187], a[76:79], v[40:43], v[184:187]
    ds_read_b64_tr_b16 a[150:151], v77 offset:16384
    v_mfma_f32_16x16x32_bf16 v[184:187], a[44:47], v[44:47], v[184:187]
    ds_read_b128 v[104:107], v20 offset:61440
    v_mfma_f32_16x16x32_bf16 v[180:183], a[76:79], v[32:35], v[180:183]
    ds_read_b64_tr_b16 a[154:155], v78 offset:16384
    v_mfma_f32_16x16x32_bf16 v[180:183], a[44:47], v[36:39], v[180:183]
    buffer_load_dwordx4 v58, s[36:39], s92 offen offset:2048 lds
    v_mfma_f32_16x16x32_bf16 v[176:179], a[76:79], v[24:27], v[176:179]
    ds_read_b64_tr_b16 a[158:159], v79 offset:16384
    v_mfma_f32_16x16x32_bf16 v[176:179], a[44:47], v[28:31], v[176:179]
    s_waitcnt vmcnt(15)
    ds_read_b128 v[108:111], v21 offset:61440
    v_mfma_f32_16x16x32_bf16 v[192:195], a[80:83], v[24:27], v[192:195]
    ds_read_b64_tr_b16 a[192:193], v64 offset:0
    v_mfma_f32_16x16x32_bf16 v[192:195], a[48:51], v[28:31], v[192:195]
    buffer_load_dwordx4 v59, s[36:39], s92 offen offset:3072 lds
    v_mfma_f32_16x16x32_bf16 v[196:199], a[80:83], v[32:35], v[196:199]
    s_add_u32 s92, s92, 32768
    ds_read_b64_tr_b16 a[196:197], v65 offset:0
    v_mfma_f32_16x16x32_bf16 v[196:199], a[48:51], v[36:39], v[196:199]
    v_mfma_f32_16x16x32_bf16 v[200:203], a[80:83], v[40:43], v[200:203]
    s_waitcnt lgkmcnt(3)
    s_add_u32 m0, s91, 147456
    ds_read_b64_tr_b16 a[200:201], v66 offset:0
    v_mfma_f32_16x16x32_bf16 v[200:203], a[48:51], v[44:47], v[200:203]
    buffer_load_dwordx4 v56, s[36:39], s92 offen offset:0 lds
    v_mfma_f32_16x16x32_bf16 v[204:207], a[80:83], v[48:51], v[204:207]
    ds_read_b64_tr_b16 a[204:205], v67 offset:0
    v_mfma_f32_16x16x32_bf16 v[204:207], a[48:51], v[52:55], v[204:207]
    v_mfma_f32_16x16x32_bf16 v[220:223], a[84:87], v[48:51], v[220:223]
    ds_read_b64_tr_b16 a[208:209], v68 offset:0
    v_mfma_f32_16x16x32_bf16 v[220:223], a[52:55], v[52:55], v[220:223]
    buffer_load_dwordx4 v57, s[36:39], s92 offen offset:1024 lds
    v_mfma_f32_16x16x32_bf16 v[216:219], a[84:87], v[40:43], v[216:219]
    ds_read_b64_tr_b16 a[212:213], v69 offset:0
    v_mfma_f32_16x16x32_bf16 v[216:219], a[52:55], v[44:47], v[216:219]
    v_mfma_f32_16x16x32_bf16 v[212:215], a[84:87], v[32:35], v[212:215]
    ds_read_b64_tr_b16 a[216:217], v70 offset:0
    v_mfma_f32_16x16x32_bf16 v[212:215], a[52:55], v[36:39], v[212:215]
    buffer_load_dwordx4 v58, s[36:39], s92 offen offset:2048 lds
    v_mfma_f32_16x16x32_bf16 v[208:211], a[84:87], v[24:27], v[208:211]
    ds_read_b64_tr_b16 a[220:221], v71 offset:0
    v_mfma_f32_16x16x32_bf16 v[208:211], a[52:55], v[28:31], v[208:211]
    s_waitcnt vmcnt(15)
    v_mfma_f32_16x16x32_bf16 v[224:227], a[88:91], v[24:27], v[224:227]
    ds_read_b64_tr_b16 a[194:195], v64 offset:16384
    v_mfma_f32_16x16x32_bf16 v[224:227], a[56:59], v[28:31], v[224:227]
    buffer_load_dwordx4 v59, s[36:39], s92 offen offset:3072 lds
    v_mfma_f32_16x16x32_bf16 v[228:231], a[88:91], v[32:35], v[228:231]
    s_add_u32 s92, s92, 229376
    ds_read_b64_tr_b16 a[198:199], v65 offset:16384
    v_mfma_f32_16x16x32_bf16 v[228:231], a[56:59], v[36:39], v[228:231]
    v_mfma_f32_16x16x32_bf16 v[232:235], a[88:91], v[40:43], v[232:235]
    s_waitcnt lgkmcnt(2)
    s_add_u32 s81, s81, 16384
    s_and_b32 s81, s81, 0x7ffff
    s_add_u32 s82, s82, 32768
    s_sub_u32 s92, s82, 163840
    s_min_u32 s82, s82, s92
    s_add_u32 m0, s82, 0
    s_add_u32 s92, s81, 2880
    ds_read_b64_tr_b16 a[202:203], v66 offset:16384
    v_mfma_f32_16x16x32_bf16 v[232:235], a[56:59], v[44:47], v[232:235]
    buffer_load_dwordx4 v15, s[20:23], s92 offen offset:0  lds
    v_mfma_f32_16x16x32_bf16 v[236:239], a[88:91], v[48:51], v[236:239]
    ds_read_b64_tr_b16 a[206:207], v67 offset:16384
    v_mfma_f32_16x16x32_bf16 v[236:239], a[56:59], v[52:55], v[236:239]
    v_mfma_f32_16x16x32_bf16 v[252:255], a[92:95], v[48:51], v[252:255]
    s_add_u32 s92, s81, 1920
    ds_read_b64_tr_b16 a[210:211], v68 offset:16384
    v_mfma_f32_16x16x32_bf16 v[252:255], a[60:63], v[52:55], v[252:255]
    buffer_load_dwordx4 v15, s[20:23], s92 offen offset:1024  lds
    v_mfma_f32_16x16x32_bf16 v[248:251], a[92:95], v[40:43], v[248:251]
    ds_read_b64_tr_b16 a[214:215], v69 offset:16384
    v_mfma_f32_16x16x32_bf16 v[248:251], a[60:63], v[44:47], v[248:251]
    v_mfma_f32_16x16x32_bf16 v[244:247], a[92:95], v[32:35], v[244:247]
    s_add_u32 s92, s81, 960
    ds_read_b64_tr_b16 a[218:219], v70 offset:16384
    v_mfma_f32_16x16x32_bf16 v[244:247], a[60:63], v[36:39], v[244:247]
    buffer_load_dwordx4 v15, s[20:23], s92 offen offset:2048  lds
    v_mfma_f32_16x16x32_bf16 v[240:243], a[92:95], v[24:27], v[240:243]
    ds_read_b64_tr_b16 a[222:223], v71 offset:16384
    v_mfma_f32_16x16x32_bf16 v[240:243], a[60:63], v[28:31], v[240:243]
    s_waitcnt vmcnt(15) lgkmcnt(5)
    v_mfma_f32_16x16x32_bf16 v[128:131], a[128:131], v[80:83], v[128:131]
    s_add_u32 s92, s81, 0
    ds_read_b64_tr_b16 a[160:161], v64 offset:32768
    v_mfma_f32_16x16x32_bf16 v[128:131], a[192:195], v[84:87], v[128:131]
    buffer_load_dwordx4 v15, s[20:23], s92 offen offset:3072  lds
    v_mfma_f32_16x16x32_bf16 v[132:135], a[128:131], v[88:91], v[132:135]
    ds_read_b64_tr_b16 a[164:165], v65 offset:32768
    v_mfma_f32_16x16x32_bf16 v[132:135], a[192:195], v[92:95], v[132:135]
    ds_read_b128 v[24:27], v20 offset:14336
    v_mfma_f32_16x16x32_bf16 v[136:139], a[128:131], v[96:99], v[136:139]
    s_waitcnt lgkmcnt(3)
    s_add_u32 m0, s82, 16384
    s_add_u32 s92, s81, 2880
    ds_read_b64_tr_b16 a[168:169], v66 offset:32768
    v_mfma_f32_16x16x32_bf16 v[136:139], a[192:195], v[100:103], v[136:139]
    buffer_load_dwordx4 v15, s[24:27], s92 offen offset:0  lds
    v_mfma_f32_16x16x32_bf16 v[140:143], a[128:131], v[104:107], v[140:143]
    ds_read_b64_tr_b16 a[172:173], v67 offset:32768
    v_mfma_f32_16x16x32_bf16 v[140:143], a[192:195], v[108:111], v[140:143]
    ds_read_b128 v[28:31], v21 offset:14336
    v_mfma_f32_16x16x32_bf16 v[156:159], a[132:135], v[104:107], v[156:159]
    s_add_u32 s92, s81, 1920
    ds_read_b64_tr_b16 a[176:177], v68 offset:32768
    v_mfma_f32_16x16x32_bf16 v[156:159], a[196:199], v[108:111], v[156:159]
    buffer_load_dwordx4 v15, s[24:27], s92 offen offset:1024  lds
    v_mfma_f32_16x16x32_bf16 v[152:155], a[132:135], v[96:99], v[152:155]
    ds_read_b64_tr_b16 a[180:181], v69 offset:32768
    v_mfma_f32_16x16x32_bf16 v[152:155], a[196:199], v[100:103], v[152:155]
    ds_read_b128 v[32:35], v20 offset:30720
    v_mfma_f32_16x16x32_bf16 v[148:151], a[132:135], v[88:91], v[148:151]
    s_add_u32 s92, s81, 960
    ds_read_b64_tr_b16 a[184:185], v70 offset:32768
    v_mfma_f32_16x16x32_bf16 v[148:151], a[196:199], v[92:95], v[148:151]
    buffer_load_dwordx4 v15, s[24:27], s92 offen offset:2048  lds
    v_mfma_f32_16x16x32_bf16 v[144:147], a[132:135], v[80:83], v[144:147]
    ds_read_b64_tr_b16 a[188:189], v71 offset:32768
    v_mfma_f32_16x16x32_bf16 v[144:147], a[196:199], v[84:87], v[144:147]
    s_waitcnt vmcnt(15)
    ds_read_b128 v[36:39], v21 offset:30720
    v_mfma_f32_16x16x32_bf16 v[160:163], a[136:139], v[80:83], v[160:163]
    s_add_u32 s92, s81, 0
    ds_read_b64_tr_b16 a[162:163], v64 offset:49152
    v_mfma_f32_16x16x32_bf16 v[160:163], a[200:203], v[84:87], v[160:163]
    buffer_load_dwordx4 v15, s[24:27], s92 offen offset:3072  lds
    v_mfma_f32_16x16x32_bf16 v[164:167], a[136:139], v[88:91], v[164:167]
    ds_read_b64_tr_b16 a[166:167], v65 offset:49152
    v_mfma_f32_16x16x32_bf16 v[164:167], a[200:203], v[92:95], v[164:167]
    ds_read_b128 v[40:43], v20 offset:47104
    v_mfma_f32_16x16x32_bf16 v[168:171], a[136:139], v[96:99], v[168:171]
    s_waitcnt lgkmcnt(4)
    s_add_u32 s81, s81, 16384
    s_and_b32 s81, s81, 0x7ffff
    s_add_u32 s82, s82, 32768
    s_sub_u32 s92, s82, 163840
    s_min_u32 s82, s82, s92
    s_add_u32 m0, s82, 0
    s_add_u32 s92, s81, 2880
    ds_read_b64_tr_b16 a[170:171], v66 offset:49152
    v_mfma_f32_16x16x32_bf16 v[168:171], a[200:203], v[100:103], v[168:171]
    buffer_load_dwordx4 v15, s[20:23], s92 offen offset:0  lds
    v_mfma_f32_16x16x32_bf16 v[172:175], a[136:139], v[104:107], v[172:175]
    ds_read_b64_tr_b16 a[174:175], v67 offset:49152
    v_mfma_f32_16x16x32_bf16 v[172:175], a[200:203], v[108:111], v[172:175]
    ds_read_b128 v[44:47], v21 offset:47104
    v_mfma_f32_16x16x32_bf16 v[188:191], a[140:143], v[104:107], v[188:191]
    s_add_u32 s92, s81, 1920
    ds_read_b64_tr_b16 a[178:179], v68 offset:49152
    v_mfma_f32_16x16x32_bf16 v[188:191], a[204:207], v[108:111], v[188:191]
    buffer_load_dwordx4 v15, s[20:23], s92 offen offset:1024  lds
    v_mfma_f32_16x16x32_bf16 v[184:187], a[140:143], v[96:99], v[184:187]
    ds_read_b64_tr_b16 a[182:183], v69 offset:49152
    v_mfma_f32_16x16x32_bf16 v[184:187], a[204:207], v[100:103], v[184:187]
    ds_read_b128 v[48:51], v20 offset:63488
    v_mfma_f32_16x16x32_bf16 v[180:183], a[140:143], v[88:91], v[180:183]
    s_add_u32 s92, s81, 960
    ds_read_b64_tr_b16 a[186:187], v70 offset:49152
    v_mfma_f32_16x16x32_bf16 v[180:183], a[204:207], v[92:95], v[180:183]
    buffer_load_dwordx4 v15, s[20:23], s92 offen offset:2048  lds
    v_mfma_f32_16x16x32_bf16 v[176:179], a[140:143], v[80:83], v[176:179]
    ds_read_b64_tr_b16 a[190:191], v71 offset:49152
    v_mfma_f32_16x16x32_bf16 v[176:179], a[204:207], v[84:87], v[176:179]
    s_waitcnt vmcnt(15)
    ds_read_b128 v[52:55], v21 offset:63488
    v_mfma_f32_16x16x32_bf16 v[192:195], a[144:147], v[80:83], v[192:195]
    s_add_u32 s92, s81, 0
    ds_read_b64_tr_b16 a[224:225], v72 offset:0
    v_mfma_f32_16x16x32_bf16 v[192:195], a[208:211], v[84:87], v[192:195]
    buffer_load_dwordx4 v15, s[20:23], s92 offen offset:3072  lds
    v_mfma_f32_16x16x32_bf16 v[196:199], a[144:147], v[88:91], v[196:199]
    ds_read_b64_tr_b16 a[228:229], v73 offset:0
    v_mfma_f32_16x16x32_bf16 v[196:199], a[208:211], v[92:95], v[196:199]
    v_mfma_f32_16x16x32_bf16 v[200:203], a[144:147], v[96:99], v[200:203]
    s_waitcnt lgkmcnt(3)
    s_add_u32 m0, s82, 16384
    s_add_u32 s92, s81, 2880
    ds_read_b64_tr_b16 a[232:233], v74 offset:0
    v_mfma_f32_16x16x32_bf16 v[200:203], a[208:211], v[100:103], v[200:203]
    buffer_load_dwordx4 v15, s[24:27], s92 offen offset:0  lds
    v_mfma_f32_16x16x32_bf16 v[204:207], a[144:147], v[104:107], v[204:207]
    ds_read_b64_tr_b16 a[236:237], v75 offset:0
    v_mfma_f32_16x16x32_bf16 v[204:207], a[208:211], v[108:111], v[204:207]
    v_mfma_f32_16x16x32_bf16 v[220:223], a[148:151], v[104:107], v[220:223]
    s_add_u32 s92, s81, 1920
    ds_read_b64_tr_b16 a[240:241], v76 offset:0
    v_mfma_f32_16x16x32_bf16 v[220:223], a[212:215], v[108:111], v[220:223]
    buffer_load_dwordx4 v15, s[24:27], s92 offen offset:1024  lds
    v_mfma_f32_16x16x32_bf16 v[216:219], a[148:151], v[96:99], v[216:219]
    ds_read_b64_tr_b16 a[244:245], v77 offset:0
    v_mfma_f32_16x16x32_bf16 v[216:219], a[212:215], v[100:103], v[216:219]
    v_mfma_f32_16x16x32_bf16 v[212:215], a[148:151], v[88:91], v[212:215]
    s_add_u32 s92, s81, 960
    ds_read_b64_tr_b16 a[248:249], v78 offset:0
    v_mfma_f32_16x16x32_bf16 v[212:215], a[212:215], v[92:95], v[212:215]
    buffer_load_dwordx4 v15, s[24:27], s92 offen offset:2048  lds
    v_mfma_f32_16x16x32_bf16 v[208:211], a[148:151], v[80:83], v[208:211]
    ds_read_b64_tr_b16 a[252:253], v79 offset:0
    v_mfma_f32_16x16x32_bf16 v[208:211], a[212:215], v[84:87], v[208:211]
    s_waitcnt vmcnt(15)
    v_mfma_f32_16x16x32_bf16 v[224:227], a[152:155], v[80:83], v[224:227]
    s_add_u32 s92, s81, 0
    ds_read_b64_tr_b16 a[226:227], v72 offset:16384
    v_mfma_f32_16x16x32_bf16 v[224:227], a[216:219], v[84:87], v[224:227]
    buffer_load_dwordx4 v15, s[24:27], s92 offen offset:3072  lds
    v_mfma_f32_16x16x32_bf16 v[228:231], a[152:155], v[88:91], v[228:231]
    ds_read_b64_tr_b16 a[230:231], v73 offset:16384
    v_mfma_f32_16x16x32_bf16 v[228:231], a[216:219], v[92:95], v[228:231]
    v_mfma_f32_16x16x32_bf16 v[232:235], a[152:155], v[96:99], v[232:235]
    s_waitcnt lgkmcnt(2)
    ds_read_b64_tr_b16 a[234:235], v74 offset:16384
    v_mfma_f32_16x16x32_bf16 v[232:235], a[216:219], v[100:103], v[232:235]
    v_mfma_f32_16x16x32_bf16 v[236:239], a[152:155], v[104:107], v[236:239]
    ds_read_b64_tr_b16 a[238:239], v75 offset:16384
    v_mfma_f32_16x16x32_bf16 v[236:239], a[216:219], v[108:111], v[236:239]
    v_mfma_f32_16x16x32_bf16 v[252:255], a[156:159], v[104:107], v[252:255]
    ds_read_b64_tr_b16 a[242:243], v76 offset:16384
    v_mfma_f32_16x16x32_bf16 v[252:255], a[220:223], v[108:111], v[252:255]
    buffer_store_dword v3, v5, s[32:35], s86 offen sc1
    v_mfma_f32_16x16x32_bf16 v[248:251], a[156:159], v[96:99], v[248:251]
    ds_read_b64_tr_b16 a[246:247], v77 offset:16384
    v_mfma_f32_16x16x32_bf16 v[248:251], a[220:223], v[100:103], v[248:251]
    v_mfma_f32_16x16x32_bf16 v[244:247], a[156:159], v[88:91], v[244:247]
    ds_read_b64_tr_b16 a[250:251], v78 offset:16384
    v_mfma_f32_16x16x32_bf16 v[244:247], a[220:223], v[92:95], v[244:247]
    v_mfma_f32_16x16x32_bf16 v[240:243], a[156:159], v[80:83], v[240:243]
    ds_read_b64_tr_b16 a[254:255], v79 offset:16384
    v_mfma_f32_16x16x32_bf16 v[240:243], a[220:223], v[84:87], v[240:243]
    s_waitcnt lgkmcnt(5)
    v_mfma_f32_16x16x32_bf16 v[128:131], a[160:163], v[24:27], v[128:131]
    v_mov_b32 v2, s88
    v_and_b32 v3, 3, v0
    v_mfma_f32_16x16x32_bf16 v[128:131], a[224:227], v[28:31], v[128:131]
    v_cmp_gt_u32 vcc, 2, v3
    v_mov_b32 v0, 0x44444444
    v_mfma_f32_16x16x32_bf16 v[144:147], a[164:167], v[24:27], v[144:147]
    v_mov_b32 v4, 0xeeeeeeee
    v_cndmask_b32 v2, 0, v2, vcc
    v_mfma_f32_16x16x32_bf16 v[144:147], a[228:231], v[28:31], v[144:147]
    v_cmp_eq_u32 vcc, 1, v3
    v_accvgpr_write_b32 a108, v2
    v_mfma_f32_16x16x32_bf16 v[160:163], a[168:171], v[24:27], v[160:163]
    s_waitcnt lgkmcnt(0)
    v_accvgpr_write_b32 a109, v2
    v_accvgpr_write_b32 a110, v2
    v_mfma_f32_16x16x32_bf16 v[160:163], a[232:235], v[28:31], v[160:163]
    v_accvgpr_write_b32 a111, v2
    v_cndmask_b32 v0, v0, v4, vcc
    v_mfma_f32_16x16x32_bf16 v[176:179], a[172:175], v[24:27], v[176:179]
    v_accvgpr_write_b32 a112, 0
    v_accvgpr_write_b32 a113, 0
    v_mfma_f32_16x16x32_bf16 v[176:179], a[236:239], v[28:31], v[176:179]
    v_accvgpr_write_b32 a114, 0
    v_accvgpr_write_b32 a115, 0
    v_mfma_f32_16x16x32_bf16 v[192:195], a[176:179], v[24:27], v[192:195]
    v_accvgpr_write_b32 a116, 0
    v_accvgpr_write_b32 a117, 0
    v_mfma_f32_16x16x32_bf16 v[192:195], a[240:243], v[28:31], v[192:195]
    v_accvgpr_write_b32 a118, 0
    v_accvgpr_write_b32 a119, 0
    v_mfma_f32_16x16x32_bf16 v[208:211], a[180:183], v[24:27], v[208:211]
    v_accvgpr_write_b32 a120, 0
    v_accvgpr_write_b32 a121, 0
    v_mfma_f32_16x16x32_bf16 v[208:211], a[244:247], v[28:31], v[208:211]
    v_accvgpr_write_b32 a122, 0
    v_accvgpr_write_b32 a123, 0
    v_mfma_f32_16x16x32_bf16 v[224:227], a[184:187], v[24:27], v[224:227]
    v_accvgpr_write_b32 a124, 0
    v_accvgpr_write_b32 a125, 0
    v_mfma_f32_16x16x32_bf16 v[224:227], a[248:251], v[28:31], v[224:227]
    v_accvgpr_write_b32 a126, 0
    v_accvgpr_write_b32 a127, 0
    v_mfma_f32_16x16x32_bf16 v[240:243], a[188:191], v[24:27], v[240:243]
    v_mfma_f32_16x16x32_bf16 v[240:243], a[252:255], v[28:31], v[240:243]
    v_mfma_f32_16x16x32_bf16 v[132:135], a[160:163], v[32:35], v[132:135]
    v_cvt_pk_bf16_f32 v64, v128, v129
    v_mfma_f32_16x16x32_bf16 v[132:135], a[224:227], v[36:39], v[132:135]
    v_cvt_pk_bf16_f32 v65, v130, v131
    v_mfma_f32_16x16x32_bf16 v[148:151], a[164:167], v[32:35], v[148:151]
    v_cvt_pk_bf16_f32 v66, v144, v145
    v_mfma_f32_16x16x32_bf16 v[148:151], a[228:231], v[36:39], v[148:151]
    v_cvt_pk_bf16_f32 v67, v146, v147
    v_mfma_f32_16x16x32_bf16 v[164:167], a[168:171], v[32:35], v[164:167]
    v_cvt_pk_bf16_f32 v68, v160, v161
    v_mfma_f32_16x16x32_bf16 v[164:167], a[232:235], v[36:39], v[164:167]
    v_cvt_pk_bf16_f32 v69, v162, v163
    v_mfma_f32_16x16x32_bf16 v[180:183], a[172:175], v[32:35], v[180:183]
    v_cvt_pk_bf16_f32 v70, v176, v177
    v_mfma_f32_16x16x32_bf16 v[180:183], a[236:239], v[36:39], v[180:183]
    v_cvt_pk_bf16_f32 v71, v178, v179
    v_mfma_f32_16x16x32_bf16 v[196:199], a[176:179], v[32:35], v[196:199]
    v_cvt_pk_bf16_f32 v72, v192, v193
    v_mfma_f32_16x16x32_bf16 v[196:199], a[240:243], v[36:39], v[196:199]
    v_cvt_pk_bf16_f32 v73, v194, v195
    v_mfma_f32_16x16x32_bf16 v[212:215], a[180:183], v[32:35], v[212:215]
    v_cvt_pk_bf16_f32 v74, v208, v209
    v_mfma_f32_16x16x32_bf16 v[212:215], a[244:247], v[36:39], v[212:215]
    v_cvt_pk_bf16_f32 v75, v210, v211
    v_mfma_f32_16x16x32_bf16 v[228:231], a[184:187], v[32:35], v[228:231]
    s_branch L_ov4
L_pad4:
    s_setpc_b64 s[86:87]
L_ov4:
    v_cvt_pk_bf16_f32 v76, v224, v225
    v_mfma_f32_16x16x32_bf16 v[228:231], a[248:251], v[36:39], v[228:231]
    v_cvt_pk_bf16_f32 v77, v226, v227
    v_mfma_f32_16x16x32_bf16 v[244:247], a[188:191], v[32:35], v[244:247]
    v_cvt_pk_bf16_f32 v78, v240, v241
    v_mfma_f32_16x16x32_bf16 v[244:247], a[252:255], v[36:39], v[244:247]
    v_cvt_pk_bf16_f32 v79, v242, v243
    v_mfma_f32_16x16x32_bf16 v[136:139], a[160:163], v[40:43], v[136:139]
    v_cvt_pk_bf16_f32 v80, v132, v133
    v_mfma_f32_16x16x32_bf16 v[136:139], a[224:227], v[44:47], v[136:139]
    v_cvt_pk_bf16_f32 v81, v134, v135
    v_mfma_f32_16x16x32_bf16 v[152:155], a[164:167], v[40:43], v[152:155]
    v_cvt_pk_bf16_f32 v82, v148, v149
    v_mfma_f32_16x16x32_bf16 v[152:155], a[228:231], v[44:47], v[152:155]
    v_cvt_pk_bf16_f32 v83, v150, v151
    v_mfma_f32_16x16x32_bf16 v[168:171], a[168:171], v[40:43], v[168:171]
    v_cvt_pk_bf16_f32 v84, v164, v165
    v_mfma_f32_16x16x32_bf16 v[168:171], a[232:235], v[44:47], v[168:171]
    v_cvt_pk_bf16_f32 v85, v166, v167
    v_mfma_f32_16x16x32_bf16 v[184:187], a[172:175], v[40:43], v[184:187]
    v_cvt_pk_bf16_f32 v86, v180, v181
    v_mfma_f32_16x16x32_bf16 v[184:187], a[236:239], v[44:47], v[184:187]
    v_cvt_pk_bf16_f32 v87, v182, v183
    v_mfma_f32_16x16x32_bf16 v[200:203], a[176:179], v[40:43], v[200:203]
    v_cvt_pk_bf16_f32 v88, v196, v197
    v_mfma_f32_16x16x32_bf16 v[200:203], a[240:243], v[44:47], v[200:203]
    v_cvt_pk_bf16_f32 v89, v198, v199
    v_mfma_f32_16x16x32_bf16 v[216:219], a[180:183], v[40:43], v[216:219]
    v_cvt_pk_bf16_f32 v90, v212, v213
    v_mfma_f32_16x16x32_bf16 v[216:219], a[244:247], v[44:47], v[216:219]
    v_cvt_pk_bf16_f32 v91, v214, v215
    v_mfma_f32_16x16x32_bf16 v[232:235], a[184:187], v[40:43], v[232:235]
    v_cvt_pk_bf16_f32 v92, v228, v229
    v_mfma_f32_16x16x32_bf16 v[232:235], a[248:251], v[44:47], v[232:235]
    v_cvt_pk_bf16_f32 v93, v230, v231
    v_mfma_f32_16x16x32_bf16 v[248:251], a[188:191], v[40:43], v[248:251]
    s_waitcnt vmcnt(9)
    v_cvt_pk_bf16_f32 v94, v244, v245
    v_mfma_f32_16x16x32_bf16 v[248:251], a[252:255], v[44:47], v[248:251]
    s_barrier
    v_cvt_pk_bf16_f32 v95, v246, v247
    v_mfma_f32_16x16x32_bf16 v[140:143], a[160:163], v[48:51], v[140:143]
    ds_read_b128 a[128:131], v10 offset:0
    v_cvt_pk_bf16_f32 v96, v136, v137
    v_mfma_f32_16x16x32_bf16 v[140:143], a[224:227], v[52:55], v[140:143]
    ds_read_b128 a[132:135], v10 offset:1024
    v_cvt_pk_bf16_f32 v97, v138, v139
    v_mfma_f32_16x16x32_bf16 v[156:159], a[164:167], v[48:51], v[156:159]
    ds_read_b128 a[136:139], v10 offset:2048
    v_cvt_pk_bf16_f32 v98, v152, v153
    v_mfma_f32_16x16x32_bf16 v[156:159], a[228:231], v[52:55], v[156:159]
    ds_read_b128 a[140:143], v10 offset:3072
    v_cvt_pk_bf16_f32 v99, v154, v155
    v_mfma_f32_16x16x32_bf16 v[172:175], a[168:171], v[48:51], v[172:175]
    ds_read_b128 a[156:159], v10 offset:7168
    v_cvt_pk_bf16_f32 v100, v168, v169
    v_mfma_f32_16x16x32_bf16 v[172:175], a[232:235], v[52:55], v[172:175]
    ds_read_b128 a[152:155], v10 offset:6144
    v_cvt_pk_bf16_f32 v101, v170, v171
    v_mfma_f32_16x16x32_bf16 v[188:191], a[172:175], v[48:51], v[188:191]
    ds_read_b128 a[148:151], v10 offset:5120
    v_cvt_pk_bf16_f32 v102, v184, v185
    v_mfma_f32_16x16x32_bf16 v[188:191], a[236:239], v[52:55], v[188:191]
    ds_read_b128 a[144:147], v10 offset:4096
    v_cvt_pk_bf16_f32 v103, v186, v187
    v_mfma_f32_16x16x32_bf16 v[204:207], a[176:179], v[48:51], v[204:207]
    v_cvt_pk_bf16_f32 v104, v200, v201
    v_mfma_f32_16x16x32_bf16 v[204:207], a[240:243], v[52:55], v[204:207]
    v_cvt_pk_bf16_f32 v105, v202, v203
    v_mfma_f32_16x16x32_bf16 v[220:223], a[180:183], v[48:51], v[220:223]
    v_cvt_pk_bf16_f32 v106, v216, v217
    v_mfma_f32_16x16x32_bf16 v[220:223], a[244:247], v[52:55], v[220:223]
    v_cvt_pk_bf16_f32 v107, v218, v219
    v_mfma_f32_16x16x32_bf16 v[236:239], a[184:187], v[48:51], v[236:239]
    v_cvt_pk_bf16_f32 v108, v232, v233
    v_mfma_f32_16x16x32_bf16 v[236:239], a[248:251], v[52:55], v[236:239]
    v_cvt_pk_bf16_f32 v109, v234, v235
    v_mfma_f32_16x16x32_bf16 v[252:255], a[188:191], v[48:51], v[252:255]
    v_cvt_pk_bf16_f32 v110, v248, v249
    v_mfma_f32_16x16x32_bf16 v[252:255], a[252:255], v[52:55], v[252:255]
    v_cvt_pk_bf16_f32 v111, v250, v251
    s_waitcnt lgkmcnt(0)
    v_mfma_f32_16x16x32_bf16 v[24:27], a[128:131], v[64:67], 0
    ds_read_b128 a[160:163], v10 offset:8192
    v_cvt_pk_bf16_f32 v112, v140, v141
    v_mfma_f32_16x16x32_bf16 v[24:27], a[132:135], v[68:71], v[24:27]
    s_add_u32 s81, s81, 16384
    s_and_b32 s81, s81, 0x7ffff
    s_add_u32 s82, s82, 32768
    s_sub_u32 s92, s82, 163840
    s_min_u32 s82, s82, s92
    s_add_u32 m0, s82, 0
    s_add_u32 s92, s81, 2880
    ds_read_b128 a[164:167], v10 offset:9216
    v_cvt_pk_bf16_f32 v113, v142, v143
    v_mfma_f32_16x16x32_bf16 v[24:27], a[136:139], v[72:75], v[24:27]
    ds_read_b128 a[168:171], v10 offset:10240
    v_cvt_pk_bf16_f32 v114, v156, v157
    v_mfma_f32_16x16x32_bf16 v[24:27], a[140:143], v[76:79], v[24:27]
    buffer_load_dwordx4 v15, s[20:23], s92 offen offset:0  lds
    v_cvt_pk_bf16_f32 v115, v158, v159
    v_mfma_f32_16x16x32_bf16 v[28:31], a[156:159], v[76:79], 0
    ds_read_b128 a[172:175], v10 offset:11264
    v_cvt_pk_bf16_f32 v116, v172, v173
    v_mfma_f32_16x16x32_bf16 v[28:31], a[152:155], v[72:75], v[28:31]
    s_add_u32 s92, s81, 1920
    ds_read_b128 a[188:191], v10 offset:15360
    v_cvt_pk_bf16_f32 v117, v174, v175
    v_mfma_f32_16x16x32_bf16 v[28:31], a[148:151], v[68:71], v[28:31]
    ds_read_b128 a[184:187], v10 offset:14336
    v_cvt_pk_bf16_f32 v118, v188, v189
    v_mfma_f32_16x16x32_bf16 v[28:31], a[144:147], v[64:67], v[28:31]
    buffer_load_dwordx4 v15, s[20:23], s92 offen offset:1024  lds
    v_cvt_pk_bf16_f32 v119, v190, v191
    v_mfma_f32_16x16x32_bf16 v[32:35], a[128:131], v[80:83], 0
    ds_read_b128 a[180:183], v10 offset:13312
    v_cvt_pk_bf16_f32 v120, v204, v205
    v_mfma_f32_16x16x32_bf16 v[32:35], a[132:135], v[84:87], v[32:35]
    s_add_u32 s92, s81, 960
    ds_read_b128 a[176:179], v10 offset:12288
    v_cvt_pk_bf16_f32 v121, v206, v207
    v_mfma_f32_16x16x32_bf16 v[32:35], a[136:139], v[88:91], v[32:35]
    ds_read_b64_tr_b16 a[192:193], v19 offset:16384
    v_cvt_pk_bf16_f32 v122, v220, v221
    v_mfma_f32_16x16x32_bf16 v[32:35], a[140:143], v[92:95], v[32:35]
    buffer_load_dwordx4 v15, s[20:23], s92 offen offset:2048  lds
    v_cvt_pk_bf16_f32 v123, v222, v223
    v_mfma_f32_16x16x32_bf16 v[36:39], a[156:159], v[92:95], 0
    ds_read_b64_tr_b16 a[194:195], v19 offset:20480
    v_cvt_pk_bf16_f32 v124, v236, v237
    v_mfma_f32_16x16x32_bf16 v[36:39], a[152:155], v[88:91], v[36:39]
    s_add_u32 s92, s81, 0
    ds_read_b64_tr_b16 a[224:225], v19 offset:24576
    v_cvt_pk_bf16_f32 v125, v238, v239
    v_mfma_f32_16x16x32_bf16 v[36:39], a[148:151], v[84:87], v[36:39]
    ds_read_b64_tr_b16 a[226:227], v19 offset:28672
    v_cvt_pk_bf16_f32 v126, v252, v253
    v_mfma_f32_16x16x32_bf16 v[36:39], a[144:147], v[80:83], v[36:39]
    buffer_load_dwordx4 v15, s[20:23], s92 offen offset:3072  lds
    v_cvt_pk_bf16_f32 v127, v254, v255
    v_mfma_f32_16x16x32_bf16 v[128:131], a[128:131], v[96:99], 0
    ds_read_b64_tr_b16 a[228:229], v12 offset:24576
    v_max3_f32 v2, v24, v25, v26
    v_max3_f32 v2, v2, v27, v28
    v_mfma_f32_16x16x32_bf16 v[128:131], a[132:135], v[100:103], v[128:131]
    s_add_u32 m0, s82, 16384
    s_add_u32 s92, s81, 2880
    ds_read_b64_tr_b16 a[230:231], v12 offset:28672
    v_max3_f32 v2, v2, v29, v30
    v_max_f32 v2, v2, v31
    v_mfma_f32_16x16x32_bf16 v[128:131], a[136:139], v[104:107], v[128:131]
    ds_read_b64_tr_b16 a[196:197], v12 offset:16384
    v_mfma_f32_16x16x32_bf16 v[128:131], a[140:143], v[108:111], v[128:131]
    buffer_load_dwordx4 v15, s[24:27], s92 offen offset:0  lds
    v_max3_f32 v3, v32, v33, v34
    v_max3_f32 v3, v3, v35, v36
    v_mfma_f32_16x16x32_bf16 v[144:147], a[156:159], v[108:111], 0
    ds_read_b64_tr_b16 a[198:199], v12 offset:20480
    v_max3_f32 v3, v3, v37, v38
    v_max_f32 v3, v3, v39
    v_mfma_f32_16x16x32_bf16 v[144:147], a[152:155], v[104:107], v[144:147]
    s_add_u32 s92, s81, 1920
    ds_read_b64_tr_b16 a[200:201], v19 offset:17408
    v_mov_b32 v20, v2
    v_mov_b32 v21, v3
    v_mfma_f32_16x16x32_bf16 v[144:147], a[148:151], v[100:103], v[144:147]
    ds_read_b64_tr_b16 a[202:203], v19 offset:21504
    v_permlane16_swap_b32 v2, v20
    v_permlane16_swap_b32 v3, v21
    v_mfma_f32_16x16x32_bf16 v[144:147], a[144:147], v[96:99], v[144:147]
    buffer_load_dwordx4 v15, s[24:27], s92 offen offset:1024  lds
    v_max_f32 v2, v2, v20
    v_max_f32 v3, v3, v21
    v_mfma_f32_16x16x32_bf16 v[160:163], a[128:131], v[112:115], 0
    ds_read_b64_tr_b16 a[232:233], v19 offset:25600
    v_mov_b32 v20, v2
    v_mov_b32 v21, v3
    v_mfma_f32_16x16x32_bf16 v[160:163], a[132:135], v[116:119], v[160:163]
    s_add_u32 s92, s81, 960
    ds_read_b64_tr_b16 a[234:235], v19 offset:29696
    v_permlane32_swap_b32 v2, v20
    v_permlane32_swap_b32 v3, v21
    v_mfma_f32_16x16x32_bf16 v[160:163], a[136:139], v[120:123], v[160:163]
    ds_read_b64_tr_b16 a[236:237], v12 offset:25600
    v_max_f32 v2, v2, v20
    v_max_f32 v3, v3, v21
    v_mfma_f32_16x16x32_bf16 v[160:163], a[140:143], v[124:127], v[160:163]
    buffer_load_dwordx4 v15, s[24:27], s92 offen offset:2048  lds
    v_sub_f32 v48, 0, v2
    v_sub_f32 v49, 0, v2
    v_mfma_f32_16x16x32_bf16 v[176:179], a[156:159], v[124:127], 0
    ds_read_b64_tr_b16 a[238:239], v12 offset:29696
    v_sub_f32 v50, 0, v2
    v_sub_f32 v51, 0, v2
    v_mfma_f32_16x16x32_bf16 v[176:179], a[152:155], v[120:123], v[176:179]
    s_add_u32 s92, s81, 0
    ds_read_b64_tr_b16 a[204:205], v12 offset:17408
    v_sub_f32 v24, v24, v2
    v_sub_f32 v25, v25, v2
    v_mfma_f32_16x16x32_bf16 v[176:179], a[148:151], v[116:119], v[176:179]
    ds_read_b64_tr_b16 a[206:207], v12 offset:21504
    v_sub_f32 v26, v26, v2
    v_sub_f32 v27, v27, v2
    v_mfma_f32_16x16x32_bf16 v[176:179], a[144:147], v[112:115], v[176:179]
    buffer_load_dwordx4 v15, s[24:27], s92 offen offset:3072  lds
    v_sub_f32 v28, v28, v2
    v_sub_f32 v29, v29, v2
    s_waitcnt lgkmcnt(15)
    v_mfma_f32_16x16x32_bf16 v[32:35], a[160:163], v[64:67], v[48:51]
    v_exp_f32 v24, v24
    v_sub_f32 v30, v30, v2
    v_sub_f32 v31, v31, v2
    v_max3_f32 v4, v128, v129, v130
    v_max3_f32 v4, v4, v131, v144
    v_mfma_f32_16x16x32_bf16 v[32:35], a[164:167], v[68:71], v[32:35]
    v_exp_f32 v25, v25
    v_max3_f32 v4, v4, v145, v146
    v_max_f32 v4, v4, v147
    v_sub_f32 v52, 0, v3
    v_sub_f32 v53, 0, v3
    v_mfma_f32_16x16x32_bf16 v[32:35], a[168:171], v[72:75], v[32:35]
    v_exp_f32 v26, v26
    v_max3_f32 v5, v160, v161, v162
    v_max3_f32 v5, v5, v163, v176
    v_max3_f32 v5, v5, v177, v178
    v_max_f32 v5, v5, v179
    v_mfma_f32_16x16x32_bf16 v[32:35], a[172:175], v[76:79], v[32:35]
    v_exp_f32 v27, v27
    v_mov_b32 v20, v4
    v_mov_b32 v21, v5
    v_sub_f32 v54, 0, v3
    v_sub_f32 v55, 0, v3
    v_mfma_f32_16x16x32_bf16 v[36:39], a[188:191], v[76:79], v[48:51]
    v_exp_f32 v28, v28
    v_permlane16_swap_b32 v4, v20
    v_permlane16_swap_b32 v5, v21
    v_cvt_pk_bf16_f32 v40, v24, v25
    v_mfma_f32_16x16x32_bf16 v[36:39], a[184:187], v[72:75], v[36:39]
    v_exp_f32 v29, v29
    v_max_f32 v4, v4, v20
    v_max_f32 v5, v5, v21
    v_mov_b32 v20, v4
    v_mov_b32 v21, v5
    v_mfma_f32_16x16x32_bf16 v[36:39], a[180:183], v[68:71], v[36:39]
    v_exp_f32 v30, v30
    v_permlane32_swap_b32 v4, v20
    v_permlane32_swap_b32 v5, v21
    v_cvt_pk_bf16_f32 v41, v26, v27
    v_mfma_f32_16x16x32_bf16 v[36:39], a[176:179], v[64:67], v[36:39]
    v_exp_f32 v31, v31
    v_max_f32 v4, v4, v20
    v_max_f32 v5, v5, v21
    v_cvt_pk_bf16_f32 v42, v28, v29
    v_sub_f32 v56, 0, v4
    v_sub_f32 v57, 0, v4
    v_sub_f32 v58, 0, v4
    v_sub_f32 v59, 0, v4
    v_sub_f32 v60, 0, v5
    v_sub_f32 v61, 0, v5
    v_sub_f32 v62, 0, v5
    v_sub_f32 v63, 0, v5
    v_cvt_pk_bf16_f32 v43, v30, v31
    s_waitcnt lgkmcnt(0)
    s_add_u32 s81, s81, 16384
    s_and_b32 s81, s81, 0x7ffff
    s_add_u32 s82, s82, 32768
    s_sub_u32 s92, s82, 163840
    s_min_u32 s82, s82, s92
    s_add_u32 m0, s82, 0
    s_add_u32 s92, s81, 2880
    v_mfma_f32_16x16x32_bf16 v[24:27], a[128:131], v[80:83], v[52:55]
    v_exp_f32 v32, v32
    v_mfma_f32_16x16x32_bf16 v[24:27], a[132:135], v[84:87], v[24:27]
    buffer_load_dwordx4 v15, s[20:23], s92 offen offset:0  lds
    v_exp_f32 v33, v33
    v_mfma_f32_16x16x32_bf16 v[24:27], a[136:139], v[88:91], v[24:27]
    s_add_u32 s92, s81, 1920
    ds_read_b64_tr_b16 a[208:209], v19 offset:18432
    v_exp_f32 v34, v34
    v_cvt_pk_bf16_f32 v44, v32, v33
    v_mfma_f32_16x16x32_bf16 v[24:27], a[140:143], v[92:95], v[24:27]
    v_exp_f32 v35, v35
    v_mfma_f32_16x16x32_bf16 v[28:31], a[156:159], v[92:95], v[52:55]
    ds_read_b64_tr_b16 a[210:211], v19 offset:22528
    v_exp_f32 v36, v36
    v_cvt_pk_bf16_f32 v45, v34, v35
    v_mfma_f32_16x16x32_bf16 v[28:31], a[152:155], v[88:91], v[28:31]
    buffer_load_dwordx4 v15, s[20:23], s92 offen offset:1024  lds
    v_exp_f32 v37, v37
    v_mfma_f32_16x16x32_bf16 v[28:31], a[148:151], v[84:87], v[28:31]
    s_add_u32 s92, s81, 960
    v_exp_f32 v38, v38
    v_cvt_pk_bf16_f32 v46, v36, v37
    v_mfma_f32_16x16x32_bf16 v[28:31], a[144:147], v[80:83], v[28:31]
    ds_read_b64_tr_b16 a[240:241], v19 offset:26624
    v_exp_f32 v39, v39
    s_nop 0
    v_cvt_pk_bf16_f32 v47, v38, v39
    s_nop 1
    v_mfma_f32_16x16x32_bf16 v[32:35], a[160:163], v[80:83], v[52:55]
    ds_read_b64_tr_b16 a[242:243], v19 offset:30720
    v_mfma_f32_16x16x32_bf16 v[32:35], a[164:167], v[84:87], v[32:35]
    ds_read_b64_tr_b16 a[244:245], v12 offset:26624
    v_mfma_f32_16x16x32_bf16 v[32:35], a[168:171], v[88:91], v[32:35]
    v_exp_f32 v24, v24
    v_mfma_f32_16x16x32_bf16 v[32:35], a[172:175], v[92:95], v[32:35]
    v_exp_f32 v25, v25
    v_mfma_f32_16x16x32_bf16 v[36:39], a[188:191], v[92:95], v[52:55]
    ds_read_b64_tr_b16 a[246:247], v12 offset:30720
    v_cvt_pk_bf16_f32 v2, v24, v25
    v_mfma_f32_16x16x32_bf16 v[36:39], a[184:187], v[88:91], v[36:39]
    ds_read_b64_tr_b16 a[212:213], v12 offset:18432
    v_exp_f32 v26, v26
    v_mfma_f32_16x16x32_bf16 v[36:39], a[180:183], v[84:87], v[36:39]
    v_exp_f32 v27, v27
    v_mfma_f32_16x16x32_bf16 v[36:39], a[176:179], v[80:83], v[36:39]
    ds_read_b64_tr_b16 a[214:215], v12 offset:22528
    v_cvt_pk_bf16_f32 v3, v26, v27
    v_mfma_f32_16x16x32_bf16 v[128:131], a[192:195], v[40:43], 0
    ds_read_b64_tr_b16 a[216:217], v19 offset:19456
    v_exp_f32 v28, v28
    v_mfma_f32_16x16x32_bf16 v[128:131], a[224:227], v[44:47], v[128:131]
    v_exp_f32 v29, v29
    v_mfma_f32_16x16x32_bf16 v[144:147], a[228:231], v[44:47], 0
    ds_read_b64_tr_b16 a[218:219], v19 offset:23552
    v_cvt_pk_bf16_f32 v4, v28, v29
    v_mfma_f32_16x16x32_bf16 v[144:147], a[196:199], v[40:43], v[144:147]
    ds_read_b64_tr_b16 a[248:249], v19 offset:27648
    v_mfma_f32_16x16x32_bf16 v[160:163], a[200:203], v[40:43], 0
    ds_read_b64_tr_b16 a[250:251], v19 offset:31744
    v_mfma_f32_16x16x32_bf16 v[160:163], a[232:235], v[44:47], v[160:163]
    ds_read_b64_tr_b16 a[252:253], v12 offset:27648
    v_exp_f32 v30, v30
    v_mfma_f32_16x16x32_bf16 v[176:179], a[236:239], v[44:47], 0
    v_exp_f32 v31, v31
    v_mfma_f32_16x16x32_bf16 v[176:179], a[204:207], v[40:43], v[176:179]
    ds_read_b64_tr_b16 a[254:255], v12 offset:31744
    v_cvt_pk_bf16_f32 v5, v30, v31
    v_mfma_f32_16x16x32_bf16 v[24:27], a[128:131], v[96:99], v[56:59]
    ds_read_b64_tr_b16 a[220:221], v12 offset:19456
    v_mfma_f32_16x16x32_bf16 v[24:27], a[132:135], v[100:103], v[24:27]
    ds_read_b64_tr_b16 a[222:223], v12 offset:23552
    v_mfma_f32_16x16x32_bf16 v[24:27], a[136:139], v[104:107], v[24:27]
    v_exp_f32 v32, v32
    v_mfma_f32_16x16x32_bf16 v[24:27], a[140:143], v[108:111], v[24:27]
    v_exp_f32 v33, v33
    v_mfma_f32_16x16x32_bf16 v[28:31], a[156:159], v[108:111], v[56:59]
    v_cvt_pk_bf16_f32 v6, v32, v33
    v_mfma_f32_16x16x32_bf16 v[28:31], a[152:155], v[104:107], v[28:31]
    buffer_load_dwordx4 v15, s[20:23], s92 offen offset:2048  lds
    v_mfma_f32_16x16x32_bf16 v[28:31], a[148:151], v[100:103], v[28:31]
    s_add_u32 s92, s81, 0
    v_exp_f32 v34, v34
    v_mfma_f32_16x16x32_bf16 v[28:31], a[144:147], v[96:99], v[28:31]
    s_waitcnt lgkmcnt(4)
    v_exp_f32 v35, v35
    v_mfma_f32_16x16x32_bf16 v[192:195], a[208:211], v[40:43], 0
    v_cvt_pk_bf16_f32 v7, v34, v35
    v_mfma_f32_16x16x32_bf16 v[192:195], a[240:243], v[44:47], v[192:195]
    v_exp_f32 v36, v36
    v_mfma_f32_16x16x32_bf16 v[208:211], a[244:247], v[44:47], 0
    v_exp_f32 v37, v37
    v_mfma_f32_16x16x32_bf16 v[208:211], a[212:215], v[40:43], v[208:211]
    v_cvt_pk_bf16_f32 v8, v36, v37
    v_mfma_f32_16x16x32_bf16 v[224:227], a[216:219], v[40:43], 0
    v_mfma_f32_16x16x32_bf16 v[224:227], a[248:251], v[44:47], v[224:227]
    s_waitcnt lgkmcnt(2)
    buffer_load_dwordx4 v15, s[20:23], s92 offen offset:3072  lds
    v_mfma_f32_16x16x32_bf16 v[240:243], a[252:255], v[44:47], 0
    s_waitcnt lgkmcnt(0)
    v_exp_f32 v38, v38
    v_mfma_f32_16x16x32_bf16 v[240:243], a[220:223], v[40:43], v[240:243]
    s_add_u32 m0, s82, 16384
    v_exp_f32 v39, v39
    v_smfmac_f32_16x16x64_bf16 a[112:115], a[108:111], v[40:47], v0
    s_add_u32 s92, s81, 2880
    v_cvt_pk_bf16_f32 v9, v38, v39
    v_mfma_f32_16x16x32_bf16 v[32:35], a[160:163], v[96:99], v[56:59]
    v_mfma_f32_16x16x32_bf16 v[32:35], a[164:167], v[100:103], v[32:35]
    s_add_u32 s83, s83, 32768
    buffer_load_dwordx4 v15, s[24:27], s92 offen offset:0  lds
    v_mfma_f32_16x16x32_bf16 v[32:35], a[168:171], v[104:107], v[32:35]
    s_sub_u32 s90, s83, 163840
    v_exp_f32 v24, v24
    v_mfma_f32_16x16x32_bf16 v[32:35], a[172:175], v[108:111], v[32:35]
    s_min_u32 s83, s83, s90
    v_exp_f32 v25, v25
    v_mfma_f32_16x16x32_bf16 v[36:39], a[188:191], v[108:111], v[56:59]
    s_add_u32 s92, s81, 1920
    v_cvt_pk_bf16_f32 v40, v24, v25
    v_add_u32 v10, s83, v13
    v_mfma_f32_16x16x32_bf16 v[36:39], a[184:187], v[104:107], v[36:39]
    v_exp_f32 v26, v26
    v_mfma_f32_16x16x32_bf16 v[36:39], a[180:183], v[100:103], v[36:39]
    v_exp_f32 v27, v27
    v_mfma_f32_16x16x32_bf16 v[36:39], a[176:179], v[96:99], v[36:39]
    buffer_load_dwordx4 v15, s[24:27], s92 offen offset:1024  lds
    v_cvt_pk_bf16_f32 v41, v26, v27
    v_mfma_f32_16x16x32_bf16 v[132:135], a[192:195], v[2:5], 0
    s_add_u32 s92, s81, 960
    v_exp_f32 v28, v28
    v_mfma_f32_16x16x32_bf16 v[132:135], a[224:227], v[6:9], v[132:135]
    v_exp_f32 v29, v29
    v_mfma_f32_16x16x32_bf16 v[148:151], a[228:231], v[6:9], 0
    v_cvt_pk_bf16_f32 v42, v28, v29
    v_mfma_f32_16x16x32_bf16 v[148:151], a[196:199], v[2:5], v[148:151]
    v_mfma_f32_16x16x32_bf16 v[164:167], a[200:203], v[2:5], 0
    buffer_load_dwordx4 v15, s[24:27], s92 offen offset:2048  lds
    v_mfma_f32_16x16x32_bf16 v[164:167], a[232:235], v[6:9], v[164:167]
    s_add_u32 s92, s81, 0
    v_exp_f32 v30, v30
    v_mfma_f32_16x16x32_bf16 v[180:183], a[236:239], v[6:9], 0
    v_exp_f32 v31, v31
    v_mfma_f32_16x16x32_bf16 v[180:183], a[204:207], v[2:5], v[180:183]
    buffer_load_dwordx4 v15, s[24:27], s92 offen offset:3072  lds
    v_cvt_pk_bf16_f32 v43, v30, v31
    v_mfma_f32_16x16x32_bf16 v[24:27], a[128:131], v[112:115], v[60:63]
    s_waitcnt vmcnt(17)
    v_mfma_f32_16x16x32_bf16 v[24:27], a[132:135], v[116:119], v[24:27]
    s_barrier
    v_mfma_f32_16x16x32_bf16 v[24:27], a[136:139], v[120:123], v[24:27]
    s_add_u32 s81, s81, 16384
    v_exp_f32 v32, v32
    v_mfma_f32_16x16x32_bf16 v[24:27], a[140:143], v[124:127], v[24:27]
    s_and_b32 s81, s81, 0x7ffff
    v_exp_f32 v33, v33
    v_mfma_f32_16x16x32_bf16 v[28:31], a[156:159], v[124:127], v[60:63]
    s_add_u32 s82, s82, 32768
    ds_read_b128 a[128:131], v10 offset:0
    v_cvt_pk_bf16_f32 v44, v32, v33
    v_mfma_f32_16x16x32_bf16 v[28:31], a[152:155], v[120:123], v[28:31]
    s_sub_u32 s92, s82, 163840
    ds_read_b128 a[132:135], v10 offset:1024
    v_mfma_f32_16x16x32_bf16 v[28:31], a[148:151], v[116:119], v[28:31]
    s_min_u32 s82, s82, s92
    v_exp_f32 v34, v34
    v_mfma_f32_16x16x32_bf16 v[28:31], a[144:147], v[112:115], v[28:31]
    s_add_u32 m0, s82, 0
    v_exp_f32 v35, v35
    v_mfma_f32_16x16x32_bf16 v[196:199], a[208:211], v[2:5], 0
    s_add_u32 s92, s81, 2880
    ds_read_b128 a[136:139], v10 offset:2048
    v_cvt_pk_bf16_f32 v45, v34, v35
    v_mfma_f32_16x16x32_bf16 v[196:199], a[240:243], v[6:9], v[196:199]
    v_exp_f32 v36, v36
    v_mfma_f32_16x16x32_bf16 v[212:215], a[244:247], v[6:9], 0
    v_exp_f32 v37, v37
    v_mfma_f32_16x16x32_bf16 v[212:215], a[212:215], v[2:5], v[212:215]
    ds_read_b128 a[140:143], v10 offset:3072
    v_cvt_pk_bf16_f32 v46, v36, v37
    v_mfma_f32_16x16x32_bf16 v[228:231], a[216:219], v[2:5], 0
    ds_read_b128 a[156:159], v10 offset:7168
    v_mfma_f32_16x16x32_bf16 v[228:231], a[248:251], v[6:9], v[228:231]
    buffer_load_dwordx4 v15, s[20:23], s92 offen offset:0  lds
    v_mfma_f32_16x16x32_bf16 v[244:247], a[252:255], v[6:9], 0
    s_add_u32 s92, s81, 1920
    v_exp_f32 v38, v38
    v_mfma_f32_16x16x32_bf16 v[244:247], a[220:223], v[2:5], v[244:247]
    v_exp_f32 v39, v39
    v_smfmac_f32_16x16x64_bf16 a[116:119], a[108:111], v[2:9], v0
    ds_read_b128 a[152:155], v10 offset:6144
    v_cvt_pk_bf16_f32 v47, v38, v39
    v_mfma_f32_16x16x32_bf16 v[32:35], a[160:163], v[112:115], v[60:63]
    ds_read_b128 a[148:151], v10 offset:5120
    v_mfma_f32_16x16x32_bf16 v[32:35], a[164:167], v[116:119], v[32:35]
    buffer_load_dwordx4 v15, s[20:23], s92 offen offset:1024  lds
    v_mfma_f32_16x16x32_bf16 v[32:35], a[168:171], v[120:123], v[32:35]
    s_add_u32 s92, s81, 960
    v_exp_f32 v24, v24
    v_mfma_f32_16x16x32_bf16 v[32:35], a[172:175], v[124:127], v[32:35]
    v_exp_f32 v25, v25
    v_mfma_f32_16x16x32_bf16 v[36:39], a[188:191], v[124:127], v[60:63]
    ds_read_b128 a[144:147], v10 offset:4096
    v_cvt_pk_bf16_f32 v2, v24, v25
    v_mfma_f32_16x16x32_bf16 v[36:39], a[184:187], v[120:123], v[36:39]
    v_exp_f32 v26, v26
    v_mfma_f32_16x16x32_bf16 v[36:39], a[180:183], v[116:119], v[36:39]
    v_exp_f32 v27, v27
    v_mfma_f32_16x16x32_bf16 v[36:39], a[176:179], v[112:115], v[36:39]
    ds_read_b128 a[160:163], v10 offset:8192
    v_cvt_pk_bf16_f32 v3, v26, v27
    v_mfma_f32_16x16x32_bf16 v[136:139], a[192:195], v[40:43], 0
    v_exp_f32 v28, v28
    v_mfma_f32_16x16x32_bf16 v[136:139], a[224:227], v[44:47], v[136:139]
    v_exp_f32 v29, v29
    v_mfma_f32_16x16x32_bf16 v[152:155], a[228:231], v[44:47], 0
    ds_read_b128 a[164:167], v10 offset:9216
    v_cvt_pk_bf16_f32 v4, v28, v29
    v_mfma_f32_16x16x32_bf16 v[152:155], a[196:199], v[40:43], v[152:155]
    ds_read_b128 a[168:171], v10 offset:10240
    v_mfma_f32_16x16x32_bf16 v[168:171], a[200:203], v[40:43], 0
    buffer_load_dwordx4 v15, s[20:23], s92 offen offset:2048  lds
    v_mfma_f32_16x16x32_bf16 v[168:171], a[232:235], v[44:47], v[168:171]
    s_add_u32 s92, s81, 0
    v_exp_f32 v30, v30
    v_mfma_f32_16x16x32_bf16 v[184:187], a[236:239], v[44:47], 0
    v_exp_f32 v31, v31
    v_mfma_f32_16x16x32_bf16 v[184:187], a[204:207], v[40:43], v[184:187]
    s_waitcnt lgkmcnt(3)
    ds_read_b128 a[172:175], v10 offset:11264
    v_cvt_pk_bf16_f32 v5, v30, v31
    v_mfma_f32_16x16x32_bf16 v[24:27], a[128:131], v[64:67], v[48:51]
    ds_read_b128 a[188:191], v10 offset:15360
    v_mfma_f32_16x16x32_bf16 v[24:27], a[132:135], v[68:71], v[24:27]
    buffer_load_dwordx4 v15, s[20:23], s92 offen offset:3072  lds
    v_mfma_f32_16x16x32_bf16 v[24:27], a[136:139], v[72:75], v[24:27]
    s_add_u32 m0, s82, 16384
    v_exp_f32 v32, v32
    v_mfma_f32_16x16x32_bf16 v[24:27], a[140:143], v[76:79], v[24:27]
    s_add_u32 s92, s81, 2880
    v_exp_f32 v33, v33
    v_mfma_f32_16x16x32_bf16 v[28:31], a[156:159], v[76:79], v[48:51]
    ds_read_b128 a[184:187], v10 offset:14336
    v_cvt_pk_bf16_f32 v6, v32, v33
    v_mfma_f32_16x16x32_bf16 v[28:31], a[152:155], v[72:75], v[28:31]
    v_add_u32 v19, s83, v14
    v_xor_b32 v12, 32, v19
    v_mfma_f32_16x16x32_bf16 v[28:31], a[148:151], v[68:71], v[28:31]
    v_exp_f32 v34, v34
    v_mfma_f32_16x16x32_bf16 v[28:31], a[144:147], v[64:67], v[28:31]
    v_exp_f32 v35, v35
    v_mfma_f32_16x16x32_bf16 v[200:203], a[208:211], v[40:43], 0
    ds_read_b128 a[180:183], v10 offset:13312
    v_cvt_pk_bf16_f32 v7, v34, v35
    v_mfma_f32_16x16x32_bf16 v[200:203], a[240:243], v[44:47], v[200:203]
    s_add_u32 s83, s83, 32768
    v_exp_f32 v36, v36
    v_mfma_f32_16x16x32_bf16 v[216:219], a[244:247], v[44:47], 0
    s_sub_u32 s90, s83, 163840
    v_exp_f32 v37, v37
    v_mfma_f32_16x16x32_bf16 v[216:219], a[212:215], v[40:43], v[216:219]
    s_min_u32 s83, s83, s90
    ds_read_b128 a[176:179], v10 offset:12288
    v_cvt_pk_bf16_f32 v8, v36, v37
    v_mfma_f32_16x16x32_bf16 v[232:235], a[216:219], v[40:43], 0
    v_add_u32 v10, s83, v13
    v_mfma_f32_16x16x32_bf16 v[232:235], a[248:251], v[44:47], v[232:235]
    buffer_load_dwordx4 v15, s[24:27], s92 offen offset:0  lds
    v_mfma_f32_16x16x32_bf16 v[248:251], a[252:255], v[44:47], 0
    s_add_u32 s92, s81, 1920
    v_exp_f32 v38, v38
    v_mfma_f32_16x16x32_bf16 v[248:251], a[220:223], v[40:43], v[248:251]
    v_exp_f32 v39, v39
    v_smfmac_f32_16x16x64_bf16 a[120:123], a[108:111], v[40:47], v0
    s_waitcnt lgkmcnt(3)
    v_cvt_pk_bf16_f32 v9, v38, v39
    v_mfma_f32_16x16x32_bf16 v[32:35], a[160:163], v[64:67], v[48:51]
    v_exp_f32 v24, v24
    v_mfma_f32_16x16x32_bf16 v[32:35], a[164:167], v[68:71], v[32:35]
    v_exp_f32 v25, v25
    v_mfma_f32_16x16x32_bf16 v[32:35], a[168:171], v[72:75], v[32:35]
    v_exp_f32 v26, v26
    v_mfma_f32_16x16x32_bf16 v[32:35], a[172:175], v[76:79], v[32:35]
    v_exp_f32 v27, v27
    v_mfma_f32_16x16x32_bf16 v[36:39], a[188:191], v[76:79], v[48:51]
    s_waitcnt lgkmcnt(2)
    v_exp_f32 v28, v28
    v_mfma_f32_16x16x32_bf16 v[36:39], a[184:187], v[72:75], v[36:39]
    s_waitcnt lgkmcnt(1)
    v_exp_f32 v29, v29
    v_mfma_f32_16x16x32_bf16 v[36:39], a[180:183], v[68:71], v[36:39]
    s_waitcnt lgkmcnt(0)
    v_exp_f32 v30, v30
    v_mfma_f32_16x16x32_bf16 v[36:39], a[176:179], v[64:67], v[36:39]
    v_exp_f32 v31, v31
    v_mfma_f32_16x16x32_bf16 v[140:143], a[192:195], v[2:5], 0
    v_cvt_pk_bf16_f32 v40, v24, v25
    v_cvt_pk_bf16_f32 v41, v26, v27
    v_mfma_f32_16x16x32_bf16 v[140:143], a[224:227], v[6:9], v[140:143]
    ds_read_b64_tr_b16 a[192:193], v19 offset:16384
    v_cvt_pk_bf16_f32 v42, v28, v29
    v_mfma_f32_16x16x32_bf16 v[156:159], a[228:231], v[6:9], 0
    ds_read_b64_tr_b16 a[194:195], v19 offset:20480
    v_mfma_f32_16x16x32_bf16 v[156:159], a[196:199], v[2:5], v[156:159]
    ds_read_b64_tr_b16 a[224:225], v19 offset:24576
    v_cvt_pk_bf16_f32 v43, v30, v31
    v_mfma_f32_16x16x32_bf16 v[172:175], a[200:203], v[2:5], 0
    ds_read_b64_tr_b16 a[226:227], v19 offset:28672
    v_mfma_f32_16x16x32_bf16 v[172:175], a[232:235], v[6:9], v[172:175]
    ds_read_b64_tr_b16 a[228:229], v12 offset:24576
    v_mfma_f32_16x16x32_bf16 v[188:191], a[236:239], v[6:9], 0
    ds_read_b64_tr_b16 a[230:231], v12 offset:28672
    v_mfma_f32_16x16x32_bf16 v[188:191], a[204:207], v[2:5], v[188:191]
    ds_read_b64_tr_b16 a[196:197], v12 offset:16384
    v_mfma_f32_16x16x32_bf16 v[24:27], a[128:131], v[80:83], v[52:55]
    ds_read_b64_tr_b16 a[198:199], v12 offset:20480
    v_mfma_f32_16x16x32_bf16 v[24:27], a[132:135], v[84:87], v[24:27]
    ds_read_b64_tr_b16 a[200:201], v19 offset:17408
    v_mfma_f32_16x16x32_bf16 v[24:27], a[136:139], v[88:91], v[24:27]
    s_branch L_ov5
L_pad5:
    s_setpc_b64 s[86:87]
L_ov5:
    v_exp_f32 v32, v32
    v_mfma_f32_16x16x32_bf16 v[24:27], a[140:143], v[92:95], v[24:27]
    v_exp_f32 v33, v33
    v_mfma_f32_16x16x32_bf16 v[28:31], a[156:159], v[92:95], v[52:55]
    ds_read_b64_tr_b16 a[202:203], v19 offset:21504
    v_cvt_pk_bf16_f32 v44, v32, v33
    v_mfma_f32_16x16x32_bf16 v[28:31], a[152:155], v[88:91], v[28:31]
    ds_read_b64_tr_b16 a[232:233], v19 offset:25600
    v_mfma_f32_16x16x32_bf16 v[28:31], a[148:151], v[84:87], v[28:31]
    v_exp_f32 v34, v34
    v_mfma_f32_16x16x32_bf16 v[28:31], a[144:147], v[80:83], v[28:31]
    v_exp_f32 v35, v35
    v_mfma_f32_16x16x32_bf16 v[204:207], a[208:211], v[2:5], 0
    ds_read_b64_tr_b16 a[234:235], v19 offset:29696
    v_cvt_pk_bf16_f32 v45, v34, v35
    v_mfma_f32_16x16x32_bf16 v[204:207], a[240:243], v[6:9], v[204:207]
    v_exp_f32 v36, v36
    v_mfma_f32_16x16x32_bf16 v[220:223], a[244:247], v[6:9], 0
    v_exp_f32 v37, v37
    v_mfma_f32_16x16x32_bf16 v[220:223], a[212:215], v[2:5], v[220:223]
    ds_read_b64_tr_b16 a[236:237], v12 offset:25600
    v_cvt_pk_bf16_f32 v46, v36, v37
    v_mfma_f32_16x16x32_bf16 v[236:239], a[216:219], v[2:5], 0
    ds_read_b64_tr_b16 a[238:239], v12 offset:29696
    v_mfma_f32_16x16x32_bf16 v[236:239], a[248:251], v[6:9], v[236:239]
    ds_read_b64_tr_b16 a[204:205], v12 offset:17408
    v_mfma_f32_16x16x32_bf16 v[252:255], a[252:255], v[6:9], 0
    v_exp_f32 v38, v38
    v_mfma_f32_16x16x32_bf16 v[252:255], a[220:223], v[2:5], v[252:255]
    v_exp_f32 v39, v39
    v_smfmac_f32_16x16x64_bf16 a[124:127], a[108:111], v[2:9], v0
    ds_read_b64_tr_b16 a[206:207], v12 offset:21504
    v_cvt_pk_bf16_f32 v47, v38, v39
    v_mfma_f32_16x16x32_bf16 v[32:35], a[160:163], v[80:83], v[52:55]
    ds_read_b64_tr_b16 a[208:209], v19 offset:18432
    v_mfma_f32_16x16x32_bf16 v[32:35], a[164:167], v[84:87], v[32:35]
    ds_read_b64_tr_b16 a[210:211], v19 offset:22528
    v_mfma_f32_16x16x32_bf16 v[32:35], a[168:171], v[88:91], v[32:35]
    ds_read_b64_tr_b16 a[240:241], v19 offset:26624
    v_exp_f32 v24, v24
    v_mfma_f32_16x16x32_bf16 v[32:35], a[172:175], v[92:95], v[32:35]
    v_exp_f32 v25, v25
    v_mfma_f32_16x16x32_bf16 v[36:39], a[188:191], v[92:95], v[52:55]
    ds_read_b64_tr_b16 a[242:243], v19 offset:30720
    v_cvt_pk_bf16_f32 v2, v24, v25
    v_mfma_f32_16x16x32_bf16 v[36:39], a[184:187], v[88:91], v[36:39]
    v_exp_f32 v26, v26
    v_mfma_f32_16x16x32_bf16 v[36:39], a[180:183], v[84:87], v[36:39]
    v_exp_f32 v27, v27
    v_mfma_f32_16x16x32_bf16 v[36:39], a[176:179], v[80:83], v[36:39]
    s_waitcnt lgkmcnt(4)
    ds_read_b64_tr_b16 a[244:245], v12 offset:26624
    v_cvt_pk_bf16_f32 v3, v26, v27
    v_mfma_f32_16x16x32_bf16 v[128:131], a[192:195], v[40:43], v[128:131]
    v_exp_f32 v28, v28
    v_mfma_f32_16x16x32_bf16 v[128:131], a[224:227], v[44:47], v[128:131]
    v_exp_f32 v29, v29
    v_mfma_f32_16x16x32_bf16 v[144:147], a[228:231], v[44:47], v[144:147]
    ds_read_b64_tr_b16 a[246:247], v12 offset:30720
    v_cvt_pk_bf16_f32 v4, v28, v29
    v_mfma_f32_16x16x32_bf16 v[144:147], a[196:199], v[40:43], v[144:147]
    ds_read_b64_tr_b16 a[212:213], v12 offset:18432
    v_mfma_f32_16x16x32_bf16 v[160:163], a[200:203], v[40:43], v[160:163]
    ds_read_b64_tr_b16 a[214:215], v12 offset:22528
    v_mfma_f32_16x16x32_bf16 v[160:163], a[232:235], v[44:47], v[160:163]
    v_exp_f32 v30, v30
    v_mfma_f32_16x16x32_bf16 v[176:179], a[236:239], v[44:47], v[176:179]
    v_exp_f32 v31, v31
    v_mfma_f32_16x16x32_bf16 v[176:179], a[204:207], v[40:43], v[176:179]
    ds_read_b64_tr_b16 a[216:217], v19 offset:19456
    v_cvt_pk_bf16_f32 v5, v30, v31
    v_smfmac_f32_16x16x64_bf16 a[112:115], a[108:111], v[40:47], v0
    ds_read_b64_tr_b16 a[218:219], v19 offset:23552
    v_mfma_f32_16x16x32_bf16 v[24:27], a[128:131], v[96:99], v[56:59]
    ds_read_b64_tr_b16 a[248:249], v19 offset:27648
    v_mfma_f32_16x16x32_bf16 v[24:27], a[132:135], v[100:103], v[24:27]
    ds_read_b64_tr_b16 a[250:251], v19 offset:31744
    v_mfma_f32_16x16x32_bf16 v[24:27], a[136:139], v[104:107], v[24:27]
    ds_read_b64_tr_b16 a[252:253], v12 offset:27648
    v_mfma_f32_16x16x32_bf16 v[24:27], a[140:143], v[108:111], v[24:27]
    ds_read_b64_tr_b16 a[254:255], v12 offset:31744
    v_mfma_f32_16x16x32_bf16 v[28:31], a[156:159], v[108:111], v[56:59]
    ds_read_b64_tr_b16 a[220:221], v12 offset:19456
    v_mfma_f32_16x16x32_bf16 v[28:31], a[152:155], v[104:107], v[28:31]
    ds_read_b64_tr_b16 a[222:223], v12 offset:23552
    v_mfma_f32_16x16x32_bf16 v[28:31], a[148:151], v[100:103], v[28:31]
    v_exp_f32 v32, v32
    v_mfma_f32_16x16x32_bf16 v[28:31], a[144:147], v[96:99], v[28:31]
    s_waitcnt lgkmcnt(4)
    v_exp_f32 v33, v33
    v_mfma_f32_16x16x32_bf16 v[192:195], a[208:211], v[40:43], v[192:195]
    v_exp_f32 v34, v34
    v_mfma_f32_16x16x32_bf16 v[192:195], a[240:243], v[44:47], v[192:195]
    v_exp_f32 v35, v35
    v_mfma_f32_16x16x32_bf16 v[208:211], a[244:247], v[44:47], v[208:211]
    v_cvt_pk_bf16_f32 v6, v32, v33
    v_cvt_pk_bf16_f32 v7, v34, v35
    v_mfma_f32_16x16x32_bf16 v[208:211], a[212:215], v[40:43], v[208:211]
    v_exp_f32 v36, v36
    v_mfma_f32_16x16x32_bf16 v[224:227], a[216:219], v[40:43], v[224:227]
    v_exp_f32 v37, v37
    v_mfma_f32_16x16x32_bf16 v[224:227], a[248:251], v[44:47], v[224:227]
    s_waitcnt lgkmcnt(2)
    v_exp_f32 v38, v38
    v_mfma_f32_16x16x32_bf16 v[240:243], a[252:255], v[44:47], v[240:243]
    s_waitcnt lgkmcnt(0)
    v_exp_f32 v39, v39
    v_mfma_f32_16x16x32_bf16 v[240:243], a[220:223], v[40:43], v[240:243]
    v_cvt_pk_bf16_f32 v8, v36, v37
    v_cvt_pk_bf16_f32 v9, v38, v39
    v_mfma_f32_16x16x32_bf16 v[32:35], a[160:163], v[96:99], v[56:59]
    v_exp_f32 v24, v24
    v_mfma_f32_16x16x32_bf16 v[32:35], a[164:167], v[100:103], v[32:35]
    v_exp_f32 v25, v25
    v_mfma_f32_16x16x32_bf16 v[32:35], a[168:171], v[104:107], v[32:35]
    v_cvt_pk_bf16_f32 v40, v24, v25
    v_mfma_f32_16x16x32_bf16 v[32:35], a[172:175], v[108:111], v[32:35]
    buffer_load_dwordx4 v15, s[24:27], s92 offen offset:1024  lds
    v_mfma_f32_16x16x32_bf16 v[36:39], a[188:191], v[108:111], v[56:59]
    s_add_u32 s92, s81, 960
    v_exp_f32 v26, v26
    v_mfma_f32_16x16x32_bf16 v[36:39], a[184:187], v[104:107], v[36:39]
    v_exp_f32 v27, v27
    v_mfma_f32_16x16x32_bf16 v[36:39], a[180:183], v[100:103], v[36:39]
    v_cvt_pk_bf16_f32 v41, v26, v27
    v_mfma_f32_16x16x32_bf16 v[36:39], a[176:179], v[96:99], v[36:39]
    buffer_load_dwordx4 v15, s[24:27], s92 offen offset:2048  lds
    v_mfma_f32_16x16x32_bf16 v[132:135], a[192:195], v[2:5], v[132:135]
    s_add_u32 s92, s81, 0
    v_exp_f32 v28, v28
    v_mfma_f32_16x16x32_bf16 v[132:135], a[224:227], v[6:9], v[132:135]
    v_exp_f32 v29, v29
    v_mfma_f32_16x16x32_bf16 v[148:151], a[228:231], v[6:9], v[148:151]
    v_cvt_pk_bf16_f32 v42, v28, v29
    v_mfma_f32_16x16x32_bf16 v[148:151], a[196:199], v[2:5], v[148:151]
    buffer_load_dwordx4 v15, s[24:27], s92 offen offset:3072  lds
    v_mfma_f32_16x16x32_bf16 v[164:167], a[200:203], v[2:5], v[164:167]
    v_exp_f32 v30, v30
    v_mfma_f32_16x16x32_bf16 v[164:167], a[232:235], v[6:9], v[164:167]
    v_exp_f32 v31, v31
    v_mfma_f32_16x16x32_bf16 v[180:183], a[236:239], v[6:9], v[180:183]
    v_cvt_pk_bf16_f32 v43, v30, v31
    v_mfma_f32_16x16x32_bf16 v[180:183], a[204:207], v[2:5], v[180:183]
    s_mov_b32 s84, 27
    s_waitcnt vmcnt(24)
    s_xor_b32 s55, s5, 0
    s_cmp_lt_u32 s55, 16
    s_cbranch_scc1 L_pack
L_packed:
    s_barrier
    s_cmp_lg_u32 s3, 0
    s_cbranch_scc1 L_no_arrive
    s_lshl_b32 s86, s4, 4
    s_add_u32 s86, s86, 128
    s_mov_b64 exec, 1
    v_mov_b32 v20, 1
    v_mov_b32 v21, s86
    buffer_atomic_add v20, v21, s[76:79], 0 offen
    s_mov_b64 exec, -1
L_no_arrive:
.p2align 6
L_main_loop:
    v_mfma_f32_16x16x32_bf16 v[24:27], a[128:131], v[112:115], v[60:63]
    s_waitcnt vmcnt(16)
    v_mfma_f32_16x16x32_bf16 v[24:27], a[132:135], v[116:119], v[24:27]
    s_barrier
    v_mfma_f32_16x16x32_bf16 v[24:27], a[136:139], v[120:123], v[24:27]
    s_add_u32 s81, s81, 16384
    v_exp_f32 v32, v32
    v_mfma_f32_16x16x32_bf16 v[24:27], a[140:143], v[124:127], v[24:27]
    s_and_b32 s81, s81, 0x7ffff
    v_exp_f32 v33, v33
    v_mfma_f32_16x16x32_bf16 v[28:31], a[156:159], v[124:127], v[60:63]
    s_add_u32 s82, s82, 32768
    ds_read_b128 a[128:131], v10 offset:0
    v_cvt_pk_bf16_f32 v44, v32, v33
    v_mfma_f32_16x16x32_bf16 v[28:31], a[152:155], v[120:123], v[28:31]
    s_sub_u32 s92, s82, 163840
    ds_read_b128 a[132:135], v10 offset:1024
    v_mfma_f32_16x16x32_bf16 v[28:31], a[148:151], v[116:119], v[28:31]
    s_min_u32 s82, s82, s92
    v_exp_f32 v34, v34
    v_mfma_f32_16x16x32_bf16 v[28:31], a[144:147], v[112:115], v[28:31]
    s_add_u32 m0, s82, 0
    v_exp_f32 v35, v35
    v_mfma_f32_16x16x32_bf16 v[196:199], a[208:211], v[2:5], v[196:199]
    s_add_u32 s92, s81, 2880
    ds_read_b128 a[136:139], v10 offset:2048
    v_cvt_pk_bf16_f32 v45, v34, v35
    v_mfma_f32_16x16x32_bf16 v[196:199], a[240:243], v[6:9], v[196:199]
    v_exp_f32 v36, v36
    v_mfma_f32_16x16x32_bf16 v[212:215], a[244:247], v[6:9], v[212:215]
    v_exp_f32 v37, v37
    v_mfma_f32_16x16x32_bf16 v[212:215], a[212:215], v[2:5], v[212:215]
    ds_read_b128 a[140:143], v10 offset:3072
    v_cvt_pk_bf16_f32 v46, v36, v37
    v_mfma_f32_16x16x32_bf16 v[228:231], a[216:219], v[2:5], v[228:231]
    ds_read_b128 a[156:159], v10 offset:7168
    v_mfma_f32_16x16x32_bf16 v[228:231], a[248:251], v[6:9], v[228:231]
    buffer_load_dwordx4 v15, s[20:23], s92 offen offset:0  lds
    v_mfma_f32_16x16x32_bf16 v[244:247], a[252:255], v[6:9], v[244:247]
    s_add_u32 s92, s81, 1920
    v_exp_f32 v38, v38
    v_mfma_f32_16x16x32_bf16 v[244:247], a[220:223], v[2:5], v[244:247]
    v_exp_f32 v39, v39
    v_smfmac_f32_16x16x64_bf16 a[116:119], a[108:111], v[2:9], v0
    ds_read_b128 a[152:155], v10 offset:6144
    v_cvt_pk_bf16_f32 v47, v38, v39
    v_mfma_f32_16x16x32_bf16 v[32:35], a[160:163], v[112:115], v[60:63]
    ds_read_b128 a[148:151], v10 offset:5120
    v_mfma_f32_16x16x32_bf16 v[32:35], a[164:167], v[116:119], v[32:35]
    buffer_load_dwordx4 v15, s[20:23], s92 offen offset:1024  lds
    v_mfma_f32_16x16x32_bf16 v[32:35], a[168:171], v[120:123], v[32:35]
    s_add_u32 s92, s81, 960
    v_exp_f32 v24, v24
    v_mfma_f32_16x16x32_bf16 v[32:35], a[172:175], v[124:127], v[32:35]
    v_exp_f32 v25, v25
    v_mfma_f32_16x16x32_bf16 v[36:39], a[188:191], v[124:127], v[60:63]
    ds_read_b128 a[144:147], v10 offset:4096
    v_cvt_pk_bf16_f32 v2, v24, v25
    v_mfma_f32_16x16x32_bf16 v[36:39], a[184:187], v[120:123], v[36:39]
    v_exp_f32 v26, v26
    v_mfma_f32_16x16x32_bf16 v[36:39], a[180:183], v[116:119], v[36:39]
    v_exp_f32 v27, v27
    v_mfma_f32_16x16x32_bf16 v[36:39], a[176:179], v[112:115], v[36:39]
    ds_read_b128 a[160:163], v10 offset:8192
    v_cvt_pk_bf16_f32 v3, v26, v27
    v_mfma_f32_16x16x32_bf16 v[136:139], a[192:195], v[40:43], v[136:139]
    v_exp_f32 v28, v28
    v_mfma_f32_16x16x32_bf16 v[136:139], a[224:227], v[44:47], v[136:139]
    v_exp_f32 v29, v29
    v_mfma_f32_16x16x32_bf16 v[152:155], a[228:231], v[44:47], v[152:155]
    ds_read_b128 a[164:167], v10 offset:9216
    v_cvt_pk_bf16_f32 v4, v28, v29
    v_mfma_f32_16x16x32_bf16 v[152:155], a[196:199], v[40:43], v[152:155]
    ds_read_b128 a[168:171], v10 offset:10240
    v_mfma_f32_16x16x32_bf16 v[168:171], a[200:203], v[40:43], v[168:171]
    buffer_load_dwordx4 v15, s[20:23], s92 offen offset:2048  lds
    v_mfma_f32_16x16x32_bf16 v[168:171], a[232:235], v[44:47], v[168:171]
    s_add_u32 s92, s81, 0
    v_exp_f32 v30, v30
    v_mfma_f32_16x16x32_bf16 v[184:187], a[236:239], v[44:47], v[184:187]
    v_exp_f32 v31, v31
    v_mfma_f32_16x16x32_bf16 v[184:187], a[204:207], v[40:43], v[184:187]
    s_waitcnt lgkmcnt(3)
    ds_read_b128 a[172:175], v10 offset:11264
    v_cvt_pk_bf16_f32 v5, v30, v31
    v_mfma_f32_16x16x32_bf16 v[24:27], a[128:131], v[64:67], v[48:51]
    ds_read_b128 a[188:191], v10 offset:15360
    v_mfma_f32_16x16x32_bf16 v[24:27], a[132:135], v[68:71], v[24:27]
    buffer_load_dwordx4 v15, s[20:23], s92 offen offset:3072  lds
    v_mfma_f32_16x16x32_bf16 v[24:27], a[136:139], v[72:75], v[24:27]
    s_add_u32 m0, s82, 16384
    v_exp_f32 v32, v32
    v_mfma_f32_16x16x32_bf16 v[24:27], a[140:143], v[76:79], v[24:27]
    s_add_u32 s92, s81, 2880
    v_exp_f32 v33, v33
    v_mfma_f32_16x16x32_bf16 v[28:31], a[156:159], v[76:79], v[48:51]
    ds_read_b128 a[184:187], v10 offset:14336
    v_cvt_pk_bf16_f32 v6, v32, v33
    v_mfma_f32_16x16x32_bf16 v[28:31], a[152:155], v[72:75], v[28:31]
    v_add_u32 v19, s83, v14
    v_xor_b32 v12, 32, v19
    v_mfma_f32_16x16x32_bf16 v[28:31], a[148:151], v[68:71], v[28:31]
    v_exp_f32 v34, v34
    v_mfma_f32_16x16x32_bf16 v[28:31], a[144:147], v[64:67], v[28:31]
    v_exp_f32 v35, v35
    v_mfma_f32_16x16x32_bf16 v[200:203], a[208:211], v[40:43], v[200:203]
    ds_read_b128 a[180:183], v10 offset:13312
    v_cvt_pk_bf16_f32 v7, v34, v35
    v_mfma_f32_16x16x32_bf16 v[200:203], a[240:243], v[44:47], v[200:203]
    s_add_u32 s83, s83, 32768
    v_exp_f32 v36, v36
    v_mfma_f32_16x16x32_bf16 v[216:219], a[244:247], v[44:47], v[216:219]
    s_sub_u32 s90, s83, 163840
    v_exp_f32 v37, v37
    v_mfma_f32_16x16x32_bf16 v[216:219], a[212:215], v[40:43], v[216:219]
    s_min_u32 s83, s83, s90
    ds_read_b128 a[176:179], v10 offset:12288
    v_cvt_pk_bf16_f32 v8, v36, v37
    v_mfma_f32_16x16x32_bf16 v[232:235], a[216:219], v[40:43], v[232:235]
    v_add_u32 v10, s83, v13
    v_mfma_f32_16x16x32_bf16 v[232:235], a[248:251], v[44:47], v[232:235]
    buffer_load_dwordx4 v15, s[24:27], s92 offen offset:0  lds
    v_mfma_f32_16x16x32_bf16 v[248:251], a[252:255], v[44:47], v[248:251]
    s_add_u32 s92, s81, 1920
    v_exp_f32 v38, v38
    v_mfma_f32_16x16x32_bf16 v[248:251], a[220:223], v[40:43], v[248:251]
    v_exp_f32 v39, v39
    v_smfmac_f32_16x16x64_bf16 a[120:123], a[108:111], v[40:47], v0
    s_waitcnt lgkmcnt(3)
    v_cvt_pk_bf16_f32 v9, v38, v39
    v_mfma_f32_16x16x32_bf16 v[32:35], a[160:163], v[64:67], v[48:51]
    v_exp_f32 v24, v24
    v_mfma_f32_16x16x32_bf16 v[32:35], a[164:167], v[68:71], v[32:35]
    v_exp_f32 v25, v25
    v_mfma_f32_16x16x32_bf16 v[32:35], a[168:171], v[72:75], v[32:35]
    v_exp_f32 v26, v26
    v_mfma_f32_16x16x32_bf16 v[32:35], a[172:175], v[76:79], v[32:35]
    v_exp_f32 v27, v27
    v_mfma_f32_16x16x32_bf16 v[36:39], a[188:191], v[76:79], v[48:51]
    s_waitcnt lgkmcnt(2)
    v_exp_f32 v28, v28
    v_mfma_f32_16x16x32_bf16 v[36:39], a[184:187], v[72:75], v[36:39]
    s_waitcnt lgkmcnt(1)
    v_exp_f32 v29, v29
    v_mfma_f32_16x16x32_bf16 v[36:39], a[180:183], v[68:71], v[36:39]
    s_waitcnt lgkmcnt(0)
    v_exp_f32 v30, v30
    v_mfma_f32_16x16x32_bf16 v[36:39], a[176:179], v[64:67], v[36:39]
    v_exp_f32 v31, v31
    v_mfma_f32_16x16x32_bf16 v[140:143], a[192:195], v[2:5], v[140:143]
    v_cvt_pk_bf16_f32 v40, v24, v25
    v_cvt_pk_bf16_f32 v41, v26, v27
    v_mfma_f32_16x16x32_bf16 v[140:143], a[224:227], v[6:9], v[140:143]
    ds_read_b64_tr_b16 a[192:193], v19 offset:16384
    v_cvt_pk_bf16_f32 v42, v28, v29
    v_mfma_f32_16x16x32_bf16 v[156:159], a[228:231], v[6:9], v[156:159]
    ds_read_b64_tr_b16 a[194:195], v19 offset:20480
    v_mfma_f32_16x16x32_bf16 v[156:159], a[196:199], v[2:5], v[156:159]
    ds_read_b64_tr_b16 a[224:225], v19 offset:24576
    v_cvt_pk_bf16_f32 v43, v30, v31
    v_mfma_f32_16x16x32_bf16 v[172:175], a[200:203], v[2:5], v[172:175]
    ds_read_b64_tr_b16 a[226:227], v19 offset:28672
    v_mfma_f32_16x16x32_bf16 v[172:175], a[232:235], v[6:9], v[172:175]
    ds_read_b64_tr_b16 a[228:229], v12 offset:24576
    v_mfma_f32_16x16x32_bf16 v[188:191], a[236:239], v[6:9], v[188:191]
    ds_read_b64_tr_b16 a[230:231], v12 offset:28672
    v_mfma_f32_16x16x32_bf16 v[188:191], a[204:207], v[2:5], v[188:191]
    ds_read_b64_tr_b16 a[196:197], v12 offset:16384
    v_mfma_f32_16x16x32_bf16 v[24:27], a[128:131], v[80:83], v[52:55]
    ds_read_b64_tr_b16 a[198:199], v12 offset:20480
    v_mfma_f32_16x16x32_bf16 v[24:27], a[132:135], v[84:87], v[24:27]
    ds_read_b64_tr_b16 a[200:201], v19 offset:17408
    v_mfma_f32_16x16x32_bf16 v[24:27], a[136:139], v[88:91], v[24:27]
    v_exp_f32 v32, v32
    v_mfma_f32_16x16x32_bf16 v[24:27], a[140:143], v[92:95], v[24:27]
    v_exp_f32 v33, v33
    v_mfma_f32_16x16x32_bf16 v[28:31], a[156:159], v[92:95], v[52:55]
    ds_read_b64_tr_b16 a[202:203], v19 offset:21504
    v_cvt_pk_bf16_f32 v44, v32, v33
    v_mfma_f32_16x16x32_bf16 v[28:31], a[152:155], v[88:91], v[28:31]
    ds_read_b64_tr_b16 a[232:233], v19 offset:25600
    v_mfma_f32_16x16x32_bf16 v[28:31], a[148:151], v[84:87], v[28:31]
    v_exp_f32 v34, v34
    v_mfma_f32_16x16x32_bf16 v[28:31], a[144:147], v[80:83], v[28:31]
    v_exp_f32 v35, v35
    v_mfma_f32_16x16x32_bf16 v[204:207], a[208:211], v[2:5], v[204:207]
    ds_read_b64_tr_b16 a[234:235], v19 offset:29696
    v_cvt_pk_bf16_f32 v45, v34, v35
    v_mfma_f32_16x16x32_bf16 v[204:207], a[240:243], v[6:9], v[204:207]
    v_exp_f32 v36, v36
    v_mfma_f32_16x16x32_bf16 v[220:223], a[244:247], v[6:9], v[220:223]
    v_exp_f32 v37, v37
    v_mfma_f32_16x16x32_bf16 v[220:223], a[212:215], v[2:5], v[220:223]
    ds_read_b64_tr_b16 a[236:237], v12 offset:25600
    v_cvt_pk_bf16_f32 v46, v36, v37
    v_mfma_f32_16x16x32_bf16 v[236:239], a[216:219], v[2:5], v[236:239]
    ds_read_b64_tr_b16 a[238:239], v12 offset:29696
    v_mfma_f32_16x16x32_bf16 v[236:239], a[248:251], v[6:9], v[236:239]
    ds_read_b64_tr_b16 a[204:205], v12 offset:17408
    v_mfma_f32_16x16x32_bf16 v[252:255], a[252:255], v[6:9], v[252:255]
    v_exp_f32 v38, v38
    v_mfma_f32_16x16x32_bf16 v[252:255], a[220:223], v[2:5], v[252:255]
    v_exp_f32 v39, v39
    v_smfmac_f32_16x16x64_bf16 a[124:127], a[108:111], v[2:9], v0
    ds_read_b64_tr_b16 a[206:207], v12 offset:21504
    v_cvt_pk_bf16_f32 v47, v38, v39
    v_mfma_f32_16x16x32_bf16 v[32:35], a[160:163], v[80:83], v[52:55]
    ds_read_b64_tr_b16 a[208:209], v19 offset:18432
    v_mfma_f32_16x16x32_bf16 v[32:35], a[164:167], v[84:87], v[32:35]
    ds_read_b64_tr_b16 a[210:211], v19 offset:22528
    v_mfma_f32_16x16x32_bf16 v[32:35], a[168:171], v[88:91], v[32:35]
    ds_read_b64_tr_b16 a[240:241], v19 offset:26624
    v_exp_f32 v24, v24
    v_mfma_f32_16x16x32_bf16 v[32:35], a[172:175], v[92:95], v[32:35]
    v_exp_f32 v25, v25
    v_mfma_f32_16x16x32_bf16 v[36:39], a[188:191], v[92:95], v[52:55]
    ds_read_b64_tr_b16 a[242:243], v19 offset:30720
    v_cvt_pk_bf16_f32 v2, v24, v25
    v_mfma_f32_16x16x32_bf16 v[36:39], a[184:187], v[88:91], v[36:39]
    v_exp_f32 v26, v26
    v_mfma_f32_16x16x32_bf16 v[36:39], a[180:183], v[84:87], v[36:39]
    v_exp_f32 v27, v27
    v_mfma_f32_16x16x32_bf16 v[36:39], a[176:179], v[80:83], v[36:39]
    s_waitcnt lgkmcnt(4)
    ds_read_b64_tr_b16 a[244:245], v12 offset:26624
    v_cvt_pk_bf16_f32 v3, v26, v27
    v_mfma_f32_16x16x32_bf16 v[128:131], a[192:195], v[40:43], v[128:131]
    v_exp_f32 v28, v28
    v_mfma_f32_16x16x32_bf16 v[128:131], a[224:227], v[44:47], v[128:131]
    v_exp_f32 v29, v29
    v_mfma_f32_16x16x32_bf16 v[144:147], a[228:231], v[44:47], v[144:147]
    ds_read_b64_tr_b16 a[246:247], v12 offset:30720
    v_cvt_pk_bf16_f32 v4, v28, v29
    v_mfma_f32_16x16x32_bf16 v[144:147], a[196:199], v[40:43], v[144:147]
    ds_read_b64_tr_b16 a[212:213], v12 offset:18432
    v_mfma_f32_16x16x32_bf16 v[160:163], a[200:203], v[40:43], v[160:163]
    ds_read_b64_tr_b16 a[214:215], v12 offset:22528
    v_mfma_f32_16x16x32_bf16 v[160:163], a[232:235], v[44:47], v[160:163]
    v_exp_f32 v30, v30
    v_mfma_f32_16x16x32_bf16 v[176:179], a[236:239], v[44:47], v[176:179]
    v_exp_f32 v31, v31
    v_mfma_f32_16x16x32_bf16 v[176:179], a[204:207], v[40:43], v[176:179]
    ds_read_b64_tr_b16 a[216:217], v19 offset:19456
    v_cvt_pk_bf16_f32 v5, v30, v31
    v_smfmac_f32_16x16x64_bf16 a[112:115], a[108:111], v[40:47], v0
    ds_read_b64_tr_b16 a[218:219], v19 offset:23552
    v_mfma_f32_16x16x32_bf16 v[24:27], a[128:131], v[96:99], v[56:59]
    ds_read_b64_tr_b16 a[248:249], v19 offset:27648
    v_mfma_f32_16x16x32_bf16 v[24:27], a[132:135], v[100:103], v[24:27]
    ds_read_b64_tr_b16 a[250:251], v19 offset:31744
    v_mfma_f32_16x16x32_bf16 v[24:27], a[136:139], v[104:107], v[24:27]
    ds_read_b64_tr_b16 a[252:253], v12 offset:27648
    v_mfma_f32_16x16x32_bf16 v[24:27], a[140:143], v[108:111], v[24:27]
    ds_read_b64_tr_b16 a[254:255], v12 offset:31744
    v_mfma_f32_16x16x32_bf16 v[28:31], a[156:159], v[108:111], v[56:59]
    ds_read_b64_tr_b16 a[220:221], v12 offset:19456
    v_mfma_f32_16x16x32_bf16 v[28:31], a[152:155], v[104:107], v[28:31]
    ds_read_b64_tr_b16 a[222:223], v12 offset:23552
    v_mfma_f32_16x16x32_bf16 v[28:31], a[148:151], v[100:103], v[28:31]
    v_exp_f32 v32, v32
    v_mfma_f32_16x16x32_bf16 v[28:31], a[144:147], v[96:99], v[28:31]
    s_waitcnt lgkmcnt(4)
    v_exp_f32 v33, v33
    v_mfma_f32_16x16x32_bf16 v[192:195], a[208:211], v[40:43], v[192:195]
    v_exp_f32 v34, v34
    v_mfma_f32_16x16x32_bf16 v[192:195], a[240:243], v[44:47], v[192:195]
    v_exp_f32 v35, v35
    v_mfma_f32_16x16x32_bf16 v[208:211], a[244:247], v[44:47], v[208:211]
    v_cvt_pk_bf16_f32 v6, v32, v33
    v_cvt_pk_bf16_f32 v7, v34, v35
    v_mfma_f32_16x16x32_bf16 v[208:211], a[212:215], v[40:43], v[208:211]
    v_exp_f32 v36, v36
    v_mfma_f32_16x16x32_bf16 v[224:227], a[216:219], v[40:43], v[224:227]
    v_exp_f32 v37, v37
    v_mfma_f32_16x16x32_bf16 v[224:227], a[248:251], v[44:47], v[224:227]
    s_waitcnt lgkmcnt(2)
    v_exp_f32 v38, v38
    v_mfma_f32_16x16x32_bf16 v[240:243], a[252:255], v[44:47], v[240:243]
    s_waitcnt lgkmcnt(0)
    v_exp_f32 v39, v39
    v_mfma_f32_16x16x32_bf16 v[240:243], a[220:223], v[40:43], v[240:243]
    v_cvt_pk_bf16_f32 v8, v36, v37
    v_cvt_pk_bf16_f32 v9, v38, v39
    v_mfma_f32_16x16x32_bf16 v[32:35], a[160:163], v[96:99], v[56:59]
    v_exp_f32 v24, v24
    v_mfma_f32_16x16x32_bf16 v[32:35], a[164:167], v[100:103], v[32:35]
    v_exp_f32 v25, v25
    v_mfma_f32_16x16x32_bf16 v[32:35], a[168:171], v[104:107], v[32:35]
    v_cvt_pk_bf16_f32 v40, v24, v25
    v_mfma_f32_16x16x32_bf16 v[32:35], a[172:175], v[108:111], v[32:35]
    buffer_load_dwordx4 v15, s[24:27], s92 offen offset:1024  lds
    v_mfma_f32_16x16x32_bf16 v[36:39], a[188:191], v[108:111], v[56:59]
    s_add_u32 s92, s81, 960
    v_exp_f32 v26, v26
    v_mfma_f32_16x16x32_bf16 v[36:39], a[184:187], v[104:107], v[36:39]
    v_exp_f32 v27, v27
    v_mfma_f32_16x16x32_bf16 v[36:39], a[180:183], v[100:103], v[36:39]
    v_cvt_pk_bf16_f32 v41, v26, v27
    v_mfma_f32_16x16x32_bf16 v[36:39], a[176:179], v[96:99], v[36:39]
    buffer_load_dwordx4 v15, s[24:27], s92 offen offset:2048  lds
    v_mfma_f32_16x16x32_bf16 v[132:135], a[192:195], v[2:5], v[132:135]
    s_add_u32 s92, s81, 0
    v_exp_f32 v28, v28
    v_mfma_f32_16x16x32_bf16 v[132:135], a[224:227], v[6:9], v[132:135]
    v_exp_f32 v29, v29
    v_mfma_f32_16x16x32_bf16 v[148:151], a[228:231], v[6:9], v[148:151]
    v_cvt_pk_bf16_f32 v42, v28, v29
    v_mfma_f32_16x16x32_bf16 v[148:151], a[196:199], v[2:5], v[148:151]
    buffer_load_dwordx4 v15, s[24:27], s92 offen offset:3072  lds
    v_mfma_f32_16x16x32_bf16 v[164:167], a[200:203], v[2:5], v[164:167]
    v_exp_f32 v30, v30
    v_mfma_f32_16x16x32_bf16 v[164:167], a[232:235], v[6:9], v[164:167]
    s_sub_u32 s84, s84, 1
    v_exp_f32 v31, v31
    v_mfma_f32_16x16x32_bf16 v[180:183], a[236:239], v[6:9], v[180:183]
    s_cmp_lg_u32 s84, 0
    v_cvt_pk_bf16_f32 v43, v30, v31
    v_mfma_f32_16x16x32_bf16 v[180:183], a[204:207], v[2:5], v[180:183]
    s_cbranch_scc1 L_main_loop
    v_mfma_f32_16x16x32_bf16 v[24:27], a[128:131], v[112:115], v[60:63]
    s_waitcnt vmcnt(16)
    v_and_b32 v21, 0x70, v1
    v_add_u32 v21, 128, v21
    v_mfma_f32_16x16x32_bf16 v[24:27], a[132:135], v[116:119], v[24:27]
    s_barrier
    v_lshlrev_b32 v22, 3, v1
    v_mfma_f32_16x16x32_bf16 v[24:27], a[136:139], v[120:123], v[24:27]
    s_and_b32 s68, s5, 31
    v_exp_f32 v32, v32
    v_mfma_f32_16x16x32_bf16 v[24:27], a[140:143], v[124:127], v[24:27]
    s_mul_i32 s68, s68, 9472
    v_exp_f32 v33, v33
    v_mfma_f32_16x16x32_bf16 v[28:31], a[156:159], v[124:127], v[60:63]
    s_add_u32 s68, s68, s80
    ds_read_b128 a[128:131], v10 offset:0
    v_cvt_pk_bf16_f32 v44, v32, v33
    v_mfma_f32_16x16x32_bf16 v[28:31], a[152:155], v[120:123], v[28:31]
    s_add_u32 s69, s68, 8192
    ds_read_b128 a[132:135], v10 offset:1024
    v_mfma_f32_16x16x32_bf16 v[28:31], a[148:151], v[116:119], v[28:31]
    s_add_u32 s70, s68, 16384
    v_exp_f32 v34, v34
    v_mfma_f32_16x16x32_bf16 v[28:31], a[144:147], v[112:115], v[28:31]
    s_lshl_b32 s87, s3, 11
    v_exp_f32 v35, v35
    v_mfma_f32_16x16x32_bf16 v[196:199], a[208:211], v[2:5], v[196:199]
    s_add_u32 m0, s87, 153600
    ds_read_b128 a[136:139], v10 offset:2048
    v_cvt_pk_bf16_f32 v45, v34, v35
    v_mfma_f32_16x16x32_bf16 v[196:199], a[240:243], v[6:9], v[196:199]
    s_add_u32 s87, s87, 4096
    v_exp_f32 v36, v36
    v_mfma_f32_16x16x32_bf16 v[212:215], a[244:247], v[6:9], v[212:215]
    s_lshr_b32 s86, s4, 1
    v_exp_f32 v37, v37
    v_mfma_f32_16x16x32_bf16 v[212:215], a[212:215], v[2:5], v[212:215]
    s_lshl_b32 s59, s4, 16
    ds_read_b128 a[140:143], v10 offset:3072
    v_cvt_pk_bf16_f32 v46, v36, v37
    v_mfma_f32_16x16x32_bf16 v[228:231], a[216:219], v[2:5], v[228:231]
    s_add_u32 s59, s59, s91
    ds_read_b128 a[156:159], v10 offset:7168
    v_mfma_f32_16x16x32_bf16 v[228:231], a[248:251], v[6:9], v[228:231]
    buffer_load_dword v20, v21, s[76:79], 0 offen sc1
    v_mfma_f32_16x16x32_bf16 v[244:247], a[252:255], v[6:9], v[244:247]
    s_add_u32 s40, s86, 1
    v_exp_f32 v38, v38
    v_mfma_f32_16x16x32_bf16 v[244:247], a[220:223], v[2:5], v[244:247]
    s_and_b32 s40, s40, 3
    v_exp_f32 v39, v39
    v_smfmac_f32_16x16x64_bf16 a[116:119], a[108:111], v[2:9], v0
    s_lshl_b32 s40, s40, 14
    ds_read_b128 a[152:155], v10 offset:6144
    v_cvt_pk_bf16_f32 v47, v38, v39
    v_mfma_f32_16x16x32_bf16 v[32:35], a[160:163], v[112:115], v[60:63]
    s_add_u32 s40, s40, s59
    ds_read_b128 a[148:151], v10 offset:5120
    v_mfma_f32_16x16x32_bf16 v[32:35], a[164:167], v[116:119], v[32:35]
    s_add_u32 s41, s86, 2
    v_mfma_f32_16x16x32_bf16 v[32:35], a[168:171], v[120:123], v[32:35]
    s_and_b32 s41, s41, 3
    v_exp_f32 v24, v24
    v_mfma_f32_16x16x32_bf16 v[32:35], a[172:175], v[124:127], v[32:35]
    s_lshl_b32 s41, s41, 14
    v_exp_f32 v25, v25
    v_mfma_f32_16x16x32_bf16 v[36:39], a[188:191], v[124:127], v[60:63]
    s_add_u32 s41, s41, s59
    ds_read_b128 a[144:147], v10 offset:4096
    v_cvt_pk_bf16_f32 v2, v24, v25
    v_mfma_f32_16x16x32_bf16 v[36:39], a[184:187], v[120:123], v[36:39]
    s_add_u32 s42, s86, 3
    v_exp_f32 v26, v26
    v_mfma_f32_16x16x32_bf16 v[36:39], a[180:183], v[116:119], v[36:39]
    s_and_b32 s42, s42, 3
    v_exp_f32 v27, v27
    v_mfma_f32_16x16x32_bf16 v[36:39], a[176:179], v[112:115], v[36:39]
    s_lshl_b32 s42, s42, 14
    ds_read_b128 a[160:163], v10 offset:8192
    v_cvt_pk_bf16_f32 v3, v26, v27
    v_mfma_f32_16x16x32_bf16 v[136:139], a[192:195], v[40:43], v[136:139]
    s_add_u32 s42, s42, s59
    v_exp_f32 v28, v28
    v_mfma_f32_16x16x32_bf16 v[136:139], a[224:227], v[44:47], v[136:139]
    s_add_u32 s43, s86, 4
    v_exp_f32 v29, v29
    v_mfma_f32_16x16x32_bf16 v[152:155], a[228:231], v[44:47], v[152:155]
    s_and_b32 s43, s43, 3
    ds_read_b128 a[164:167], v10 offset:9216
    v_cvt_pk_bf16_f32 v4, v28, v29
    v_mfma_f32_16x16x32_bf16 v[152:155], a[196:199], v[40:43], v[152:155]
    s_lshl_b32 s43, s43, 14
    ds_read_b128 a[168:171], v10 offset:10240
    v_mfma_f32_16x16x32_bf16 v[168:171], a[200:203], v[40:43], v[168:171]
    s_add_u32 s43, s43, s59
    v_mfma_f32_16x16x32_bf16 v[168:171], a[232:235], v[44:47], v[168:171]
    s_add_u32 s60, s3, 0
    v_exp_f32 v30, v30
    v_mfma_f32_16x16x32_bf16 v[184:187], a[236:239], v[44:47], v[184:187]
    s_and_b32 s60, s60, 3
    v_exp_f32 v31, v31
    v_mfma_f32_16x16x32_bf16 v[184:187], a[204:207], v[40:43], v[184:187]
    s_waitcnt lgkmcnt(3)
    ds_read_b128 a[172:175], v10 offset:11264
    v_cvt_pk_bf16_f32 v5, v30, v31
    v_mfma_f32_16x16x32_bf16 v[24:27], a[128:131], v[64:67], v[48:51]
    s_lshl_b32 s60, s60, 14
    ds_read_b128 a[188:191], v10 offset:15360
    v_mfma_f32_16x16x32_bf16 v[24:27], a[132:135], v[68:71], v[24:27]
    s_add_u32 s60, s60, 65536
    v_mfma_f32_16x16x32_bf16 v[24:27], a[136:139], v[72:75], v[24:27]
    s_add_u32 s61, s3, 1
    v_exp_f32 v32, v32
    v_mfma_f32_16x16x32_bf16 v[24:27], a[140:143], v[76:79], v[24:27]
    s_and_b32 s61, s61, 3
    v_exp_f32 v33, v33
    v_mfma_f32_16x16x32_bf16 v[28:31], a[156:159], v[76:79], v[48:51]
    s_lshl_b32 s61, s61, 14
    ds_read_b128 a[184:187], v10 offset:14336
    v_cvt_pk_bf16_f32 v6, v32, v33
    v_mfma_f32_16x16x32_bf16 v[28:31], a[152:155], v[72:75], v[28:31]
    s_add_u32 s61, s61, 65536
    v_add_u32 v19, s83, v14
    v_xor_b32 v12, 32, v19
    v_mfma_f32_16x16x32_bf16 v[28:31], a[148:151], v[68:71], v[28:31]
    s_add_u32 s62, s3, 2
    v_exp_f32 v34, v34
    v_mfma_f32_16x16x32_bf16 v[28:31], a[144:147], v[64:67], v[28:31]
    s_branch L_ov6
L_pad6:
    s_setpc_b64 s[86:87]
L_ov6:
    s_and_b32 s62, s62, 3
    v_exp_f32 v35, v35
    v_mfma_f32_16x16x32_bf16 v[200:203], a[208:211], v[40:43], v[200:203]
    s_lshl_b32 s62, s62, 14
    ds_read_b128 a[180:183], v10 offset:13312
    v_cvt_pk_bf16_f32 v7, v34, v35
    v_mfma_f32_16x16x32_bf16 v[200:203], a[240:243], v[44:47], v[200:203]
    s_add_u32 s83, s83, 32768
    v_exp_f32 v36, v36
    v_mfma_f32_16x16x32_bf16 v[216:219], a[244:247], v[44:47], v[216:219]
    s_sub_u32 s90, s83, 163840
    v_exp_f32 v37, v37
    v_mfma_f32_16x16x32_bf16 v[216:219], a[212:215], v[40:43], v[216:219]
    s_min_u32 s83, s83, s90
    ds_read_b128 a[176:179], v10 offset:12288
    v_cvt_pk_bf16_f32 v8, v36, v37
    v_mfma_f32_16x16x32_bf16 v[232:235], a[216:219], v[40:43], v[232:235]
    s_add_u32 s62, s62, 65536
    v_add_u32 v10, s83, v13
    v_mfma_f32_16x16x32_bf16 v[232:235], a[248:251], v[44:47], v[232:235]
    s_add_u32 s63, s3, 3
    v_mfma_f32_16x16x32_bf16 v[248:251], a[252:255], v[44:47], v[248:251]
    s_and_b32 s63, s63, 3
    v_exp_f32 v38, v38
    v_mfma_f32_16x16x32_bf16 v[248:251], a[220:223], v[40:43], v[248:251]
    s_lshl_b32 s63, s63, 14
    v_exp_f32 v39, v39
    v_smfmac_f32_16x16x64_bf16 a[120:123], a[108:111], v[40:47], v0
    s_waitcnt lgkmcnt(3)
    v_cvt_pk_bf16_f32 v9, v38, v39
    v_mfma_f32_16x16x32_bf16 v[32:35], a[160:163], v[64:67], v[48:51]
    s_add_u32 s63, s63, 65536
    v_exp_f32 v24, v24
    v_mfma_f32_16x16x32_bf16 v[32:35], a[164:167], v[68:71], v[32:35]
    s_sub_u32 s59, s3, s86
    v_exp_f32 v25, v25
    v_mfma_f32_16x16x32_bf16 v[32:35], a[168:171], v[72:75], v[32:35]
    s_add_u32 s59, s59, 3
    v_exp_f32 v26, v26
    v_mfma_f32_16x16x32_bf16 v[32:35], a[172:175], v[76:79], v[32:35]
    s_and_b32 s59, s59, 3
    v_exp_f32 v27, v27
    v_mfma_f32_16x16x32_bf16 v[36:39], a[188:191], v[76:79], v[48:51]
    s_waitcnt lgkmcnt(2)
    v_exp_f32 v28, v28
    v_mfma_f32_16x16x32_bf16 v[36:39], a[184:187], v[72:75], v[36:39]
    s_waitcnt lgkmcnt(1)
    v_exp_f32 v29, v29
    v_mfma_f32_16x16x32_bf16 v[36:39], a[180:183], v[68:71], v[36:39]
    s_waitcnt lgkmcnt(0)
    v_exp_f32 v30, v30
    v_mfma_f32_16x16x32_bf16 v[36:39], a[176:179], v[64:67], v[36:39]
    s_lshl_b32 s59, s59, 14
    v_exp_f32 v31, v31
    v_mfma_f32_16x16x32_bf16 v[140:143], a[192:195], v[2:5], v[140:143]
    s_lshl_b32 s86, s86, 1
    v_cvt_pk_bf16_f32 v40, v24, v25
    v_cvt_pk_bf16_f32 v41, v26, v27
    v_mfma_f32_16x16x32_bf16 v[140:143], a[224:227], v[6:9], v[140:143]
    s_add_u32 s44, s86, 6
    ds_read_b64_tr_b16 a[192:193], v19 offset:16384
    v_cvt_pk_bf16_f32 v42, v28, v29
    v_mfma_f32_16x16x32_bf16 v[156:159], a[228:231], v[6:9], v[156:159]
    s_and_b32 s44, s44, 7
    ds_read_b64_tr_b16 a[194:195], v19 offset:20480
    v_mfma_f32_16x16x32_bf16 v[156:159], a[196:199], v[2:5], v[156:159]
    s_lshl_b32 s44, s44, 16
    ds_read_b64_tr_b16 a[224:225], v19 offset:24576
    v_cvt_pk_bf16_f32 v43, v30, v31
    v_mfma_f32_16x16x32_bf16 v[172:175], a[200:203], v[2:5], v[172:175]
    s_add_u32 s45, s86, 7
    ds_read_b64_tr_b16 a[226:227], v19 offset:28672
    v_mfma_f32_16x16x32_bf16 v[172:175], a[232:235], v[6:9], v[172:175]
    s_and_b32 s45, s45, 7
    ds_read_b64_tr_b16 a[228:229], v12 offset:24576
    v_mfma_f32_16x16x32_bf16 v[188:191], a[236:239], v[6:9], v[188:191]
    s_lshl_b32 s45, s45, 16
    ds_read_b64_tr_b16 a[230:231], v12 offset:28672
    v_mfma_f32_16x16x32_bf16 v[188:191], a[204:207], v[2:5], v[188:191]
    s_add_u32 s46, s86, 4
    ds_read_b64_tr_b16 a[196:197], v12 offset:16384
    v_mfma_f32_16x16x32_bf16 v[24:27], a[128:131], v[80:83], v[52:55]
    s_and_b32 s46, s46, 7
    ds_read_b64_tr_b16 a[198:199], v12 offset:20480
    v_mfma_f32_16x16x32_bf16 v[24:27], a[132:135], v[84:87], v[24:27]
    ds_read_b64_tr_b16 a[200:201], v19 offset:17408
    s_waitcnt vmcnt(0)
    v_cmp_gt_u32 vcc, 32, v20
    s_nop 1
    s_cbranch_vccnz L_arr_wait
L_arr_ok:
    buffer_load_dword a104, v22, s[16:19], s68 offen sc1
    v_mfma_f32_16x16x32_bf16 v[24:27], a[136:139], v[88:91], v[24:27]
    s_lshl_b32 s46, s46, 16
    v_exp_f32 v32, v32
    v_mfma_f32_16x16x32_bf16 v[24:27], a[140:143], v[92:95], v[24:27]
    s_add_u32 s47, s86, 5
    v_exp_f32 v33, v33
    v_mfma_f32_16x16x32_bf16 v[28:31], a[156:159], v[92:95], v[52:55]
    s_and_b32 s47, s47, 7
    ds_read_b64_tr_b16 a[202:203], v19 offset:21504
    v_cvt_pk_bf16_f32 v44, v32, v33
    v_mfma_f32_16x16x32_bf16 v[28:31], a[152:155], v[88:91], v[28:31]
    s_lshl_b32 s47, s47, 16
    ds_read_b64_tr_b16 a[232:233], v19 offset:25600
    v_mfma_f32_16x16x32_bf16 v[28:31], a[148:151], v[84:87], v[28:31]
    s_add_u32 s48, s86, 2
    v_exp_f32 v34, v34
    v_mfma_f32_16x16x32_bf16 v[28:31], a[144:147], v[80:83], v[28:31]
    s_and_b32 s48, s48, 7
    v_exp_f32 v35, v35
    v_mfma_f32_16x16x32_bf16 v[204:207], a[208:211], v[2:5], v[204:207]
    s_lshl_b32 s48, s48, 16
    ds_read_b64_tr_b16 a[234:235], v19 offset:29696
    v_cvt_pk_bf16_f32 v45, v34, v35
    v_mfma_f32_16x16x32_bf16 v[204:207], a[240:243], v[6:9], v[204:207]
    s_add_u32 s49, s86, 3
    v_exp_f32 v36, v36
    v_mfma_f32_16x16x32_bf16 v[220:223], a[244:247], v[6:9], v[220:223]
    s_and_b32 s49, s49, 7
    v_exp_f32 v37, v37
    v_mfma_f32_16x16x32_bf16 v[220:223], a[212:215], v[2:5], v[220:223]
    s_lshl_b32 s49, s49, 16
    ds_read_b64_tr_b16 a[236:237], v12 offset:25600
    v_cvt_pk_bf16_f32 v46, v36, v37
    v_mfma_f32_16x16x32_bf16 v[236:239], a[216:219], v[2:5], v[236:239]
    s_xor_b32 s50, s4, 1
    ds_read_b64_tr_b16 a[238:239], v12 offset:29696
    v_mfma_f32_16x16x32_bf16 v[236:239], a[248:251], v[6:9], v[236:239]
    ds_read_b64_tr_b16 a[204:205], v12 offset:17408
    buffer_load_dword a104, v22, s[16:19], s69 offen sc1
    v_mfma_f32_16x16x32_bf16 v[252:255], a[252:255], v[6:9], v[252:255]
    s_lshl_b32 s50, s50, 16
    v_exp_f32 v38, v38
    v_mfma_f32_16x16x32_bf16 v[252:255], a[220:223], v[2:5], v[252:255]
    s_and_b32 s86, s4, 1
    v_exp_f32 v39, v39
    v_smfmac_f32_16x16x64_bf16 a[124:127], a[108:111], v[2:9], v0
    s_lshl_b32 s86, s86, 3
    ds_read_b64_tr_b16 a[206:207], v12 offset:21504
    v_cvt_pk_bf16_f32 v47, v38, v39
    v_mfma_f32_16x16x32_bf16 v[32:35], a[160:163], v[80:83], v[52:55]
    s_lshr_b32 s54, 0xff00ff00, s86
    ds_read_b64_tr_b16 a[208:209], v19 offset:18432
    v_mfma_f32_16x16x32_bf16 v[32:35], a[164:167], v[84:87], v[32:35]
    s_mov_b32 s55, s54
    ds_read_b64_tr_b16 a[210:211], v19 offset:22528
    v_mfma_f32_16x16x32_bf16 v[32:35], a[168:171], v[88:91], v[32:35]
    s_lshl_b32 s86, s4, 2
    ds_read_b64_tr_b16 a[240:241], v19 offset:26624
    v_exp_f32 v24, v24
    v_mfma_f32_16x16x32_bf16 v[32:35], a[172:175], v[92:95], v[32:35]
    s_lshl_b32 s51, 15, s86
    v_exp_f32 v25, v25
    v_mfma_f32_16x16x32_bf16 v[36:39], a[188:191], v[92:95], v[52:55]
    s_lshl_b32 s52, s3, 17
    ds_read_b64_tr_b16 a[242:243], v19 offset:30720
    v_cvt_pk_bf16_f32 v2, v24, v25
    v_mfma_f32_16x16x32_bf16 v[36:39], a[184:187], v[88:91], v[36:39]
    s_add_u32 s53, s52, 0x10000
    v_exp_f32 v26, v26
    v_mfma_f32_16x16x32_bf16 v[36:39], a[180:183], v[84:87], v[36:39]
    v_exp_f32 v27, v27
    v_mfma_f32_16x16x32_bf16 v[36:39], a[176:179], v[80:83], v[36:39]
    s_waitcnt lgkmcnt(4)
    ds_read_b64_tr_b16 a[244:245], v12 offset:26624
    v_cvt_pk_bf16_f32 v3, v26, v27
    v_mfma_f32_16x16x32_bf16 v[128:131], a[192:195], v[40:43], v[128:131]
    v_exp_f32 v28, v28
    v_mfma_f32_16x16x32_bf16 v[128:131], a[224:227], v[44:47], v[128:131]
    v_exp_f32 v29, v29
    v_mfma_f32_16x16x32_bf16 v[144:147], a[228:231], v[44:47], v[144:147]
    ds_read_b64_tr_b16 a[246:247], v12 offset:30720
    v_cvt_pk_bf16_f32 v4, v28, v29
    v_mfma_f32_16x16x32_bf16 v[144:147], a[196:199], v[40:43], v[144:147]
    ds_read_b64_tr_b16 a[212:213], v12 offset:18432
    v_mfma_f32_16x16x32_bf16 v[160:163], a[200:203], v[40:43], v[160:163]
    ds_read_b64_tr_b16 a[214:215], v12 offset:22528
    v_mfma_f32_16x16x32_bf16 v[160:163], a[232:235], v[44:47], v[160:163]
    v_exp_f32 v30, v30
    v_mfma_f32_16x16x32_bf16 v[176:179], a[236:239], v[44:47], v[176:179]
    v_exp_f32 v31, v31
    v_mfma_f32_16x16x32_bf16 v[176:179], a[204:207], v[40:43], v[176:179]
    ds_read_b64_tr_b16 a[216:217], v19 offset:19456
    v_cvt_pk_bf16_f32 v5, v30, v31
    v_smfmac_f32_16x16x64_bf16 a[112:115], a[108:111], v[40:47], v0
    ds_read_b64_tr_b16 a[218:219], v19 offset:23552
    v_mfma_f32_16x16x32_bf16 v[24:27], a[128:131], v[96:99], v[56:59]
    ds_read_b64_tr_b16 a[248:249], v19 offset:27648
    v_mfma_f32_16x16x32_bf16 v[24:27], a[132:135], v[100:103], v[24:27]
    ds_read_b64_tr_b16 a[250:251], v19 offset:31744
    v_mfma_f32_16x16x32_bf16 v[24:27], a[136:139], v[104:107], v[24:27]
    ds_read_b64_tr_b16 a[252:253], v12 offset:27648
    v_mfma_f32_16x16x32_bf16 v[24:27], a[140:143], v[108:111], v[24:27]
    ds_read_b64_tr_b16 a[254:255], v12 offset:31744
    v_mfma_f32_16x16x32_bf16 v[28:31], a[156:159], v[108:111], v[56:59]
    ds_read_b64_tr_b16 a[220:221], v12 offset:19456
    v_mfma_f32_16x16x32_bf16 v[28:31], a[152:155], v[104:107], v[28:31]
    ds_read_b64_tr_b16 a[222:223], v12 offset:23552
    v_mfma_f32_16x16x32_bf16 v[28:31], a[148:151], v[100:103], v[28:31]
    v_exp_f32 v32, v32
    v_mfma_f32_16x16x32_bf16 v[28:31], a[144:147], v[96:99], v[28:31]
    s_waitcnt lgkmcnt(4)
    v_exp_f32 v33, v33
    v_mfma_f32_16x16x32_bf16 v[192:195], a[208:211], v[40:43], v[192:195]
    v_exp_f32 v34, v34
    v_mfma_f32_16x16x32_bf16 v[192:195], a[240:243], v[44:47], v[192:195]
    v_exp_f32 v35, v35
    v_mfma_f32_16x16x32_bf16 v[208:211], a[244:247], v[44:47], v[208:211]
    v_cvt_pk_bf16_f32 v6, v32, v33
    v_cvt_pk_bf16_f32 v7, v34, v35
    v_mfma_f32_16x16x32_bf16 v[208:211], a[212:215], v[40:43], v[208:211]
    v_exp_f32 v36, v36
    v_mfma_f32_16x16x32_bf16 v[224:227], a[216:219], v[40:43], v[224:227]
    v_exp_f32 v37, v37
    v_mfma_f32_16x16x32_bf16 v[224:227], a[248:251], v[44:47], v[224:227]
    s_waitcnt lgkmcnt(2)
    v_exp_f32 v38, v38
    v_mfma_f32_16x16x32_bf16 v[240:243], a[252:255], v[44:47], v[240:243]
    s_waitcnt lgkmcnt(0)
    v_exp_f32 v39, v39
    v_mfma_f32_16x16x32_bf16 v[240:243], a[220:223], v[40:43], v[240:243]
    v_cvt_pk_bf16_f32 v8, v36, v37
    v_cvt_pk_bf16_f32 v9, v38, v39
    v_mfma_f32_16x16x32_bf16 v[32:35], a[160:163], v[96:99], v[56:59]
    v_exp_f32 v24, v24
    v_mfma_f32_16x16x32_bf16 v[32:35], a[164:167], v[100:103], v[32:35]
    v_exp_f32 v25, v25
    v_mfma_f32_16x16x32_bf16 v[32:35], a[168:171], v[104:107], v[32:35]
    v_cvt_pk_bf16_f32 v40, v24, v25
    v_mfma_f32_16x16x32_bf16 v[32:35], a[172:175], v[108:111], v[32:35]
    v_mfma_f32_16x16x32_bf16 v[36:39], a[188:191], v[108:111], v[56:59]
    v_exp_f32 v26, v26
    v_mfma_f32_16x16x32_bf16 v[36:39], a[184:187], v[104:107], v[36:39]
    v_exp_f32 v27, v27
    v_mfma_f32_16x16x32_bf16 v[36:39], a[180:183], v[100:103], v[36:39]
    v_cvt_pk_bf16_f32 v41, v26, v27
    v_mfma_f32_16x16x32_bf16 v[36:39], a[176:179], v[96:99], v[36:39]
    v_mfma_f32_16x16x32_bf16 v[132:135], a[192:195], v[2:5], v[132:135]
    v_exp_f32 v28, v28
    v_mfma_f32_16x16x32_bf16 v[132:135], a[224:227], v[6:9], v[132:135]
    v_exp_f32 v29, v29
    v_mfma_f32_16x16x32_bf16 v[148:151], a[228:231], v[6:9], v[148:151]
    v_cvt_pk_bf16_f32 v42, v28, v29
    v_mfma_f32_16x16x32_bf16 v[148:151], a[196:199], v[2:5], v[148:151]
    v_mfma_f32_16x16x32_bf16 v[164:167], a[200:203], v[2:5], v[164:167]
    v_exp_f32 v30, v30
    v_mfma_f32_16x16x32_bf16 v[164:167], a[232:235], v[6:9], v[164:167]
    v_exp_f32 v31, v31
    v_mfma_f32_16x16x32_bf16 v[180:183], a[236:239], v[6:9], v[180:183]
    v_cvt_pk_bf16_f32 v43, v30, v31
    v_mfma_f32_16x16x32_bf16 v[180:183], a[204:207], v[2:5], v[180:183]
    v_mfma_f32_16x16x32_bf16 v[24:27], a[128:131], v[112:115], v[60:63]
    s_waitcnt vmcnt(11)
    v_mfma_f32_16x16x32_bf16 v[24:27], a[132:135], v[116:119], v[24:27]
    s_barrier
    v_mfma_f32_16x16x32_bf16 v[24:27], a[136:139], v[120:123], v[24:27]
    v_exp_f32 v32, v32
    v_mfma_f32_16x16x32_bf16 v[24:27], a[140:143], v[124:127], v[24:27]
    v_exp_f32 v33, v33
    v_mfma_f32_16x16x32_bf16 v[28:31], a[156:159], v[124:127], v[60:63]
    ds_read_b128 a[128:131], v10 offset:0
    v_cvt_pk_bf16_f32 v44, v32, v33
    v_mfma_f32_16x16x32_bf16 v[28:31], a[152:155], v[120:123], v[28:31]
    ds_read_b128 a[132:135], v10 offset:1024
    v_mfma_f32_16x16x32_bf16 v[28:31], a[148:151], v[116:119], v[28:31]
    v_exp_f32 v34, v34
    v_mfma_f32_16x16x32_bf16 v[28:31], a[144:147], v[112:115], v[28:31]
    v_exp_f32 v35, v35
    v_mfma_f32_16x16x32_bf16 v[196:199], a[208:211], v[2:5], v[196:199]
    ds_read_b128 a[136:139], v10 offset:2048
    v_cvt_pk_bf16_f32 v45, v34, v35
    v_mfma_f32_16x16x32_bf16 v[196:199], a[240:243], v[6:9], v[196:199]
    v_exp_f32 v36, v36
    v_mfma_f32_16x16x32_bf16 v[212:215], a[244:247], v[6:9], v[212:215]
    v_exp_f32 v37, v37
    v_mfma_f32_16x16x32_bf16 v[212:215], a[212:215], v[2:5], v[212:215]
    ds_read_b128 a[140:143], v10 offset:3072
    v_cvt_pk_bf16_f32 v46, v36, v37
    v_mfma_f32_16x16x32_bf16 v[228:231], a[216:219], v[2:5], v[228:231]
    ds_read_b128 a[156:159], v10 offset:7168
    v_mfma_f32_16x16x32_bf16 v[228:231], a[248:251], v[6:9], v[228:231]
    buffer_load_dwordx4 a[0:3], v1, s[16:19], s80 offen offset:0 sc1
    v_mfma_f32_16x16x32_bf16 v[244:247], a[252:255], v[6:9], v[244:247]
    v_exp_f32 v38, v38
    v_mfma_f32_16x16x32_bf16 v[244:247], a[220:223], v[2:5], v[244:247]
    v_exp_f32 v39, v39
    v_smfmac_f32_16x16x64_bf16 a[116:119], a[108:111], v[2:9], v0
    ds_read_b128 a[152:155], v10 offset:6144
    v_cvt_pk_bf16_f32 v47, v38, v39
    v_mfma_f32_16x16x32_bf16 v[32:35], a[160:163], v[112:115], v[60:63]
    ds_read_b128 a[148:151], v10 offset:5120
    v_mfma_f32_16x16x32_bf16 v[32:35], a[164:167], v[116:119], v[32:35]
    buffer_load_dwordx4 a[4:7], v1, s[16:19], s80 offen offset:1024 sc1
    v_mfma_f32_16x16x32_bf16 v[32:35], a[168:171], v[120:123], v[32:35]
    v_exp_f32 v24, v24
    v_mfma_f32_16x16x32_bf16 v[32:35], a[172:175], v[124:127], v[32:35]
    v_exp_f32 v25, v25
    v_mfma_f32_16x16x32_bf16 v[36:39], a[188:191], v[124:127], v[60:63]
    ds_read_b128 a[144:147], v10 offset:4096
    v_cvt_pk_bf16_f32 v2, v24, v25
    v_mfma_f32_16x16x32_bf16 v[36:39], a[184:187], v[120:123], v[36:39]
    v_exp_f32 v26, v26
    v_mfma_f32_16x16x32_bf16 v[36:39], a[180:183], v[116:119], v[36:39]
    v_exp_f32 v27, v27
    v_mfma_f32_16x16x32_bf16 v[36:39], a[176:179], v[112:115], v[36:39]
    ds_read_b128 a[160:163], v10 offset:8192
    v_cvt_pk_bf16_f32 v3, v26, v27
    v_mfma_f32_16x16x32_bf16 v[136:139], a[192:195], v[40:43], v[136:139]
    v_exp_f32 v28, v28
    v_mfma_f32_16x16x32_bf16 v[136:139], a[224:227], v[44:47], v[136:139]
    v_exp_f32 v29, v29
    v_mfma_f32_16x16x32_bf16 v[152:155], a[228:231], v[44:47], v[152:155]
    ds_read_b128 a[164:167], v10 offset:9216
    v_cvt_pk_bf16_f32 v4, v28, v29
    v_mfma_f32_16x16x32_bf16 v[152:155], a[196:199], v[40:43], v[152:155]
    ds_read_b128 a[168:171], v10 offset:10240
    v_mfma_f32_16x16x32_bf16 v[168:171], a[200:203], v[40:43], v[168:171]
    buffer_load_dwordx4 a[8:11], v1, s[16:19], s80 offen offset:2048 sc1
    v_mfma_f32_16x16x32_bf16 v[168:171], a[232:235], v[44:47], v[168:171]
    v_exp_f32 v30, v30
    v_mfma_f32_16x16x32_bf16 v[184:187], a[236:239], v[44:47], v[184:187]
    v_exp_f32 v31, v31
    v_mfma_f32_16x16x32_bf16 v[184:187], a[204:207], v[40:43], v[184:187]
    s_waitcnt lgkmcnt(3)
    ds_read_b128 a[172:175], v10 offset:11264
    v_cvt_pk_bf16_f32 v5, v30, v31
    v_mfma_f32_16x16x32_bf16 v[24:27], a[128:131], v[64:67], v[48:51]
    ds_read_b128 a[188:191], v10 offset:15360
    v_mfma_f32_16x16x32_bf16 v[24:27], a[132:135], v[68:71], v[24:27]
    buffer_load_dwordx4 a[12:15], v1, s[16:19], s80 offen offset:3072 sc1
    s_add_u32 s80, s80, 4096
    v_mfma_f32_16x16x32_bf16 v[24:27], a[136:139], v[72:75], v[24:27]
    v_exp_f32 v32, v32
    v_mfma_f32_16x16x32_bf16 v[24:27], a[140:143], v[76:79], v[24:27]
    v_exp_f32 v33, v33
    v_mfma_f32_16x16x32_bf16 v[28:31], a[156:159], v[76:79], v[48:51]
    ds_read_b128 a[184:187], v10 offset:14336
    v_cvt_pk_bf16_f32 v6, v32, v33
    v_mfma_f32_16x16x32_bf16 v[28:31], a[152:155], v[72:75], v[28:31]
    v_add_u32 v19, s83, v14
    v_xor_b32 v12, 32, v19
    v_mfma_f32_16x16x32_bf16 v[28:31], a[148:151], v[68:71], v[28:31]
    v_exp_f32 v34, v34
    v_mfma_f32_16x16x32_bf16 v[28:31], a[144:147], v[64:67], v[28:31]
    v_exp_f32 v35, v35
    v_mfma_f32_16x16x32_bf16 v[200:203], a[208:211], v[40:43], v[200:203]
    ds_read_b128 a[180:183], v10 offset:13312
    v_cvt_pk_bf16_f32 v7, v34, v35
    v_mfma_f32_16x16x32_bf16 v[200:203], a[240:243], v[44:47], v[200:203]
    s_add_u32 s83, s83, 32768
    v_exp_f32 v36, v36
    v_mfma_f32_16x16x32_bf16 v[216:219], a[244:247], v[44:47], v[216:219]
    s_sub_u32 s90, s83, 163840
    v_exp_f32 v37, v37
    v_mfma_f32_16x16x32_bf16 v[216:219], a[212:215], v[40:43], v[216:219]
    s_min_u32 s83, s83, s90
    ds_read_b128 a[176:179], v10 offset:12288
    v_cvt_pk_bf16_f32 v8, v36, v37
    v_mfma_f32_16x16x32_bf16 v[232:235], a[216:219], v[40:43], v[232:235]
    v_add_u32 v10, s83, v13
    v_mfma_f32_16x16x32_bf16 v[232:235], a[248:251], v[44:47], v[232:235]
    buffer_load_dwordx4 a[16:19], v1, s[16:19], s80 offen offset:0 sc1
    v_mfma_f32_16x16x32_bf16 v[248:251], a[252:255], v[44:47], v[248:251]
    v_exp_f32 v38, v38
    v_mfma_f32_16x16x32_bf16 v[248:251], a[220:223], v[40:43], v[248:251]
    v_exp_f32 v39, v39
    v_smfmac_f32_16x16x64_bf16 a[120:123], a[108:111], v[40:47], v0
    s_waitcnt lgkmcnt(3)
    v_cvt_pk_bf16_f32 v9, v38, v39
    v_mfma_f32_16x16x32_bf16 v[32:35], a[160:163], v[64:67], v[48:51]
    v_exp_f32 v24, v24
    v_mfma_f32_16x16x32_bf16 v[32:35], a[164:167], v[68:71], v[32:35]
    v_exp_f32 v25, v25
    v_mfma_f32_16x16x32_bf16 v[32:35], a[168:171], v[72:75], v[32:35]
    v_exp_f32 v26, v26
    v_mfma_f32_16x16x32_bf16 v[32:35], a[172:175], v[76:79], v[32:35]
    v_exp_f32 v27, v27
    v_mfma_f32_16x16x32_bf16 v[36:39], a[188:191], v[76:79], v[48:51]
    s_waitcnt lgkmcnt(2)
    v_exp_f32 v28, v28
    v_mfma_f32_16x16x32_bf16 v[36:39], a[184:187], v[72:75], v[36:39]
    s_waitcnt lgkmcnt(1)
    v_exp_f32 v29, v29
    v_mfma_f32_16x16x32_bf16 v[36:39], a[180:183], v[68:71], v[36:39]
    s_waitcnt lgkmcnt(0)
    v_exp_f32 v30, v30
    v_mfma_f32_16x16x32_bf16 v[36:39], a[176:179], v[64:67], v[36:39]
    v_exp_f32 v31, v31
    v_mfma_f32_16x16x32_bf16 v[140:143], a[192:195], v[2:5], v[140:143]
    v_cvt_pk_bf16_f32 v40, v24, v25
    v_cvt_pk_bf16_f32 v41, v26, v27
    v_mfma_f32_16x16x32_bf16 v[140:143], a[224:227], v[6:9], v[140:143]
    ds_read_b64_tr_b16 a[192:193], v19 offset:16384
    v_cvt_pk_bf16_f32 v42, v28, v29
    v_mfma_f32_16x16x32_bf16 v[156:159], a[228:231], v[6:9], v[156:159]
    ds_read_b64_tr_b16 a[194:195], v19 offset:20480
    v_mfma_f32_16x16x32_bf16 v[156:159], a[196:199], v[2:5], v[156:159]
    ds_read_b64_tr_b16 a[224:225], v19 offset:24576
    v_cvt_pk_bf16_f32 v43, v30, v31
    v_mfma_f32_16x16x32_bf16 v[172:175], a[200:203], v[2:5], v[172:175]
    ds_read_b64_tr_b16 a[226:227], v19 offset:28672
    v_mfma_f32_16x16x32_bf16 v[172:175], a[232:235], v[6:9], v[172:175]
    ds_read_b64_tr_b16 a[228:229], v12 offset:24576
    buffer_load_dwordx4 a[20:23], v1, s[16:19], s80 offen offset:1024 sc1
    v_mfma_f32_16x16x32_bf16 v[188:191], a[236:239], v[6:9], v[188:191]
    ds_read_b64_tr_b16 a[230:231], v12 offset:28672
    v_mfma_f32_16x16x32_bf16 v[188:191], a[204:207], v[2:5], v[188:191]
    ds_read_b64_tr_b16 a[196:197], v12 offset:16384
    v_mfma_f32_16x16x32_bf16 v[24:27], a[128:131], v[80:83], v[52:55]
    ds_read_b64_tr_b16 a[198:199], v12 offset:20480
    v_mfma_f32_16x16x32_bf16 v[24:27], a[132:135], v[84:87], v[24:27]
    ds_read_b64_tr_b16 a[200:201], v19 offset:17408
    buffer_load_dwordx4 a[24:27], v1, s[16:19], s80 offen offset:2048 sc1
    v_mfma_f32_16x16x32_bf16 v[24:27], a[136:139], v[88:91], v[24:27]
    v_exp_f32 v32, v32
    v_mfma_f32_16x16x32_bf16 v[24:27], a[140:143], v[92:95], v[24:27]
    v_exp_f32 v33, v33
    v_mfma_f32_16x16x32_bf16 v[28:31], a[156:159], v[92:95], v[52:55]
    ds_read_b64_tr_b16 a[202:203], v19 offset:21504
    v_cvt_pk_bf16_f32 v44, v32, v33
    v_mfma_f32_16x16x32_bf16 v[28:31], a[152:155], v[88:91], v[28:31]
    ds_read_b64_tr_b16 a[232:233], v19 offset:25600
    v_mfma_f32_16x16x32_bf16 v[28:31], a[148:151], v[84:87], v[28:31]
    v_exp_f32 v34, v34
    v_mfma_f32_16x16x32_bf16 v[28:31], a[144:147], v[80:83], v[28:31]
    v_exp_f32 v35, v35
    v_mfma_f32_16x16x32_bf16 v[204:207], a[208:211], v[2:5], v[204:207]
    ds_read_b64_tr_b16 a[234:235], v19 offset:29696
    v_cvt_pk_bf16_f32 v45, v34, v35
    v_mfma_f32_16x16x32_bf16 v[204:207], a[240:243], v[6:9], v[204:207]
    v_exp_f32 v36, v36
    v_mfma_f32_16x16x32_bf16 v[220:223], a[244:247], v[6:9], v[220:223]
    v_exp_f32 v37, v37
    v_mfma_f32_16x16x32_bf16 v[220:223], a[212:215], v[2:5], v[220:223]
    ds_read_b64_tr_b16 a[236:237], v12 offset:25600
    v_cvt_pk_bf16_f32 v46, v36, v37
    v_mfma_f32_16x16x32_bf16 v[236:239], a[216:219], v[2:5], v[236:239]
    ds_read_b64_tr_b16 a[238:239], v12 offset:29696
    v_mfma_f32_16x16x32_bf16 v[236:239], a[248:251], v[6:9], v[236:239]
    ds_read_b64_tr_b16 a[204:205], v12 offset:17408
    buffer_load_dwordx4 a[28:31], v1, s[16:19], s80 offen offset:3072 sc1
    s_add_u32 s80, s80, 4096
    v_mfma_f32_16x16x32_bf16 v[252:255], a[252:255], v[6:9], v[252:255]
    v_exp_f32 v38, v38
    v_mfma_f32_16x16x32_bf16 v[252:255], a[220:223], v[2:5], v[252:255]
    v_exp_f32 v39, v39
    v_smfmac_f32_16x16x64_bf16 a[124:127], a[108:111], v[2:9], v0
    ds_read_b64_tr_b16 a[206:207], v12 offset:21504
    v_cvt_pk_bf16_f32 v47, v38, v39
    v_mfma_f32_16x16x32_bf16 v[32:35], a[160:163], v[80:83], v[52:55]
    ds_read_b64_tr_b16 a[208:209], v19 offset:18432
    v_mfma_f32_16x16x32_bf16 v[32:35], a[164:167], v[84:87], v[32:35]
    ds_read_b64_tr_b16 a[210:211], v19 offset:22528
    buffer_load_dwordx4 a[32:35], v1, s[16:19], s80 offen offset:0 sc1
    v_mfma_f32_16x16x32_bf16 v[32:35], a[168:171], v[88:91], v[32:35]
    ds_read_b64_tr_b16 a[240:241], v19 offset:26624
    v_exp_f32 v24, v24
    v_mfma_f32_16x16x32_bf16 v[32:35], a[172:175], v[92:95], v[32:35]
    v_exp_f32 v25, v25
    v_mfma_f32_16x16x32_bf16 v[36:39], a[188:191], v[92:95], v[52:55]
    ds_read_b64_tr_b16 a[242:243], v19 offset:30720
    v_cvt_pk_bf16_f32 v2, v24, v25
    v_mfma_f32_16x16x32_bf16 v[36:39], a[184:187], v[88:91], v[36:39]
    v_exp_f32 v26, v26
    v_mfma_f32_16x16x32_bf16 v[36:39], a[180:183], v[84:87], v[36:39]
    v_exp_f32 v27, v27
    v_mfma_f32_16x16x32_bf16 v[36:39], a[176:179], v[80:83], v[36:39]
    s_waitcnt lgkmcnt(4)
    ds_read_b64_tr_b16 a[244:245], v12 offset:26624
    v_cvt_pk_bf16_f32 v3, v26, v27
    v_mfma_f32_16x16x32_bf16 v[128:131], a[192:195], v[40:43], v[128:131]
    v_exp_f32 v28, v28
    v_mfma_f32_16x16x32_bf16 v[128:131], a[224:227], v[44:47], v[128:131]
    v_exp_f32 v29, v29
    v_mfma_f32_16x16x32_bf16 v[144:147], a[228:231], v[44:47], v[144:147]
    ds_read_b64_tr_b16 a[246:247], v12 offset:30720
    v_cvt_pk_bf16_f32 v4, v28, v29
    v_mfma_f32_16x16x32_bf16 v[144:147], a[196:199], v[40:43], v[144:147]
    ds_read_b64_tr_b16 a[212:213], v12 offset:18432
    v_mfma_f32_16x16x32_bf16 v[160:163], a[200:203], v[40:43], v[160:163]
    ds_read_b64_tr_b16 a[214:215], v12 offset:22528
    buffer_load_dwordx4 a[36:39], v1, s[16:19], s80 offen offset:1024 sc1
    v_mfma_f32_16x16x32_bf16 v[160:163], a[232:235], v[44:47], v[160:163]
    v_exp_f32 v30, v30
    v_mfma_f32_16x16x32_bf16 v[176:179], a[236:239], v[44:47], v[176:179]
    v_exp_f32 v31, v31
    v_mfma_f32_16x16x32_bf16 v[176:179], a[204:207], v[40:43], v[176:179]
    ds_read_b64_tr_b16 a[216:217], v19 offset:19456
    v_cvt_pk_bf16_f32 v5, v30, v31
    v_smfmac_f32_16x16x64_bf16 a[112:115], a[108:111], v[40:47], v0
    ds_read_b64_tr_b16 a[218:219], v19 offset:23552
    v_mfma_f32_16x16x32_bf16 v[24:27], a[128:131], v[96:99], v[56:59]
    ds_read_b64_tr_b16 a[248:249], v19 offset:27648
    buffer_load_dwordx4 a[40:43], v1, s[16:19], s80 offen offset:2048 sc1
    v_mfma_f32_16x16x32_bf16 v[24:27], a[132:135], v[100:103], v[24:27]
    ds_read_b64_tr_b16 a[250:251], v19 offset:31744
    v_mfma_f32_16x16x32_bf16 v[24:27], a[136:139], v[104:107], v[24:27]
    ds_read_b64_tr_b16 a[252:253], v12 offset:27648
    v_mfma_f32_16x16x32_bf16 v[24:27], a[140:143], v[108:111], v[24:27]
    ds_read_b64_tr_b16 a[254:255], v12 offset:31744
    v_mfma_f32_16x16x32_bf16 v[28:31], a[156:159], v[108:111], v[56:59]
    ds_read_b64_tr_b16 a[220:221], v12 offset:19456
    buffer_load_dwordx4 a[44:47], v1, s[16:19], s80 offen offset:3072 sc1
    s_add_u32 s80, s80, 4096
    v_mfma_f32_16x16x32_bf16 v[28:31], a[152:155], v[104:107], v[28:31]
    ds_read_b64_tr_b16 a[222:223], v12 offset:23552
    v_mfma_f32_16x16x32_bf16 v[28:31], a[148:151], v[100:103], v[28:31]
    v_exp_f32 v32, v32
    v_mfma_f32_16x16x32_bf16 v[28:31], a[144:147], v[96:99], v[28:31]
    s_waitcnt lgkmcnt(4)
    v_exp_f32 v33, v33
    v_mfma_f32_16x16x32_bf16 v[192:195], a[208:211], v[40:43], v[192:195]
    v_exp_f32 v34, v34
    v_mfma_f32_16x16x32_bf16 v[192:195], a[240:243], v[44:47], v[192:195]
    v_exp_f32 v35, v35
    v_mfma_f32_16x16x32_bf16 v[208:211], a[244:247], v[44:47], v[208:211]
    v_cvt_pk_bf16_f32 v6, v32, v33
    v_cvt_pk_bf16_f32 v7, v34, v35
    v_mfma_f32_16x16x32_bf16 v[208:211], a[212:215], v[40:43], v[208:211]
    v_exp_f32 v36, v36
    v_mfma_f32_16x16x32_bf16 v[224:227], a[216:219], v[40:43], v[224:227]
    v_exp_f32 v37, v37
    v_mfma_f32_16x16x32_bf16 v[224:227], a[248:251], v[44:47], v[224:227]
    s_waitcnt lgkmcnt(2)
    v_exp_f32 v38, v38
    v_mfma_f32_16x16x32_bf16 v[240:243], a[252:255], v[44:47], v[240:243]
    s_waitcnt lgkmcnt(0)
    v_exp_f32 v39, v39
    v_mfma_f32_16x16x32_bf16 v[240:243], a[220:223], v[40:43], v[240:243]
    v_cvt_pk_bf16_f32 v8, v36, v37
    v_cvt_pk_bf16_f32 v9, v38, v39
    v_mfma_f32_16x16x32_bf16 v[32:35], a[160:163], v[96:99], v[56:59]
    v_exp_f32 v24, v24
    v_mfma_f32_16x16x32_bf16 v[32:35], a[164:167], v[100:103], v[32:35]
    v_exp_f32 v25, v25
    v_mfma_f32_16x16x32_bf16 v[32:35], a[168:171], v[104:107], v[32:35]
    v_cvt_pk_bf16_f32 v40, v24, v25
    v_mfma_f32_16x16x32_bf16 v[32:35], a[172:175], v[108:111], v[32:35]
    buffer_load_dwordx4 a[48:51], v1, s[16:19], s80 offen offset:0 sc1
    v_mfma_f32_16x16x32_bf16 v[36:39], a[188:191], v[108:111], v[56:59]
    v_exp_f32 v26, v26
    v_mfma_f32_16x16x32_bf16 v[36:39], a[184:187], v[104:107], v[36:39]
    v_exp_f32 v27, v27
    v_mfma_f32_16x16x32_bf16 v[36:39], a[180:183], v[100:103], v[36:39]
    v_cvt_pk_bf16_f32 v41, v26, v27
    v_mfma_f32_16x16x32_bf16 v[36:39], a[176:179], v[96:99], v[36:39]
    buffer_load_dwordx4 a[52:55], v1, s[16:19], s80 offen offset:1024 sc1
    v_mfma_f32_16x16x32_bf16 v[132:135], a[192:195], v[2:5], v[132:135]
    v_exp_f32 v28, v28
    v_mfma_f32_16x16x32_bf16 v[132:135], a[224:227], v[6:9], v[132:135]
    v_exp_f32 v29, v29
    v_mfma_f32_16x16x32_bf16 v[148:151], a[228:231], v[6:9], v[148:151]
    v_cvt_pk_bf16_f32 v42, v28, v29
    v_mfma_f32_16x16x32_bf16 v[148:151], a[196:199], v[2:5], v[148:151]
    buffer_load_dwordx4 a[56:59], v1, s[16:19], s80 offen offset:2048 sc1
    v_mfma_f32_16x16x32_bf16 v[164:167], a[200:203], v[2:5], v[164:167]
    v_exp_f32 v30, v30
    v_mfma_f32_16x16x32_bf16 v[164:167], a[232:235], v[6:9], v[164:167]
    v_exp_f32 v31, v31
    v_mfma_f32_16x16x32_bf16 v[180:183], a[236:239], v[6:9], v[180:183]
    v_cvt_pk_bf16_f32 v43, v30, v31
    v_mfma_f32_16x16x32_bf16 v[180:183], a[204:207], v[2:5], v[180:183]
    buffer_load_dwordx4 a[60:63], v1, s[16:19], s80 offen offset:3072 sc1
    s_add_u32 s80, s80, 4096
    v_mfma_f32_16x16x32_bf16 v[24:27], a[128:131], v[112:115], v[60:63]
    s_waitcnt vmcnt(19)
    v_mfma_f32_16x16x32_bf16 v[24:27], a[132:135], v[116:119], v[24:27]
    s_barrier
    v_mfma_f32_16x16x32_bf16 v[24:27], a[136:139], v[120:123], v[24:27]
    v_exp_f32 v32, v32
    v_mfma_f32_16x16x32_bf16 v[24:27], a[140:143], v[124:127], v[24:27]
    v_exp_f32 v33, v33
    v_mfma_f32_16x16x32_bf16 v[28:31], a[156:159], v[124:127], v[60:63]
    ds_read_b128 a[128:131], v10 offset:0
    v_cvt_pk_bf16_f32 v44, v32, v33
    v_mfma_f32_16x16x32_bf16 v[28:31], a[152:155], v[120:123], v[28:31]
    ds_read_b128 a[132:135], v10 offset:1024
    v_mfma_f32_16x16x32_bf16 v[28:31], a[148:151], v[116:119], v[28:31]
    v_exp_f32 v34, v34
    v_mfma_f32_16x16x32_bf16 v[28:31], a[144:147], v[112:115], v[28:31]
    v_exp_f32 v35, v35
    v_mfma_f32_16x16x32_bf16 v[196:199], a[208:211], v[2:5], v[196:199]
    ds_read_b128 a[136:139], v10 offset:2048
    v_cvt_pk_bf16_f32 v45, v34, v35
    v_mfma_f32_16x16x32_bf16 v[196:199], a[240:243], v[6:9], v[196:199]
    v_exp_f32 v36, v36
    v_mfma_f32_16x16x32_bf16 v[212:215], a[244:247], v[6:9], v[212:215]
    v_exp_f32 v37, v37
    v_mfma_f32_16x16x32_bf16 v[212:215], a[212:215], v[2:5], v[212:215]
    ds_read_b128 a[140:143], v10 offset:3072
    v_cvt_pk_bf16_f32 v46, v36, v37
    v_mfma_f32_16x16x32_bf16 v[228:231], a[216:219], v[2:5], v[228:231]
    ds_read_b128 a[156:159], v10 offset:7168
    v_mfma_f32_16x16x32_bf16 v[228:231], a[248:251], v[6:9], v[228:231]
    v_mfma_f32_16x16x32_bf16 v[244:247], a[252:255], v[6:9], v[244:247]
    v_exp_f32 v38, v38
    v_mfma_f32_16x16x32_bf16 v[244:247], a[220:223], v[2:5], v[244:247]
    v_exp_f32 v39, v39
    v_smfmac_f32_16x16x64_bf16 a[116:119], a[108:111], v[2:9], v0
    ds_read_b128 a[152:155], v10 offset:6144
    v_cvt_pk_bf16_f32 v47, v38, v39
    v_mfma_f32_16x16x32_bf16 v[32:35], a[160:163], v[112:115], v[60:63]
    s_branch L_ov7
L_pad7:
    s_setpc_b64 s[86:87]
L_ov7:
    ds_read_b128 a[148:151], v10 offset:5120
    v_mfma_f32_16x16x32_bf16 v[32:35], a[164:167], v[116:119], v[32:35]
    buffer_load_dwordx4 a[64:67], v1, s[16:19], s80 offen offset:0 sc1
    v_mfma_f32_16x16x32_bf16 v[32:35], a[168:171], v[120:123], v[32:35]
    v_exp_f32 v24, v24
    v_mfma_f32_16x16x32_bf16 v[32:35], a[172:175], v[124:127], v[32:35]
    v_exp_f32 v25, v25
    v_mfma_f32_16x16x32_bf16 v[36:39], a[188:191], v[124:127], v[60:63]
    ds_read_b128 a[144:147], v10 offset:4096
    v_cvt_pk_bf16_f32 v2, v24, v25
    v_mfma_f32_16x16x32_bf16 v[36:39], a[184:187], v[120:123], v[36:39]
    v_exp_f32 v26, v26
    v_mfma_f32_16x16x32_bf16 v[36:39], a[180:183], v[116:119], v[36:39]
    v_exp_f32 v27, v27
    v_mfma_f32_16x16x32_bf16 v[36:39], a[176:179], v[112:115], v[36:39]
    ds_read_b128 a[160:163], v10 offset:8192
    v_cvt_pk_bf16_f32 v3, v26, v27
    v_mfma_f32_16x16x32_bf16 v[136:139], a[192:195], v[40:43], v[136:139]
    v_exp_f32 v28, v28
    v_mfma_f32_16x16x32_bf16 v[136:139], a[224:227], v[44:47], v[136:139]
    v_exp_f32 v29, v29
    v_mfma_f32_16x16x32_bf16 v[152:155], a[228:231], v[44:47], v[152:155]
    ds_read_b128 a[164:167], v10 offset:9216
    v_cvt_pk_bf16_f32 v4, v28, v29
    v_mfma_f32_16x16x32_bf16 v[152:155], a[196:199], v[40:43], v[152:155]
    ds_read_b128 a[168:171], v10 offset:10240
    v_mfma_f32_16x16x32_bf16 v[168:171], a[200:203], v[40:43], v[168:171]
    buffer_load_dwordx4 a[68:71], v1, s[16:19], s80 offen offset:1024 sc1
    v_mfma_f32_16x16x32_bf16 v[168:171], a[232:235], v[44:47], v[168:171]
    v_exp_f32 v30, v30
    v_mfma_f32_16x16x32_bf16 v[184:187], a[236:239], v[44:47], v[184:187]
    v_exp_f32 v31, v31
    v_mfma_f32_16x16x32_bf16 v[184:187], a[204:207], v[40:43], v[184:187]
    s_waitcnt lgkmcnt(3)
    ds_read_b128 a[172:175], v10 offset:11264
    v_cvt_pk_bf16_f32 v5, v30, v31
    v_mfma_f32_16x16x32_bf16 v[24:27], a[128:131], v[64:67], v[48:51]
    ds_read_b128 a[188:191], v10 offset:15360
    v_mfma_f32_16x16x32_bf16 v[24:27], a[132:135], v[68:71], v[24:27]
    buffer_load_dwordx4 a[72:75], v1, s[16:19], s80 offen offset:2048 sc1
    v_mfma_f32_16x16x32_bf16 v[24:27], a[136:139], v[72:75], v[24:27]
    v_exp_f32 v32, v32
    v_mfma_f32_16x16x32_bf16 v[24:27], a[140:143], v[76:79], v[24:27]
    v_exp_f32 v33, v33
    v_mfma_f32_16x16x32_bf16 v[28:31], a[156:159], v[76:79], v[48:51]
    ds_read_b128 a[184:187], v10 offset:14336
    v_cvt_pk_bf16_f32 v6, v32, v33
    v_mfma_f32_16x16x32_bf16 v[28:31], a[152:155], v[72:75], v[28:31]
    v_add_u32 v19, s83, v14
    v_xor_b32 v12, 32, v19
    v_mfma_f32_16x16x32_bf16 v[28:31], a[148:151], v[68:71], v[28:31]
    v_exp_f32 v34, v34
    v_mfma_f32_16x16x32_bf16 v[28:31], a[144:147], v[64:67], v[28:31]
    v_exp_f32 v35, v35
    v_mfma_f32_16x16x32_bf16 v[200:203], a[208:211], v[40:43], v[200:203]
    ds_read_b128 a[180:183], v10 offset:13312
    v_cvt_pk_bf16_f32 v7, v34, v35
    v_mfma_f32_16x16x32_bf16 v[200:203], a[240:243], v[44:47], v[200:203]
    s_add_u32 s83, s83, 32768
    v_exp_f32 v36, v36
    v_mfma_f32_16x16x32_bf16 v[216:219], a[244:247], v[44:47], v[216:219]
    s_sub_u32 s90, s83, 163840
    v_exp_f32 v37, v37
    v_mfma_f32_16x16x32_bf16 v[216:219], a[212:215], v[40:43], v[216:219]
    s_min_u32 s83, s83, s90
    ds_read_b128 a[176:179], v10 offset:12288
    v_cvt_pk_bf16_f32 v8, v36, v37
    v_mfma_f32_16x16x32_bf16 v[232:235], a[216:219], v[40:43], v[232:235]
    v_add_u32 v10, s83, v13
    v_mfma_f32_16x16x32_bf16 v[232:235], a[248:251], v[44:47], v[232:235]
    buffer_load_dwordx4 a[76:79], v1, s[16:19], s80 offen offset:3072 sc1
    s_add_u32 s80, s80, 4096
    v_mfma_f32_16x16x32_bf16 v[248:251], a[252:255], v[44:47], v[248:251]
    v_exp_f32 v38, v38
    v_mfma_f32_16x16x32_bf16 v[248:251], a[220:223], v[40:43], v[248:251]
    v_exp_f32 v39, v39
    v_smfmac_f32_16x16x64_bf16 a[120:123], a[108:111], v[40:47], v0
    s_waitcnt lgkmcnt(3)
    v_cvt_pk_bf16_f32 v9, v38, v39
    v_mfma_f32_16x16x32_bf16 v[32:35], a[160:163], v[64:67], v[48:51]
    v_exp_f32 v24, v24
    v_mfma_f32_16x16x32_bf16 v[32:35], a[164:167], v[68:71], v[32:35]
    v_exp_f32 v25, v25
    v_mfma_f32_16x16x32_bf16 v[32:35], a[168:171], v[72:75], v[32:35]
    v_exp_f32 v26, v26
    v_mfma_f32_16x16x32_bf16 v[32:35], a[172:175], v[76:79], v[32:35]
    v_exp_f32 v27, v27
    v_mfma_f32_16x16x32_bf16 v[36:39], a[188:191], v[76:79], v[48:51]
    s_waitcnt lgkmcnt(2)
    v_exp_f32 v28, v28
    v_mfma_f32_16x16x32_bf16 v[36:39], a[184:187], v[72:75], v[36:39]
    s_waitcnt lgkmcnt(1)
    v_exp_f32 v29, v29
    v_mfma_f32_16x16x32_bf16 v[36:39], a[180:183], v[68:71], v[36:39]
    s_waitcnt lgkmcnt(0)
    v_exp_f32 v30, v30
    v_mfma_f32_16x16x32_bf16 v[36:39], a[176:179], v[64:67], v[36:39]
    v_exp_f32 v31, v31
    v_mfma_f32_16x16x32_bf16 v[140:143], a[192:195], v[2:5], v[140:143]
    v_cvt_pk_bf16_f32 v40, v24, v25
    v_cvt_pk_bf16_f32 v41, v26, v27
    v_mfma_f32_16x16x32_bf16 v[140:143], a[224:227], v[6:9], v[140:143]
    ds_read_b64_tr_b16 a[192:193], v19 offset:16384
    v_cvt_pk_bf16_f32 v42, v28, v29
    v_mfma_f32_16x16x32_bf16 v[156:159], a[228:231], v[6:9], v[156:159]
    ds_read_b64_tr_b16 a[194:195], v19 offset:20480
    v_mfma_f32_16x16x32_bf16 v[156:159], a[196:199], v[2:5], v[156:159]
    ds_read_b64_tr_b16 a[224:225], v19 offset:24576
    v_cvt_pk_bf16_f32 v43, v30, v31
    v_mfma_f32_16x16x32_bf16 v[172:175], a[200:203], v[2:5], v[172:175]
    ds_read_b64_tr_b16 a[226:227], v19 offset:28672
    v_mfma_f32_16x16x32_bf16 v[172:175], a[232:235], v[6:9], v[172:175]
    ds_read_b64_tr_b16 a[228:229], v12 offset:24576
    buffer_load_dwordx4 a[80:83], v1, s[16:19], s80 offen offset:0 sc1
    v_mfma_f32_16x16x32_bf16 v[188:191], a[236:239], v[6:9], v[188:191]
    ds_read_b64_tr_b16 a[230:231], v12 offset:28672
    v_mfma_f32_16x16x32_bf16 v[188:191], a[204:207], v[2:5], v[188:191]
    ds_read_b64_tr_b16 a[196:197], v12 offset:16384
    v_mfma_f32_16x16x32_bf16 v[24:27], a[128:131], v[80:83], v[52:55]
    ds_read_b64_tr_b16 a[198:199], v12 offset:20480
    v_mfma_f32_16x16x32_bf16 v[24:27], a[132:135], v[84:87], v[24:27]
    ds_read_b64_tr_b16 a[200:201], v19 offset:17408
    buffer_load_dwordx4 a[84:87], v1, s[16:19], s80 offen offset:1024 sc1
    v_mfma_f32_16x16x32_bf16 v[24:27], a[136:139], v[88:91], v[24:27]
    v_exp_f32 v32, v32
    v_mfma_f32_16x16x32_bf16 v[24:27], a[140:143], v[92:95], v[24:27]
    v_exp_f32 v33, v33
    v_mfma_f32_16x16x32_bf16 v[28:31], a[156:159], v[92:95], v[52:55]
    ds_read_b64_tr_b16 a[202:203], v19 offset:21504
    v_cvt_pk_bf16_f32 v44, v32, v33
    v_mfma_f32_16x16x32_bf16 v[28:31], a[152:155], v[88:91], v[28:31]
    ds_read_b64_tr_b16 a[232:233], v19 offset:25600
    v_mfma_f32_16x16x32_bf16 v[28:31], a[148:151], v[84:87], v[28:31]
    v_exp_f32 v34, v34
    v_mfma_f32_16x16x32_bf16 v[28:31], a[144:147], v[80:83], v[28:31]
    v_exp_f32 v35, v35
    v_mfma_f32_16x16x32_bf16 v[204:207], a[208:211], v[2:5], v[204:207]
    ds_read_b64_tr_b16 a[234:235], v19 offset:29696
    v_cvt_pk_bf16_f32 v45, v34, v35
    v_mfma_f32_16x16x32_bf16 v[204:207], a[240:243], v[6:9], v[204:207]
    v_exp_f32 v36, v36
    v_mfma_f32_16x16x32_bf16 v[220:223], a[244:247], v[6:9], v[220:223]
    v_exp_f32 v37, v37
    v_mfma_f32_16x16x32_bf16 v[220:223], a[212:215], v[2:5], v[220:223]
    ds_read_b64_tr_b16 a[236:237], v12 offset:25600
    v_cvt_pk_bf16_f32 v46, v36, v37
    v_mfma_f32_16x16x32_bf16 v[236:239], a[216:219], v[2:5], v[236:239]
    ds_read_b64_tr_b16 a[238:239], v12 offset:29696
    v_mfma_f32_16x16x32_bf16 v[236:239], a[248:251], v[6:9], v[236:239]
    ds_read_b64_tr_b16 a[204:205], v12 offset:17408
    buffer_load_dwordx4 a[88:91], v1, s[16:19], s80 offen offset:2048 sc1
    v_mfma_f32_16x16x32_bf16 v[252:255], a[252:255], v[6:9], v[252:255]
    v_exp_f32 v38, v38
    v_mfma_f32_16x16x32_bf16 v[252:255], a[220:223], v[2:5], v[252:255]
    v_exp_f32 v39, v39
    v_smfmac_f32_16x16x64_bf16 a[124:127], a[108:111], v[2:9], v0
    ds_read_b64_tr_b16 a[206:207], v12 offset:21504
    v_cvt_pk_bf16_f32 v47, v38, v39
    v_mfma_f32_16x16x32_bf16 v[32:35], a[160:163], v[80:83], v[52:55]
    ds_read_b64_tr_b16 a[208:209], v19 offset:18432
    v_mfma_f32_16x16x32_bf16 v[32:35], a[164:167], v[84:87], v[32:35]
    ds_read_b64_tr_b16 a[210:211], v19 offset:22528
    buffer_load_dwordx4 a[92:95], v1, s[16:19], s80 offen offset:3072 sc1
    s_add_u32 s80, s80, 4096
    v_mfma_f32_16x16x32_bf16 v[32:35], a[168:171], v[88:91], v[32:35]
    ds_read_b64_tr_b16 a[240:241], v19 offset:26624
    v_exp_f32 v24, v24
    v_mfma_f32_16x16x32_bf16 v[32:35], a[172:175], v[92:95], v[32:35]
    v_exp_f32 v25, v25
    v_mfma_f32_16x16x32_bf16 v[36:39], a[188:191], v[92:95], v[52:55]
    ds_read_b64_tr_b16 a[242:243], v19 offset:30720
    v_cvt_pk_bf16_f32 v2, v24, v25
    v_mfma_f32_16x16x32_bf16 v[36:39], a[184:187], v[88:91], v[36:39]
    v_exp_f32 v26, v26
    v_mfma_f32_16x16x32_bf16 v[36:39], a[180:183], v[84:87], v[36:39]
    v_exp_f32 v27, v27
    v_mfma_f32_16x16x32_bf16 v[36:39], a[176:179], v[80:83], v[36:39]
    s_waitcnt lgkmcnt(4)
    ds_read_b64_tr_b16 a[244:245], v12 offset:26624
    v_cvt_pk_bf16_f32 v3, v26, v27
    v_mfma_f32_16x16x32_bf16 v[128:131], a[192:195], v[40:43], v[128:131]
    v_exp_f32 v28, v28
    v_mfma_f32_16x16x32_bf16 v[128:131], a[224:227], v[44:47], v[128:131]
    v_exp_f32 v29, v29
    v_mfma_f32_16x16x32_bf16 v[144:147], a[228:231], v[44:47], v[144:147]
    ds_read_b64_tr_b16 a[246:247], v12 offset:30720
    v_cvt_pk_bf16_f32 v4, v28, v29
    v_mfma_f32_16x16x32_bf16 v[144:147], a[196:199], v[40:43], v[144:147]
    ds_read_b64_tr_b16 a[212:213], v12 offset:18432
    v_mfma_f32_16x16x32_bf16 v[160:163], a[200:203], v[40:43], v[160:163]
    ds_read_b64_tr_b16 a[214:215], v12 offset:22528
    buffer_load_dwordx4 a[96:99], v1, s[16:19], s80 offen offset:0 sc1
    v_mfma_f32_16x16x32_bf16 v[160:163], a[232:235], v[44:47], v[160:163]
    v_exp_f32 v30, v30
    v_mfma_f32_16x16x32_bf16 v[176:179], a[236:239], v[44:47], v[176:179]
    v_exp_f32 v31, v31
    v_mfma_f32_16x16x32_bf16 v[176:179], a[204:207], v[40:43], v[176:179]
    ds_read_b64_tr_b16 a[216:217], v19 offset:19456
    v_cvt_pk_bf16_f32 v5, v30, v31
    v_smfmac_f32_16x16x64_bf16 a[112:115], a[108:111], v[40:47], v0
    ds_read_b64_tr_b16 a[218:219], v19 offset:23552
    v_mfma_f32_16x16x32_bf16 v[24:27], a[128:131], v[96:99], v[56:59]
    ds_read_b64_tr_b16 a[248:249], v19 offset:27648
    buffer_load_dwordx4 a[100:103], v1, s[16:19], s80 offen offset:1024 sc1
    v_mfma_f32_16x16x32_bf16 v[24:27], a[132:135], v[100:103], v[24:27]
    ds_read_b64_tr_b16 a[250:251], v19 offset:31744
    v_mfma_f32_16x16x32_bf16 v[24:27], a[136:139], v[104:107], v[24:27]
    ds_read_b64_tr_b16 a[252:253], v12 offset:27648
    v_mfma_f32_16x16x32_bf16 v[24:27], a[140:143], v[108:111], v[24:27]
    ds_read_b64_tr_b16 a[254:255], v12 offset:31744
    v_mfma_f32_16x16x32_bf16 v[28:31], a[156:159], v[108:111], v[56:59]
    ds_read_b64_tr_b16 a[220:221], v12 offset:19456
    buffer_load_dwordx4 a[104:107], v1, s[16:19], s80 offen offset:2048 sc1
    v_mfma_f32_16x16x32_bf16 v[28:31], a[152:155], v[104:107], v[28:31]
    ds_read_b64_tr_b16 a[222:223], v12 offset:23552
    v_mfma_f32_16x16x32_bf16 v[28:31], a[148:151], v[100:103], v[28:31]
    v_exp_f32 v32, v32
    v_mfma_f32_16x16x32_bf16 v[28:31], a[144:147], v[96:99], v[28:31]
    s_waitcnt lgkmcnt(4)
    v_exp_f32 v33, v33
    v_mfma_f32_16x16x32_bf16 v[192:195], a[208:211], v[40:43], v[192:195]
    v_exp_f32 v34, v34
    v_mfma_f32_16x16x32_bf16 v[192:195], a[240:243], v[44:47], v[192:195]
    v_exp_f32 v35, v35
    v_mfma_f32_16x16x32_bf16 v[208:211], a[244:247], v[44:47], v[208:211]
    v_cvt_pk_bf16_f32 v6, v32, v33
    v_cvt_pk_bf16_f32 v7, v34, v35
    v_mfma_f32_16x16x32_bf16 v[208:211], a[212:215], v[40:43], v[208:211]
    v_exp_f32 v36, v36
    v_mfma_f32_16x16x32_bf16 v[224:227], a[216:219], v[40:43], v[224:227]
    v_exp_f32 v37, v37
    v_mfma_f32_16x16x32_bf16 v[224:227], a[248:251], v[44:47], v[224:227]
    s_waitcnt lgkmcnt(2)
    v_exp_f32 v38, v38
    v_mfma_f32_16x16x32_bf16 v[240:243], a[252:255], v[44:47], v[240:243]
    s_waitcnt lgkmcnt(0)
    v_exp_f32 v39, v39
    v_mfma_f32_16x16x32_bf16 v[240:243], a[220:223], v[40:43], v[240:243]
    v_cvt_pk_bf16_f32 v8, v36, v37
    v_cvt_pk_bf16_f32 v9, v38, v39
    v_mfma_f32_16x16x32_bf16 v[32:35], a[160:163], v[96:99], v[56:59]
    v_exp_f32 v24, v24
    v_mfma_f32_16x16x32_bf16 v[32:35], a[164:167], v[100:103], v[32:35]
    v_exp_f32 v25, v25
    v_mfma_f32_16x16x32_bf16 v[32:35], a[168:171], v[104:107], v[32:35]
    v_cvt_pk_bf16_f32 v40, v24, v25
    v_mfma_f32_16x16x32_bf16 v[32:35], a[172:175], v[108:111], v[32:35]
    buffer_load_dwordx4 v1, s[12:15], s87 offen offset:0 sc1 lds
    v_mfma_f32_16x16x32_bf16 v[36:39], a[188:191], v[108:111], v[56:59]
    v_exp_f32 v26, v26
    v_mfma_f32_16x16x32_bf16 v[36:39], a[184:187], v[104:107], v[36:39]
    v_exp_f32 v27, v27
    v_mfma_f32_16x16x32_bf16 v[36:39], a[180:183], v[100:103], v[36:39]
    v_cvt_pk_bf16_f32 v41, v26, v27
    v_mfma_f32_16x16x32_bf16 v[36:39], a[176:179], v[96:99], v[36:39]
    buffer_load_dwordx4 v1, s[12:15], s87 offen offset:1024 sc1 lds
    v_mfma_f32_16x16x32_bf16 v[132:135], a[192:195], v[2:5], v[132:135]
    v_exp_f32 v28, v28
    v_mfma_f32_16x16x32_bf16 v[132:135], a[224:227], v[6:9], v[132:135]
    v_exp_f32 v29, v29
    v_mfma_f32_16x16x32_bf16 v[148:151], a[228:231], v[6:9], v[148:151]
    v_cvt_pk_bf16_f32 v42, v28, v29
    v_mfma_f32_16x16x32_bf16 v[148:151], a[196:199], v[2:5], v[148:151]
    v_mfma_f32_16x16x32_bf16 v[164:167], a[200:203], v[2:5], v[164:167]
    v_exp_f32 v30, v30
    v_mfma_f32_16x16x32_bf16 v[164:167], a[232:235], v[6:9], v[164:167]
    v_exp_f32 v31, v31
    v_mfma_f32_16x16x32_bf16 v[180:183], a[236:239], v[6:9], v[180:183]
    v_cvt_pk_bf16_f32 v43, v30, v31
    v_mfma_f32_16x16x32_bf16 v[180:183], a[204:207], v[2:5], v[180:183]
    v_mfma_f32_16x16x32_bf16 v[24:27], a[128:131], v[112:115], v[60:63]
    v_mfma_f32_16x16x32_bf16 v[24:27], a[132:135], v[116:119], v[24:27]
    v_mfma_f32_16x16x32_bf16 v[24:27], a[136:139], v[120:123], v[24:27]
    v_exp_f32 v32, v32
    v_mfma_f32_16x16x32_bf16 v[24:27], a[140:143], v[124:127], v[24:27]
    v_exp_f32 v33, v33
    v_mfma_f32_16x16x32_bf16 v[28:31], a[156:159], v[124:127], v[60:63]
    v_cvt_pk_bf16_f32 v44, v32, v33
    v_mfma_f32_16x16x32_bf16 v[28:31], a[152:155], v[120:123], v[28:31]
    v_mfma_f32_16x16x32_bf16 v[28:31], a[148:151], v[116:119], v[28:31]
    v_exp_f32 v34, v34
    v_mfma_f32_16x16x32_bf16 v[28:31], a[144:147], v[112:115], v[28:31]
    v_exp_f32 v35, v35
    v_mfma_f32_16x16x32_bf16 v[196:199], a[208:211], v[2:5], v[196:199]
    v_cvt_pk_bf16_f32 v45, v34, v35
    v_mfma_f32_16x16x32_bf16 v[196:199], a[240:243], v[6:9], v[196:199]
    v_exp_f32 v36, v36
    v_mfma_f32_16x16x32_bf16 v[212:215], a[244:247], v[6:9], v[212:215]
    v_exp_f32 v37, v37
    v_mfma_f32_16x16x32_bf16 v[212:215], a[212:215], v[2:5], v[212:215]
    buffer_load_dwordx4 a[128:131], v1, s[16:19], s80 offen offset:3072 sc1
    s_add_u32 s80, s80, 4096
    v_cvt_pk_bf16_f32 v46, v36, v37
    v_mfma_f32_16x16x32_bf16 v[228:231], a[216:219], v[2:5], v[228:231]
    v_mfma_f32_16x16x32_bf16 v[228:231], a[248:251], v[6:9], v[228:231]
    v_mfma_f32_16x16x32_bf16 v[244:247], a[252:255], v[6:9], v[244:247]
    v_exp_f32 v38, v38
    v_mfma_f32_16x16x32_bf16 v[244:247], a[220:223], v[2:5], v[244:247]
    v_exp_f32 v39, v39
    v_smfmac_f32_16x16x64_bf16 a[116:119], a[108:111], v[2:9], v0
    buffer_load_dwordx4 a[132:135], v1, s[16:19], s80 offen offset:0 sc1
    v_cvt_pk_bf16_f32 v47, v38, v39
    v_mfma_f32_16x16x32_bf16 v[32:35], a[160:163], v[112:115], v[60:63]
    v_mfma_f32_16x16x32_bf16 v[32:35], a[164:167], v[116:119], v[32:35]
    v_mfma_f32_16x16x32_bf16 v[32:35], a[168:171], v[120:123], v[32:35]
    v_exp_f32 v24, v24
    v_mfma_f32_16x16x32_bf16 v[32:35], a[172:175], v[124:127], v[32:35]
    v_exp_f32 v25, v25
    v_mfma_f32_16x16x32_bf16 v[36:39], a[188:191], v[124:127], v[60:63]
    buffer_load_dwordx4 a[136:139], v1, s[16:19], s80 offen offset:1024 sc1
    v_cvt_pk_bf16_f32 v2, v24, v25
    v_mfma_f32_16x16x32_bf16 v[36:39], a[184:187], v[120:123], v[36:39]
    v_exp_f32 v26, v26
    v_mfma_f32_16x16x32_bf16 v[36:39], a[180:183], v[116:119], v[36:39]
    v_exp_f32 v27, v27
    v_mfma_f32_16x16x32_bf16 v[36:39], a[176:179], v[112:115], v[36:39]
    v_cvt_pk_bf16_f32 v3, v26, v27
    v_mfma_f32_16x16x32_bf16 v[136:139], a[192:195], v[40:43], v[136:139]
    v_exp_f32 v28, v28
    v_mfma_f32_16x16x32_bf16 v[136:139], a[224:227], v[44:47], v[136:139]
    v_exp_f32 v29, v29
    v_mfma_f32_16x16x32_bf16 v[152:155], a[228:231], v[44:47], v[152:155]
    buffer_load_dwordx4 a[140:143], v1, s[16:19], s80 offen offset:2048 sc1
    v_cvt_pk_bf16_f32 v4, v28, v29
    v_mfma_f32_16x16x32_bf16 v[152:155], a[196:199], v[40:43], v[152:155]
    v_mfma_f32_16x16x32_bf16 v[168:171], a[200:203], v[40:43], v[168:171]
    v_mfma_f32_16x16x32_bf16 v[168:171], a[232:235], v[44:47], v[168:171]
    v_exp_f32 v30, v30
    v_mfma_f32_16x16x32_bf16 v[184:187], a[236:239], v[44:47], v[184:187]
    v_exp_f32 v31, v31
    v_mfma_f32_16x16x32_bf16 v[184:187], a[204:207], v[40:43], v[184:187]
    buffer_load_dwordx4 a[144:147], v1, s[16:19], s80 offen offset:3072 sc1
    s_add_u32 s80, s80, 4096
    v_cvt_pk_bf16_f32 v5, v30, v31
    v_mfma_f32_16x16x32_bf16 v[200:203], a[208:211], v[40:43], v[200:203]
    v_exp_f32 v32, v32
    v_mfma_f32_16x16x32_bf16 v[200:203], a[240:243], v[44:47], v[200:203]
    v_exp_f32 v33, v33
    v_mfma_f32_16x16x32_bf16 v[216:219], a[244:247], v[44:47], v[216:219]
    v_exp_f32 v34, v34
    v_cvt_pk_bf16_f32 v6, v32, v33
    v_mfma_f32_16x16x32_bf16 v[216:219], a[212:215], v[40:43], v[216:219]
    v_exp_f32 v35, v35
    v_mfma_f32_16x16x32_bf16 v[232:235], a[216:219], v[40:43], v[232:235]
    v_exp_f32 v36, v36
    v_cvt_pk_bf16_f32 v7, v34, v35
    v_mfma_f32_16x16x32_bf16 v[232:235], a[248:251], v[44:47], v[232:235]
    v_exp_f32 v37, v37
    v_mfma_f32_16x16x32_bf16 v[248:251], a[252:255], v[44:47], v[248:251]
    v_exp_f32 v38, v38
    v_cvt_pk_bf16_f32 v8, v36, v37
    v_mfma_f32_16x16x32_bf16 v[248:251], a[220:223], v[40:43], v[248:251]
    v_exp_f32 v39, v39
    v_smfmac_f32_16x16x64_bf16 a[120:123], a[108:111], v[40:47], v0
    v_cvt_pk_bf16_f32 v9, v38, v39
    s_nop 1
    v_mfma_f32_16x16x32_bf16 v[140:143], a[192:195], v[2:5], v[140:143]
    buffer_load_dwordx4 a[148:151], v1, s[16:19], s80 offen offset:0 sc1
    v_mfma_f32_16x16x32_bf16 v[140:143], a[224:227], v[6:9], v[140:143]
    v_mfma_f32_16x16x32_bf16 v[156:159], a[228:231], v[6:9], v[156:159]
    v_mfma_f32_16x16x32_bf16 v[156:159], a[196:199], v[2:5], v[156:159]
    v_mfma_f32_16x16x32_bf16 v[172:175], a[200:203], v[2:5], v[172:175]
    buffer_load_dwordx4 a[152:155], v1, s[16:19], s80 offen offset:1024 sc1
    v_mfma_f32_16x16x32_bf16 v[172:175], a[232:235], v[6:9], v[172:175]
    v_mfma_f32_16x16x32_bf16 v[188:191], a[236:239], v[6:9], v[188:191]
    v_mfma_f32_16x16x32_bf16 v[188:191], a[204:207], v[2:5], v[188:191]
    v_mfma_f32_16x16x32_bf16 v[204:207], a[208:211], v[2:5], v[204:207]
    buffer_load_dwordx4 a[156:159], v1, s[16:19], s80 offen offset:2048 sc1
    v_mfma_f32_16x16x32_bf16 v[204:207], a[240:243], v[6:9], v[204:207]
    v_mfma_f32_16x16x32_bf16 v[220:223], a[244:247], v[6:9], v[220:223]
    v_mfma_f32_16x16x32_bf16 v[220:223], a[212:215], v[2:5], v[220:223]
    v_mfma_f32_16x16x32_bf16 v[236:239], a[216:219], v[2:5], v[236:239]
    buffer_load_dwordx4 a[160:163], v1, s[16:19], s80 offen offset:3072 sc1
    s_add_u32 s80, s80, 4096
    v_mfma_f32_16x16x32_bf16 v[236:239], a[248:251], v[6:9], v[236:239]
    v_mfma_f32_16x16x32_bf16 v[252:255], a[252:255], v[6:9], v[252:255]
    v_mfma_f32_16x16x32_bf16 v[252:255], a[220:223], v[2:5], v[252:255]
    v_smfmac_f32_16x16x64_bf16 a[124:127], a[108:111], v[2:9], v0
    buffer_load_dwordx4 a[164:167], v1, s[16:19], s80 offen offset:0 sc1
    s_nop 2
    v_lshrrev_b32 v0, 4, v1
    v_accvgpr_read_b32 v60, a112
    v_accvgpr_read_b32 v56, a113
    v_accvgpr_read_b32 v61, a116
    v_accvgpr_read_b32 v57, a117
    v_accvgpr_read_b32 v62, a120
    v_accvgpr_read_b32 v58, a121
    v_accvgpr_read_b32 v63, a124
    v_accvgpr_read_b32 v59, a125
    v_add_f32 v60, v60, v56
    v_add_f32 v61, v61, v57
    v_add_f32 v62, v62, v58
    v_add_f32 v63, v63, v59
L_main_norm:
    s_mov_b32 s86, 0x53800000
    v_cmp_ngt_f32 vcc, s86, v60
    v_cmp_ngt_f32 s[70:71], s86, v61
    v_cmp_ngt_f32 s[72:73], s86, v62
    v_cmp_ngt_f32 s[74:75], s86, v63
    v_rcp_f32 v2, v60
    v_rcp_f32 v4, v61
    v_rcp_f32 v6, v62
    v_rcp_f32 v8, v63
    s_or_b64 vcc, vcc, s[70:71]
    s_or_b64 vcc, vcc, s[72:73]
    s_or_b64 vcc, vcc, s[74:75]
    s_cselect_b32 s86, 1, 0
    s_andn2_b32 s86, s86, s85
    s_lshl_b32 s87, s3, 2
    s_add_u32 s87, s87, 161792
    v_mov_b32 v20, s86
    v_mov_b32 v21, s87
    ds_write_b32 v21, v20
    v_mov_b32 v21, 161792
    v_add_u32 v22, s60, v1
    v_pk_mul_f32 v[128:129], v[128:129], v[2:3] op_sel_hi:[1,0]
    v_pk_mul_f32 v[130:131], v[130:131], v[2:3] op_sel_hi:[1,0]
    v_pk_mul_f32 v[144:145], v[144:145], v[2:3] op_sel_hi:[1,0]
    v_pk_mul_f32 v[146:147], v[146:147], v[2:3] op_sel_hi:[1,0]
    v_cvt_pk_bf16_f32 v24, v128, v129
    v_cvt_pk_bf16_f32 v25, v130, v131
    v_cvt_pk_bf16_f32 v26, v144, v145
    v_cvt_pk_bf16_f32 v27, v146, v147
    v_pk_mul_f32 v[160:161], v[160:161], v[2:3] op_sel_hi:[1,0]
    v_pk_mul_f32 v[162:163], v[162:163], v[2:3] op_sel_hi:[1,0]
    v_pk_mul_f32 v[176:177], v[176:177], v[2:3] op_sel_hi:[1,0]
    v_pk_mul_f32 v[178:179], v[178:179], v[2:3] op_sel_hi:[1,0]
    v_cvt_pk_bf16_f32 v28, v160, v161
    v_cvt_pk_bf16_f32 v29, v162, v163
    v_cvt_pk_bf16_f32 v30, v176, v177
    v_cvt_pk_bf16_f32 v31, v178, v179
    v_pk_mul_f32 v[192:193], v[192:193], v[2:3] op_sel_hi:[1,0]
    v_pk_mul_f32 v[194:195], v[194:195], v[2:3] op_sel_hi:[1,0]
    v_pk_mul_f32 v[208:209], v[208:209], v[2:3] op_sel_hi:[1,0]
    v_pk_mul_f32 v[210:211], v[210:211], v[2:3] op_sel_hi:[1,0]
    v_cvt_pk_bf16_f32 v32, v192, v193
    v_cvt_pk_bf16_f32 v33, v194, v195
    v_cvt_pk_bf16_f32 v34, v208, v209
    v_cvt_pk_bf16_f32 v35, v210, v211
    v_pk_mul_f32 v[224:225], v[224:225], v[2:3] op_sel_hi:[1,0]
    v_pk_mul_f32 v[226:227], v[226:227], v[2:3] op_sel_hi:[1,0]
    v_pk_mul_f32 v[240:241], v[240:241], v[2:3] op_sel_hi:[1,0]
    v_pk_mul_f32 v[242:243], v[242:243], v[2:3] op_sel_hi:[1,0]
    v_cvt_pk_bf16_f32 v36, v224, v225
    v_cvt_pk_bf16_f32 v37, v226, v227
    v_cvt_pk_bf16_f32 v38, v240, v241
    v_cvt_pk_bf16_f32 v39, v242, v243
    v_pk_mul_f32 v[132:133], v[132:133], v[4:5] op_sel_hi:[1,0]
    v_pk_mul_f32 v[134:135], v[134:135], v[4:5] op_sel_hi:[1,0]
    v_pk_mul_f32 v[148:149], v[148:149], v[4:5] op_sel_hi:[1,0]
    v_pk_mul_f32 v[150:151], v[150:151], v[4:5] op_sel_hi:[1,0]
    v_pk_mul_f32 v[164:165], v[164:165], v[4:5] op_sel_hi:[1,0]
    v_pk_mul_f32 v[166:167], v[166:167], v[4:5] op_sel_hi:[1,0]
    v_pk_mul_f32 v[180:181], v[180:181], v[4:5] op_sel_hi:[1,0]
    v_pk_mul_f32 v[182:183], v[182:183], v[4:5] op_sel_hi:[1,0]
    v_pk_mul_f32 v[196:197], v[196:197], v[4:5] op_sel_hi:[1,0]
    v_pk_mul_f32 v[198:199], v[198:199], v[4:5] op_sel_hi:[1,0]
    v_pk_mul_f32 v[212:213], v[212:213], v[4:5] op_sel_hi:[1,0]
    v_pk_mul_f32 v[214:215], v[214:215], v[4:5] op_sel_hi:[1,0]
    v_pk_mul_f32 v[228:229], v[228:229], v[4:5] op_sel_hi:[1,0]
    v_pk_mul_f32 v[230:231], v[230:231], v[4:5] op_sel_hi:[1,0]
    v_pk_mul_f32 v[244:245], v[244:245], v[4:5] op_sel_hi:[1,0]
    v_pk_mul_f32 v[246:247], v[246:247], v[4:5] op_sel_hi:[1,0]
    v_pk_mul_f32 v[136:137], v[136:137], v[6:7] op_sel_hi:[1,0]
    v_pk_mul_f32 v[138:139], v[138:139], v[6:7] op_sel_hi:[1,0]
    v_pk_mul_f32 v[152:153], v[152:153], v[6:7] op_sel_hi:[1,0]
    v_pk_mul_f32 v[154:155], v[154:155], v[6:7] op_sel_hi:[1,0]
    v_pk_mul_f32 v[168:169], v[168:169], v[6:7] op_sel_hi:[1,0]
    v_pk_mul_f32 v[170:171], v[170:171], v[6:7] op_sel_hi:[1,0]
    v_pk_mul_f32 v[184:185], v[184:185], v[6:7] op_sel_hi:[1,0]
    v_pk_mul_f32 v[186:187], v[186:187], v[6:7] op_sel_hi:[1,0]
    v_pk_mul_f32 v[200:201], v[200:201], v[6:7] op_sel_hi:[1,0]
    v_pk_mul_f32 v[202:203], v[202:203], v[6:7] op_sel_hi:[1,0]
    v_pk_mul_f32 v[216:217], v[216:217], v[6:7] op_sel_hi:[1,0]
    v_pk_mul_f32 v[218:219], v[218:219], v[6:7] op_sel_hi:[1,0]
    v_pk_mul_f32 v[232:233], v[232:233], v[6:7] op_sel_hi:[1,0]
    v_pk_mul_f32 v[234:235], v[234:235], v[6:7] op_sel_hi:[1,0]
    v_pk_mul_f32 v[248:249], v[248:249], v[6:7] op_sel_hi:[1,0]
    v_pk_mul_f32 v[250:251], v[250:251], v[6:7] op_sel_hi:[1,0]
    s_waitcnt vmcnt(30)
    v_mfma_f32_16x16x32_bf16 v[128:131], a[0:3], v[24:27], 0
    v_mul_f32 v140, v140, v8
    v_mul_f32 v141, v141, v8
    v_mfma_f32_16x16x32_bf16 v[144:147], a[4:7], v[24:27], 0
    buffer_load_dwordx4 a[168:171], v1, s[16:19], s80 offen offset:1024 sc1
    v_mfma_f32_16x16x32_bf16 v[160:163], a[8:11], v[24:27], 0
    v_cvt_pk_bf16_f32 v40, v132, v133
    v_cvt_pk_bf16_f32 v41, v134, v135
    v_mfma_f32_16x16x32_bf16 v[176:179], a[12:15], v[24:27], 0
    ds_write_b128 v22, v[24:27] offset:0
    v_mfma_f32_16x16x32_bf16 v[192:195], a[16:19], v[24:27], 0
    v_mul_f32 v142, v142, v8
    v_mul_f32 v143, v143, v8
    v_mfma_f32_16x16x32_bf16 v[208:211], a[20:23], v[24:27], 0
    buffer_load_dwordx4 a[172:175], v1, s[16:19], s80 offen offset:2048 sc1
    v_mfma_f32_16x16x32_bf16 v[224:227], a[24:27], v[24:27], 0
    v_cvt_pk_bf16_f32 v42, v148, v149
    v_cvt_pk_bf16_f32 v43, v150, v151
    v_mfma_f32_16x16x32_bf16 v[240:243], a[28:31], v[24:27], 0
    ds_write_b128 v22, v[28:31] offset:4096
    v_mfma_f32_16x16x32_bf16 v[128:131], a[32:35], v[28:31], v[128:131]
    s_waitcnt vmcnt(23)
    v_mul_f32 v156, v156, v8
    v_mul_f32 v157, v157, v8
    v_mfma_f32_16x16x32_bf16 v[144:147], a[36:39], v[28:31], v[144:147]
    buffer_load_dwordx4 a[176:179], v1, s[16:19], s80 offen offset:3072 sc1
    v_mfma_f32_16x16x32_bf16 v[160:163], a[40:43], v[28:31], v[160:163]
    s_add_u32 s80, s80, 4096
    v_cvt_pk_bf16_f32 v44, v164, v165
    v_cvt_pk_bf16_f32 v45, v166, v167
    v_mfma_f32_16x16x32_bf16 v[176:179], a[44:47], v[28:31], v[176:179]
    ds_write_b128 v22, v[40:43] offset:1024
    v_mfma_f32_16x16x32_bf16 v[192:195], a[48:51], v[28:31], v[192:195]
    s_waitcnt lgkmcnt(3)
    v_mul_f32 v158, v158, v8
    v_mul_f32 v159, v159, v8
    v_mfma_f32_16x16x32_bf16 v[208:211], a[52:55], v[28:31], v[208:211]
    buffer_load_dwordx4 a[180:183], v1, s[16:19], s80 offen offset:0 sc1
    v_mfma_f32_16x16x32_bf16 v[224:227], a[56:59], v[28:31], v[224:227]
    s_barrier
    v_cvt_pk_bf16_f32 v46, v180, v181
    v_cvt_pk_bf16_f32 v47, v182, v183
    v_mfma_f32_16x16x32_bf16 v[240:243], a[60:63], v[28:31], v[240:243]
    ds_read_b128 v[56:59], v21
    v_mfma_f32_16x16x32_bf16 v[128:131], a[64:67], v[32:35], v[128:131]
    v_mul_f32 v172, v172, v8
    v_mul_f32 v173, v173, v8
    v_mfma_f32_16x16x32_bf16 v[144:147], a[68:71], v[32:35], v[144:147]
    s_waitcnt vmcnt(16)
    buffer_load_dwordx4 a[184:187], v1, s[16:19], s80 offen offset:1024 sc1
    v_mfma_f32_16x16x32_bf16 v[160:163], a[72:75], v[32:35], v[160:163]
    v_cvt_pk_bf16_f32 v48, v196, v197
    v_cvt_pk_bf16_f32 v49, v198, v199
    v_mfma_f32_16x16x32_bf16 v[176:179], a[76:79], v[32:35], v[176:179]
    ds_write_b128 v22, v[44:47] offset:5120
    v_mfma_f32_16x16x32_bf16 v[192:195], a[80:83], v[32:35], v[192:195]
    v_mul_f32 v174, v174, v8
    v_mul_f32 v175, v175, v8
    v_mfma_f32_16x16x32_bf16 v[208:211], a[84:87], v[32:35], v[208:211]
    buffer_load_dwordx4 a[188:191], v1, s[16:19], s80 offen offset:2048 sc1
    v_mfma_f32_16x16x32_bf16 v[224:227], a[88:91], v[32:35], v[224:227]
    v_cvt_pk_bf16_f32 v50, v212, v213
    v_cvt_pk_bf16_f32 v51, v214, v215
    v_mfma_f32_16x16x32_bf16 v[240:243], a[92:95], v[32:35], v[240:243]
    ds_write_b128 v22, v[32:35] offset:8192
    v_mfma_f32_16x16x32_bf16 v[128:131], a[96:99], v[36:39], v[128:131]
    v_mul_f32 v188, v188, v8
    v_mul_f32 v189, v189, v8
    v_mfma_f32_16x16x32_bf16 v[144:147], a[100:103], v[36:39], v[144:147]
    buffer_load_dwordx4 a[108:111], v1, s[16:19], s80 offen offset:3072 sc1
    v_mfma_f32_16x16x32_bf16 v[160:163], a[104:107], v[36:39], v[160:163]
    s_add_u32 s80, s80, 4096
    s_waitcnt vmcnt(12)
    v_cvt_pk_bf16_f32 v52, v228, v229
    v_cvt_pk_bf16_f32 v53, v230, v231
    v_mfma_f32_16x16x32_bf16 v[176:179], a[128:131], v[36:39], v[176:179]
    ds_write_b128 v22, v[48:51] offset:9216
    v_mfma_f32_16x16x32_bf16 v[192:195], a[132:135], v[36:39], v[192:195]
    v_mul_f32 v190, v190, v8
    v_mul_f32 v191, v191, v8
    v_mfma_f32_16x16x32_bf16 v[208:211], a[136:139], v[36:39], v[208:211]
    s_waitcnt lgkmcnt(3)
    v_or_b32 v56, v56, v57
    v_or3_b32 v56, v56, v58, v59
    v_cmp_ne_u32 vcc, 0, v56
    v_mfma_f32_16x16x32_bf16 v[224:227], a[140:143], v[36:39], v[224:227]
    v_cvt_pk_bf16_f32 v54, v244, v245
    v_cvt_pk_bf16_f32 v55, v246, v247
    v_mfma_f32_16x16x32_bf16 v[240:243], a[144:147], v[36:39], v[240:243]
    s_cbranch_vccnz L_main_slow
    ds_write_b128 v22, v[36:39] offset:12288
    v_mfma_f32_16x16x32_bf16 v[132:135], a[0:3], v[40:43], 0
    v_mul_f32 v204, v204, v8
    v_mul_f32 v205, v205, v8
    v_mfma_f32_16x16x32_bf16 v[132:135], a[32:35], v[44:47], v[132:135]
    buffer_load_dwordx4 a[112:115], v1, s[16:19], s80 offen offset:0 sc1
    v_mfma_f32_16x16x32_bf16 v[132:135], a[64:67], v[48:51], v[132:135]
    v_cvt_pk_bf16_f32 v24, v136, v137
    v_cvt_pk_bf16_f32 v25, v138, v139
    v_mfma_f32_16x16x32_bf16 v[132:135], a[96:99], v[52:55], v[132:135]
    ds_write_b128 v22, v[52:55] offset:13312
    v_mfma_f32_16x16x32_bf16 v[148:151], a[4:7], v[40:43], 0
    v_mul_f32 v206, v206, v8
    v_mul_f32 v207, v207, v8
    v_mfma_f32_16x16x32_bf16 v[148:151], a[36:39], v[44:47], v[148:151]
    s_branch L_ov8
L_pad8:
    s_setpc_b64 s[86:87]
L_ov8:
    buffer_load_dwordx4 a[116:119], v1, s[16:19], s80 offen offset:1024 sc1
    v_mfma_f32_16x16x32_bf16 v[148:151], a[68:71], v[48:51], v[148:151]
    v_cvt_pk_bf16_f32 v26, v152, v153
    v_cvt_pk_bf16_f32 v27, v154, v155
    v_mfma_f32_16x16x32_bf16 v[148:151], a[100:103], v[52:55], v[148:151]
    s_lshl_b32 s86, s5, 16
    v_mfma_f32_16x16x32_bf16 v[164:167], a[8:11], v[40:43], 0
    v_mul_f32 v220, v220, v8
    v_mul_f32 v221, v221, v8
    v_mfma_f32_16x16x32_bf16 v[164:167], a[40:43], v[44:47], v[164:167]
    buffer_load_dwordx4 a[120:123], v1, s[16:19], s80 offen offset:2048 sc1
    v_mfma_f32_16x16x32_bf16 v[164:167], a[72:75], v[48:51], v[164:167]
    v_cvt_pk_bf16_f32 v28, v168, v169
    v_cvt_pk_bf16_f32 v29, v170, v171
    v_mfma_f32_16x16x32_bf16 v[164:167], a[104:107], v[52:55], v[164:167]
    s_add_u32 s86, s86, 0x300000
    ds_write_b128 v22, v[24:27] offset:2048
    v_mfma_f32_16x16x32_bf16 v[180:183], a[12:15], v[40:43], 0
    v_mul_f32 v222, v222, v8
    v_mul_f32 v223, v223, v8
    v_mfma_f32_16x16x32_bf16 v[180:183], a[44:47], v[44:47], v[180:183]
    buffer_load_dwordx4 a[124:127], v1, s[16:19], s80 offen offset:3072 sc1
    v_mfma_f32_16x16x32_bf16 v[180:183], a[76:79], v[48:51], v[180:183]
    s_add_u32 s80, s80, 4096
    v_cvt_pk_bf16_f32 v30, v184, v185
    v_cvt_pk_bf16_f32 v31, v186, v187
    v_mfma_f32_16x16x32_bf16 v[180:183], a[128:131], v[52:55], v[180:183]
    s_add_u32 s28, s66, s86
    s_addc_u32 s29, s67, 0
    v_mfma_f32_16x16x32_bf16 v[196:199], a[16:19], v[40:43], 0
    v_mul_f32 v236, v236, v8
    v_mul_f32 v237, v237, v8
    v_mfma_f32_16x16x32_bf16 v[196:199], a[48:51], v[44:47], v[196:199]
    buffer_load_dwordx4 a[192:195], v1, s[16:19], s80 offen offset:0 sc1
    v_mfma_f32_16x16x32_bf16 v[196:199], a[80:83], v[48:51], v[196:199]
    v_cvt_pk_bf16_f32 v32, v200, v201
    v_cvt_pk_bf16_f32 v33, v202, v203
    v_mfma_f32_16x16x32_bf16 v[196:199], a[132:135], v[52:55], v[196:199]
    s_and_b32 s29, s29, 0xffff
    ds_write_b128 v22, v[28:31] offset:6144
    v_mfma_f32_16x16x32_bf16 v[212:215], a[20:23], v[40:43], 0
    v_mul_f32 v238, v238, v8
    v_mul_f32 v239, v239, v8
    v_mfma_f32_16x16x32_bf16 v[212:215], a[52:55], v[44:47], v[212:215]
    buffer_load_dwordx4 a[196:199], v1, s[16:19], s80 offen offset:1024 sc1
    v_mfma_f32_16x16x32_bf16 v[212:215], a[84:87], v[48:51], v[212:215]
    v_cvt_pk_bf16_f32 v34, v216, v217
    v_cvt_pk_bf16_f32 v35, v218, v219
    v_mfma_f32_16x16x32_bf16 v[212:215], a[136:139], v[52:55], v[212:215]
    s_mov_b32 s30, 0x10000
    v_mfma_f32_16x16x32_bf16 v[228:231], a[24:27], v[40:43], 0
    v_mul_f32 v252, v252, v8
    v_mul_f32 v253, v253, v8
    v_mfma_f32_16x16x32_bf16 v[228:231], a[56:59], v[44:47], v[228:231]
    buffer_load_dwordx4 a[200:203], v1, s[16:19], s80 offen offset:2048 sc1
    v_mfma_f32_16x16x32_bf16 v[228:231], a[88:91], v[48:51], v[228:231]
    v_cvt_pk_bf16_f32 v36, v232, v233
    v_cvt_pk_bf16_f32 v37, v234, v235
    v_mfma_f32_16x16x32_bf16 v[228:231], a[140:143], v[52:55], v[228:231]
    s_mov_b32 s31, 0x20000
    ds_write_b128 v22, v[32:35] offset:10240
    v_mfma_f32_16x16x32_bf16 v[244:247], a[28:31], v[40:43], 0
    v_mul_f32 v254, v254, v8
    v_mul_f32 v255, v255, v8
    v_mfma_f32_16x16x32_bf16 v[244:247], a[60:63], v[44:47], v[244:247]
    buffer_load_dwordx4 a[204:207], v1, s[16:19], s80 offen offset:3072 sc1
    v_mfma_f32_16x16x32_bf16 v[244:247], a[92:95], v[48:51], v[244:247]
    s_add_u32 s80, s80, 4096
    v_cvt_pk_bf16_f32 v38, v248, v249
    v_cvt_pk_bf16_f32 v39, v250, v251
    v_mfma_f32_16x16x32_bf16 v[244:247], a[144:147], v[52:55], v[244:247]
    s_mov_b32 s36, s94
    v_mfma_f32_16x16x32_bf16 v[136:139], a[0:3], v[24:27], 0
    v_mfma_f32_16x16x32_bf16 v[136:139], a[32:35], v[28:31], v[136:139]
    buffer_load_dwordx4 a[208:211], v1, s[16:19], s80 offen offset:0 sc1
    v_mfma_f32_16x16x32_bf16 v[136:139], a[64:67], v[32:35], v[136:139]
    v_cvt_pk_bf16_f32 v40, v140, v141
    v_cvt_pk_bf16_f32 v41, v142, v143
    v_mfma_f32_16x16x32_bf16 v[136:139], a[96:99], v[36:39], v[136:139]
    s_and_b32 s37, s95, 0xffff
    ds_write_b128 v22, v[36:39] offset:14336
    v_mfma_f32_16x16x32_bf16 v[152:155], a[4:7], v[24:27], 0
    v_mfma_f32_16x16x32_bf16 v[152:155], a[36:39], v[28:31], v[152:155]
    buffer_load_dwordx4 a[212:215], v1, s[16:19], s80 offen offset:1024 sc1
    v_mfma_f32_16x16x32_bf16 v[152:155], a[68:71], v[32:35], v[152:155]
    v_cvt_pk_bf16_f32 v42, v156, v157
    v_cvt_pk_bf16_f32 v43, v158, v159
    v_mfma_f32_16x16x32_bf16 v[152:155], a[100:103], v[36:39], v[152:155]
    s_mov_b32 s38, 0x200000
    v_mfma_f32_16x16x32_bf16 v[168:171], a[8:11], v[24:27], 0
    v_mfma_f32_16x16x32_bf16 v[168:171], a[40:43], v[28:31], v[168:171]
    buffer_load_dwordx4 a[216:219], v1, s[16:19], s80 offen offset:2048 sc1
    v_mfma_f32_16x16x32_bf16 v[168:171], a[72:75], v[32:35], v[168:171]
    v_cvt_pk_bf16_f32 v44, v172, v173
    v_cvt_pk_bf16_f32 v45, v174, v175
    v_mfma_f32_16x16x32_bf16 v[168:171], a[104:107], v[36:39], v[168:171]
    s_mov_b32 s39, 0x20000
    ds_write_b128 v22, v[40:43] offset:3072
    v_mfma_f32_16x16x32_bf16 v[184:187], a[12:15], v[24:27], 0
    v_mfma_f32_16x16x32_bf16 v[184:187], a[44:47], v[28:31], v[184:187]
    buffer_load_dwordx4 a[220:223], v1, s[16:19], s80 offen offset:3072 sc1
    v_mfma_f32_16x16x32_bf16 v[184:187], a[76:79], v[32:35], v[184:187]
    s_add_u32 s80, s80, 4096
    v_cvt_pk_bf16_f32 v46, v188, v189
    v_cvt_pk_bf16_f32 v47, v190, v191
    v_mfma_f32_16x16x32_bf16 v[184:187], a[128:131], v[36:39], v[184:187]
    s_mov_b32 s88, s93
    v_mfma_f32_16x16x32_bf16 v[200:203], a[16:19], v[24:27], 0
    v_mfma_f32_16x16x32_bf16 v[200:203], a[48:51], v[28:31], v[200:203]
    buffer_load_dwordx4 a[224:227], v1, s[16:19], s80 offen offset:0 sc1
    v_mfma_f32_16x16x32_bf16 v[200:203], a[80:83], v[32:35], v[200:203]
    v_cvt_pk_bf16_f32 v48, v204, v205
    v_cvt_pk_bf16_f32 v49, v206, v207
    v_mfma_f32_16x16x32_bf16 v[200:203], a[132:135], v[36:39], v[200:203]
    s_lshl_b32 s86, s5, 19
    ds_write_b128 v22, v[44:47] offset:7168
    v_mfma_f32_16x16x32_bf16 v[216:219], a[20:23], v[24:27], 0
    v_mfma_f32_16x16x32_bf16 v[216:219], a[52:55], v[28:31], v[216:219]
    buffer_load_dwordx4 a[228:231], v1, s[16:19], s80 offen offset:1024 sc1
    v_mfma_f32_16x16x32_bf16 v[216:219], a[84:87], v[32:35], v[216:219]
    v_cvt_pk_bf16_f32 v50, v220, v221
    v_cvt_pk_bf16_f32 v51, v222, v223
    v_mfma_f32_16x16x32_bf16 v[216:219], a[136:139], v[36:39], v[216:219]
    s_add_u32 s86, s86, 0x1000000
    v_mfma_f32_16x16x32_bf16 v[232:235], a[24:27], v[24:27], 0
    v_mfma_f32_16x16x32_bf16 v[232:235], a[56:59], v[28:31], v[232:235]
    buffer_load_dwordx4 a[232:235], v1, s[16:19], s80 offen offset:2048 sc1
    v_mfma_f32_16x16x32_bf16 v[232:235], a[88:91], v[32:35], v[232:235]
    v_cvt_pk_bf16_f32 v52, v236, v237
    v_cvt_pk_bf16_f32 v53, v238, v239
    v_mfma_f32_16x16x32_bf16 v[232:235], a[140:143], v[36:39], v[232:235]
    s_add_u32 s24, s66, s86
    s_addc_u32 s25, s67, 0
    ds_write_b128 v22, v[48:51] offset:11264
    v_mfma_f32_16x16x32_bf16 v[248:251], a[28:31], v[24:27], 0
    v_mfma_f32_16x16x32_bf16 v[248:251], a[60:63], v[28:31], v[248:251]
    buffer_load_dwordx4 a[236:239], v1, s[16:19], s80 offen offset:3072 sc1
    v_mfma_f32_16x16x32_bf16 v[248:251], a[92:95], v[32:35], v[248:251]
    s_add_u32 s80, s80, 4096
    v_cvt_pk_bf16_f32 v54, v252, v253
    v_cvt_pk_bf16_f32 v55, v254, v255
    v_mfma_f32_16x16x32_bf16 v[248:251], a[144:147], v[36:39], v[248:251]
    s_and_b32 s25, s25, 0xffff
    v_mfma_f32_16x16x32_bf16 v[140:143], a[0:3], v[40:43], 0
    v_mfma_f32_16x16x32_bf16 v[140:143], a[32:35], v[44:47], v[140:143]
    buffer_load_dwordx4 a[240:243], v1, s[16:19], s80 offen offset:0 sc1
    v_mfma_f32_16x16x32_bf16 v[140:143], a[64:67], v[48:51], v[140:143]
    v_add_u32 v20, s61, v1
    v_mfma_f32_16x16x32_bf16 v[140:143], a[96:99], v[52:55], v[140:143]
    s_mov_b32 s26, 0x80000
    ds_write_b128 v22, v[52:55] offset:15360
    v_mfma_f32_16x16x32_bf16 v[156:159], a[4:7], v[40:43], 0
    v_add_u32 v21, s62, v1
    v_mfma_f32_16x16x32_bf16 v[156:159], a[36:39], v[44:47], v[156:159]
    buffer_load_dwordx4 a[244:247], v1, s[16:19], s80 offen offset:1024 sc1
    v_mfma_f32_16x16x32_bf16 v[156:159], a[68:71], v[48:51], v[156:159]
    v_add_u32 v23, s63, v1
    v_mfma_f32_16x16x32_bf16 v[156:159], a[100:103], v[52:55], v[156:159]
    s_mov_b32 s27, 0x20000
    v_mfma_f32_16x16x32_bf16 v[172:175], a[8:11], v[40:43], 0
    v_mfma_f32_16x16x32_bf16 v[172:175], a[40:43], v[44:47], v[172:175]
    buffer_load_dwordx4 a[248:251], v1, s[16:19], s80 offen offset:2048 sc1
    v_mfma_f32_16x16x32_bf16 v[172:175], a[72:75], v[48:51], v[172:175]
    s_waitcnt vmcnt(36) lgkmcnt(0)
    s_barrier
    v_mfma_f32_16x16x32_bf16 v[172:175], a[104:107], v[52:55], v[172:175]
    v_mfma_f32_16x16x32_bf16 v[188:191], a[12:15], v[40:43], 0
    ds_read_b128 v[80:83], v20 offset:0
    v_mfma_f32_16x16x32_bf16 v[188:191], a[44:47], v[44:47], v[188:191]
    buffer_load_dwordx4 a[252:255], v1, s[16:19], s80 offen offset:3072 sc1
    v_mfma_f32_16x16x32_bf16 v[188:191], a[76:79], v[48:51], v[188:191]
    s_add_u32 s80, s80, 4096
    ds_read_b128 v[84:87], v20 offset:4096
    v_mfma_f32_16x16x32_bf16 v[188:191], a[128:131], v[52:55], v[188:191]
    v_mfma_f32_16x16x32_bf16 v[204:207], a[16:19], v[40:43], 0
    ds_read_b128 v[88:91], v20 offset:1024
    v_mfma_f32_16x16x32_bf16 v[204:207], a[48:51], v[44:47], v[204:207]
    buffer_load_dwordx4 a[0:3], v1, s[16:19], s80 offen offset:0 sc1
    v_mfma_f32_16x16x32_bf16 v[204:207], a[80:83], v[48:51], v[204:207]
    ds_read_b128 v[92:95], v20 offset:5120
    v_mfma_f32_16x16x32_bf16 v[204:207], a[132:135], v[52:55], v[204:207]
    v_mfma_f32_16x16x32_bf16 v[220:223], a[20:23], v[40:43], 0
    ds_read_b128 v[96:99], v20 offset:2048
    v_mfma_f32_16x16x32_bf16 v[220:223], a[52:55], v[44:47], v[220:223]
    buffer_load_dwordx4 a[4:7], v1, s[16:19], s80 offen offset:1024 sc1
    v_mfma_f32_16x16x32_bf16 v[220:223], a[84:87], v[48:51], v[220:223]
    ds_read_b128 v[100:103], v20 offset:6144
    v_mfma_f32_16x16x32_bf16 v[220:223], a[136:139], v[52:55], v[220:223]
    v_mfma_f32_16x16x32_bf16 v[236:239], a[24:27], v[40:43], 0
    ds_read_b128 v[104:107], v20 offset:3072
    v_mfma_f32_16x16x32_bf16 v[236:239], a[56:59], v[44:47], v[236:239]
    buffer_load_dwordx4 a[8:11], v1, s[16:19], s80 offen offset:2048 sc1
    v_mfma_f32_16x16x32_bf16 v[236:239], a[88:91], v[48:51], v[236:239]
    ds_read_b128 v[108:111], v20 offset:7168
    v_mfma_f32_16x16x32_bf16 v[236:239], a[140:143], v[52:55], v[236:239]
    v_mfma_f32_16x16x32_bf16 v[252:255], a[28:31], v[40:43], 0
    v_mfma_f32_16x16x32_bf16 v[252:255], a[60:63], v[44:47], v[252:255]
    buffer_load_dwordx4 a[12:15], v1, s[16:19], s80 offen offset:3072 sc1
    v_mfma_f32_16x16x32_bf16 v[252:255], a[92:95], v[48:51], v[252:255]
    s_add_u32 s80, s80, 4096
    v_mfma_f32_16x16x32_bf16 v[252:255], a[144:147], v[52:55], v[252:255]
    s_waitcnt vmcnt(27) lgkmcnt(2)
    v_mfma_f32_16x16x32_bf16 v[128:131], a[148:151], v[80:83], v[128:131]
    v_lshrrev_b32 v2, 4, v0
    v_mfma_f32_16x16x32_bf16 v[128:131], a[180:183], v[84:87], v[128:131]
    buffer_load_dwordx4 a[16:19], v1, s[16:19], s80 offen offset:0 sc1
    v_mfma_f32_16x16x32_bf16 v[132:135], a[148:151], v[88:91], v[132:135]
    v_lshlrev_b32 v2, 7, v2
    v_mfma_f32_16x16x32_bf16 v[132:135], a[180:183], v[92:95], v[132:135]
    ds_read_b128 v[24:27], v20 offset:8192
    v_mfma_f32_16x16x32_bf16 v[136:139], a[148:151], v[96:99], v[136:139]
    v_lshlrev_b32 v3, 8, v0
    v_mfma_f32_16x16x32_bf16 v[136:139], a[180:183], v[100:103], v[136:139]
    s_waitcnt lgkmcnt(2)
    buffer_load_dwordx4 a[20:23], v1, s[16:19], s80 offen offset:1024 sc1
    v_mfma_f32_16x16x32_bf16 v[140:143], a[148:151], v[104:107], v[140:143]
    s_waitcnt lgkmcnt(1)
    v_lshrrev_b32 v12, 2, v11
    v_mfma_f32_16x16x32_bf16 v[140:143], a[180:183], v[108:111], v[140:143]
    ds_read_b128 v[28:31], v20 offset:12288
    v_mfma_f32_16x16x32_bf16 v[144:147], a[152:155], v[80:83], v[144:147]
    s_waitcnt vmcnt(27)
    v_and_b32 v12, 0xc00, v12
    v_mfma_f32_16x16x32_bf16 v[144:147], a[184:187], v[84:87], v[144:147]
    buffer_load_dwordx4 a[24:27], v1, s[16:19], s80 offen offset:2048 sc1
    v_mfma_f32_16x16x32_bf16 v[148:151], a[152:155], v[88:91], v[148:151]
    v_and_b32 v10, 7, v0
    v_mfma_f32_16x16x32_bf16 v[148:151], a[184:187], v[92:95], v[148:151]
    ds_read_b128 v[32:35], v20 offset:9216
    v_mfma_f32_16x16x32_bf16 v[152:155], a[152:155], v[96:99], v[152:155]
    v_lshl_add_u32 v10, v10, 7, v12
    v_mfma_f32_16x16x32_bf16 v[152:155], a[184:187], v[100:103], v[152:155]
    buffer_load_dwordx4 a[28:31], v1, s[16:19], s80 offen offset:3072 sc1
    v_mfma_f32_16x16x32_bf16 v[156:159], a[152:155], v[104:107], v[156:159]
    s_add_u32 s80, s80, 4096
    v_add_u32 v12, v12, v2
    v_mfma_f32_16x16x32_bf16 v[156:159], a[184:187], v[108:111], v[156:159]
    ds_read_b128 v[36:39], v20 offset:13312
    v_mfma_f32_16x16x32_bf16 v[160:163], a[156:159], v[80:83], v[160:163]
    v_and_b32 v13, 0xc080, v11
    v_mfma_f32_16x16x32_bf16 v[160:163], a[188:191], v[84:87], v[160:163]
    buffer_load_dwordx4 a[32:35], v1, s[16:19], s80 offen offset:0 sc1
    v_mfma_f32_16x16x32_bf16 v[164:167], a[156:159], v[88:91], v[164:167]
    v_add_u32 v13, v13, v3
    v_mfma_f32_16x16x32_bf16 v[164:167], a[188:191], v[92:95], v[164:167]
    ds_read_b128 v[40:43], v20 offset:10240
    v_mfma_f32_16x16x32_bf16 v[168:171], a[156:159], v[96:99], v[168:171]
    v_mov_b32 v14, s50
    v_mfma_f32_16x16x32_bf16 v[168:171], a[188:191], v[100:103], v[168:171]
    buffer_load_dwordx4 a[36:39], v1, s[16:19], s80 offen offset:1024 sc1
    v_mfma_f32_16x16x32_bf16 v[172:175], a[156:159], v[104:107], v[172:175]
    v_writelane_b32 v14, s44, 0
    v_mfma_f32_16x16x32_bf16 v[172:175], a[188:191], v[108:111], v[172:175]
    ds_read_b128 v[44:47], v20 offset:14336
    v_mfma_f32_16x16x32_bf16 v[176:179], a[160:163], v[80:83], v[176:179]
    s_waitcnt vmcnt(29)
    v_writelane_b32 v14, s45, 1
    v_mfma_f32_16x16x32_bf16 v[176:179], a[108:111], v[84:87], v[176:179]
    buffer_load_dwordx4 a[40:43], v1, s[16:19], s80 offen offset:2048 sc1
    v_mfma_f32_16x16x32_bf16 v[180:183], a[160:163], v[88:91], v[180:183]
    v_writelane_b32 v14, s46, 2
    v_mfma_f32_16x16x32_bf16 v[180:183], a[108:111], v[92:95], v[180:183]
    ds_read_b128 v[48:51], v20 offset:11264
    v_mfma_f32_16x16x32_bf16 v[184:187], a[160:163], v[96:99], v[184:187]
    v_writelane_b32 v14, s47, 3
    v_mfma_f32_16x16x32_bf16 v[184:187], a[108:111], v[100:103], v[184:187]
    buffer_load_dwordx4 a[44:47], v1, s[16:19], s80 offen offset:3072 sc1
    v_mfma_f32_16x16x32_bf16 v[188:191], a[160:163], v[104:107], v[188:191]
    s_add_u32 s80, s80, 4096
    v_writelane_b32 v14, s48, 4
    v_mfma_f32_16x16x32_bf16 v[188:191], a[108:111], v[108:111], v[188:191]
    ds_read_b128 v[52:55], v20 offset:15360
    v_mfma_f32_16x16x32_bf16 v[192:195], a[164:167], v[80:83], v[192:195]
    v_writelane_b32 v14, s49, 5
    v_mfma_f32_16x16x32_bf16 v[192:195], a[112:115], v[84:87], v[192:195]
    buffer_load_dwordx4 a[48:51], v1, s[16:19], s80 offen offset:0 sc1
    v_mfma_f32_16x16x32_bf16 v[196:199], a[164:167], v[88:91], v[196:199]
    v_lshrrev_b32 v14, 7, v14
    v_mfma_f32_16x16x32_bf16 v[196:199], a[112:115], v[92:95], v[196:199]
    v_mfma_f32_16x16x32_bf16 v[200:203], a[164:167], v[96:99], v[200:203]
    v_lshrrev_b32 v2, 5, v11
    v_mfma_f32_16x16x32_bf16 v[200:203], a[112:115], v[100:103], v[200:203]
    buffer_load_dwordx4 a[52:55], v1, s[16:19], s80 offen offset:1024 sc1
    v_mfma_f32_16x16x32_bf16 v[204:207], a[164:167], v[104:107], v[204:207]
    v_and_b32 v2, 0x180, v2
    v_mfma_f32_16x16x32_bf16 v[204:207], a[112:115], v[108:111], v[204:207]
    v_mfma_f32_16x16x32_bf16 v[208:211], a[168:171], v[80:83], v[208:211]
    s_waitcnt vmcnt(31)
    v_add_u32 v14, v14, v2
    v_mfma_f32_16x16x32_bf16 v[208:211], a[116:119], v[84:87], v[208:211]
    buffer_load_dwordx4 a[56:59], v1, s[16:19], s80 offen offset:2048 sc1
    v_mfma_f32_16x16x32_bf16 v[212:215], a[168:171], v[88:91], v[212:215]
    v_and_b32 v15, 0x3fff, v11
    v_mfma_f32_16x16x32_bf16 v[212:215], a[116:119], v[92:95], v[212:215]
    v_mfma_f32_16x16x32_bf16 v[216:219], a[168:171], v[96:99], v[216:219]
    v_add_u32 v15, 0, v15
    v_mfma_f32_16x16x32_bf16 v[216:219], a[116:119], v[100:103], v[216:219]
    buffer_load_dwordx4 a[60:63], v1, s[16:19], s80 offen offset:3072 sc1
    v_mfma_f32_16x16x32_bf16 v[220:223], a[168:171], v[104:107], v[220:223]
    s_add_u32 s80, s80, 4096
    v_add_u32 v22, s91, v1
    v_mfma_f32_16x16x32_bf16 v[220:223], a[116:119], v[108:111], v[220:223]
    v_mfma_f32_16x16x32_bf16 v[224:227], a[172:175], v[80:83], v[224:227]
    v_add_u32 v22, 0, v22
    v_mfma_f32_16x16x32_bf16 v[224:227], a[120:123], v[84:87], v[224:227]
    buffer_load_dwordx4 a[64:67], v1, s[16:19], s80 offen offset:0 sc1
    v_mfma_f32_16x16x32_bf16 v[228:231], a[172:175], v[88:91], v[228:231]
    v_and_b32 v19, 0x3ff, v18
    v_mfma_f32_16x16x32_bf16 v[228:231], a[120:123], v[92:95], v[228:231]
    v_mfma_f32_16x16x32_bf16 v[232:235], a[172:175], v[96:99], v[232:235]
    v_lshlrev_b32 v19, 1, v19
    v_mfma_f32_16x16x32_bf16 v[232:235], a[120:123], v[100:103], v[232:235]
    buffer_load_dwordx4 a[68:71], v1, s[16:19], s80 offen offset:1024 sc1
    v_mfma_f32_16x16x32_bf16 v[236:239], a[172:175], v[104:107], v[236:239]
    v_add_u32 v19, 153600, v19
    v_mfma_f32_16x16x32_bf16 v[236:239], a[120:123], v[108:111], v[236:239]
    v_mfma_f32_16x16x32_bf16 v[240:243], a[176:179], v[80:83], v[240:243]
    s_waitcnt vmcnt(25)
    v_mfma_f32_16x16x32_bf16 v[240:243], a[124:127], v[84:87], v[240:243]
    buffer_load_dwordx4 a[72:75], v1, s[16:19], s80 offen offset:2048 sc1
    v_mfma_f32_16x16x32_bf16 v[244:247], a[176:179], v[88:91], v[244:247]
    v_mfma_f32_16x16x32_bf16 v[244:247], a[124:127], v[92:95], v[244:247]
    v_mfma_f32_16x16x32_bf16 v[248:251], a[176:179], v[96:99], v[248:251]
    v_mfma_f32_16x16x32_bf16 v[248:251], a[124:127], v[100:103], v[248:251]
    buffer_load_dwordx4 a[76:79], v1, s[16:19], s80 offen offset:3072 sc1
    v_mfma_f32_16x16x32_bf16 v[252:255], a[176:179], v[104:107], v[252:255]
    s_add_u32 s80, s80, 4096
    v_mfma_f32_16x16x32_bf16 v[252:255], a[124:127], v[108:111], v[252:255]
    s_waitcnt lgkmcnt(2)
    v_mfma_f32_16x16x32_bf16 v[128:131], a[192:195], v[24:27], v[128:131]
    v_mfma_f32_16x16x32_bf16 v[128:131], a[224:227], v[28:31], v[128:131]
    buffer_load_dwordx4 a[80:83], v1, s[16:19], s80 offen offset:0 sc1
    v_mfma_f32_16x16x32_bf16 v[132:135], a[192:195], v[32:35], v[132:135]
    v_mfma_f32_16x16x32_bf16 v[132:135], a[224:227], v[36:39], v[132:135]
    ds_read_b128 v[80:83], v21 offset:0
    v_mfma_f32_16x16x32_bf16 v[136:139], a[192:195], v[40:43], v[136:139]
    v_mfma_f32_16x16x32_bf16 v[136:139], a[224:227], v[44:47], v[136:139]
    s_waitcnt lgkmcnt(2)
    buffer_load_dwordx4 a[84:87], v1, s[16:19], s80 offen offset:1024 sc1
    v_mfma_f32_16x16x32_bf16 v[140:143], a[192:195], v[48:51], v[140:143]
    s_waitcnt lgkmcnt(1)
    v_mfma_f32_16x16x32_bf16 v[140:143], a[224:227], v[52:55], v[140:143]
    ds_read_b128 v[84:87], v21 offset:4096
    v_mfma_f32_16x16x32_bf16 v[144:147], a[196:199], v[24:27], v[144:147]
    s_waitcnt vmcnt(27)
    v_mfma_f32_16x16x32_bf16 v[144:147], a[228:231], v[28:31], v[144:147]
    buffer_load_dwordx4 a[88:91], v1, s[16:19], s80 offen offset:2048 sc1
    v_mfma_f32_16x16x32_bf16 v[148:151], a[196:199], v[32:35], v[148:151]
    v_mfma_f32_16x16x32_bf16 v[148:151], a[228:231], v[36:39], v[148:151]
    ds_read_b128 v[88:91], v21 offset:1024
    v_mfma_f32_16x16x32_bf16 v[152:155], a[196:199], v[40:43], v[152:155]
    v_mfma_f32_16x16x32_bf16 v[152:155], a[228:231], v[44:47], v[152:155]
    buffer_load_dwordx4 a[92:95], v1, s[16:19], s80 offen offset:3072 sc1
    v_mfma_f32_16x16x32_bf16 v[156:159], a[196:199], v[48:51], v[156:159]
    s_add_u32 s80, s80, 4096
    v_mfma_f32_16x16x32_bf16 v[156:159], a[228:231], v[52:55], v[156:159]
    ds_read_b128 v[92:95], v21 offset:5120
    v_mfma_f32_16x16x32_bf16 v[160:163], a[200:203], v[24:27], v[160:163]
    v_mfma_f32_16x16x32_bf16 v[160:163], a[232:235], v[28:31], v[160:163]
    buffer_load_dwordx4 a[96:99], v1, s[16:19], s80 offen offset:0 sc1
    v_mfma_f32_16x16x32_bf16 v[164:167], a[200:203], v[32:35], v[164:167]
    v_mfma_f32_16x16x32_bf16 v[164:167], a[232:235], v[36:39], v[164:167]
    ds_read_b128 v[96:99], v21 offset:2048
    v_mfma_f32_16x16x32_bf16 v[168:171], a[200:203], v[40:43], v[168:171]
    v_mfma_f32_16x16x32_bf16 v[168:171], a[232:235], v[44:47], v[168:171]
    buffer_load_dwordx4 a[100:103], v1, s[16:19], s80 offen offset:1024 sc1
    v_mfma_f32_16x16x32_bf16 v[172:175], a[200:203], v[48:51], v[172:175]
    v_mfma_f32_16x16x32_bf16 v[172:175], a[232:235], v[52:55], v[172:175]
    ds_read_b128 v[100:103], v21 offset:6144
    v_mfma_f32_16x16x32_bf16 v[176:179], a[204:207], v[24:27], v[176:179]
    s_waitcnt vmcnt(29)
    v_mfma_f32_16x16x32_bf16 v[176:179], a[236:239], v[28:31], v[176:179]
    buffer_load_dwordx4 a[104:107], v1, s[16:19], s80 offen offset:2048 sc1
    v_mfma_f32_16x16x32_bf16 v[180:183], a[204:207], v[32:35], v[180:183]
    v_mfma_f32_16x16x32_bf16 v[180:183], a[236:239], v[36:39], v[180:183]
    ds_read_b128 v[104:107], v21 offset:3072
    v_mfma_f32_16x16x32_bf16 v[184:187], a[204:207], v[40:43], v[184:187]
    v_mfma_f32_16x16x32_bf16 v[184:187], a[236:239], v[44:47], v[184:187]
    buffer_load_dwordx4 a[128:131], v1, s[16:19], s80 offen offset:3072 sc1
    v_mfma_f32_16x16x32_bf16 v[188:191], a[204:207], v[48:51], v[188:191]
    s_add_u32 s80, s80, 4096
    v_mfma_f32_16x16x32_bf16 v[188:191], a[236:239], v[52:55], v[188:191]
    ds_read_b128 v[108:111], v21 offset:7168
    v_mfma_f32_16x16x32_bf16 v[192:195], a[208:211], v[24:27], v[192:195]
    v_mfma_f32_16x16x32_bf16 v[192:195], a[240:243], v[28:31], v[192:195]
    buffer_load_dwordx4 a[132:135], v1, s[16:19], s80 offen offset:0 sc1
    v_mfma_f32_16x16x32_bf16 v[196:199], a[208:211], v[32:35], v[196:199]
    v_mfma_f32_16x16x32_bf16 v[196:199], a[240:243], v[36:39], v[196:199]
    v_mfma_f32_16x16x32_bf16 v[200:203], a[208:211], v[40:43], v[200:203]
    v_mfma_f32_16x16x32_bf16 v[200:203], a[240:243], v[44:47], v[200:203]
    buffer_load_dwordx4 a[136:139], v1, s[16:19], s80 offen offset:1024 sc1
    v_mfma_f32_16x16x32_bf16 v[204:207], a[208:211], v[48:51], v[204:207]
    v_mfma_f32_16x16x32_bf16 v[204:207], a[240:243], v[52:55], v[204:207]
    v_mfma_f32_16x16x32_bf16 v[208:211], a[212:215], v[24:27], v[208:211]
    s_waitcnt vmcnt(31)
    v_mfma_f32_16x16x32_bf16 v[208:211], a[244:247], v[28:31], v[208:211]
    buffer_load_dwordx4 a[140:143], v1, s[16:19], s80 offen offset:2048 sc1
    v_mfma_f32_16x16x32_bf16 v[212:215], a[212:215], v[32:35], v[212:215]
    v_mfma_f32_16x16x32_bf16 v[212:215], a[244:247], v[36:39], v[212:215]
    v_mfma_f32_16x16x32_bf16 v[216:219], a[212:215], v[40:43], v[216:219]
    v_mfma_f32_16x16x32_bf16 v[216:219], a[244:247], v[44:47], v[216:219]
    buffer_load_dwordx4 a[144:147], v1, s[16:19], s80 offen offset:3072 sc1
    v_mfma_f32_16x16x32_bf16 v[220:223], a[212:215], v[48:51], v[220:223]
    s_add_u32 s80, s80, 4096
    v_mfma_f32_16x16x32_bf16 v[220:223], a[244:247], v[52:55], v[220:223]
    v_mfma_f32_16x16x32_bf16 v[224:227], a[216:219], v[24:27], v[224:227]
    v_mfma_f32_16x16x32_bf16 v[224:227], a[248:251], v[28:31], v[224:227]
    buffer_load_dwordx4 a[148:151], v1, s[16:19], s80 offen offset:0 sc1
    v_mfma_f32_16x16x32_bf16 v[228:231], a[216:219], v[32:35], v[228:231]
    v_mfma_f32_16x16x32_bf16 v[228:231], a[248:251], v[36:39], v[228:231]
    v_mfma_f32_16x16x32_bf16 v[232:235], a[216:219], v[40:43], v[232:235]
    v_mfma_f32_16x16x32_bf16 v[232:235], a[248:251], v[44:47], v[232:235]
    buffer_load_dwordx4 a[152:155], v1, s[16:19], s80 offen offset:1024 sc1
    v_mfma_f32_16x16x32_bf16 v[236:239], a[216:219], v[48:51], v[236:239]
    v_mfma_f32_16x16x32_bf16 v[236:239], a[248:251], v[52:55], v[236:239]
    v_mfma_f32_16x16x32_bf16 v[240:243], a[220:223], v[24:27], v[240:243]
    s_waitcnt vmcnt(25)
    v_mfma_f32_16x16x32_bf16 v[240:243], a[252:255], v[28:31], v[240:243]
    buffer_load_dwordx4 a[156:159], v1, s[16:19], s80 offen offset:2048 sc1
    v_mfma_f32_16x16x32_bf16 v[244:247], a[220:223], v[32:35], v[244:247]
    v_mfma_f32_16x16x32_bf16 v[244:247], a[252:255], v[36:39], v[244:247]
    v_mfma_f32_16x16x32_bf16 v[248:251], a[220:223], v[40:43], v[248:251]
    v_mfma_f32_16x16x32_bf16 v[248:251], a[252:255], v[44:47], v[248:251]
    buffer_load_dwordx4 a[160:163], v1, s[16:19], s80 offen offset:3072 sc1
    v_mfma_f32_16x16x32_bf16 v[252:255], a[220:223], v[48:51], v[252:255]
    s_add_u32 s80, s80, 4096
    v_mfma_f32_16x16x32_bf16 v[252:255], a[252:255], v[52:55], v[252:255]
    s_waitcnt lgkmcnt(2)
    v_mfma_f32_16x16x32_bf16 v[128:131], a[0:3], v[80:83], v[128:131]
    v_mfma_f32_16x16x32_bf16 v[128:131], a[32:35], v[84:87], v[128:131]
    buffer_load_dwordx4 a[164:167], v1, s[16:19], s80 offen offset:0 sc1
    v_mfma_f32_16x16x32_bf16 v[132:135], a[0:3], v[88:91], v[132:135]
    v_mfma_f32_16x16x32_bf16 v[132:135], a[32:35], v[92:95], v[132:135]
    ds_read_b128 v[24:27], v21 offset:8192
    v_mfma_f32_16x16x32_bf16 v[136:139], a[0:3], v[96:99], v[136:139]
    v_mfma_f32_16x16x32_bf16 v[136:139], a[32:35], v[100:103], v[136:139]
    s_waitcnt lgkmcnt(2)
    buffer_load_dwordx4 a[168:171], v1, s[16:19], s80 offen offset:1024 sc1
    v_mfma_f32_16x16x32_bf16 v[140:143], a[0:3], v[104:107], v[140:143]
    s_waitcnt lgkmcnt(1)
    v_mfma_f32_16x16x32_bf16 v[140:143], a[32:35], v[108:111], v[140:143]
    ds_read_b128 v[28:31], v21 offset:12288
    v_mfma_f32_16x16x32_bf16 v[144:147], a[4:7], v[80:83], v[144:147]
    s_waitcnt vmcnt(27)
    v_mfma_f32_16x16x32_bf16 v[144:147], a[36:39], v[84:87], v[144:147]
    buffer_load_dwordx4 a[172:175], v1, s[16:19], s80 offen offset:2048 sc1
    v_mfma_f32_16x16x32_bf16 v[148:151], a[4:7], v[88:91], v[148:151]
    v_mfma_f32_16x16x32_bf16 v[148:151], a[36:39], v[92:95], v[148:151]
    ds_read_b128 v[32:35], v21 offset:9216
    v_mfma_f32_16x16x32_bf16 v[152:155], a[4:7], v[96:99], v[152:155]
    v_mfma_f32_16x16x32_bf16 v[152:155], a[36:39], v[100:103], v[152:155]
    buffer_load_dwordx4 a[176:179], v1, s[16:19], s80 offen offset:3072 sc1
    v_mfma_f32_16x16x32_bf16 v[156:159], a[4:7], v[104:107], v[156:159]
    s_add_u32 s80, s80, 4096
    v_mfma_f32_16x16x32_bf16 v[156:159], a[36:39], v[108:111], v[156:159]
    ds_read_b128 v[36:39], v21 offset:13312
    v_mfma_f32_16x16x32_bf16 v[160:163], a[8:11], v[80:83], v[160:163]
    v_mfma_f32_16x16x32_bf16 v[160:163], a[40:43], v[84:87], v[160:163]
    buffer_load_dwordx4 a[180:183], v1, s[16:19], s80 offen offset:0 sc1
    v_mfma_f32_16x16x32_bf16 v[164:167], a[8:11], v[88:91], v[164:167]
    v_mfma_f32_16x16x32_bf16 v[164:167], a[40:43], v[92:95], v[164:167]
    ds_read_b128 v[40:43], v21 offset:10240
    v_mfma_f32_16x16x32_bf16 v[168:171], a[8:11], v[96:99], v[168:171]
    v_mfma_f32_16x16x32_bf16 v[168:171], a[40:43], v[100:103], v[168:171]
    buffer_load_dwordx4 a[184:187], v1, s[16:19], s80 offen offset:1024 sc1
    v_mfma_f32_16x16x32_bf16 v[172:175], a[8:11], v[104:107], v[172:175]
    v_mfma_f32_16x16x32_bf16 v[172:175], a[40:43], v[108:111], v[172:175]
    ds_read_b128 v[44:47], v21 offset:14336
    v_mfma_f32_16x16x32_bf16 v[176:179], a[12:15], v[80:83], v[176:179]
    s_waitcnt vmcnt(29)
    v_mfma_f32_16x16x32_bf16 v[176:179], a[44:47], v[84:87], v[176:179]
    buffer_load_dwordx4 a[188:191], v1, s[16:19], s80 offen offset:2048 sc1
    v_mfma_f32_16x16x32_bf16 v[180:183], a[12:15], v[88:91], v[180:183]
    v_mfma_f32_16x16x32_bf16 v[180:183], a[44:47], v[92:95], v[180:183]
    ds_read_b128 v[48:51], v21 offset:11264
    v_mfma_f32_16x16x32_bf16 v[184:187], a[12:15], v[96:99], v[184:187]
    v_mfma_f32_16x16x32_bf16 v[184:187], a[44:47], v[100:103], v[184:187]
    buffer_load_dwordx4 a[108:111], v1, s[16:19], s80 offen offset:3072 sc1
    v_mfma_f32_16x16x32_bf16 v[188:191], a[12:15], v[104:107], v[188:191]
    s_add_u32 s80, s80, 4096
    v_mfma_f32_16x16x32_bf16 v[188:191], a[44:47], v[108:111], v[188:191]
    ds_read_b128 v[52:55], v21 offset:15360
    v_mfma_f32_16x16x32_bf16 v[192:195], a[16:19], v[80:83], v[192:195]
    v_mfma_f32_16x16x32_bf16 v[192:195], a[48:51], v[84:87], v[192:195]
    buffer_load_dwordx4 a[112:115], v1, s[16:19], s80 offen offset:0 sc1
    v_mfma_f32_16x16x32_bf16 v[196:199], a[16:19], v[88:91], v[196:199]
    v_mfma_f32_16x16x32_bf16 v[196:199], a[48:51], v[92:95], v[196:199]
    v_mfma_f32_16x16x32_bf16 v[200:203], a[16:19], v[96:99], v[200:203]
    v_mfma_f32_16x16x32_bf16 v[200:203], a[48:51], v[100:103], v[200:203]
    buffer_load_dwordx4 a[116:119], v1, s[16:19], s80 offen offset:1024 sc1
    v_mfma_f32_16x16x32_bf16 v[204:207], a[16:19], v[104:107], v[204:207]
    v_mfma_f32_16x16x32_bf16 v[204:207], a[48:51], v[108:111], v[204:207]
    v_mfma_f32_16x16x32_bf16 v[208:211], a[20:23], v[80:83], v[208:211]
    s_waitcnt vmcnt(31)
    v_mfma_f32_16x16x32_bf16 v[208:211], a[52:55], v[84:87], v[208:211]
    buffer_load_dwordx4 a[120:123], v1, s[16:19], s80 offen offset:2048 sc1
    v_mfma_f32_16x16x32_bf16 v[212:215], a[20:23], v[88:91], v[212:215]
    v_mfma_f32_16x16x32_bf16 v[212:215], a[52:55], v[92:95], v[212:215]
    v_mfma_f32_16x16x32_bf16 v[216:219], a[20:23], v[96:99], v[216:219]
    v_mfma_f32_16x16x32_bf16 v[216:219], a[52:55], v[100:103], v[216:219]
    buffer_load_dwordx4 a[124:127], v1, s[16:19], s80 offen offset:3072 sc1
    v_mfma_f32_16x16x32_bf16 v[220:223], a[20:23], v[104:107], v[220:223]
    s_add_u32 s80, s80, 4096
    v_mfma_f32_16x16x32_bf16 v[220:223], a[52:55], v[108:111], v[220:223]
    v_mfma_f32_16x16x32_bf16 v[224:227], a[24:27], v[80:83], v[224:227]
    v_mfma_f32_16x16x32_bf16 v[224:227], a[56:59], v[84:87], v[224:227]
    buffer_load_dwordx4 a[192:195], v1, s[16:19], s80 offen offset:0 sc1
    v_mfma_f32_16x16x32_bf16 v[228:231], a[24:27], v[88:91], v[228:231]
    v_mfma_f32_16x16x32_bf16 v[228:231], a[56:59], v[92:95], v[228:231]
    v_mfma_f32_16x16x32_bf16 v[232:235], a[24:27], v[96:99], v[232:235]
    v_mfma_f32_16x16x32_bf16 v[232:235], a[56:59], v[100:103], v[232:235]
    buffer_load_dwordx4 a[196:199], v1, s[16:19], s80 offen offset:1024 sc1
    v_mfma_f32_16x16x32_bf16 v[236:239], a[24:27], v[104:107], v[236:239]
    v_mfma_f32_16x16x32_bf16 v[236:239], a[56:59], v[108:111], v[236:239]
    v_mfma_f32_16x16x32_bf16 v[240:243], a[28:31], v[80:83], v[240:243]
    s_waitcnt vmcnt(25)
    v_mfma_f32_16x16x32_bf16 v[240:243], a[60:63], v[84:87], v[240:243]
    buffer_load_dwordx4 a[200:203], v1, s[16:19], s80 offen offset:2048 sc1
    v_mfma_f32_16x16x32_bf16 v[244:247], a[28:31], v[88:91], v[244:247]
    v_mfma_f32_16x16x32_bf16 v[244:247], a[60:63], v[92:95], v[244:247]
    v_mfma_f32_16x16x32_bf16 v[248:251], a[28:31], v[96:99], v[248:251]
    v_mfma_f32_16x16x32_bf16 v[248:251], a[60:63], v[100:103], v[248:251]
    buffer_load_dwordx4 a[204:207], v1, s[16:19], s80 offen offset:3072 sc1
    v_mfma_f32_16x16x32_bf16 v[252:255], a[28:31], v[104:107], v[252:255]
    s_add_u32 s80, s80, 4096
    v_mfma_f32_16x16x32_bf16 v[252:255], a[60:63], v[108:111], v[252:255]
    s_waitcnt lgkmcnt(2)
    v_mfma_f32_16x16x32_bf16 v[128:131], a[64:67], v[24:27], v[128:131]
    v_mfma_f32_16x16x32_bf16 v[128:131], a[96:99], v[28:31], v[128:131]
    buffer_load_dwordx4 a[208:211], v1, s[16:19], s80 offen offset:0 sc1
    v_mfma_f32_16x16x32_bf16 v[132:135], a[64:67], v[32:35], v[132:135]
    v_mfma_f32_16x16x32_bf16 v[132:135], a[96:99], v[36:39], v[132:135]
    ds_read_b128 v[80:83], v23 offset:0
    v_mfma_f32_16x16x32_bf16 v[136:139], a[64:67], v[40:43], v[136:139]
    v_mfma_f32_16x16x32_bf16 v[136:139], a[96:99], v[44:47], v[136:139]
    s_waitcnt lgkmcnt(2)
    buffer_load_dwordx4 a[212:215], v1, s[16:19], s80 offen offset:1024 sc1
    v_mfma_f32_16x16x32_bf16 v[140:143], a[64:67], v[48:51], v[140:143]
    s_waitcnt lgkmcnt(1)
    v_mfma_f32_16x16x32_bf16 v[140:143], a[96:99], v[52:55], v[140:143]
    ds_read_b128 v[84:87], v23 offset:4096
    v_mfma_f32_16x16x32_bf16 v[144:147], a[68:71], v[24:27], v[144:147]
    s_branch L_ov9
L_pad9:
    s_setpc_b64 s[86:87]
L_ov9:
    s_waitcnt vmcnt(27)
    v_mfma_f32_16x16x32_bf16 v[144:147], a[100:103], v[28:31], v[144:147]
    buffer_load_dwordx4 a[216:219], v1, s[16:19], s80 offen offset:2048 sc1
    v_mfma_f32_16x16x32_bf16 v[148:151], a[68:71], v[32:35], v[148:151]
    v_mfma_f32_16x16x32_bf16 v[148:151], a[100:103], v[36:39], v[148:151]
    ds_read_b128 v[88:91], v23 offset:8192
    v_mfma_f32_16x16x32_bf16 v[152:155], a[68:71], v[40:43], v[152:155]
    v_mfma_f32_16x16x32_bf16 v[152:155], a[100:103], v[44:47], v[152:155]
    buffer_load_dwordx4 a[220:223], v1, s[16:19], s80 offen offset:3072 sc1
    v_mfma_f32_16x16x32_bf16 v[156:159], a[68:71], v[48:51], v[156:159]
    s_add_u32 s80, s80, 4096
    v_mfma_f32_16x16x32_bf16 v[156:159], a[100:103], v[52:55], v[156:159]
    ds_read_b128 v[92:95], v23 offset:12288
    v_mfma_f32_16x16x32_bf16 v[160:163], a[72:75], v[24:27], v[160:163]
    v_mfma_f32_16x16x32_bf16 v[160:163], a[104:107], v[28:31], v[160:163]
    buffer_load_dwordx4 a[224:227], v1, s[16:19], s80 offen offset:0 sc1
    v_mfma_f32_16x16x32_bf16 v[164:167], a[72:75], v[32:35], v[164:167]
    v_mfma_f32_16x16x32_bf16 v[164:167], a[104:107], v[36:39], v[164:167]
    v_mfma_f32_16x16x32_bf16 v[168:171], a[72:75], v[40:43], v[168:171]
    v_mfma_f32_16x16x32_bf16 v[168:171], a[104:107], v[44:47], v[168:171]
    buffer_load_dwordx4 a[228:231], v1, s[16:19], s80 offen offset:1024 sc1
    v_mfma_f32_16x16x32_bf16 v[172:175], a[72:75], v[48:51], v[172:175]
    v_mfma_f32_16x16x32_bf16 v[172:175], a[104:107], v[52:55], v[172:175]
    v_mfma_f32_16x16x32_bf16 v[176:179], a[76:79], v[24:27], v[176:179]
    s_waitcnt vmcnt(29)
    v_mfma_f32_16x16x32_bf16 v[176:179], a[128:131], v[28:31], v[176:179]
    buffer_load_dwordx4 a[232:235], v1, s[16:19], s80 offen offset:2048 sc1
    v_mfma_f32_16x16x32_bf16 v[180:183], a[76:79], v[32:35], v[180:183]
    v_mfma_f32_16x16x32_bf16 v[180:183], a[128:131], v[36:39], v[180:183]
    v_mfma_f32_16x16x32_bf16 v[184:187], a[76:79], v[40:43], v[184:187]
    v_mfma_f32_16x16x32_bf16 v[184:187], a[128:131], v[44:47], v[184:187]
    buffer_load_dwordx4 a[236:239], v1, s[16:19], s80 offen offset:3072 sc1
    v_mfma_f32_16x16x32_bf16 v[188:191], a[76:79], v[48:51], v[188:191]
    s_add_u32 s80, s80, 4096
    v_mfma_f32_16x16x32_bf16 v[188:191], a[128:131], v[52:55], v[188:191]
    v_mfma_f32_16x16x32_bf16 v[192:195], a[80:83], v[24:27], v[192:195]
    v_mfma_f32_16x16x32_bf16 v[192:195], a[132:135], v[28:31], v[192:195]
    buffer_load_dwordx4 a[240:243], v1, s[16:19], s80 offen offset:0 sc1
    v_mfma_f32_16x16x32_bf16 v[196:199], a[80:83], v[32:35], v[196:199]
    v_mfma_f32_16x16x32_bf16 v[196:199], a[132:135], v[36:39], v[196:199]
    v_mfma_f32_16x16x32_bf16 v[200:203], a[80:83], v[40:43], v[200:203]
    v_mfma_f32_16x16x32_bf16 v[200:203], a[132:135], v[44:47], v[200:203]
    buffer_load_dwordx4 a[244:247], v1, s[16:19], s80 offen offset:1024 sc1
    v_mfma_f32_16x16x32_bf16 v[204:207], a[80:83], v[48:51], v[204:207]
    v_mfma_f32_16x16x32_bf16 v[204:207], a[132:135], v[52:55], v[204:207]
    v_mfma_f32_16x16x32_bf16 v[208:211], a[84:87], v[24:27], v[208:211]
    s_waitcnt vmcnt(31)
    v_mfma_f32_16x16x32_bf16 v[208:211], a[136:139], v[28:31], v[208:211]
    buffer_load_dwordx4 a[248:251], v1, s[16:19], s80 offen offset:2048 sc1
    v_mfma_f32_16x16x32_bf16 v[212:215], a[84:87], v[32:35], v[212:215]
    v_mfma_f32_16x16x32_bf16 v[212:215], a[136:139], v[36:39], v[212:215]
    v_mfma_f32_16x16x32_bf16 v[216:219], a[84:87], v[40:43], v[216:219]
    v_mfma_f32_16x16x32_bf16 v[216:219], a[136:139], v[44:47], v[216:219]
    buffer_load_dwordx4 a[252:255], v1, s[16:19], s80 offen offset:3072 sc1
    v_mfma_f32_16x16x32_bf16 v[220:223], a[84:87], v[48:51], v[220:223]
    s_add_u32 s80, s80, 4096
    v_mfma_f32_16x16x32_bf16 v[220:223], a[136:139], v[52:55], v[220:223]
    v_mfma_f32_16x16x32_bf16 v[224:227], a[88:91], v[24:27], v[224:227]
    v_mfma_f32_16x16x32_bf16 v[224:227], a[140:143], v[28:31], v[224:227]
    buffer_load_dwordx4 a[0:3], v1, s[16:19], s80 offen offset:0 sc1
    v_mfma_f32_16x16x32_bf16 v[228:231], a[88:91], v[32:35], v[228:231]
    v_mfma_f32_16x16x32_bf16 v[228:231], a[140:143], v[36:39], v[228:231]
    v_mfma_f32_16x16x32_bf16 v[232:235], a[88:91], v[40:43], v[232:235]
    v_mfma_f32_16x16x32_bf16 v[232:235], a[140:143], v[44:47], v[232:235]
    buffer_load_dwordx4 a[4:7], v1, s[16:19], s80 offen offset:1024 sc1
    v_mfma_f32_16x16x32_bf16 v[236:239], a[88:91], v[48:51], v[236:239]
    v_mfma_f32_16x16x32_bf16 v[236:239], a[140:143], v[52:55], v[236:239]
    v_mfma_f32_16x16x32_bf16 v[240:243], a[92:95], v[24:27], v[240:243]
    s_waitcnt vmcnt(32)
    v_mfma_f32_16x16x32_bf16 v[240:243], a[144:147], v[28:31], v[240:243]
    buffer_load_dwordx4 a[8:11], v1, s[16:19], s80 offen offset:2048 sc1
    v_mfma_f32_16x16x32_bf16 v[244:247], a[92:95], v[32:35], v[244:247]
    v_mfma_f32_16x16x32_bf16 v[244:247], a[144:147], v[36:39], v[244:247]
    v_mfma_f32_16x16x32_bf16 v[248:251], a[92:95], v[40:43], v[248:251]
    v_mfma_f32_16x16x32_bf16 v[248:251], a[144:147], v[44:47], v[248:251]
    buffer_load_dwordx4 a[12:15], v1, s[16:19], s80 offen offset:3072 sc1
    v_mfma_f32_16x16x32_bf16 v[252:255], a[92:95], v[48:51], v[252:255]
    s_add_u32 s80, s80, 4096
    v_mfma_f32_16x16x32_bf16 v[252:255], a[144:147], v[52:55], v[252:255]
    s_waitcnt lgkmcnt(2)
    v_mfma_f32_16x16x32_bf16 v[128:131], a[148:151], v[80:83], v[128:131]
    v_mfma_f32_16x16x32_bf16 v[144:147], a[152:155], v[80:83], v[144:147]
    s_waitcnt vmcnt(25)
    buffer_load_dwordx4 a[16:19], v1, s[16:19], s80 offen offset:0 sc1
    v_mfma_f32_16x16x32_bf16 v[160:163], a[156:159], v[80:83], v[160:163]
    v_mfma_f32_16x16x32_bf16 v[176:179], a[160:163], v[80:83], v[176:179]
    ds_read_b128 v[24:27], v23 offset:1024
    v_mfma_f32_16x16x32_bf16 v[192:195], a[164:167], v[80:83], v[192:195]
    v_mfma_f32_16x16x32_bf16 v[208:211], a[168:171], v[80:83], v[208:211]
    buffer_load_dwordx4 a[20:23], v1, s[16:19], s80 offen offset:1024 sc1
    v_mfma_f32_16x16x32_bf16 v[224:227], a[172:175], v[80:83], v[224:227]
    v_mfma_f32_16x16x32_bf16 v[240:243], a[176:179], v[80:83], v[240:243]
    ds_read_b128 v[28:31], v23 offset:5120
    v_mfma_f32_16x16x32_bf16 v[128:131], a[180:183], v[84:87], v[128:131]
    v_mfma_f32_16x16x32_bf16 v[144:147], a[184:187], v[84:87], v[144:147]
    buffer_load_dwordx4 a[24:27], v1, s[16:19], s80 offen offset:2048 sc1
    v_mfma_f32_16x16x32_bf16 v[160:163], a[188:191], v[84:87], v[160:163]
    s_waitcnt vmcnt(19)
    v_mfma_f32_16x16x32_bf16 v[176:179], a[108:111], v[84:87], v[176:179]
    ds_read_b128 v[32:35], v23 offset:9216
    v_mfma_f32_16x16x32_bf16 v[192:195], a[112:115], v[84:87], v[192:195]
    v_mfma_f32_16x16x32_bf16 v[208:211], a[116:119], v[84:87], v[208:211]
    buffer_load_dwordx4 a[28:31], v1, s[16:19], s80 offen offset:3072 sc1
    v_mfma_f32_16x16x32_bf16 v[224:227], a[120:123], v[84:87], v[224:227]
    s_add_u32 s80, s80, 4096
    v_mfma_f32_16x16x32_bf16 v[240:243], a[124:127], v[84:87], v[240:243]
    s_waitcnt lgkmcnt(3)
    ds_read_b128 v[36:39], v23 offset:13312
    v_mfma_f32_16x16x32_bf16 v[128:131], a[192:195], v[88:91], v[128:131]
    v_mfma_f32_16x16x32_bf16 v[144:147], a[196:199], v[88:91], v[144:147]
    buffer_load_dwordx4 a[32:35], v1, s[16:19], s80 offen offset:0 sc1
    v_mfma_f32_16x16x32_bf16 v[160:163], a[200:203], v[88:91], v[160:163]
    v_mfma_f32_16x16x32_bf16 v[176:179], a[204:207], v[88:91], v[176:179]
    s_waitcnt vmcnt(12)
    v_mfma_f32_16x16x32_bf16 v[192:195], a[208:211], v[88:91], v[192:195]
    v_mfma_f32_16x16x32_bf16 v[208:211], a[212:215], v[88:91], v[208:211]
    buffer_load_dwordx4 a[36:39], v1, s[16:19], s80 offen offset:1024 sc1
    v_mfma_f32_16x16x32_bf16 v[224:227], a[216:219], v[88:91], v[224:227]
    v_mfma_f32_16x16x32_bf16 v[240:243], a[220:223], v[88:91], v[240:243]
    v_mfma_f32_16x16x32_bf16 v[128:131], a[224:227], v[92:95], v[128:131]
    v_mfma_f32_16x16x32_bf16 v[144:147], a[228:231], v[92:95], v[144:147]
    buffer_load_dwordx4 v[112:115], v18, s[8:11], 0 offen offset:0
    v_mfma_f32_16x16x32_bf16 v[160:163], a[232:235], v[92:95], v[160:163]
    v_mfma_f32_16x16x32_bf16 v[176:179], a[236:239], v[92:95], v[176:179]
    v_mfma_f32_16x16x32_bf16 v[192:195], a[240:243], v[92:95], v[192:195]
    s_waitcnt vmcnt(11)
    v_mfma_f32_16x16x32_bf16 v[208:211], a[244:247], v[92:95], v[208:211]
    buffer_load_dwordx4 v[116:119], v18, s[8:11], 0 offen offset:128
    v_mfma_f32_16x16x32_bf16 v[224:227], a[248:251], v[92:95], v[224:227]
    v_mfma_f32_16x16x32_bf16 v[240:243], a[252:255], v[92:95], v[240:243]
    s_waitcnt lgkmcnt(2)
    v_mfma_f32_16x16x32_bf16 v[132:135], a[148:151], v[24:27], v[132:135]
    v_mfma_f32_16x16x32_bf16 v[132:135], a[180:183], v[28:31], v[132:135]
    s_waitcnt lgkmcnt(1)
    v_mfma_f32_16x16x32_bf16 v[132:135], a[192:195], v[32:35], v[132:135]
    s_waitcnt lgkmcnt(0)
    v_mfma_f32_16x16x32_bf16 v[132:135], a[224:227], v[36:39], v[132:135]
    ds_read_b128 v[80:83], v23 offset:2048
    v_mfma_f32_16x16x32_bf16 v[148:151], a[152:155], v[24:27], v[148:151]
    v_mfma_f32_16x16x32_bf16 v[148:151], a[184:187], v[28:31], v[148:151]
    v_mfma_f32_16x16x32_bf16 v[148:151], a[196:199], v[32:35], v[148:151]
    v_mfma_f32_16x16x32_bf16 v[148:151], a[228:231], v[36:39], v[148:151]
    ds_read_b128 v[84:87], v23 offset:6144
    v_mfma_f32_16x16x32_bf16 v[164:167], a[156:159], v[24:27], v[164:167]
    v_cvt_pk_bf16_f32 v56, v128, v144
    v_cvt_pk_bf16_f32 v57, v160, v176
    v_mfma_f32_16x16x32_bf16 v[164:167], a[188:191], v[28:31], v[164:167]
    v_mfma_f32_16x16x32_bf16 v[164:167], a[200:203], v[32:35], v[164:167]
    v_cvt_pk_bf16_f32 v58, v129, v145
    v_cvt_pk_bf16_f32 v59, v161, v177
    v_mfma_f32_16x16x32_bf16 v[164:167], a[232:235], v[36:39], v[164:167]
    ds_read_b128 v[88:91], v23 offset:10240
    v_mfma_f32_16x16x32_bf16 v[180:183], a[160:163], v[24:27], v[180:183]
    v_mfma_f32_16x16x32_bf16 v[180:183], a[108:111], v[28:31], v[180:183]
    buffer_store_dwordx4 v[56:59], v1, s[24:27], s40 offen offset:0 sc1
    v_mfma_f32_16x16x32_bf16 v[180:183], a[204:207], v[32:35], v[180:183]
    v_mfma_f32_16x16x32_bf16 v[180:183], a[236:239], v[36:39], v[180:183]
    ds_read_b128 v[92:95], v23 offset:14336
    v_mfma_f32_16x16x32_bf16 v[196:199], a[164:167], v[24:27], v[196:199]
    v_cvt_pk_bf16_f32 v60, v130, v146
    v_cvt_pk_bf16_f32 v61, v162, v178
    v_mfma_f32_16x16x32_bf16 v[196:199], a[112:115], v[28:31], v[196:199]
    v_mfma_f32_16x16x32_bf16 v[196:199], a[208:211], v[32:35], v[196:199]
    v_cvt_pk_bf16_f32 v62, v131, v147
    v_cvt_pk_bf16_f32 v63, v163, v179
    v_mfma_f32_16x16x32_bf16 v[196:199], a[240:243], v[36:39], v[196:199]
    v_mfma_f32_16x16x32_bf16 v[212:215], a[168:171], v[24:27], v[212:215]
    v_mfma_f32_16x16x32_bf16 v[212:215], a[116:119], v[28:31], v[212:215]
    buffer_store_dwordx4 v[60:63], v1, s[24:27], s40 offen offset:1024 sc1
    v_mfma_f32_16x16x32_bf16 v[212:215], a[212:215], v[32:35], v[212:215]
    v_mfma_f32_16x16x32_bf16 v[212:215], a[244:247], v[36:39], v[212:215]
    v_mfma_f32_16x16x32_bf16 v[228:231], a[172:175], v[24:27], v[228:231]
    v_cvt_pk_bf16_f32 v56, v192, v208
    v_cvt_pk_bf16_f32 v57, v224, v240
    v_mfma_f32_16x16x32_bf16 v[228:231], a[120:123], v[28:31], v[228:231]
    v_mfma_f32_16x16x32_bf16 v[228:231], a[216:219], v[32:35], v[228:231]
    v_cvt_pk_bf16_f32 v58, v193, v209
    v_cvt_pk_bf16_f32 v59, v225, v241
    v_mfma_f32_16x16x32_bf16 v[228:231], a[248:251], v[36:39], v[228:231]
    v_mfma_f32_16x16x32_bf16 v[244:247], a[176:179], v[24:27], v[244:247]
    v_mfma_f32_16x16x32_bf16 v[244:247], a[124:127], v[28:31], v[244:247]
    buffer_store_dwordx4 v[56:59], v1, s[24:27], s40 offen offset:2048 sc1
    v_mfma_f32_16x16x32_bf16 v[244:247], a[220:223], v[32:35], v[244:247]
    v_mfma_f32_16x16x32_bf16 v[244:247], a[252:255], v[36:39], v[244:247]
    s_waitcnt lgkmcnt(2)
    v_mfma_f32_16x16x32_bf16 v[136:139], a[148:151], v[80:83], v[136:139]
    v_cvt_pk_bf16_f32 v60, v194, v210
    v_cvt_pk_bf16_f32 v61, v226, v242
    v_mfma_f32_16x16x32_bf16 v[136:139], a[180:183], v[84:87], v[136:139]
    s_waitcnt lgkmcnt(1)
    v_mfma_f32_16x16x32_bf16 v[136:139], a[192:195], v[88:91], v[136:139]
    s_waitcnt lgkmcnt(0)
    v_cvt_pk_bf16_f32 v62, v195, v211
    v_cvt_pk_bf16_f32 v63, v227, v243
    v_mfma_f32_16x16x32_bf16 v[136:139], a[224:227], v[92:95], v[136:139]
    ds_read_b128 v[24:27], v23 offset:3072
    v_mfma_f32_16x16x32_bf16 v[152:155], a[152:155], v[80:83], v[152:155]
    v_mfma_f32_16x16x32_bf16 v[152:155], a[184:187], v[84:87], v[152:155]
    buffer_store_dwordx4 v[60:63], v1, s[24:27], s40 offen offset:3072 sc1
    v_mfma_f32_16x16x32_bf16 v[152:155], a[196:199], v[88:91], v[152:155]
    v_mfma_f32_16x16x32_bf16 v[152:155], a[228:231], v[92:95], v[152:155]
    ds_read_b128 v[28:31], v23 offset:7168
    v_mfma_f32_16x16x32_bf16 v[168:171], a[156:159], v[80:83], v[168:171]
    v_cvt_pk_bf16_f32 v56, v132, v148
    v_cvt_pk_bf16_f32 v57, v164, v180
    v_mfma_f32_16x16x32_bf16 v[168:171], a[188:191], v[84:87], v[168:171]
    v_mfma_f32_16x16x32_bf16 v[168:171], a[200:203], v[88:91], v[168:171]
    v_cvt_pk_bf16_f32 v58, v133, v149
    v_cvt_pk_bf16_f32 v59, v165, v181
    v_mfma_f32_16x16x32_bf16 v[168:171], a[232:235], v[92:95], v[168:171]
    ds_read_b128 v[32:35], v23 offset:11264
    v_mfma_f32_16x16x32_bf16 v[184:187], a[160:163], v[80:83], v[184:187]
    v_mfma_f32_16x16x32_bf16 v[184:187], a[108:111], v[84:87], v[184:187]
    buffer_store_dwordx4 v[56:59], v1, s[24:27], s41 offen offset:0 sc1
    v_mfma_f32_16x16x32_bf16 v[184:187], a[204:207], v[88:91], v[184:187]
    v_mfma_f32_16x16x32_bf16 v[184:187], a[236:239], v[92:95], v[184:187]
    ds_read_b128 v[36:39], v23 offset:15360
    v_mfma_f32_16x16x32_bf16 v[200:203], a[164:167], v[80:83], v[200:203]
    v_cvt_pk_bf16_f32 v60, v134, v150
    v_cvt_pk_bf16_f32 v61, v166, v182
    v_mfma_f32_16x16x32_bf16 v[200:203], a[112:115], v[84:87], v[200:203]
    v_mfma_f32_16x16x32_bf16 v[200:203], a[208:211], v[88:91], v[200:203]
    v_cvt_pk_bf16_f32 v62, v135, v151
    v_cvt_pk_bf16_f32 v63, v167, v183
    v_mfma_f32_16x16x32_bf16 v[200:203], a[240:243], v[92:95], v[200:203]
    v_mfma_f32_16x16x32_bf16 v[216:219], a[168:171], v[80:83], v[216:219]
    v_mfma_f32_16x16x32_bf16 v[216:219], a[116:119], v[84:87], v[216:219]
    buffer_store_dwordx4 v[60:63], v1, s[24:27], s41 offen offset:1024 sc1
    v_mfma_f32_16x16x32_bf16 v[216:219], a[212:215], v[88:91], v[216:219]
    v_mfma_f32_16x16x32_bf16 v[216:219], a[244:247], v[92:95], v[216:219]
    v_mfma_f32_16x16x32_bf16 v[232:235], a[172:175], v[80:83], v[232:235]
    v_cvt_pk_bf16_f32 v56, v196, v212
    v_cvt_pk_bf16_f32 v57, v228, v244
    v_mfma_f32_16x16x32_bf16 v[232:235], a[120:123], v[84:87], v[232:235]
    v_mfma_f32_16x16x32_bf16 v[232:235], a[216:219], v[88:91], v[232:235]
    v_cvt_pk_bf16_f32 v58, v197, v213
    v_cvt_pk_bf16_f32 v59, v229, v245
    v_mfma_f32_16x16x32_bf16 v[232:235], a[248:251], v[92:95], v[232:235]
    v_mfma_f32_16x16x32_bf16 v[248:251], a[176:179], v[80:83], v[248:251]
    v_mfma_f32_16x16x32_bf16 v[248:251], a[124:127], v[84:87], v[248:251]
    buffer_store_dwordx4 v[56:59], v1, s[24:27], s41 offen offset:2048 sc1
    v_mfma_f32_16x16x32_bf16 v[248:251], a[220:223], v[88:91], v[248:251]
    v_mfma_f32_16x16x32_bf16 v[248:251], a[252:255], v[92:95], v[248:251]
    s_waitcnt lgkmcnt(2)
    v_mfma_f32_16x16x32_bf16 v[140:143], a[148:151], v[24:27], v[140:143]
    v_cvt_pk_bf16_f32 v60, v198, v214
    v_cvt_pk_bf16_f32 v61, v230, v246
    v_mfma_f32_16x16x32_bf16 v[140:143], a[180:183], v[28:31], v[140:143]
    s_waitcnt lgkmcnt(1)
    v_mfma_f32_16x16x32_bf16 v[140:143], a[192:195], v[32:35], v[140:143]
    s_waitcnt lgkmcnt(0)
    v_cvt_pk_bf16_f32 v62, v199, v215
    v_cvt_pk_bf16_f32 v63, v231, v247
    v_mfma_f32_16x16x32_bf16 v[140:143], a[224:227], v[36:39], v[140:143]
    v_mfma_f32_16x16x32_bf16 v[156:159], a[152:155], v[24:27], v[156:159]
    v_mfma_f32_16x16x32_bf16 v[156:159], a[184:187], v[28:31], v[156:159]
    buffer_store_dwordx4 v[60:63], v1, s[24:27], s41 offen offset:3072 sc1
    v_mfma_f32_16x16x32_bf16 v[156:159], a[196:199], v[32:35], v[156:159]
    v_mfma_f32_16x16x32_bf16 v[156:159], a[228:231], v[36:39], v[156:159]
    v_mfma_f32_16x16x32_bf16 v[172:175], a[156:159], v[24:27], v[172:175]
    v_cvt_pk_bf16_f32 v56, v136, v152
    v_cvt_pk_bf16_f32 v57, v168, v184
    v_mfma_f32_16x16x32_bf16 v[172:175], a[188:191], v[28:31], v[172:175]
    v_mfma_f32_16x16x32_bf16 v[172:175], a[200:203], v[32:35], v[172:175]
    v_cvt_pk_bf16_f32 v58, v137, v153
    v_cvt_pk_bf16_f32 v59, v169, v185
    v_mfma_f32_16x16x32_bf16 v[172:175], a[232:235], v[36:39], v[172:175]
    v_mfma_f32_16x16x32_bf16 v[188:191], a[160:163], v[24:27], v[188:191]
    v_cvt_pk_bf16_f32 v60, v138, v154
    v_cvt_pk_bf16_f32 v61, v170, v186
    v_mfma_f32_16x16x32_bf16 v[188:191], a[108:111], v[28:31], v[188:191]
    buffer_store_dwordx4 v[56:59], v1, s[24:27], s42 offen offset:0 sc1
    v_mfma_f32_16x16x32_bf16 v[188:191], a[204:207], v[32:35], v[188:191]
    v_cvt_pk_bf16_f32 v62, v139, v155
    v_cvt_pk_bf16_f32 v63, v171, v187
    v_mfma_f32_16x16x32_bf16 v[188:191], a[236:239], v[36:39], v[188:191]
    v_mfma_f32_16x16x32_bf16 v[204:207], a[164:167], v[24:27], v[204:207]
    v_cvt_pk_bf16_f32 v56, v200, v216
    v_cvt_pk_bf16_f32 v57, v232, v248
    v_mfma_f32_16x16x32_bf16 v[204:207], a[112:115], v[28:31], v[204:207]
    buffer_store_dwordx4 v[60:63], v1, s[24:27], s42 offen offset:1024 sc1
    v_mfma_f32_16x16x32_bf16 v[204:207], a[208:211], v[32:35], v[204:207]
    v_cvt_pk_bf16_f32 v58, v201, v217
    v_cvt_pk_bf16_f32 v59, v233, v249
    v_mfma_f32_16x16x32_bf16 v[204:207], a[240:243], v[36:39], v[204:207]
    v_mfma_f32_16x16x32_bf16 v[220:223], a[168:171], v[24:27], v[220:223]
    v_cvt_pk_bf16_f32 v60, v202, v218
    v_cvt_pk_bf16_f32 v61, v234, v250
    v_mfma_f32_16x16x32_bf16 v[220:223], a[116:119], v[28:31], v[220:223]
    buffer_store_dwordx4 v[56:59], v1, s[24:27], s42 offen offset:2048 sc1
    v_mfma_f32_16x16x32_bf16 v[220:223], a[212:215], v[32:35], v[220:223]
    v_cvt_pk_bf16_f32 v62, v203, v219
    v_cvt_pk_bf16_f32 v63, v235, v251
    v_mfma_f32_16x16x32_bf16 v[220:223], a[244:247], v[36:39], v[220:223]
    v_mfma_f32_16x16x32_bf16 v[236:239], a[172:175], v[24:27], v[236:239]
    v_cvt_pk_bf16_f32 v56, v140, v156
    v_cvt_pk_bf16_f32 v57, v172, v188
    v_mfma_f32_16x16x32_bf16 v[236:239], a[120:123], v[28:31], v[236:239]
    buffer_store_dwordx4 v[60:63], v1, s[24:27], s42 offen offset:3072 sc1
    v_mfma_f32_16x16x32_bf16 v[236:239], a[216:219], v[32:35], v[236:239]
    v_cvt_pk_bf16_f32 v58, v141, v157
    v_cvt_pk_bf16_f32 v59, v173, v189
    v_mfma_f32_16x16x32_bf16 v[236:239], a[248:251], v[36:39], v[236:239]
    v_mfma_f32_16x16x32_bf16 v[252:255], a[176:179], v[24:27], v[252:255]
    v_mfma_f32_16x16x32_bf16 v[252:255], a[124:127], v[28:31], v[252:255]
    s_mov_b64 exec, s[54:55]
    buffer_store_dwordx4 v[56:59], v1, s[24:27], s43 offen offset:0 sc1
    s_mov_b64 exec, -1
    v_mfma_f32_16x16x32_bf16 v[252:255], a[220:223], v[32:35], v[252:255]
    ds_write_b128 v22, v[56:59] offset:0
    v_mfma_f32_16x16x32_bf16 v[252:255], a[252:255], v[36:39], v[252:255]
    s_nop 7
    v_cvt_pk_bf16_f32 v28, v142, v158
    v_cvt_pk_bf16_f32 v29, v174, v190
    v_cvt_pk_bf16_f32 v30, v143, v159
    v_cvt_pk_bf16_f32 v31, v175, v191
    s_mov_b64 exec, s[54:55]
    buffer_store_dwordx4 v[28:31], v1, s[24:27], s43 offen offset:1024 sc1
    s_mov_b64 exec, -1
    v_cvt_pk_bf16_f32 v32, v204, v220
    v_cvt_pk_bf16_f32 v33, v236, v252
    v_cvt_pk_bf16_f32 v34, v205, v221
    v_cvt_pk_bf16_f32 v35, v237, v253
    s_mov_b64 exec, s[54:55]
    buffer_store_dwordx4 v[32:35], v1, s[24:27], s43 offen offset:2048 sc1
    s_mov_b64 exec, -1
    v_cvt_pk_bf16_f32 v36, v206, v222
    v_cvt_pk_bf16_f32 v37, v238, v254
    v_cvt_pk_bf16_f32 v38, v207, v223
    v_cvt_pk_bf16_f32 v39, v239, v255
    s_mov_b64 exec, s[54:55]
    buffer_store_dwordx4 v[36:39], v1, s[24:27], s43 offen offset:3072 sc1
    s_mov_b64 exec, -1
    ds_write_b128 v22, v[28:31] offset:1024
    ds_write_b128 v22, v[32:35] offset:2048
    ds_write_b128 v22, v[36:39] offset:3072
    buffer_load_dword v5, v14, s[32:35], s89 offen sc1
    ds_read_b128 v[208:211], v19 offset:0
    ds_read_b128 v[212:215], v19 offset:16
    ds_read_b128 v[216:219], v19 offset:256
    ds_read_b128 v[220:223], v19 offset:272
    ds_read_b128 v[224:227], v19 offset:2048
    ds_read_b128 v[228:231], v19 offset:2064
    ds_read_b128 v[232:235], v19 offset:2304
    ds_read_b128 v[236:239], v19 offset:2320
    ds_read_b128 v[240:243], v19 offset:4096
    ds_read_b128 v[244:247], v19 offset:4112
    ds_read_b128 v[248:251], v19 offset:4352
    ds_read_b128 v[252:255], v19 offset:4368
    s_waitcnt lgkmcnt(0)
    ds_read_b128 v[184:187], v15 offset:0
    ds_read_b128 v[188:191], v15 offset:2048
    s_waitcnt lgkmcnt(0)
    v_lshlrev_b32 v192, 16, v184
    v_and_b32 v193, 0xffff0000, v184
    v_lshlrev_b32 v194, 16, v185
    v_and_b32 v195, 0xffff0000, v185
    v_lshlrev_b32 v196, 16, v186
    v_and_b32 v197, 0xffff0000, v186
    v_lshlrev_b32 v198, 16, v187
    v_and_b32 v199, 0xffff0000, v187
    v_lshlrev_b32 v200, 16, v188
    v_and_b32 v201, 0xffff0000, v188
    v_lshlrev_b32 v202, 16, v189
    v_and_b32 v203, 0xffff0000, v189
    v_lshlrev_b32 v204, 16, v190
    v_and_b32 v205, 0xffff0000, v190
    v_lshlrev_b32 v206, 16, v191
    v_and_b32 v207, 0xffff0000, v191
    s_waitcnt vmcnt(16)
    v_lshlrev_b32 v64, 16, v112
    v_and_b32 v65, 0xffff0000, v112
    v_lshlrev_b32 v66, 16, v113
    v_and_b32 v67, 0xffff0000, v113
    v_lshlrev_b32 v68, 16, v114
    v_and_b32 v69, 0xffff0000, v114
    v_lshlrev_b32 v70, 16, v115
    v_and_b32 v71, 0xffff0000, v115
    v_lshlrev_b32 v72, 16, v116
    v_and_b32 v73, 0xffff0000, v116
    v_lshlrev_b32 v74, 16, v117
    v_and_b32 v75, 0xffff0000, v117
    v_lshlrev_b32 v76, 16, v118
    v_and_b32 v77, 0xffff0000, v118
    v_lshlrev_b32 v78, 16, v119
    v_and_b32 v79, 0xffff0000, v119
L_pads_b:
    s_cmp_lg_u32 s3, 0
    s_cbranch_scc1 L_pc_10_0
    s_call_b64 s[86:87], L_pad10
L_pc_10_0:
    s_cmp_lg_u32 s3, 1
    s_cbranch_scc1 L_pc_10_1
    s_call_b64 s[86:87], L_pad11
L_pc_10_1:
    s_cmp_lg_u32 s3, 2
    s_cbranch_scc1 L_pc_10_2
    s_call_b64 s[86:87], L_pad12
L_pc_10_2:
    s_cmp_lg_u32 s3, 3
    s_cbranch_scc1 L_pc_10_3
    s_call_b64 s[86:87], L_pad13
L_pc_10_3:
    v_mov_b32 v2, 1
    v_lshl_add_u32 v3, v0, 2, s88
    s_waitcnt vmcnt(0)
    s_mov_b64 exec, 1
    buffer_store_dword v2, v3, s[32:35], s89 offen sc1
    s_mov_b64 exec, -1
    v_cmp_ne_u32 vcc, 1, v5
    s_mov_b32 s58, 1
    s_and_b32 s86, vcc_lo, 0x7f
    s_cbranch_scc0 L_no_early_fill
    s_mov_b32 s58, 0
    buffer_load_dwordx4 a[40:43], v1, s[16:19], s80 offen offset:2048 sc1
    buffer_load_dwordx4 a[44:47], v1, s[16:19], s80 offen offset:3072 sc1
    s_add_u32 s80, s80, 4096
    buffer_load_dwordx4 a[48:51], v1, s[16:19], s80 offen offset:0 sc1
    buffer_load_dwordx4 a[52:55], v1, s[16:19], s80 offen offset:1024 sc1
    buffer_load_dwordx4 a[56:59], v1, s[16:19], s80 offen offset:2048 sc1
    buffer_load_dwordx4 a[60:63], v1, s[16:19], s80 offen offset:3072 sc1
    s_add_u32 s80, s80, 4096
    buffer_load_dwordx4 a[64:67], v1, s[16:19], s80 offen offset:0 sc1
    buffer_load_dwordx4 a[68:71], v1, s[16:19], s80 offen offset:1024 sc1
    buffer_load_dwordx4 a[72:75], v1, s[16:19], s80 offen offset:2048 sc1
    buffer_load_dwordx4 a[76:79], v1, s[16:19], s80 offen offset:3072 sc1
    s_add_u32 s80, s80, 4096
    buffer_load_dwordx4 a[80:83], v1, s[16:19], s80 offen offset:0 sc1
    buffer_load_dwordx4 a[84:87], v1, s[16:19], s80 offen offset:1024 sc1
L_no_early_fill:
    s_mov_b32 s90, 0x40000
    s_mov_b32 s56, 0x7f
    s_branch L_g_look
L_g_poll:
    buffer_load_dword v5, v14, s[32:35], s89 offen sc1
    s_mov_b64 vcc, 0
    s_sub_u32 s90, s90, 1
    s_cbranch_scc1 L_g_look
    s_waitcnt vmcnt(0)
    v_cmp_ne_u32 vcc, 1, v5
    s_nop 0
L_g_look:
    s_andn2_b32 s57, s56, vcc_lo
    s_cbranch_scc0 L_g_poll
    s_bitcmp1_b32 s57, 0
    s_cbranch_scc0 L_g_i0
    buffer_load_dwordx4 v[128:131], v11, s[24:27], s44 offen offset:0 sc1
    buffer_load_dwordx4 v[132:135], v11, s[24:27], s44 offen offset:2048 sc1
L_g_i0:
    s_bitcmp1_b32 s57, 1
    s_cbranch_scc0 L_g_i1
    buffer_load_dwordx4 v[136:139], v11, s[24:27], s45 offen offset:0 sc1
    buffer_load_dwordx4 v[140:143], v11, s[24:27], s45 offen offset:2048 sc1
L_g_i1:
    s_bitcmp1_b32 s57, 2
    s_cbranch_scc0 L_g_i2
    buffer_load_dwordx4 v[144:147], v11, s[24:27], s46 offen offset:0 sc1
    buffer_load_dwordx4 v[148:151], v11, s[24:27], s46 offen offset:2048 sc1
L_g_i2:
    s_bitcmp1_b32 s57, 3
    s_cbranch_scc0 L_g_i3
    buffer_load_dwordx4 v[152:155], v11, s[24:27], s47 offen offset:0 sc1
    buffer_load_dwordx4 v[156:159], v11, s[24:27], s47 offen offset:2048 sc1
L_g_i3:
    s_bitcmp1_b32 s57, 4
    s_cbranch_scc0 L_g_i4
    buffer_load_dwordx4 v[160:163], v11, s[24:27], s48 offen offset:0 sc1
    buffer_load_dwordx4 v[164:167], v11, s[24:27], s48 offen offset:2048 sc1
L_g_i4:
    s_bitcmp1_b32 s57, 5
    s_cbranch_scc0 L_g_i5
    buffer_load_dwordx4 v[168:171], v11, s[24:27], s49 offen offset:0 sc1
    buffer_load_dwordx4 v[172:175], v11, s[24:27], s49 offen offset:2048 sc1
L_g_i5:
    s_bitcmp1_b32 s57, 6
    s_cbranch_scc0 L_g_i6
    buffer_load_dwordx4 v[176:179], v11, s[24:27], s50 offen offset:0 sc1
    buffer_load_dwordx4 v[180:183], v11, s[24:27], s50 offen offset:2048 sc1
L_g_i6:
    s_cmp_eq_u32 s57, 0x7f
    s_cbranch_scc1 L_g_all
    s_waitcnt vmcnt(0)
L_g_all:
    s_bitcmp1_b32 s57, 0
    s_cbranch_scc0 L_g_a0
    s_waitcnt vmcnt(12)
    v_lshlrev_b32 v6, 16, v128
    v_and_b32 v7, 0xffff0000, v128
    v_pk_add_f32 v[192:193], v[192:193], v[6:7]
    v_lshlrev_b32 v8, 16, v129
    v_and_b32 v9, 0xffff0000, v129
    v_pk_add_f32 v[194:195], v[194:195], v[8:9]
    v_lshlrev_b32 v6, 16, v130
    v_and_b32 v7, 0xffff0000, v130
    v_pk_add_f32 v[196:197], v[196:197], v[6:7]
    v_lshlrev_b32 v8, 16, v131
    v_and_b32 v9, 0xffff0000, v131
    v_pk_add_f32 v[198:199], v[198:199], v[8:9]
    v_lshlrev_b32 v6, 16, v132
    v_and_b32 v7, 0xffff0000, v132
    v_pk_add_f32 v[200:201], v[200:201], v[6:7]
    v_lshlrev_b32 v8, 16, v133
    v_and_b32 v9, 0xffff0000, v133
    v_pk_add_f32 v[202:203], v[202:203], v[8:9]
    v_lshlrev_b32 v6, 16, v134
    v_and_b32 v7, 0xffff0000, v134
    v_pk_add_f32 v[204:205], v[204:205], v[6:7]
    v_lshlrev_b32 v8, 16, v135
    v_and_b32 v9, 0xffff0000, v135
    v_pk_add_f32 v[206:207], v[206:207], v[8:9]
L_g_a0:
    s_bitcmp1_b32 s57, 1
    s_cbranch_scc0 L_g_a1
    s_waitcnt vmcnt(10)
    v_lshlrev_b32 v6, 16, v136
    v_and_b32 v7, 0xffff0000, v136
    v_pk_add_f32 v[192:193], v[192:193], v[6:7]
    v_lshlrev_b32 v8, 16, v137
    v_and_b32 v9, 0xffff0000, v137
    v_pk_add_f32 v[194:195], v[194:195], v[8:9]
    v_lshlrev_b32 v6, 16, v138
    v_and_b32 v7, 0xffff0000, v138
    v_pk_add_f32 v[196:197], v[196:197], v[6:7]
    v_lshlrev_b32 v8, 16, v139
    v_and_b32 v9, 0xffff0000, v139
    v_pk_add_f32 v[198:199], v[198:199], v[8:9]
    v_lshlrev_b32 v6, 16, v140
    v_and_b32 v7, 0xffff0000, v140
    v_pk_add_f32 v[200:201], v[200:201], v[6:7]
    v_lshlrev_b32 v8, 16, v141
    v_and_b32 v9, 0xffff0000, v141
    v_pk_add_f32 v[202:203], v[202:203], v[8:9]
    v_lshlrev_b32 v6, 16, v142
    v_and_b32 v7, 0xffff0000, v142
    v_pk_add_f32 v[204:205], v[204:205], v[6:7]
    v_lshlrev_b32 v8, 16, v143
    v_and_b32 v9, 0xffff0000, v143
    v_pk_add_f32 v[206:207], v[206:207], v[8:9]
L_g_a1:
    s_bitcmp1_b32 s57, 2
    s_cbranch_scc0 L_g_a2
    s_waitcnt vmcnt(8)
    v_lshlrev_b32 v6, 16, v144
    v_and_b32 v7, 0xffff0000, v144
    v_pk_add_f32 v[192:193], v[192:193], v[6:7]
    v_lshlrev_b32 v8, 16, v145
    v_and_b32 v9, 0xffff0000, v145
    v_pk_add_f32 v[194:195], v[194:195], v[8:9]
    v_lshlrev_b32 v6, 16, v146
    v_and_b32 v7, 0xffff0000, v146
    v_pk_add_f32 v[196:197], v[196:197], v[6:7]
    v_lshlrev_b32 v8, 16, v147
    v_and_b32 v9, 0xffff0000, v147
    v_pk_add_f32 v[198:199], v[198:199], v[8:9]
    v_lshlrev_b32 v6, 16, v148
    v_and_b32 v7, 0xffff0000, v148
    v_pk_add_f32 v[200:201], v[200:201], v[6:7]
    v_lshlrev_b32 v8, 16, v149
    v_and_b32 v9, 0xffff0000, v149
    v_pk_add_f32 v[202:203], v[202:203], v[8:9]
    v_lshlrev_b32 v6, 16, v150
    v_and_b32 v7, 0xffff0000, v150
    v_pk_add_f32 v[204:205], v[204:205], v[6:7]
    v_lshlrev_b32 v8, 16, v151
    v_and_b32 v9, 0xffff0000, v151
    v_pk_add_f32 v[206:207], v[206:207], v[8:9]
L_g_a2:
    s_bitcmp1_b32 s57, 3
    s_cbranch_scc0 L_g_a3
    s_waitcnt vmcnt(6)
    v_lshlrev_b32 v6, 16, v152
    v_and_b32 v7, 0xffff0000, v152
    v_pk_add_f32 v[192:193], v[192:193], v[6:7]
    v_lshlrev_b32 v8, 16, v153
    v_and_b32 v9, 0xffff0000, v153
    v_pk_add_f32 v[194:195], v[194:195], v[8:9]
    v_lshlrev_b32 v6, 16, v154
    v_and_b32 v7, 0xffff0000, v154
    v_pk_add_f32 v[196:197], v[196:197], v[6:7]
    v_lshlrev_b32 v8, 16, v155
    v_and_b32 v9, 0xffff0000, v155
    v_pk_add_f32 v[198:199], v[198:199], v[8:9]
    v_lshlrev_b32 v6, 16, v156
    v_and_b32 v7, 0xffff0000, v156
    v_pk_add_f32 v[200:201], v[200:201], v[6:7]
    v_lshlrev_b32 v8, 16, v157
    v_and_b32 v9, 0xffff0000, v157
    v_pk_add_f32 v[202:203], v[202:203], v[8:9]
    v_lshlrev_b32 v6, 16, v158
    v_and_b32 v7, 0xffff0000, v158
    v_pk_add_f32 v[204:205], v[204:205], v[6:7]
    v_lshlrev_b32 v8, 16, v159
    v_and_b32 v9, 0xffff0000, v159
    v_pk_add_f32 v[206:207], v[206:207], v[8:9]
L_g_a3:
    s_bitcmp1_b32 s57, 4
    s_cbranch_scc0 L_g_a4
    s_waitcnt vmcnt(4)
    v_lshlrev_b32 v6, 16, v160
    v_and_b32 v7, 0xffff0000, v160
    v_pk_add_f32 v[192:193], v[192:193], v[6:7]
    v_lshlrev_b32 v8, 16, v161
    v_and_b32 v9, 0xffff0000, v161
    v_pk_add_f32 v[194:195], v[194:195], v[8:9]
    v_lshlrev_b32 v6, 16, v162
    v_and_b32 v7, 0xffff0000, v162
    v_pk_add_f32 v[196:197], v[196:197], v[6:7]
    s_branch L_ov10
L_pad10:
    s_setpc_b64 s[86:87]
L_ov10:
    v_lshlrev_b32 v8, 16, v163
    v_and_b32 v9, 0xffff0000, v163
    v_pk_add_f32 v[198:199], v[198:199], v[8:9]
    v_lshlrev_b32 v6, 16, v164
    v_and_b32 v7, 0xffff0000, v164
    v_pk_add_f32 v[200:201], v[200:201], v[6:7]
    v_lshlrev_b32 v8, 16, v165
    v_and_b32 v9, 0xffff0000, v165
    v_pk_add_f32 v[202:203], v[202:203], v[8:9]
    v_lshlrev_b32 v6, 16, v166
    v_and_b32 v7, 0xffff0000, v166
    v_pk_add_f32 v[204:205], v[204:205], v[6:7]
    v_lshlrev_b32 v8, 16, v167
    v_and_b32 v9, 0xffff0000, v167
    v_pk_add_f32 v[206:207], v[206:207], v[8:9]
L_g_a4:
    s_bitcmp1_b32 s57, 5
    s_cbranch_scc0 L_g_a5
    s_waitcnt vmcnt(2)
    v_lshlrev_b32 v6, 16, v168
    v_and_b32 v7, 0xffff0000, v168
    v_pk_add_f32 v[192:193], v[192:193], v[6:7]
    v_lshlrev_b32 v8, 16, v169
    v_and_b32 v9, 0xffff0000, v169
    v_pk_add_f32 v[194:195], v[194:195], v[8:9]
    v_lshlrev_b32 v6, 16, v170
    v_and_b32 v7, 0xffff0000, v170
    v_pk_add_f32 v[196:197], v[196:197], v[6:7]
    v_lshlrev_b32 v8, 16, v171
    v_and_b32 v9, 0xffff0000, v171
    v_pk_add_f32 v[198:199], v[198:199], v[8:9]
    v_lshlrev_b32 v6, 16, v172
    v_and_b32 v7, 0xffff0000, v172
    v_pk_add_f32 v[200:201], v[200:201], v[6:7]
    v_lshlrev_b32 v8, 16, v173
    v_and_b32 v9, 0xffff0000, v173
    v_pk_add_f32 v[202:203], v[202:203], v[8:9]
    v_lshlrev_b32 v6, 16, v174
    v_and_b32 v7, 0xffff0000, v174
    v_pk_add_f32 v[204:205], v[204:205], v[6:7]
    v_lshlrev_b32 v8, 16, v175
    v_and_b32 v9, 0xffff0000, v175
    v_pk_add_f32 v[206:207], v[206:207], v[8:9]
L_g_a5:
    s_bitcmp1_b32 s57, 6
    s_cbranch_scc0 L_g_a6
    s_waitcnt vmcnt(0)
    v_lshlrev_b32 v6, 16, v176
    v_and_b32 v7, 0xffff0000, v176
    v_pk_add_f32 v[192:193], v[192:193], v[6:7]
    v_lshlrev_b32 v8, 16, v177
    v_and_b32 v9, 0xffff0000, v177
    v_pk_add_f32 v[194:195], v[194:195], v[8:9]
    v_lshlrev_b32 v6, 16, v178
    v_and_b32 v7, 0xffff0000, v178
    v_pk_add_f32 v[196:197], v[196:197], v[6:7]
    v_lshlrev_b32 v8, 16, v179
    v_and_b32 v9, 0xffff0000, v179
    v_pk_add_f32 v[198:199], v[198:199], v[8:9]
    v_lshlrev_b32 v6, 16, v180
    v_and_b32 v7, 0xffff0000, v180
    v_pk_add_f32 v[200:201], v[200:201], v[6:7]
    v_lshlrev_b32 v8, 16, v181
    v_and_b32 v9, 0xffff0000, v181
    v_pk_add_f32 v[202:203], v[202:203], v[8:9]
    v_lshlrev_b32 v6, 16, v182
    v_and_b32 v7, 0xffff0000, v182
    v_pk_add_f32 v[204:205], v[204:205], v[6:7]
    v_lshlrev_b32 v8, 16, v183
    v_and_b32 v9, 0xffff0000, v183
    v_pk_add_f32 v[206:207], v[206:207], v[8:9]
L_g_a6:
    s_andn2_b32 s56, s56, s57
    s_cbranch_scc1 L_g_poll
    s_add_u32 s89, s89, 131072
    s_cmp_eq_u32 s58, 0
    s_cbranch_scc1 L_no_late_fill
    buffer_load_dwordx4 a[40:43], v1, s[16:19], s80 offen offset:2048 sc1
    buffer_load_dwordx4 a[44:47], v1, s[16:19], s80 offen offset:3072 sc1
    s_add_u32 s80, s80, 4096
    buffer_load_dwordx4 a[48:51], v1, s[16:19], s80 offen offset:0 sc1
    buffer_load_dwordx4 a[52:55], v1, s[16:19], s80 offen offset:1024 sc1
    buffer_load_dwordx4 a[56:59], v1, s[16:19], s80 offen offset:2048 sc1
    buffer_load_dwordx4 a[60:63], v1, s[16:19], s80 offen offset:3072 sc1
    s_add_u32 s80, s80, 4096
    buffer_load_dwordx4 a[64:67], v1, s[16:19], s80 offen offset:0 sc1
    buffer_load_dwordx4 a[68:71], v1, s[16:19], s80 offen offset:1024 sc1
    buffer_load_dwordx4 a[72:75], v1, s[16:19], s80 offen offset:2048 sc1
    buffer_load_dwordx4 a[76:79], v1, s[16:19], s80 offen offset:3072 sc1
    s_add_u32 s80, s80, 4096
    buffer_load_dwordx4 a[80:83], v1, s[16:19], s80 offen offset:0 sc1
    buffer_load_dwordx4 a[84:87], v1, s[16:19], s80 offen offset:1024 sc1
L_no_late_fill:
    v_pk_fma_f32 v[64:65], v[192:193], v[208:209], v[64:65]
    buffer_load_dwordx4 a[88:91], v1, s[16:19], s80 offen offset:2048 sc1
    v_pk_fma_f32 v[66:67], v[194:195], v[210:211], v[66:67]
    v_pk_fma_f32 v[68:69], v[196:197], v[212:213], v[68:69]
    v_pk_fma_f32 v[70:71], v[198:199], v[214:215], v[70:71]
    v_pk_fma_f32 v[72:73], v[200:201], v[216:217], v[72:73]
    v_pk_fma_f32 v[74:75], v[202:203], v[218:219], v[74:75]
    v_pk_fma_f32 v[76:77], v[204:205], v[220:221], v[76:77]
    buffer_load_dwordx4 a[92:95], v1, s[16:19], s80 offen offset:3072 sc1
    s_add_u32 s80, s80, 4096
    v_pk_fma_f32 v[78:79], v[206:207], v[222:223], v[78:79]
    v_pk_add_f32 v[2:3], v[64:65], v[66:67]
    v_pk_mul_f32 v[4:5], v[64:65], v[64:65]
    v_pk_fma_f32 v[4:5], v[66:67], v[66:67], v[4:5]
    v_pk_add_f32 v[2:3], v[2:3], v[68:69]
    v_pk_fma_f32 v[4:5], v[68:69], v[68:69], v[4:5]
    buffer_load_dwordx4 a[96:99], v1, s[16:19], s80 offen offset:0 sc1
    v_pk_add_f32 v[2:3], v[2:3], v[70:71]
    v_pk_fma_f32 v[4:5], v[70:71], v[70:71], v[4:5]
    v_pk_add_f32 v[2:3], v[2:3], v[72:73]
    v_pk_fma_f32 v[4:5], v[72:73], v[72:73], v[4:5]
    v_pk_add_f32 v[2:3], v[2:3], v[74:75]
    v_pk_fma_f32 v[4:5], v[74:75], v[74:75], v[4:5]
    buffer_load_dwordx4 a[100:103], v1, s[16:19], s80 offen offset:1024 sc1
    v_pk_add_f32 v[2:3], v[2:3], v[76:77]
    v_pk_fma_f32 v[4:5], v[76:77], v[76:77], v[4:5]
    v_pk_add_f32 v[2:3], v[2:3], v[78:79]
    v_pk_fma_f32 v[4:5], v[78:79], v[78:79], v[4:5]
    v_add_f32 v2, v2, v3
    v_add_f32 v3, v4, v5
    buffer_load_dwordx4 a[104:107], v1, s[16:19], s80 offen offset:2048 sc1
    v_and_b32 v6, 7, v0
    v_lshlrev_b32 v6, 3, v6
    v_add_f32_dpp v2, v2, v2 row_ror:8 row_mask:0xf bank_mask:0xf
    v_add_f32_dpp v3, v3, v3 row_ror:8 row_mask:0xf bank_mask:0xf
    v_mov_b32 v4, v2
    v_mov_b32 v5, v3
    buffer_load_dwordx4 a[128:131], v1, s[16:19], s80 offen offset:3072 sc1
    s_add_u32 s80, s80, 4096
    s_nop 1
    v_permlane16_swap_b32 v2, v4
    v_permlane16_swap_b32 v3, v5
    s_nop 1
    v_add_f32 v2, v2, v4
    v_add_f32 v3, v3, v5
    buffer_load_dwordx4 a[132:135], v1, s[16:19], s80 offen offset:0 sc1
    v_mov_b32 v4, v2
    v_mov_b32 v5, v3
    s_nop 1
    v_permlane32_swap_b32 v2, v4
    v_permlane32_swap_b32 v3, v5
    s_nop 1
    buffer_load_dwordx4 a[136:139], v1, s[16:19], s80 offen offset:1024 sc1
    v_add_f32 v2, v2, v4
    v_add_f32 v3, v3, v5
    s_lshl_b32 s86, s3, 6
    s_add_u32 s86, s86, 161856
    v_add_u32 v7, s86, v6
    v_add_u32 v6, 161856, v6
    buffer_load_dwordx4 a[140:143], v1, s[16:19], s80 offen offset:2048 sc1
    ds_write_b64 v7, v[2:3]
    s_waitcnt lgkmcnt(0)
    s_barrier
    ds_read_b64 v[128:129], v6 offset:0
    ds_read_b64 v[130:131], v6 offset:64
    ds_read_b64 v[132:133], v6 offset:128
    buffer_load_dwordx4 a[144:147], v1, s[16:19], s80 offen offset:3072 sc1
    s_add_u32 s80, s80, 4096
    ds_read_b64 v[134:135], v6 offset:192
    s_waitcnt lgkmcnt(0)
    v_pk_add_f32 v[128:129], v[128:129], v[130:131]
    v_pk_add_f32 v[132:133], v[132:133], v[134:135]
    v_pk_add_f32 v[2:3], v[128:129], v[132:133]
    v_mul_f32 v2, 0x3b000000, v2
    buffer_load_dwordx4 a[148:151], v1, s[16:19], s80 offen offset:0 sc1
    v_mul_f32 v3, 0x3b000000, v3
    v_fma_f32 v3, -v2, v2, v3
    v_max_f32 v3, 0, v3
    v_add_f32 v3, 0x3727c5ac, v3
    v_rsq_f32 v4, v3
    s_nop 0
    buffer_load_dwordx4 a[152:155], v1, s[16:19], s80 offen offset:1024 sc1
    v_mul_f32 v5, -v2, v4
    v_pk_fma_f32 v[192:193], v[64:65], v[4:5], v[4:5] op_sel:[0,0,1] op_sel_hi:[1,0,1]
    v_pk_fma_f32 v[194:195], v[66:67], v[4:5], v[4:5] op_sel:[0,0,1] op_sel_hi:[1,0,1]
    v_pk_fma_f32 v[196:197], v[68:69], v[4:5], v[4:5] op_sel:[0,0,1] op_sel_hi:[1,0,1]
    v_pk_fma_f32 v[198:199], v[70:71], v[4:5], v[4:5] op_sel:[0,0,1] op_sel_hi:[1,0,1]
    v_pk_fma_f32 v[200:201], v[72:73], v[4:5], v[4:5] op_sel:[0,0,1] op_sel_hi:[1,0,1]
    v_pk_fma_f32 v[202:203], v[74:75], v[4:5], v[4:5] op_sel:[0,0,1] op_sel_hi:[1,0,1]
    v_pk_fma_f32 v[204:205], v[76:77], v[4:5], v[4:5] op_sel:[0,0,1] op_sel_hi:[1,0,1]
    v_pk_fma_f32 v[206:207], v[78:79], v[4:5], v[4:5] op_sel:[0,0,1] op_sel_hi:[1,0,1]
    v_pk_fma_f32 v[192:193], v[192:193], v[240:241], v[224:225]
    v_pk_fma_f32 v[194:195], v[194:195], v[242:243], v[226:227]
    v_pk_fma_f32 v[196:197], v[196:197], v[244:245], v[228:229]
    v_pk_fma_f32 v[198:199], v[198:199], v[246:247], v[230:231]
    v_pk_fma_f32 v[200:201], v[200:201], v[248:249], v[232:233]
    v_pk_fma_f32 v[202:203], v[202:203], v[250:251], v[234:235]
    v_pk_fma_f32 v[204:205], v[204:205], v[252:253], v[236:237]
    v_pk_fma_f32 v[206:207], v[206:207], v[254:255], v[238:239]
    v_cvt_pk_bf16_f32 v128, v192, v193
    v_cvt_pk_bf16_f32 v129, v194, v195
    v_cvt_pk_bf16_f32 v130, v196, v197
    v_cvt_pk_bf16_f32 v131, v198, v199
    v_cvt_pk_bf16_f32 v132, v200, v201
    v_cvt_pk_bf16_f32 v133, v202, v203
    v_cvt_pk_bf16_f32 v134, v204, v205
    v_cvt_pk_bf16_f32 v135, v206, v207
    buffer_store_dwordx4 v[128:131], v11, s[28:31], 0 offen offset:0 sc1
    buffer_store_dwordx4 v[132:135], v11, s[28:31], 0 offen offset:2048 sc1
    v_mov_b32 v2, 1
    v_lshl_add_u32 v3, v0, 2, s88
    s_waitcnt vmcnt(0)
    s_mov_b64 exec, 1
    buffer_store_dword v2, v3, s[32:35], s89 offen sc1
    s_mov_b64 exec, -1
    buffer_load_dwordx4 a[156:159], v1, s[16:19], s80 offen offset:2048 sc1
    buffer_load_dwordx4 a[160:163], v1, s[16:19], s80 offen offset:3072 sc1
    s_add_u32 s80, s80, 4096
    buffer_load_dwordx4 a[164:167], v1, s[16:19], s80 offen offset:0 sc1
    buffer_load_dwordx4 a[168:171], v1, s[16:19], s80 offen offset:1024 sc1
    buffer_load_dwordx4 a[172:175], v1, s[16:19], s80 offen offset:2048 sc1
    buffer_load_dwordx4 a[176:179], v1, s[16:19], s80 offen offset:3072 sc1
    s_add_u32 s80, s80, 4096
    buffer_load_dwordx4 a[180:183], v1, s[16:19], s80 offen offset:0 sc1
    buffer_load_dwordx4 a[184:187], v1, s[16:19], s80 offen offset:1024 sc1
    buffer_load_dwordx4 a[188:191], v1, s[16:19], s80 offen offset:2048 sc1
    buffer_load_dwordx4 a[108:111], v1, s[16:19], s80 offen offset:3072 sc1
    s_add_u32 s80, s80, 4096
    buffer_load_dwordx4 a[112:115], v1, s[16:19], s80 offen offset:0 sc1
    buffer_load_dwordx4 a[116:119], v1, s[16:19], s80 offen offset:1024 sc1
    buffer_load_dwordx4 a[120:123], v1, s[16:19], s80 offen offset:2048 sc1
    buffer_load_dwordx4 a[124:127], v1, s[16:19], s80 offen offset:3072 sc1
    s_add_u32 s80, s80, 4096
    buffer_load_dwordx4 a[192:195], v1, s[16:19], s80 offen offset:0 sc1
    buffer_load_dwordx4 a[196:199], v1, s[16:19], s80 offen offset:1024 sc1
    v_add_u32 v20, 0, v1
    s_mov_b32 s90, 0x40000
    s_lshl_b32 s86, s3, 3
    s_lshr_b32 s56, s51, s86
    s_mov_b32 s87, 0xff
L_wait1:
    buffer_load_dword v2, v10, s[32:35], s89 offen sc1
    s_sub_u32 s90, s90, 1
    s_cbranch_scc1 L_wait1x
    s_waitcnt vmcnt(0)
    v_cmp_ne_u32 vcc, 1, v2
    s_nop 0
    s_and_b32 m0, vcc_lo, s87
    s_cbranch_scc1 L_wait1
L_wait1x:
    s_add_u32 s89, s89, 131072
    s_lshl_b32 s87, s3, 14
    s_add_u32 m0, s59, 0
    s_nop 0
    buffer_load_dwordx4 v1, s[28:31], s87 offen offset:0 sc1 lds
    buffer_load_dwordx4 v1, s[28:31], s87 offen offset:1024 sc1 lds
    buffer_load_dwordx4 v1, s[28:31], s87 offen offset:2048 sc1 lds
    buffer_load_dwordx4 v1, s[28:31], s87 offen offset:3072 sc1 lds
    s_add_u32 m0, s59, 4096
    s_add_u32 s87, s87, 4096
    buffer_load_dwordx4 v1, s[28:31], s87 offen offset:0 sc1 lds
    buffer_load_dwordx4 v1, s[28:31], s87 offen offset:1024 sc1 lds
    buffer_load_dwordx4 v1, s[28:31], s87 offen offset:2048 sc1 lds
    buffer_load_dwordx4 v1, s[28:31], s87 offen offset:3072 sc1 lds
    s_add_u32 m0, s59, 8192
    s_add_u32 s87, s87, 4096
    buffer_load_dwordx4 v1, s[28:31], s87 offen offset:0 sc1 lds
    buffer_load_dwordx4 v1, s[28:31], s87 offen offset:1024 sc1 lds
    buffer_load_dwordx4 v1, s[28:31], s87 offen offset:2048 sc1 lds
    buffer_load_dwordx4 v1, s[28:31], s87 offen offset:3072 sc1 lds
    s_add_u32 m0, s59, 12288
    s_add_u32 s87, s87, 4096
    buffer_load_dwordx4 v1, s[28:31], s87 offen offset:0 sc1 lds
    buffer_load_dwordx4 v1, s[28:31], s87 offen offset:1024 sc1 lds
    buffer_load_dwordx4 v1, s[28:31], s87 offen offset:2048 sc1 lds
    buffer_load_dwordx4 v1, s[28:31], s87 offen offset:3072 sc1 lds
    buffer_load_dwordx4 a[200:203], v1, s[16:19], s80 offen offset:2048 sc1
    buffer_load_dwordx4 a[204:207], v1, s[16:19], s80 offen offset:3072 sc1
    s_add_u32 s80, s80, 4096
    buffer_load_dwordx4 a[208:211], v1, s[16:19], s80 offen offset:0 sc1
    buffer_load_dwordx4 a[212:215], v1, s[16:19], s80 offen offset:1024 sc1
    buffer_load_dwordx4 a[216:219], v1, s[16:19], s80 offen offset:2048 sc1
    buffer_load_dwordx4 a[220:223], v1, s[16:19], s80 offen offset:3072 sc1
    s_add_u32 s80, s80, 4096
    s_lshl_b32 s86, s3, 2
    s_add_u32 s86, s86, 131072
    v_add_u32 v21, s86, v1
    v_add_u32 v23, 131072, v1
    s_add_u32 s24, s24, 0x1000000
    s_addc_u32 s25, s25, 0
    s_waitcnt vmcnt(18)
    s_barrier
    ds_read_b128 v[24:27], v20 offset:0
    ds_read_b128 v[28:31], v20 offset:1024
    ds_read_b128 v[32:35], v20 offset:16384
    ds_read_b128 v[36:39], v20 offset:17408
    ds_read_b128 v[40:43], v20 offset:32768
    ds_read_b128 v[44:47], v20 offset:33792
    ds_read_b128 v[48:51], v20 offset:49152
    ds_read_b128 v[52:55], v20 offset:50176
    s_waitcnt lgkmcnt(2)
    v_mfma_f32_16x16x32_bf16 v[128:131], a[0:3], v[24:27], 0
    v_mfma_f32_16x16x32_bf16 v[128:131], a[28:31], v[28:31], v[128:131]
    buffer_load_dwordx4 a[224:227], v1, s[16:19], s80 offen offset:0 sc1
    v_mfma_f32_16x16x32_bf16 v[132:135], a[0:3], v[32:35], 0
    v_mfma_f32_16x16x32_bf16 v[132:135], a[28:31], v[36:39], v[132:135]
    ds_read_b128 v[80:83], v20 offset:2048
    v_mfma_f32_16x16x32_bf16 v[136:139], a[0:3], v[40:43], 0
    v_mfma_f32_16x16x32_bf16 v[136:139], a[28:31], v[44:47], v[136:139]
    s_waitcnt lgkmcnt(2)
    buffer_load_dwordx4 a[228:231], v1, s[16:19], s80 offen offset:1024 sc1
    v_mfma_f32_16x16x32_bf16 v[140:143], a[0:3], v[48:51], 0
    s_waitcnt lgkmcnt(1)
    v_mfma_f32_16x16x32_bf16 v[140:143], a[28:31], v[52:55], v[140:143]
    ds_read_b128 v[84:87], v20 offset:3072
    v_mfma_f32_16x16x32_bf16 v[144:147], a[4:7], v[24:27], 0
    v_mfma_f32_16x16x32_bf16 v[144:147], a[32:35], v[28:31], v[144:147]
    buffer_load_dwordx4 a[232:235], v1, s[16:19], s80 offen offset:2048 sc1
    v_mfma_f32_16x16x32_bf16 v[148:151], a[4:7], v[32:35], 0
    v_mfma_f32_16x16x32_bf16 v[148:151], a[32:35], v[36:39], v[148:151]
    ds_read_b128 v[88:91], v20 offset:18432
    v_mfma_f32_16x16x32_bf16 v[152:155], a[4:7], v[40:43], 0
    v_mfma_f32_16x16x32_bf16 v[152:155], a[32:35], v[44:47], v[152:155]
    buffer_load_dwordx4 a[236:239], v1, s[16:19], s80 offen offset:3072 sc1
    v_mfma_f32_16x16x32_bf16 v[156:159], a[4:7], v[48:51], 0
    s_add_u32 s80, s80, 4096
    v_mfma_f32_16x16x32_bf16 v[156:159], a[32:35], v[52:55], v[156:159]
    ds_read_b128 v[92:95], v20 offset:19456
    v_mfma_f32_16x16x32_bf16 v[160:163], a[8:11], v[24:27], 0
    v_mfma_f32_16x16x32_bf16 v[160:163], a[36:39], v[28:31], v[160:163]
    buffer_load_dwordx4 a[240:243], v1, s[16:19], s80 offen offset:0 sc1
    v_mfma_f32_16x16x32_bf16 v[164:167], a[8:11], v[32:35], 0
    v_mfma_f32_16x16x32_bf16 v[164:167], a[36:39], v[36:39], v[164:167]
    ds_read_b128 v[96:99], v20 offset:34816
    v_mfma_f32_16x16x32_bf16 v[168:171], a[8:11], v[40:43], 0
    v_mfma_f32_16x16x32_bf16 v[168:171], a[36:39], v[44:47], v[168:171]
    buffer_load_dwordx4 a[244:247], v1, s[16:19], s80 offen offset:1024 sc1
    v_mfma_f32_16x16x32_bf16 v[172:175], a[8:11], v[48:51], 0
    v_mfma_f32_16x16x32_bf16 v[172:175], a[36:39], v[52:55], v[172:175]
    ds_read_b128 v[100:103], v20 offset:35840
    v_mfma_f32_16x16x32_bf16 v[176:179], a[12:15], v[24:27], 0
    v_mfma_f32_16x16x32_bf16 v[176:179], a[40:43], v[28:31], v[176:179]
    buffer_load_dwordx4 a[248:251], v1, s[16:19], s80 offen offset:2048 sc1
    v_mfma_f32_16x16x32_bf16 v[180:183], a[12:15], v[32:35], 0
    v_mfma_f32_16x16x32_bf16 v[180:183], a[40:43], v[36:39], v[180:183]
    ds_read_b128 v[104:107], v20 offset:51200
    v_mfma_f32_16x16x32_bf16 v[184:187], a[12:15], v[40:43], 0
    v_mfma_f32_16x16x32_bf16 v[184:187], a[40:43], v[44:47], v[184:187]
    buffer_load_dwordx4 a[252:255], v1, s[16:19], s80 offen offset:3072 sc1
    v_mfma_f32_16x16x32_bf16 v[188:191], a[12:15], v[48:51], 0
    s_add_u32 s80, s80, 4096
    v_mfma_f32_16x16x32_bf16 v[188:191], a[40:43], v[52:55], v[188:191]
    ds_read_b128 v[108:111], v20 offset:52224
    v_mfma_f32_16x16x32_bf16 v[192:195], a[16:19], v[24:27], 0
    v_mfma_f32_16x16x32_bf16 v[192:195], a[44:47], v[28:31], v[192:195]
    buffer_load_dwordx4 a[0:3], v1, s[16:19], s80 offen offset:0 sc1
    v_mfma_f32_16x16x32_bf16 v[196:199], a[16:19], v[32:35], 0
    v_mfma_f32_16x16x32_bf16 v[196:199], a[44:47], v[36:39], v[196:199]
    v_mfma_f32_16x16x32_bf16 v[200:203], a[16:19], v[40:43], 0
    v_mfma_f32_16x16x32_bf16 v[200:203], a[44:47], v[44:47], v[200:203]
    buffer_load_dwordx4 a[4:7], v1, s[16:19], s80 offen offset:1024 sc1
    v_mfma_f32_16x16x32_bf16 v[204:207], a[16:19], v[48:51], 0
    v_mfma_f32_16x16x32_bf16 v[204:207], a[44:47], v[52:55], v[204:207]
    v_mfma_f32_16x16x32_bf16 v[208:211], a[20:23], v[24:27], 0
    v_mfma_f32_16x16x32_bf16 v[208:211], a[48:51], v[28:31], v[208:211]
    buffer_load_dwordx4 a[8:11], v1, s[16:19], s80 offen offset:2048 sc1
    v_mfma_f32_16x16x32_bf16 v[212:215], a[20:23], v[32:35], 0
    v_mfma_f32_16x16x32_bf16 v[212:215], a[48:51], v[36:39], v[212:215]
    v_mfma_f32_16x16x32_bf16 v[216:219], a[20:23], v[40:43], 0
    v_mfma_f32_16x16x32_bf16 v[216:219], a[48:51], v[44:47], v[216:219]
    buffer_load_dwordx4 a[12:15], v1, s[16:19], s80 offen offset:3072 sc1
    v_mfma_f32_16x16x32_bf16 v[220:223], a[20:23], v[48:51], 0
    s_add_u32 s80, s80, 4096
    v_mfma_f32_16x16x32_bf16 v[220:223], a[48:51], v[52:55], v[220:223]
    v_mfma_f32_16x16x32_bf16 v[224:227], a[24:27], v[24:27], 0
    v_mfma_f32_16x16x32_bf16 v[224:227], a[52:55], v[28:31], v[224:227]
    buffer_load_dwordx4 a[16:19], v1, s[16:19], s80 offen offset:0 sc1
    v_mfma_f32_16x16x32_bf16 v[228:231], a[24:27], v[32:35], 0
    v_mfma_f32_16x16x32_bf16 v[228:231], a[52:55], v[36:39], v[228:231]
    v_mfma_f32_16x16x32_bf16 v[232:235], a[24:27], v[40:43], 0
    v_mfma_f32_16x16x32_bf16 v[232:235], a[52:55], v[44:47], v[232:235]
    buffer_load_dwordx4 a[20:23], v1, s[16:19], s80 offen offset:1024 sc1
    v_mfma_f32_16x16x32_bf16 v[236:239], a[24:27], v[48:51], 0
    v_mfma_f32_16x16x32_bf16 v[236:239], a[52:55], v[52:55], v[236:239]
    s_waitcnt lgkmcnt(2)
    v_mfma_f32_16x16x32_bf16 v[128:131], a[56:59], v[80:83], v[128:131]
    v_mfma_f32_16x16x32_bf16 v[128:131], a[84:87], v[84:87], v[128:131]
    buffer_load_dwordx4 a[24:27], v1, s[16:19], s80 offen offset:2048 sc1
    v_mfma_f32_16x16x32_bf16 v[132:135], a[56:59], v[88:91], v[132:135]
    s_waitcnt vmcnt(29)
    s_barrier
    v_mfma_f32_16x16x32_bf16 v[132:135], a[84:87], v[92:95], v[132:135]
    ds_read_b128 v[24:27], v20 offset:4096
    v_mfma_f32_16x16x32_bf16 v[136:139], a[56:59], v[96:99], v[136:139]
    v_mfma_f32_16x16x32_bf16 v[136:139], a[84:87], v[100:103], v[136:139]
    s_waitcnt lgkmcnt(2)
    buffer_load_dwordx4 a[28:31], v1, s[16:19], s80 offen offset:3072 sc1
    v_mfma_f32_16x16x32_bf16 v[140:143], a[56:59], v[104:107], v[140:143]
    s_add_u32 s80, s80, 4096
    s_waitcnt lgkmcnt(1)
    v_mfma_f32_16x16x32_bf16 v[140:143], a[84:87], v[108:111], v[140:143]
    ds_read_b128 v[28:31], v20 offset:5120
    v_mfma_f32_16x16x32_bf16 v[144:147], a[60:63], v[80:83], v[144:147]
    v_mfma_f32_16x16x32_bf16 v[144:147], a[88:91], v[84:87], v[144:147]
    buffer_load_dwordx4 a[32:35], v1, s[16:19], s80 offen offset:0 sc1
    v_mfma_f32_16x16x32_bf16 v[148:151], a[60:63], v[88:91], v[148:151]
    v_mfma_f32_16x16x32_bf16 v[148:151], a[88:91], v[92:95], v[148:151]
    ds_read_b128 v[32:35], v20 offset:20480
    v_mfma_f32_16x16x32_bf16 v[152:155], a[60:63], v[96:99], v[152:155]
    v_mfma_f32_16x16x32_bf16 v[152:155], a[88:91], v[100:103], v[152:155]
    buffer_load_dwordx4 a[36:39], v1, s[16:19], s80 offen offset:1024 sc1
    v_mfma_f32_16x16x32_bf16 v[156:159], a[60:63], v[104:107], v[156:159]
    v_mfma_f32_16x16x32_bf16 v[156:159], a[88:91], v[108:111], v[156:159]
    ds_read_b128 v[36:39], v20 offset:21504
    v_mfma_f32_16x16x32_bf16 v[160:163], a[64:67], v[80:83], v[160:163]
    v_mfma_f32_16x16x32_bf16 v[160:163], a[92:95], v[84:87], v[160:163]
    buffer_load_dwordx4 a[40:43], v1, s[16:19], s80 offen offset:2048 sc1
    v_mfma_f32_16x16x32_bf16 v[164:167], a[64:67], v[88:91], v[164:167]
    v_mfma_f32_16x16x32_bf16 v[164:167], a[92:95], v[92:95], v[164:167]
    ds_read_b128 v[40:43], v20 offset:36864
    v_mfma_f32_16x16x32_bf16 v[168:171], a[64:67], v[96:99], v[168:171]
    v_mfma_f32_16x16x32_bf16 v[168:171], a[92:95], v[100:103], v[168:171]
    buffer_load_dwordx4 a[44:47], v1, s[16:19], s80 offen offset:3072 sc1
    v_mfma_f32_16x16x32_bf16 v[172:175], a[64:67], v[104:107], v[172:175]
    s_add_u32 s80, s80, 4096
    v_mfma_f32_16x16x32_bf16 v[172:175], a[92:95], v[108:111], v[172:175]
    ds_read_b128 v[44:47], v20 offset:37888
    v_mfma_f32_16x16x32_bf16 v[176:179], a[68:71], v[80:83], v[176:179]
    v_mfma_f32_16x16x32_bf16 v[176:179], a[96:99], v[84:87], v[176:179]
    buffer_load_dwordx4 a[48:51], v1, s[16:19], s80 offen offset:0 sc1
    v_mfma_f32_16x16x32_bf16 v[180:183], a[68:71], v[88:91], v[180:183]
    v_mfma_f32_16x16x32_bf16 v[180:183], a[96:99], v[92:95], v[180:183]
    ds_read_b128 v[48:51], v20 offset:53248
    v_mfma_f32_16x16x32_bf16 v[184:187], a[68:71], v[96:99], v[184:187]
    v_mfma_f32_16x16x32_bf16 v[184:187], a[96:99], v[100:103], v[184:187]
    buffer_load_dwordx4 a[52:55], v1, s[16:19], s80 offen offset:1024 sc1
    v_mfma_f32_16x16x32_bf16 v[188:191], a[68:71], v[104:107], v[188:191]
    v_mfma_f32_16x16x32_bf16 v[188:191], a[96:99], v[108:111], v[188:191]
    ds_read_b128 v[52:55], v20 offset:54272
    v_mfma_f32_16x16x32_bf16 v[192:195], a[72:75], v[80:83], v[192:195]
    v_mfma_f32_16x16x32_bf16 v[192:195], a[100:103], v[84:87], v[192:195]
    buffer_load_dwordx4 a[56:59], v1, s[16:19], s80 offen offset:2048 sc1
    v_mfma_f32_16x16x32_bf16 v[196:199], a[72:75], v[88:91], v[196:199]
    v_mfma_f32_16x16x32_bf16 v[196:199], a[100:103], v[92:95], v[196:199]
    v_mfma_f32_16x16x32_bf16 v[200:203], a[72:75], v[96:99], v[200:203]
    v_mfma_f32_16x16x32_bf16 v[200:203], a[100:103], v[100:103], v[200:203]
    buffer_load_dwordx4 a[60:63], v1, s[16:19], s80 offen offset:3072 sc1
    v_mfma_f32_16x16x32_bf16 v[204:207], a[72:75], v[104:107], v[204:207]
    s_add_u32 s80, s80, 4096
    v_mfma_f32_16x16x32_bf16 v[204:207], a[100:103], v[108:111], v[204:207]
    v_mfma_f32_16x16x32_bf16 v[208:211], a[76:79], v[80:83], v[208:211]
    v_mfma_f32_16x16x32_bf16 v[208:211], a[104:107], v[84:87], v[208:211]
    buffer_load_dwordx4 a[64:67], v1, s[16:19], s80 offen offset:0 sc1
    v_mfma_f32_16x16x32_bf16 v[212:215], a[76:79], v[88:91], v[212:215]
    v_mfma_f32_16x16x32_bf16 v[212:215], a[104:107], v[92:95], v[212:215]
    v_mfma_f32_16x16x32_bf16 v[216:219], a[76:79], v[96:99], v[216:219]
    v_mfma_f32_16x16x32_bf16 v[216:219], a[104:107], v[100:103], v[216:219]
    buffer_load_dwordx4 a[68:71], v1, s[16:19], s80 offen offset:1024 sc1
    v_mfma_f32_16x16x32_bf16 v[220:223], a[76:79], v[104:107], v[220:223]
    v_mfma_f32_16x16x32_bf16 v[220:223], a[104:107], v[108:111], v[220:223]
    v_mfma_f32_16x16x32_bf16 v[224:227], a[80:83], v[80:83], v[224:227]
    v_mfma_f32_16x16x32_bf16 v[224:227], a[128:131], v[84:87], v[224:227]
    buffer_load_dwordx4 a[72:75], v1, s[16:19], s80 offen offset:2048 sc1
    v_mfma_f32_16x16x32_bf16 v[228:231], a[80:83], v[88:91], v[228:231]
    v_mfma_f32_16x16x32_bf16 v[228:231], a[128:131], v[92:95], v[228:231]
    v_mfma_f32_16x16x32_bf16 v[232:235], a[80:83], v[96:99], v[232:235]
    v_mfma_f32_16x16x32_bf16 v[232:235], a[128:131], v[100:103], v[232:235]
    buffer_load_dwordx4 a[76:79], v1, s[16:19], s80 offen offset:3072 sc1
    v_mfma_f32_16x16x32_bf16 v[236:239], a[80:83], v[104:107], v[236:239]
    s_add_u32 s80, s80, 4096
    v_mfma_f32_16x16x32_bf16 v[236:239], a[128:131], v[108:111], v[236:239]
    s_waitcnt lgkmcnt(2)
    v_mfma_f32_16x16x32_bf16 v[128:131], a[132:135], v[24:27], v[128:131]
    v_mfma_f32_16x16x32_bf16 v[128:131], a[160:163], v[28:31], v[128:131]
    buffer_load_dwordx4 a[80:83], v1, s[16:19], s80 offen offset:0 sc1
    v_mfma_f32_16x16x32_bf16 v[132:135], a[132:135], v[32:35], v[132:135]
    v_mfma_f32_16x16x32_bf16 v[132:135], a[160:163], v[36:39], v[132:135]
    ds_read_b128 v[80:83], v20 offset:6144
    v_mfma_f32_16x16x32_bf16 v[136:139], a[132:135], v[40:43], v[136:139]
    v_mfma_f32_16x16x32_bf16 v[136:139], a[160:163], v[44:47], v[136:139]
    s_waitcnt lgkmcnt(2)
    buffer_load_dwordx4 a[84:87], v1, s[16:19], s80 offen offset:1024 sc1
    v_mfma_f32_16x16x32_bf16 v[140:143], a[132:135], v[48:51], v[140:143]
    s_waitcnt lgkmcnt(1)
    v_mfma_f32_16x16x32_bf16 v[140:143], a[160:163], v[52:55], v[140:143]
    ds_read_b128 v[84:87], v20 offset:7168
    v_mfma_f32_16x16x32_bf16 v[144:147], a[136:139], v[24:27], v[144:147]
    v_mfma_f32_16x16x32_bf16 v[144:147], a[164:167], v[28:31], v[144:147]
    buffer_load_dwordx4 a[88:91], v1, s[16:19], s80 offen offset:2048 sc1
    v_mfma_f32_16x16x32_bf16 v[148:151], a[136:139], v[32:35], v[148:151]
    v_mfma_f32_16x16x32_bf16 v[148:151], a[164:167], v[36:39], v[148:151]
    ds_read_b128 v[88:91], v20 offset:22528
    v_mfma_f32_16x16x32_bf16 v[152:155], a[136:139], v[40:43], v[152:155]
    v_mfma_f32_16x16x32_bf16 v[152:155], a[164:167], v[44:47], v[152:155]
    buffer_load_dwordx4 a[92:95], v1, s[16:19], s80 offen offset:3072 sc1
    v_mfma_f32_16x16x32_bf16 v[156:159], a[136:139], v[48:51], v[156:159]
    s_add_u32 s80, s80, 4096
    v_mfma_f32_16x16x32_bf16 v[156:159], a[164:167], v[52:55], v[156:159]
    ds_read_b128 v[92:95], v20 offset:23552
    v_mfma_f32_16x16x32_bf16 v[160:163], a[140:143], v[24:27], v[160:163]
    v_mfma_f32_16x16x32_bf16 v[160:163], a[168:171], v[28:31], v[160:163]
    buffer_load_dwordx4 a[96:99], v1, s[16:19], s80 offen offset:0 sc1
    v_mfma_f32_16x16x32_bf16 v[164:167], a[140:143], v[32:35], v[164:167]
    v_mfma_f32_16x16x32_bf16 v[164:167], a[168:171], v[36:39], v[164:167]
    ds_read_b128 v[96:99], v20 offset:38912
    v_mfma_f32_16x16x32_bf16 v[168:171], a[140:143], v[40:43], v[168:171]
    v_mfma_f32_16x16x32_bf16 v[168:171], a[168:171], v[44:47], v[168:171]
    buffer_load_dwordx4 a[100:103], v1, s[16:19], s80 offen offset:1024 sc1
    v_mfma_f32_16x16x32_bf16 v[172:175], a[140:143], v[48:51], v[172:175]
    v_mfma_f32_16x16x32_bf16 v[172:175], a[168:171], v[52:55], v[172:175]
    ds_read_b128 v[100:103], v20 offset:39936
    v_mfma_f32_16x16x32_bf16 v[176:179], a[144:147], v[24:27], v[176:179]
    v_mfma_f32_16x16x32_bf16 v[176:179], a[172:175], v[28:31], v[176:179]
    buffer_load_dwordx4 a[104:107], v1, s[16:19], s80 offen offset:2048 sc1
    v_mfma_f32_16x16x32_bf16 v[180:183], a[144:147], v[32:35], v[180:183]
    v_mfma_f32_16x16x32_bf16 v[180:183], a[172:175], v[36:39], v[180:183]
    ds_read_b128 v[104:107], v20 offset:55296
    v_mfma_f32_16x16x32_bf16 v[184:187], a[144:147], v[40:43], v[184:187]
    v_mfma_f32_16x16x32_bf16 v[184:187], a[172:175], v[44:47], v[184:187]
    buffer_load_dwordx4 a[128:131], v1, s[16:19], s80 offen offset:3072 sc1
    v_mfma_f32_16x16x32_bf16 v[188:191], a[144:147], v[48:51], v[188:191]
    s_add_u32 s80, s80, 4096
    v_mfma_f32_16x16x32_bf16 v[188:191], a[172:175], v[52:55], v[188:191]
    ds_read_b128 v[108:111], v20 offset:56320
    v_mfma_f32_16x16x32_bf16 v[192:195], a[148:151], v[24:27], v[192:195]
    v_mfma_f32_16x16x32_bf16 v[192:195], a[176:179], v[28:31], v[192:195]
    buffer_load_dwordx4 a[132:135], v1, s[16:19], s80 offen offset:0 sc1
    v_mfma_f32_16x16x32_bf16 v[196:199], a[148:151], v[32:35], v[196:199]
    v_mfma_f32_16x16x32_bf16 v[196:199], a[176:179], v[36:39], v[196:199]
    v_mfma_f32_16x16x32_bf16 v[200:203], a[148:151], v[40:43], v[200:203]
    v_mfma_f32_16x16x32_bf16 v[200:203], a[176:179], v[44:47], v[200:203]
    buffer_load_dwordx4 a[136:139], v1, s[16:19], s80 offen offset:1024 sc1
    v_mfma_f32_16x16x32_bf16 v[204:207], a[148:151], v[48:51], v[204:207]
    v_mfma_f32_16x16x32_bf16 v[204:207], a[176:179], v[52:55], v[204:207]
    v_mfma_f32_16x16x32_bf16 v[208:211], a[152:155], v[24:27], v[208:211]
    v_mfma_f32_16x16x32_bf16 v[208:211], a[180:183], v[28:31], v[208:211]
    buffer_load_dwordx4 a[140:143], v1, s[16:19], s80 offen offset:2048 sc1
    v_mfma_f32_16x16x32_bf16 v[212:215], a[152:155], v[32:35], v[212:215]
    v_mfma_f32_16x16x32_bf16 v[212:215], a[180:183], v[36:39], v[212:215]
    v_mfma_f32_16x16x32_bf16 v[216:219], a[152:155], v[40:43], v[216:219]
    v_mfma_f32_16x16x32_bf16 v[216:219], a[180:183], v[44:47], v[216:219]
    buffer_load_dwordx4 a[144:147], v1, s[16:19], s80 offen offset:3072 sc1
    v_mfma_f32_16x16x32_bf16 v[220:223], a[152:155], v[48:51], v[220:223]
    s_add_u32 s80, s80, 4096
    v_mfma_f32_16x16x32_bf16 v[220:223], a[180:183], v[52:55], v[220:223]
    v_mfma_f32_16x16x32_bf16 v[224:227], a[156:159], v[24:27], v[224:227]
    v_mfma_f32_16x16x32_bf16 v[224:227], a[184:187], v[28:31], v[224:227]
    buffer_load_dwordx4 a[148:151], v1, s[16:19], s80 offen offset:0 sc1
    v_mfma_f32_16x16x32_bf16 v[228:231], a[156:159], v[32:35], v[228:231]
    v_mfma_f32_16x16x32_bf16 v[228:231], a[184:187], v[36:39], v[228:231]
    v_mfma_f32_16x16x32_bf16 v[232:235], a[156:159], v[40:43], v[232:235]
    v_mfma_f32_16x16x32_bf16 v[232:235], a[184:187], v[44:47], v[232:235]
    buffer_load_dwordx4 a[152:155], v1, s[16:19], s80 offen offset:1024 sc1
    v_mfma_f32_16x16x32_bf16 v[236:239], a[156:159], v[48:51], v[236:239]
    v_mfma_f32_16x16x32_bf16 v[236:239], a[184:187], v[52:55], v[236:239]
    s_waitcnt lgkmcnt(2)
    v_mfma_f32_16x16x32_bf16 v[128:131], a[188:191], v[80:83], v[128:131]
    v_mfma_f32_16x16x32_bf16 v[128:131], a[196:199], v[84:87], v[128:131]
    buffer_load_dwordx4 a[156:159], v1, s[16:19], s80 offen offset:2048 sc1
    v_mfma_f32_16x16x32_bf16 v[132:135], a[188:191], v[88:91], v[132:135]
    s_waitcnt vmcnt(53)
    s_barrier
    v_mfma_f32_16x16x32_bf16 v[132:135], a[196:199], v[92:95], v[132:135]
    ds_read_b128 v[24:27], v20 offset:8192
    v_mfma_f32_16x16x32_bf16 v[136:139], a[188:191], v[96:99], v[136:139]
    v_mfma_f32_16x16x32_bf16 v[136:139], a[196:199], v[100:103], v[136:139]
    s_waitcnt lgkmcnt(2)
    buffer_load_dwordx4 a[160:163], v1, s[16:19], s80 offen offset:3072 sc1
    v_mfma_f32_16x16x32_bf16 v[140:143], a[188:191], v[104:107], v[140:143]
    s_branch L_ov11
L_pad11:
    s_setpc_b64 s[86:87]
L_ov11:
    s_add_u32 s80, s80, 4096
    s_waitcnt lgkmcnt(1)
    v_mfma_f32_16x16x32_bf16 v[140:143], a[196:199], v[108:111], v[140:143]
    ds_read_b128 v[28:31], v20 offset:9216
    v_mfma_f32_16x16x32_bf16 v[144:147], a[108:111], v[80:83], v[144:147]
    s_waitcnt vmcnt(48)
    v_mfma_f32_16x16x32_bf16 v[144:147], a[200:203], v[84:87], v[144:147]
    buffer_load_dwordx4 a[164:167], v1, s[16:19], s80 offen offset:0 sc1
    v_mfma_f32_16x16x32_bf16 v[148:151], a[108:111], v[88:91], v[148:151]
    v_mfma_f32_16x16x32_bf16 v[148:151], a[200:203], v[92:95], v[148:151]
    ds_read_b128 v[32:35], v20 offset:24576
    v_mfma_f32_16x16x32_bf16 v[152:155], a[108:111], v[96:99], v[152:155]
    v_mfma_f32_16x16x32_bf16 v[152:155], a[200:203], v[100:103], v[152:155]
    buffer_load_dwordx4 a[168:171], v1, s[16:19], s80 offen offset:1024 sc1
    v_mfma_f32_16x16x32_bf16 v[156:159], a[108:111], v[104:107], v[156:159]
    v_mfma_f32_16x16x32_bf16 v[156:159], a[200:203], v[108:111], v[156:159]
    ds_read_b128 v[36:39], v20 offset:25600
    v_mfma_f32_16x16x32_bf16 v[160:163], a[112:115], v[80:83], v[160:163]
    v_mfma_f32_16x16x32_bf16 v[160:163], a[204:207], v[84:87], v[160:163]
    buffer_load_dwordx4 a[172:175], v1, s[16:19], s80 offen offset:2048 sc1
    v_mfma_f32_16x16x32_bf16 v[164:167], a[112:115], v[88:91], v[164:167]
    v_mfma_f32_16x16x32_bf16 v[164:167], a[204:207], v[92:95], v[164:167]
    ds_read_b128 v[40:43], v20 offset:40960
    v_mfma_f32_16x16x32_bf16 v[168:171], a[112:115], v[96:99], v[168:171]
    v_mfma_f32_16x16x32_bf16 v[168:171], a[204:207], v[100:103], v[168:171]
    buffer_load_dwordx4 a[176:179], v1, s[16:19], s80 offen offset:3072 sc1
    v_mfma_f32_16x16x32_bf16 v[172:175], a[112:115], v[104:107], v[172:175]
    s_add_u32 s80, s80, 4096
    v_mfma_f32_16x16x32_bf16 v[172:175], a[204:207], v[108:111], v[172:175]
    ds_read_b128 v[44:47], v20 offset:41984
    v_mfma_f32_16x16x32_bf16 v[176:179], a[116:119], v[80:83], v[176:179]
    s_waitcnt vmcnt(50)
    v_mfma_f32_16x16x32_bf16 v[176:179], a[208:211], v[84:87], v[176:179]
    buffer_load_dwordx4 a[180:183], v1, s[16:19], s80 offen offset:0 sc1
    v_mfma_f32_16x16x32_bf16 v[180:183], a[116:119], v[88:91], v[180:183]
    v_mfma_f32_16x16x32_bf16 v[180:183], a[208:211], v[92:95], v[180:183]
    ds_read_b128 v[48:51], v20 offset:57344
    v_mfma_f32_16x16x32_bf16 v[184:187], a[116:119], v[96:99], v[184:187]
    v_mfma_f32_16x16x32_bf16 v[184:187], a[208:211], v[100:103], v[184:187]
    buffer_load_dwordx4 a[184:187], v1, s[16:19], s80 offen offset:1024 sc1
    v_mfma_f32_16x16x32_bf16 v[188:191], a[116:119], v[104:107], v[188:191]
    v_mfma_f32_16x16x32_bf16 v[188:191], a[208:211], v[108:111], v[188:191]
    ds_read_b128 v[52:55], v20 offset:58368
    v_mfma_f32_16x16x32_bf16 v[192:195], a[120:123], v[80:83], v[192:195]
    v_mfma_f32_16x16x32_bf16 v[192:195], a[212:215], v[84:87], v[192:195]
    buffer_load_dwordx4 a[188:191], v1, s[16:19], s80 offen offset:2048 sc1
    v_mfma_f32_16x16x32_bf16 v[196:199], a[120:123], v[88:91], v[196:199]
    v_mfma_f32_16x16x32_bf16 v[196:199], a[212:215], v[92:95], v[196:199]
    v_mfma_f32_16x16x32_bf16 v[200:203], a[120:123], v[96:99], v[200:203]
    v_mfma_f32_16x16x32_bf16 v[200:203], a[212:215], v[100:103], v[200:203]
    buffer_load_dwordx4 a[108:111], v1, s[16:19], s80 offen offset:3072 sc1
    v_mfma_f32_16x16x32_bf16 v[204:207], a[120:123], v[104:107], v[204:207]
    s_add_u32 s80, s80, 4096
    v_mfma_f32_16x16x32_bf16 v[204:207], a[212:215], v[108:111], v[204:207]
    v_mfma_f32_16x16x32_bf16 v[208:211], a[124:127], v[80:83], v[208:211]
    s_waitcnt vmcnt(52)
    v_mfma_f32_16x16x32_bf16 v[208:211], a[216:219], v[84:87], v[208:211]
    buffer_load_dwordx4 a[112:115], v1, s[16:19], s80 offen offset:0 sc1
    v_mfma_f32_16x16x32_bf16 v[212:215], a[124:127], v[88:91], v[212:215]
    v_mfma_f32_16x16x32_bf16 v[212:215], a[216:219], v[92:95], v[212:215]
    v_mfma_f32_16x16x32_bf16 v[216:219], a[124:127], v[96:99], v[216:219]
    v_mfma_f32_16x16x32_bf16 v[216:219], a[216:219], v[100:103], v[216:219]
    buffer_load_dwordx4 a[116:119], v1, s[16:19], s80 offen offset:1024 sc1
    v_mfma_f32_16x16x32_bf16 v[220:223], a[124:127], v[104:107], v[220:223]
    v_mfma_f32_16x16x32_bf16 v[220:223], a[216:219], v[108:111], v[220:223]
    v_mfma_f32_16x16x32_bf16 v[224:227], a[192:195], v[80:83], v[224:227]
    v_mfma_f32_16x16x32_bf16 v[224:227], a[220:223], v[84:87], v[224:227]
    buffer_load_dwordx4 a[120:123], v1, s[16:19], s80 offen offset:2048 sc1
    v_mfma_f32_16x16x32_bf16 v[228:231], a[192:195], v[88:91], v[228:231]
    v_mfma_f32_16x16x32_bf16 v[228:231], a[220:223], v[92:95], v[228:231]
    v_mfma_f32_16x16x32_bf16 v[232:235], a[192:195], v[96:99], v[232:235]
    v_mfma_f32_16x16x32_bf16 v[232:235], a[220:223], v[100:103], v[232:235]
    buffer_load_dwordx4 a[124:127], v1, s[16:19], s80 offen offset:3072 sc1
    v_mfma_f32_16x16x32_bf16 v[236:239], a[192:195], v[104:107], v[236:239]
    s_add_u32 s80, s80, 4096
    v_mfma_f32_16x16x32_bf16 v[236:239], a[220:223], v[108:111], v[236:239]
    s_waitcnt vmcnt(48) lgkmcnt(2)
    v_mfma_f32_16x16x32_bf16 v[128:131], a[224:227], v[24:27], v[128:131]
    v_mfma_f32_16x16x32_bf16 v[128:131], a[252:255], v[28:31], v[128:131]
    buffer_load_dwordx4 a[192:195], v1, s[16:19], s80 offen offset:0 sc1
    v_mfma_f32_16x16x32_bf16 v[132:135], a[224:227], v[32:35], v[132:135]
    v_mfma_f32_16x16x32_bf16 v[132:135], a[252:255], v[36:39], v[132:135]
    ds_read_b128 v[80:83], v20 offset:10240
    v_mfma_f32_16x16x32_bf16 v[136:139], a[224:227], v[40:43], v[136:139]
    v_mfma_f32_16x16x32_bf16 v[136:139], a[252:255], v[44:47], v[136:139]
    s_waitcnt lgkmcnt(2)
    buffer_load_dwordx4 a[196:199], v1, s[16:19], s80 offen offset:1024 sc1
    v_mfma_f32_16x16x32_bf16 v[140:143], a[224:227], v[48:51], v[140:143]
    s_waitcnt lgkmcnt(1)
    v_mfma_f32_16x16x32_bf16 v[140:143], a[252:255], v[52:55], v[140:143]
    ds_read_b128 v[84:87], v20 offset:11264
    v_mfma_f32_16x16x32_bf16 v[144:147], a[228:231], v[24:27], v[144:147]
    s_waitcnt vmcnt(48)
    v_mfma_f32_16x16x32_bf16 v[144:147], a[0:3], v[28:31], v[144:147]
    buffer_load_dwordx4 a[200:203], v1, s[16:19], s80 offen offset:2048 sc1
    v_mfma_f32_16x16x32_bf16 v[148:151], a[228:231], v[32:35], v[148:151]
    v_mfma_f32_16x16x32_bf16 v[148:151], a[0:3], v[36:39], v[148:151]
    ds_read_b128 v[88:91], v20 offset:26624
    v_mfma_f32_16x16x32_bf16 v[152:155], a[228:231], v[40:43], v[152:155]
    v_mfma_f32_16x16x32_bf16 v[152:155], a[0:3], v[44:47], v[152:155]
    buffer_load_dwordx4 a[204:207], v1, s[16:19], s80 offen offset:3072 sc1
    v_mfma_f32_16x16x32_bf16 v[156:159], a[228:231], v[48:51], v[156:159]
    s_add_u32 s80, s80, 4096
    v_mfma_f32_16x16x32_bf16 v[156:159], a[0:3], v[52:55], v[156:159]
    ds_read_b128 v[92:95], v20 offset:27648
    v_mfma_f32_16x16x32_bf16 v[160:163], a[232:235], v[24:27], v[160:163]
    v_mfma_f32_16x16x32_bf16 v[160:163], a[4:7], v[28:31], v[160:163]
    buffer_load_dwordx4 a[208:211], v1, s[16:19], s80 offen offset:0 sc1
    v_mfma_f32_16x16x32_bf16 v[164:167], a[232:235], v[32:35], v[164:167]
    v_mfma_f32_16x16x32_bf16 v[164:167], a[4:7], v[36:39], v[164:167]
    ds_read_b128 v[96:99], v20 offset:43008
    v_mfma_f32_16x16x32_bf16 v[168:171], a[232:235], v[40:43], v[168:171]
    v_mfma_f32_16x16x32_bf16 v[168:171], a[4:7], v[44:47], v[168:171]
    buffer_load_dwordx4 a[212:215], v1, s[16:19], s80 offen offset:1024 sc1
    v_mfma_f32_16x16x32_bf16 v[172:175], a[232:235], v[48:51], v[172:175]
    v_mfma_f32_16x16x32_bf16 v[172:175], a[4:7], v[52:55], v[172:175]
    ds_read_b128 v[100:103], v20 offset:44032
    v_mfma_f32_16x16x32_bf16 v[176:179], a[236:239], v[24:27], v[176:179]
    s_waitcnt vmcnt(50)
    v_mfma_f32_16x16x32_bf16 v[176:179], a[8:11], v[28:31], v[176:179]
    buffer_load_dwordx4 a[216:219], v1, s[16:19], s80 offen offset:2048 sc1
    v_mfma_f32_16x16x32_bf16 v[180:183], a[236:239], v[32:35], v[180:183]
    v_mfma_f32_16x16x32_bf16 v[180:183], a[8:11], v[36:39], v[180:183]
    ds_read_b128 v[104:107], v20 offset:59392
    v_mfma_f32_16x16x32_bf16 v[184:187], a[236:239], v[40:43], v[184:187]
    v_mfma_f32_16x16x32_bf16 v[184:187], a[8:11], v[44:47], v[184:187]
    buffer_load_dwordx4 a[220:223], v1, s[16:19], s80 offen offset:3072 sc1
    v_mfma_f32_16x16x32_bf16 v[188:191], a[236:239], v[48:51], v[188:191]
    s_add_u32 s80, s80, 4096
    v_mfma_f32_16x16x32_bf16 v[188:191], a[8:11], v[52:55], v[188:191]
    ds_read_b128 v[108:111], v20 offset:60416
    v_mfma_f32_16x16x32_bf16 v[192:195], a[240:243], v[24:27], v[192:195]
    v_mfma_f32_16x16x32_bf16 v[192:195], a[12:15], v[28:31], v[192:195]
    buffer_load_dwordx4 a[224:227], v1, s[16:19], s80 offen offset:0 sc1
    v_mfma_f32_16x16x32_bf16 v[196:199], a[240:243], v[32:35], v[196:199]
    v_mfma_f32_16x16x32_bf16 v[196:199], a[12:15], v[36:39], v[196:199]
    v_mfma_f32_16x16x32_bf16 v[200:203], a[240:243], v[40:43], v[200:203]
    v_mfma_f32_16x16x32_bf16 v[200:203], a[12:15], v[44:47], v[200:203]
    buffer_load_dwordx4 a[228:231], v1, s[16:19], s80 offen offset:1024 sc1
    v_mfma_f32_16x16x32_bf16 v[204:207], a[240:243], v[48:51], v[204:207]
    v_mfma_f32_16x16x32_bf16 v[204:207], a[12:15], v[52:55], v[204:207]
    v_mfma_f32_16x16x32_bf16 v[208:211], a[244:247], v[24:27], v[208:211]
    s_waitcnt vmcnt(52)
    v_mfma_f32_16x16x32_bf16 v[208:211], a[16:19], v[28:31], v[208:211]
    buffer_load_dwordx4 a[232:235], v1, s[16:19], s80 offen offset:2048 sc1
    v_mfma_f32_16x16x32_bf16 v[212:215], a[244:247], v[32:35], v[212:215]
    v_mfma_f32_16x16x32_bf16 v[212:215], a[16:19], v[36:39], v[212:215]
    v_mfma_f32_16x16x32_bf16 v[216:219], a[244:247], v[40:43], v[216:219]
    v_mfma_f32_16x16x32_bf16 v[216:219], a[16:19], v[44:47], v[216:219]
    buffer_load_dwordx4 a[236:239], v1, s[16:19], s80 offen offset:3072 sc1
    v_mfma_f32_16x16x32_bf16 v[220:223], a[244:247], v[48:51], v[220:223]
    s_add_u32 s80, s80, 4096
    v_mfma_f32_16x16x32_bf16 v[220:223], a[16:19], v[52:55], v[220:223]
    v_mfma_f32_16x16x32_bf16 v[224:227], a[248:251], v[24:27], v[224:227]
    v_mfma_f32_16x16x32_bf16 v[224:227], a[20:23], v[28:31], v[224:227]
    buffer_load_dwordx4 a[240:243], v1, s[16:19], s80 offen offset:0 sc1
    v_mfma_f32_16x16x32_bf16 v[228:231], a[248:251], v[32:35], v[228:231]
    v_mfma_f32_16x16x32_bf16 v[228:231], a[20:23], v[36:39], v[228:231]
    v_mfma_f32_16x16x32_bf16 v[232:235], a[248:251], v[40:43], v[232:235]
    v_mfma_f32_16x16x32_bf16 v[232:235], a[20:23], v[44:47], v[232:235]
    buffer_load_dwordx4 a[244:247], v1, s[16:19], s80 offen offset:1024 sc1
    v_mfma_f32_16x16x32_bf16 v[236:239], a[248:251], v[48:51], v[236:239]
    v_mfma_f32_16x16x32_bf16 v[236:239], a[20:23], v[52:55], v[236:239]
    s_waitcnt vmcnt(48) lgkmcnt(2)
    v_mfma_f32_16x16x32_bf16 v[128:131], a[24:27], v[80:83], v[128:131]
    v_mfma_f32_16x16x32_bf16 v[128:131], a[52:55], v[84:87], v[128:131]
    buffer_load_dwordx4 a[248:251], v1, s[16:19], s80 offen offset:2048 sc1
    v_mfma_f32_16x16x32_bf16 v[132:135], a[24:27], v[88:91], v[132:135]
    s_waitcnt vmcnt(63)
    s_barrier
    v_mfma_f32_16x16x32_bf16 v[132:135], a[52:55], v[92:95], v[132:135]
    ds_read_b128 v[24:27], v20 offset:12288
    v_mfma_f32_16x16x32_bf16 v[136:139], a[24:27], v[96:99], v[136:139]
    v_mfma_f32_16x16x32_bf16 v[136:139], a[52:55], v[100:103], v[136:139]
    s_waitcnt lgkmcnt(2)
    buffer_load_dwordx4 a[252:255], v1, s[16:19], s80 offen offset:3072 sc1
    v_mfma_f32_16x16x32_bf16 v[140:143], a[24:27], v[104:107], v[140:143]
    s_add_u32 s80, s80, 4096
    s_waitcnt lgkmcnt(1)
    v_mfma_f32_16x16x32_bf16 v[140:143], a[52:55], v[108:111], v[140:143]
    ds_read_b128 v[28:31], v20 offset:13312
    v_mfma_f32_16x16x32_bf16 v[144:147], a[28:31], v[80:83], v[144:147]
    s_waitcnt vmcnt(48)
    v_mfma_f32_16x16x32_bf16 v[144:147], a[56:59], v[84:87], v[144:147]
    buffer_load_dwordx4 a[0:3], v1, s[16:19], s80 offen offset:0 sc1
    v_mfma_f32_16x16x32_bf16 v[148:151], a[28:31], v[88:91], v[148:151]
    v_mfma_f32_16x16x32_bf16 v[148:151], a[56:59], v[92:95], v[148:151]
    ds_read_b128 v[32:35], v20 offset:28672
    v_mfma_f32_16x16x32_bf16 v[152:155], a[28:31], v[96:99], v[152:155]
    v_mfma_f32_16x16x32_bf16 v[152:155], a[56:59], v[100:103], v[152:155]
    buffer_load_dwordx4 a[4:7], v1, s[16:19], s80 offen offset:1024 sc1
    v_mfma_f32_16x16x32_bf16 v[156:159], a[28:31], v[104:107], v[156:159]
    v_mfma_f32_16x16x32_bf16 v[156:159], a[56:59], v[108:111], v[156:159]
    ds_read_b128 v[36:39], v20 offset:29696
    v_mfma_f32_16x16x32_bf16 v[160:163], a[32:35], v[80:83], v[160:163]
    v_mfma_f32_16x16x32_bf16 v[160:163], a[60:63], v[84:87], v[160:163]
    buffer_load_dwordx4 a[8:11], v1, s[16:19], s80 offen offset:2048 sc1
    v_mfma_f32_16x16x32_bf16 v[164:167], a[32:35], v[88:91], v[164:167]
    v_mfma_f32_16x16x32_bf16 v[164:167], a[60:63], v[92:95], v[164:167]
    ds_read_b128 v[40:43], v20 offset:45056
    v_mfma_f32_16x16x32_bf16 v[168:171], a[32:35], v[96:99], v[168:171]
    v_mfma_f32_16x16x32_bf16 v[168:171], a[60:63], v[100:103], v[168:171]
    buffer_load_dwordx4 a[12:15], v1, s[16:19], s80 offen offset:3072 sc1
    v_mfma_f32_16x16x32_bf16 v[172:175], a[32:35], v[104:107], v[172:175]
    s_add_u32 s80, s80, 4096
    v_mfma_f32_16x16x32_bf16 v[172:175], a[60:63], v[108:111], v[172:175]
    ds_read_b128 v[44:47], v20 offset:46080
    v_mfma_f32_16x16x32_bf16 v[176:179], a[36:39], v[80:83], v[176:179]
    s_waitcnt vmcnt(50)
    v_mfma_f32_16x16x32_bf16 v[176:179], a[64:67], v[84:87], v[176:179]
    buffer_load_dwordx4 a[16:19], v1, s[16:19], s80 offen offset:0 sc1
    v_mfma_f32_16x16x32_bf16 v[180:183], a[36:39], v[88:91], v[180:183]
    v_mfma_f32_16x16x32_bf16 v[180:183], a[64:67], v[92:95], v[180:183]
    ds_read_b128 v[48:51], v20 offset:61440
    v_mfma_f32_16x16x32_bf16 v[184:187], a[36:39], v[96:99], v[184:187]
    v_mfma_f32_16x16x32_bf16 v[184:187], a[64:67], v[100:103], v[184:187]
    buffer_load_dwordx4 a[20:23], v1, s[16:19], s80 offen offset:1024 sc1
    v_mfma_f32_16x16x32_bf16 v[188:191], a[36:39], v[104:107], v[188:191]
    v_mfma_f32_16x16x32_bf16 v[188:191], a[64:67], v[108:111], v[188:191]
    ds_read_b128 v[52:55], v20 offset:62464
    v_mfma_f32_16x16x32_bf16 v[192:195], a[40:43], v[80:83], v[192:195]
    v_mfma_f32_16x16x32_bf16 v[192:195], a[68:71], v[84:87], v[192:195]
    buffer_load_dwordx4 a[24:27], v1, s[16:19], s80 offen offset:2048 sc1
    v_mfma_f32_16x16x32_bf16 v[196:199], a[40:43], v[88:91], v[196:199]
    v_mfma_f32_16x16x32_bf16 v[196:199], a[68:71], v[92:95], v[196:199]
    v_mfma_f32_16x16x32_bf16 v[200:203], a[40:43], v[96:99], v[200:203]
    v_mfma_f32_16x16x32_bf16 v[200:203], a[68:71], v[100:103], v[200:203]
    buffer_load_dwordx4 a[28:31], v1, s[16:19], s80 offen offset:3072 sc1
    v_mfma_f32_16x16x32_bf16 v[204:207], a[40:43], v[104:107], v[204:207]
    s_add_u32 s80, s80, 4096
    v_mfma_f32_16x16x32_bf16 v[204:207], a[68:71], v[108:111], v[204:207]
    v_mfma_f32_16x16x32_bf16 v[208:211], a[44:47], v[80:83], v[208:211]
    s_waitcnt vmcnt(52)
    v_mfma_f32_16x16x32_bf16 v[208:211], a[72:75], v[84:87], v[208:211]
    buffer_load_dwordx4 a[32:35], v1, s[16:19], s80 offen offset:0 sc1
    v_mfma_f32_16x16x32_bf16 v[212:215], a[44:47], v[88:91], v[212:215]
    v_mfma_f32_16x16x32_bf16 v[212:215], a[72:75], v[92:95], v[212:215]
    v_mfma_f32_16x16x32_bf16 v[216:219], a[44:47], v[96:99], v[216:219]
    v_mfma_f32_16x16x32_bf16 v[216:219], a[72:75], v[100:103], v[216:219]
    buffer_load_dwordx4 a[36:39], v1, s[16:19], s80 offen offset:1024 sc1
    v_mfma_f32_16x16x32_bf16 v[220:223], a[44:47], v[104:107], v[220:223]
    v_mfma_f32_16x16x32_bf16 v[220:223], a[72:75], v[108:111], v[220:223]
    v_mfma_f32_16x16x32_bf16 v[224:227], a[48:51], v[80:83], v[224:227]
    v_mfma_f32_16x16x32_bf16 v[224:227], a[76:79], v[84:87], v[224:227]
    buffer_load_dwordx4 a[40:43], v1, s[16:19], s80 offen offset:2048 sc1
    v_mfma_f32_16x16x32_bf16 v[228:231], a[48:51], v[88:91], v[228:231]
    v_mfma_f32_16x16x32_bf16 v[228:231], a[76:79], v[92:95], v[228:231]
    v_mfma_f32_16x16x32_bf16 v[232:235], a[48:51], v[96:99], v[232:235]
    v_mfma_f32_16x16x32_bf16 v[232:235], a[76:79], v[100:103], v[232:235]
    buffer_load_dwordx4 a[44:47], v1, s[16:19], s80 offen offset:3072 sc1
    v_mfma_f32_16x16x32_bf16 v[236:239], a[48:51], v[104:107], v[236:239]
    s_add_u32 s80, s80, 4096
    v_mfma_f32_16x16x32_bf16 v[236:239], a[76:79], v[108:111], v[236:239]
    s_waitcnt vmcnt(48) lgkmcnt(2)
    v_mfma_f32_16x16x32_bf16 v[128:131], a[80:83], v[24:27], v[128:131]
    v_mfma_f32_16x16x32_bf16 v[128:131], a[128:131], v[28:31], v[128:131]
    buffer_load_dwordx4 a[48:51], v1, s[16:19], s80 offen offset:0 sc1
    v_mfma_f32_16x16x32_bf16 v[132:135], a[80:83], v[32:35], v[132:135]
    v_mfma_f32_16x16x32_bf16 v[132:135], a[128:131], v[36:39], v[132:135]
    ds_read_b128 v[80:83], v20 offset:14336
    v_mfma_f32_16x16x32_bf16 v[136:139], a[80:83], v[40:43], v[136:139]
    v_mfma_f32_16x16x32_bf16 v[136:139], a[128:131], v[44:47], v[136:139]
    s_waitcnt lgkmcnt(2)
    buffer_load_dwordx4 a[52:55], v1, s[16:19], s80 offen offset:1024 sc1
    v_mfma_f32_16x16x32_bf16 v[140:143], a[80:83], v[48:51], v[140:143]
    s_waitcnt lgkmcnt(1)
    v_mfma_f32_16x16x32_bf16 v[140:143], a[128:131], v[52:55], v[140:143]
    ds_read_b128 v[84:87], v20 offset:15360
    v_mfma_f32_16x16x32_bf16 v[144:147], a[84:87], v[24:27], v[144:147]
    s_waitcnt vmcnt(48)
    v_mfma_f32_16x16x32_bf16 v[144:147], a[132:135], v[28:31], v[144:147]
    buffer_load_dwordx4 a[56:59], v1, s[16:19], s80 offen offset:2048 sc1
    v_mfma_f32_16x16x32_bf16 v[148:151], a[84:87], v[32:35], v[148:151]
    v_mfma_f32_16x16x32_bf16 v[148:151], a[132:135], v[36:39], v[148:151]
    ds_read_b128 v[88:91], v20 offset:30720
    v_mfma_f32_16x16x32_bf16 v[152:155], a[84:87], v[40:43], v[152:155]
    v_mfma_f32_16x16x32_bf16 v[152:155], a[132:135], v[44:47], v[152:155]
    buffer_load_dwordx4 a[60:63], v1, s[16:19], s80 offen offset:3072 sc1
    v_mfma_f32_16x16x32_bf16 v[156:159], a[84:87], v[48:51], v[156:159]
    s_add_u32 s80, s80, 4096
    v_mfma_f32_16x16x32_bf16 v[156:159], a[132:135], v[52:55], v[156:159]
    ds_read_b128 v[92:95], v20 offset:31744
    v_mfma_f32_16x16x32_bf16 v[160:163], a[88:91], v[24:27], v[160:163]
    v_mfma_f32_16x16x32_bf16 v[160:163], a[136:139], v[28:31], v[160:163]
    buffer_load_dwordx4 a[64:67], v1, s[16:19], s80 offen offset:0 sc1
    v_mfma_f32_16x16x32_bf16 v[164:167], a[88:91], v[32:35], v[164:167]
    v_mfma_f32_16x16x32_bf16 v[164:167], a[136:139], v[36:39], v[164:167]
    ds_read_b128 v[96:99], v20 offset:47104
    v_mfma_f32_16x16x32_bf16 v[168:171], a[88:91], v[40:43], v[168:171]
    v_mfma_f32_16x16x32_bf16 v[168:171], a[136:139], v[44:47], v[168:171]
    buffer_load_dwordx4 a[68:71], v1, s[16:19], s80 offen offset:1024 sc1
    v_mfma_f32_16x16x32_bf16 v[172:175], a[88:91], v[48:51], v[172:175]
    v_mfma_f32_16x16x32_bf16 v[172:175], a[136:139], v[52:55], v[172:175]
    ds_read_b128 v[100:103], v20 offset:48128
    v_mfma_f32_16x16x32_bf16 v[176:179], a[92:95], v[24:27], v[176:179]
    s_waitcnt vmcnt(50)
    v_mfma_f32_16x16x32_bf16 v[176:179], a[140:143], v[28:31], v[176:179]
    buffer_load_dwordx4 a[72:75], v1, s[16:19], s80 offen offset:2048 sc1
    v_mfma_f32_16x16x32_bf16 v[180:183], a[92:95], v[32:35], v[180:183]
    v_mfma_f32_16x16x32_bf16 v[180:183], a[140:143], v[36:39], v[180:183]
    ds_read_b128 v[104:107], v20 offset:63488
    v_mfma_f32_16x16x32_bf16 v[184:187], a[92:95], v[40:43], v[184:187]
    v_mfma_f32_16x16x32_bf16 v[184:187], a[140:143], v[44:47], v[184:187]
    buffer_load_dwordx4 a[76:79], v1, s[16:19], s80 offen offset:3072 sc1
    v_mfma_f32_16x16x32_bf16 v[188:191], a[92:95], v[48:51], v[188:191]
    s_add_u32 s80, s80, 4096
    v_mfma_f32_16x16x32_bf16 v[188:191], a[140:143], v[52:55], v[188:191]
    ds_read_b128 v[108:111], v20 offset:64512
    v_mfma_f32_16x16x32_bf16 v[192:195], a[96:99], v[24:27], v[192:195]
    v_mfma_f32_16x16x32_bf16 v[192:195], a[144:147], v[28:31], v[192:195]
    buffer_load_dwordx4 a[80:83], v1, s[16:19], s80 offen offset:0 sc1
    v_mfma_f32_16x16x32_bf16 v[196:199], a[96:99], v[32:35], v[196:199]
    v_mfma_f32_16x16x32_bf16 v[196:199], a[144:147], v[36:39], v[196:199]
    v_mfma_f32_16x16x32_bf16 v[200:203], a[96:99], v[40:43], v[200:203]
    v_mfma_f32_16x16x32_bf16 v[200:203], a[144:147], v[44:47], v[200:203]
    buffer_load_dwordx4 a[84:87], v1, s[16:19], s80 offen offset:1024 sc1
    v_mfma_f32_16x16x32_bf16 v[204:207], a[96:99], v[48:51], v[204:207]
    v_mfma_f32_16x16x32_bf16 v[204:207], a[144:147], v[52:55], v[204:207]
    v_mfma_f32_16x16x32_bf16 v[208:211], a[100:103], v[24:27], v[208:211]
    s_waitcnt vmcnt(52)
    v_mfma_f32_16x16x32_bf16 v[208:211], a[148:151], v[28:31], v[208:211]
    buffer_load_dwordx4 a[88:91], v1, s[16:19], s80 offen offset:2048 sc1
    v_mfma_f32_16x16x32_bf16 v[212:215], a[100:103], v[32:35], v[212:215]
    v_mfma_f32_16x16x32_bf16 v[212:215], a[148:151], v[36:39], v[212:215]
    v_mfma_f32_16x16x32_bf16 v[216:219], a[100:103], v[40:43], v[216:219]
    v_mfma_f32_16x16x32_bf16 v[216:219], a[148:151], v[44:47], v[216:219]
    buffer_load_dwordx4 a[92:95], v1, s[16:19], s80 offen offset:3072 sc1
    v_mfma_f32_16x16x32_bf16 v[220:223], a[100:103], v[48:51], v[220:223]
    s_add_u32 s80, s80, 4096
    v_mfma_f32_16x16x32_bf16 v[220:223], a[148:151], v[52:55], v[220:223]
    v_mfma_f32_16x16x32_bf16 v[224:227], a[104:107], v[24:27], v[224:227]
    v_mfma_f32_16x16x32_bf16 v[224:227], a[152:155], v[28:31], v[224:227]
    buffer_load_dwordx4 a[96:99], v1, s[16:19], s80 offen offset:0 sc1
    v_mfma_f32_16x16x32_bf16 v[228:231], a[104:107], v[32:35], v[228:231]
    v_mfma_f32_16x16x32_bf16 v[228:231], a[152:155], v[36:39], v[228:231]
    v_mfma_f32_16x16x32_bf16 v[232:235], a[104:107], v[40:43], v[232:235]
    v_mfma_f32_16x16x32_bf16 v[232:235], a[152:155], v[44:47], v[232:235]
    buffer_load_dwordx4 a[100:103], v1, s[16:19], s80 offen offset:1024 sc1
    v_mfma_f32_16x16x32_bf16 v[236:239], a[104:107], v[48:51], v[236:239]
    v_mfma_f32_16x16x32_bf16 v[236:239], a[152:155], v[52:55], v[236:239]
    s_waitcnt vmcnt(48) lgkmcnt(2)
    v_mfma_f32_16x16x32_bf16 v[128:131], a[156:159], v[80:83], v[128:131]
    v_mfma_f32_16x16x32_bf16 v[128:131], a[184:187], v[84:87], v[128:131]
    buffer_load_dwordx4 a[104:107], v1, s[16:19], s80 offen offset:2048 sc1
    v_mfma_f32_16x16x32_bf16 v[132:135], a[156:159], v[88:91], v[132:135]
    v_mfma_f32_16x16x32_bf16 v[132:135], a[184:187], v[92:95], v[132:135]
    v_mfma_f32_16x16x32_bf16 v[136:139], a[156:159], v[96:99], v[136:139]
    v_mfma_f32_16x16x32_bf16 v[136:139], a[184:187], v[100:103], v[136:139]
    s_waitcnt lgkmcnt(1)
    buffer_load_dwordx4 a[128:131], v1, s[16:19], s80 offen offset:3072 sc1
    v_mfma_f32_16x16x32_bf16 v[140:143], a[156:159], v[104:107], v[140:143]
    s_add_u32 s80, s80, 4096
    s_waitcnt lgkmcnt(0)
    v_mfma_f32_16x16x32_bf16 v[140:143], a[184:187], v[108:111], v[140:143]
    v_mfma_f32_16x16x32_bf16 v[144:147], a[160:163], v[80:83], v[144:147]
    s_waitcnt vmcnt(48)
    v_mfma_f32_16x16x32_bf16 v[144:147], a[188:191], v[84:87], v[144:147]
    buffer_load_dwordx4 a[132:135], v1, s[16:19], s80 offen offset:0 sc1
    v_mfma_f32_16x16x32_bf16 v[148:151], a[160:163], v[88:91], v[148:151]
    v_mfma_f32_16x16x32_bf16 v[148:151], a[188:191], v[92:95], v[148:151]
    v_mfma_f32_16x16x32_bf16 v[152:155], a[160:163], v[96:99], v[152:155]
    v_mfma_f32_16x16x32_bf16 v[152:155], a[188:191], v[100:103], v[152:155]
    buffer_load_dwordx4 a[136:139], v1, s[16:19], s80 offen offset:1024 sc1
    v_mfma_f32_16x16x32_bf16 v[156:159], a[160:163], v[104:107], v[156:159]
    v_mfma_f32_16x16x32_bf16 v[156:159], a[188:191], v[108:111], v[156:159]
    v_mfma_f32_16x16x32_bf16 v[160:163], a[164:167], v[80:83], v[160:163]
    v_mfma_f32_16x16x32_bf16 v[160:163], a[108:111], v[84:87], v[160:163]
    buffer_load_dwordx4 a[140:143], v1, s[16:19], s80 offen offset:2048 sc1
    v_mfma_f32_16x16x32_bf16 v[164:167], a[164:167], v[88:91], v[164:167]
    v_mfma_f32_16x16x32_bf16 v[164:167], a[108:111], v[92:95], v[164:167]
    v_mfma_f32_16x16x32_bf16 v[168:171], a[164:167], v[96:99], v[168:171]
    v_mfma_f32_16x16x32_bf16 v[168:171], a[108:111], v[100:103], v[168:171]
    buffer_load_dwordx4 a[144:147], v1, s[16:19], s80 offen offset:3072 sc1
    v_mfma_f32_16x16x32_bf16 v[172:175], a[164:167], v[104:107], v[172:175]
    s_add_u32 s80, s80, 4096
    v_mfma_f32_16x16x32_bf16 v[172:175], a[108:111], v[108:111], v[172:175]
    v_mfma_f32_16x16x32_bf16 v[176:179], a[168:171], v[80:83], v[176:179]
    s_waitcnt vmcnt(50)
    v_mfma_f32_16x16x32_bf16 v[176:179], a[112:115], v[84:87], v[176:179]
    buffer_load_dwordx4 a[148:151], v1, s[16:19], s80 offen offset:0 sc1
    v_mfma_f32_16x16x32_bf16 v[180:183], a[168:171], v[88:91], v[180:183]
    v_mfma_f32_16x16x32_bf16 v[180:183], a[112:115], v[92:95], v[180:183]
    v_mfma_f32_16x16x32_bf16 v[184:187], a[168:171], v[96:99], v[184:187]
    v_mfma_f32_16x16x32_bf16 v[184:187], a[112:115], v[100:103], v[184:187]
    buffer_load_dwordx4 a[152:155], v1, s[16:19], s80 offen offset:1024 sc1
    v_mfma_f32_16x16x32_bf16 v[188:191], a[168:171], v[104:107], v[188:191]
    v_mfma_f32_16x16x32_bf16 v[188:191], a[112:115], v[108:111], v[188:191]
    v_mfma_f32_16x16x32_bf16 v[192:195], a[172:175], v[80:83], v[192:195]
    v_mfma_f32_16x16x32_bf16 v[192:195], a[116:119], v[84:87], v[192:195]
    buffer_load_dwordx4 a[156:159], v1, s[16:19], s80 offen offset:2048 sc1
    v_mfma_f32_16x16x32_bf16 v[196:199], a[172:175], v[88:91], v[196:199]
    v_mfma_f32_16x16x32_bf16 v[196:199], a[116:119], v[92:95], v[196:199]
    v_mfma_f32_16x16x32_bf16 v[200:203], a[172:175], v[96:99], v[200:203]
    v_mfma_f32_16x16x32_bf16 v[200:203], a[116:119], v[100:103], v[200:203]
    buffer_load_dwordx4 a[160:163], v1, s[16:19], s80 offen offset:3072 sc1
    v_mfma_f32_16x16x32_bf16 v[204:207], a[172:175], v[104:107], v[204:207]
    s_add_u32 s80, s80, 4096
    v_mfma_f32_16x16x32_bf16 v[204:207], a[116:119], v[108:111], v[204:207]
    v_mfma_f32_16x16x32_bf16 v[208:211], a[176:179], v[80:83], v[208:211]
    s_waitcnt vmcnt(52)
    v_mfma_f32_16x16x32_bf16 v[208:211], a[120:123], v[84:87], v[208:211]
    buffer_load_dwordx4 a[164:167], v1, s[16:19], s80 offen offset:0 sc1
    v_mfma_f32_16x16x32_bf16 v[212:215], a[176:179], v[88:91], v[212:215]
    v_mfma_f32_16x16x32_bf16 v[212:215], a[120:123], v[92:95], v[212:215]
    v_mfma_f32_16x16x32_bf16 v[216:219], a[176:179], v[96:99], v[216:219]
    v_mfma_f32_16x16x32_bf16 v[216:219], a[120:123], v[100:103], v[216:219]
    buffer_load_dwordx4 a[168:171], v1, s[16:19], s80 offen offset:1024 sc1
    v_mfma_f32_16x16x32_bf16 v[220:223], a[176:179], v[104:107], v[220:223]
    v_mfma_f32_16x16x32_bf16 v[220:223], a[120:123], v[108:111], v[220:223]
    v_mfma_f32_16x16x32_bf16 v[224:227], a[180:183], v[80:83], v[224:227]
    v_mfma_f32_16x16x32_bf16 v[224:227], a[124:127], v[84:87], v[224:227]
    buffer_load_dwordx4 a[172:175], v1, s[16:19], s80 offen offset:2048 sc1
    v_mfma_f32_16x16x32_bf16 v[228:231], a[180:183], v[88:91], v[228:231]
    v_mfma_f32_16x16x32_bf16 v[228:231], a[124:127], v[92:95], v[228:231]
    v_mfma_f32_16x16x32_bf16 v[232:235], a[180:183], v[96:99], v[232:235]
    v_mfma_f32_16x16x32_bf16 v[232:235], a[124:127], v[100:103], v[232:235]
    buffer_load_dwordx4 a[176:179], v1, s[16:19], s80 offen offset:3072 sc1
    v_mfma_f32_16x16x32_bf16 v[236:239], a[180:183], v[104:107], v[236:239]
    s_add_u32 s80, s80, 4096
    v_mfma_f32_16x16x32_bf16 v[236:239], a[124:127], v[108:111], v[236:239]
    v_max_f32 v128, 0, v128
    v_max_f32 v129, 0, v129
    v_max_f32 v144, 0, v144
    v_max_f32 v145, 0, v145
    v_max_f32 v160, 0, v160
    v_max_f32 v161, 0, v161
    v_max_f32 v176, 0, v176
    v_max_f32 v177, 0, v177
    v_max_f32 v192, 0, v192
    v_max_f32 v193, 0, v193
    v_max_f32 v208, 0, v208
    v_max_f32 v209, 0, v209
    v_max_f32 v224, 0, v224
    v_max_f32 v225, 0, v225
    v_pk_mul_f32 v[128:129], v[128:129], v[130:131]
    v_pk_mul_f32 v[144:145], v[144:145], v[146:147]
    v_pk_mul_f32 v[160:161], v[160:161], v[162:163]
    v_pk_mul_f32 v[176:177], v[176:177], v[178:179]
    v_pk_mul_f32 v[192:193], v[192:193], v[194:195]
    v_pk_mul_f32 v[208:209], v[208:209], v[210:211]
    v_pk_mul_f32 v[224:225], v[224:225], v[226:227]
    v_cvt_pk_bf16_f32 v128, v128, v129
    v_cvt_pk_bf16_f32 v144, v144, v145
    v_cvt_pk_bf16_f32 v160, v160, v161
    v_cvt_pk_bf16_f32 v176, v176, v177
    v_cvt_pk_bf16_f32 v192, v192, v193
    v_cvt_pk_bf16_f32 v208, v208, v209
    v_cvt_pk_bf16_f32 v224, v224, v225
    ds_write_b32 v21, v128 offset:0
    ds_write_b32 v21, v144 offset:4096
    ds_write_b32 v21, v160 offset:8192
    ds_write_b32 v21, v176 offset:12288
    ds_write_b32 v21, v192 offset:16384
    ds_write_b32 v21, v208 offset:20480
    ds_write_b32 v21, v224 offset:24576
    s_waitcnt lgkmcnt(0)
    s_barrier
    ds_read_b128 v[24:27], v23 offset:0
    ds_read_b128 v[28:31], v23 offset:4096
    ds_read_b128 v[32:35], v23 offset:8192
    ds_read_b128 v[36:39], v23 offset:12288
    ds_read_b128 v[40:43], v23 offset:16384
    ds_read_b128 v[44:47], v23 offset:20480
    ds_read_b128 v[48:51], v23 offset:24576
    s_waitcnt vmcnt(47) lgkmcnt(5)
    v_mfma_f32_16x16x32_bf16 v[128:131], a[192:195], v[24:27], 0
    v_max_f32 v132, 0, v132
    v_max_f32 v133, 0, v133
    v_mfma_f32_16x16x32_bf16 v[144:147], a[196:199], v[24:27], 0
    v_mul_f32 v132, v132, v134
    v_mul_f32 v133, v133, v135
    v_mfma_f32_16x16x32_bf16 v[160:163], a[200:203], v[24:27], 0
    v_cvt_pk_bf16_f32 v132, v132, v133
    v_mfma_f32_16x16x32_bf16 v[176:179], a[204:207], v[24:27], 0
    ds_write_b32 v21, v132 offset:1024
    v_mfma_f32_16x16x32_bf16 v[192:195], a[208:211], v[24:27], 0
    v_mfma_f32_16x16x32_bf16 v[208:211], a[212:215], v[24:27], 0
    v_max_f32 v148, 0, v148
    v_max_f32 v149, 0, v149
    v_mfma_f32_16x16x32_bf16 v[224:227], a[216:219], v[24:27], 0
    v_mul_f32 v148, v148, v150
    v_mul_f32 v149, v149, v151
    v_mfma_f32_16x16x32_bf16 v[240:243], a[220:223], v[24:27], 0
    v_cvt_pk_bf16_f32 v148, v148, v149
    v_mfma_f32_16x16x32_bf16 v[128:131], a[224:227], v[28:31], v[128:131]
    s_waitcnt vmcnt(38)
    ds_write_b32 v21, v148 offset:5120
    v_mfma_f32_16x16x32_bf16 v[144:147], a[228:231], v[28:31], v[144:147]
    v_mfma_f32_16x16x32_bf16 v[160:163], a[232:235], v[28:31], v[160:163]
    v_max_f32 v164, 0, v164
    v_max_f32 v165, 0, v165
    v_mfma_f32_16x16x32_bf16 v[176:179], a[236:239], v[28:31], v[176:179]
    v_mul_f32 v164, v164, v166
    v_mul_f32 v165, v165, v167
    v_mfma_f32_16x16x32_bf16 v[192:195], a[240:243], v[28:31], v[192:195]
    v_cvt_pk_bf16_f32 v164, v164, v165
    v_mfma_f32_16x16x32_bf16 v[208:211], a[244:247], v[28:31], v[208:211]
    ds_write_b32 v21, v164 offset:9216
    v_mfma_f32_16x16x32_bf16 v[224:227], a[248:251], v[28:31], v[224:227]
    v_mfma_f32_16x16x32_bf16 v[240:243], a[252:255], v[28:31], v[240:243]
    s_waitcnt lgkmcnt(6)
    v_max_f32 v180, 0, v180
    v_max_f32 v181, 0, v181
    v_mfma_f32_16x16x32_bf16 v[128:131], a[0:3], v[32:35], v[128:131]
    v_mul_f32 v180, v180, v182
    v_mul_f32 v181, v181, v183
    v_mfma_f32_16x16x32_bf16 v[144:147], a[4:7], v[32:35], v[144:147]
    s_waitcnt vmcnt(29)
    v_cvt_pk_bf16_f32 v180, v180, v181
    v_mfma_f32_16x16x32_bf16 v[160:163], a[8:11], v[32:35], v[160:163]
    ds_write_b32 v21, v180 offset:13312
    v_mfma_f32_16x16x32_bf16 v[176:179], a[12:15], v[32:35], v[176:179]
    v_mfma_f32_16x16x32_bf16 v[192:195], a[16:19], v[32:35], v[192:195]
    v_max_f32 v196, 0, v196
    v_max_f32 v197, 0, v197
    v_mfma_f32_16x16x32_bf16 v[208:211], a[20:23], v[32:35], v[208:211]
    v_mul_f32 v196, v196, v198
    v_mul_f32 v197, v197, v199
    v_mfma_f32_16x16x32_bf16 v[224:227], a[24:27], v[32:35], v[224:227]
    v_cvt_pk_bf16_f32 v196, v196, v197
    v_mfma_f32_16x16x32_bf16 v[240:243], a[28:31], v[32:35], v[240:243]
    ds_write_b32 v21, v196 offset:17408
    v_mfma_f32_16x16x32_bf16 v[128:131], a[32:35], v[36:39], v[128:131]
    v_mfma_f32_16x16x32_bf16 v[144:147], a[36:39], v[36:39], v[144:147]
    v_max_f32 v212, 0, v212
    v_max_f32 v213, 0, v213
    v_mfma_f32_16x16x32_bf16 v[160:163], a[40:43], v[36:39], v[160:163]
    s_waitcnt vmcnt(20)
    v_mul_f32 v212, v212, v214
    v_mul_f32 v213, v213, v215
    v_mfma_f32_16x16x32_bf16 v[176:179], a[44:47], v[36:39], v[176:179]
    v_cvt_pk_bf16_f32 v212, v212, v213
    v_mfma_f32_16x16x32_bf16 v[192:195], a[48:51], v[36:39], v[192:195]
    ds_write_b32 v21, v212 offset:21504
    v_mfma_f32_16x16x32_bf16 v[208:211], a[52:55], v[36:39], v[208:211]
    v_mfma_f32_16x16x32_bf16 v[224:227], a[56:59], v[36:39], v[224:227]
    v_max_f32 v228, 0, v228
    v_max_f32 v229, 0, v229
    v_mfma_f32_16x16x32_bf16 v[240:243], a[60:63], v[36:39], v[240:243]
    s_waitcnt lgkmcnt(7)
    v_mul_f32 v228, v228, v230
    v_mul_f32 v229, v229, v231
    v_mfma_f32_16x16x32_bf16 v[128:131], a[64:67], v[40:43], v[128:131]
    v_cvt_pk_bf16_f32 v228, v228, v229
    v_mfma_f32_16x16x32_bf16 v[144:147], a[68:71], v[40:43], v[144:147]
    ds_write_b32 v21, v228 offset:25600
    v_mfma_f32_16x16x32_bf16 v[160:163], a[72:75], v[40:43], v[160:163]
    v_mfma_f32_16x16x32_bf16 v[176:179], a[76:79], v[40:43], v[176:179]
    s_waitcnt vmcnt(11)
    v_mfma_f32_16x16x32_bf16 v[192:195], a[80:83], v[40:43], v[192:195]
    s_branch L_ov12
L_pad12:
    s_setpc_b64 s[86:87]
L_ov12:
    v_mfma_f32_16x16x32_bf16 v[208:211], a[84:87], v[40:43], v[208:211]
    v_mfma_f32_16x16x32_bf16 v[224:227], a[88:91], v[40:43], v[224:227]
    v_mfma_f32_16x16x32_bf16 v[240:243], a[92:95], v[40:43], v[240:243]
    s_waitcnt lgkmcnt(0)
    v_mfma_f32_16x16x32_bf16 v[128:131], a[96:99], v[44:47], v[128:131]
    s_barrier
    v_mfma_f32_16x16x32_bf16 v[144:147], a[100:103], v[44:47], v[144:147]
    ds_read_b128 v[80:83], v23 offset:1024
    v_mfma_f32_16x16x32_bf16 v[160:163], a[104:107], v[44:47], v[160:163]
    ds_read_b128 v[84:87], v23 offset:5120
    v_mfma_f32_16x16x32_bf16 v[176:179], a[128:131], v[44:47], v[176:179]
    ds_read_b128 v[88:91], v23 offset:9216
    v_mfma_f32_16x16x32_bf16 v[192:195], a[132:135], v[44:47], v[192:195]
    s_waitcnt vmcnt(2)
    ds_read_b128 v[92:95], v23 offset:13312
    v_mfma_f32_16x16x32_bf16 v[208:211], a[136:139], v[44:47], v[208:211]
    ds_read_b128 v[96:99], v23 offset:17408
    v_mfma_f32_16x16x32_bf16 v[224:227], a[140:143], v[44:47], v[224:227]
    ds_read_b128 v[100:103], v23 offset:21504
    v_mfma_f32_16x16x32_bf16 v[240:243], a[144:147], v[44:47], v[240:243]
    s_waitcnt lgkmcnt(5)
    ds_read_b128 v[104:107], v23 offset:25600
    v_mfma_f32_16x16x32_bf16 v[128:131], a[148:151], v[48:51], v[128:131]
    v_mfma_f32_16x16x32_bf16 v[144:147], a[152:155], v[48:51], v[144:147]
    v_mfma_f32_16x16x32_bf16 v[160:163], a[156:159], v[48:51], v[160:163]
    v_mfma_f32_16x16x32_bf16 v[176:179], a[160:163], v[48:51], v[176:179]
    v_mfma_f32_16x16x32_bf16 v[192:195], a[164:167], v[48:51], v[192:195]
    v_mfma_f32_16x16x32_bf16 v[208:211], a[168:171], v[48:51], v[208:211]
    s_waitcnt vmcnt(0)
    v_mfma_f32_16x16x32_bf16 v[224:227], a[172:175], v[48:51], v[224:227]
    v_mfma_f32_16x16x32_bf16 v[240:243], a[176:179], v[48:51], v[240:243]
    v_mfma_f32_16x16x32_bf16 v[132:135], a[192:195], v[80:83], 0
    s_waitcnt lgkmcnt(2)
    v_max_f32 v136, 0, v136
    v_max_f32 v137, 0, v137
    v_mfma_f32_16x16x32_bf16 v[132:135], a[224:227], v[84:87], v[132:135]
    v_mul_f32 v136, v136, v138
    v_mul_f32 v137, v137, v139
    v_mfma_f32_16x16x32_bf16 v[132:135], a[0:3], v[88:91], v[132:135]
    v_cvt_pk_bf16_f32 v136, v136, v137
    v_mfma_f32_16x16x32_bf16 v[132:135], a[32:35], v[92:95], v[132:135]
    ds_write_b32 v21, v136 offset:2048
    v_mfma_f32_16x16x32_bf16 v[132:135], a[64:67], v[96:99], v[132:135]
    s_waitcnt lgkmcnt(2)
    v_mfma_f32_16x16x32_bf16 v[132:135], a[96:99], v[100:103], v[132:135]
    s_waitcnt lgkmcnt(1)
    v_max_f32 v152, 0, v152
    v_max_f32 v153, 0, v153
    v_mfma_f32_16x16x32_bf16 v[132:135], a[148:151], v[104:107], v[132:135]
    v_mul_f32 v152, v152, v154
    v_mul_f32 v153, v153, v155
    v_mfma_f32_16x16x32_bf16 v[148:151], a[196:199], v[80:83], 0
    v_cvt_pk_bf16_f32 v152, v152, v153
    v_mfma_f32_16x16x32_bf16 v[148:151], a[228:231], v[84:87], v[148:151]
    ds_write_b32 v21, v152 offset:6144
    v_mfma_f32_16x16x32_bf16 v[148:151], a[4:7], v[88:91], v[148:151]
    v_cvt_pk_bf16_f32 v56, v128, v144
    v_cvt_pk_bf16_f32 v57, v160, v176
    v_mfma_f32_16x16x32_bf16 v[148:151], a[36:39], v[92:95], v[148:151]
    v_max_f32 v168, 0, v168
    v_max_f32 v169, 0, v169
    v_mfma_f32_16x16x32_bf16 v[148:151], a[68:71], v[96:99], v[148:151]
    v_mul_f32 v168, v168, v170
    v_mul_f32 v169, v169, v171
    v_mfma_f32_16x16x32_bf16 v[148:151], a[100:103], v[100:103], v[148:151]
    v_cvt_pk_bf16_f32 v168, v168, v169
    v_mfma_f32_16x16x32_bf16 v[148:151], a[152:155], v[104:107], v[148:151]
    ds_write_b32 v21, v168 offset:10240
    v_mfma_f32_16x16x32_bf16 v[164:167], a[200:203], v[80:83], 0
    v_cvt_pk_bf16_f32 v58, v129, v145
    v_cvt_pk_bf16_f32 v59, v161, v177
    v_mfma_f32_16x16x32_bf16 v[164:167], a[232:235], v[84:87], v[164:167]
    v_max_f32 v184, 0, v184
    v_max_f32 v185, 0, v185
    v_mfma_f32_16x16x32_bf16 v[164:167], a[8:11], v[88:91], v[164:167]
    v_mul_f32 v184, v184, v186
    v_mul_f32 v185, v185, v187
    v_mfma_f32_16x16x32_bf16 v[164:167], a[40:43], v[92:95], v[164:167]
    v_cvt_pk_bf16_f32 v184, v184, v185
    v_mfma_f32_16x16x32_bf16 v[164:167], a[72:75], v[96:99], v[164:167]
    ds_write_b32 v21, v184 offset:14336
    v_mfma_f32_16x16x32_bf16 v[164:167], a[104:107], v[100:103], v[164:167]
    buffer_store_dwordx4 v[56:59], v1, s[24:27], s40 offen offset:0 sc1
    v_mfma_f32_16x16x32_bf16 v[164:167], a[156:159], v[104:107], v[164:167]
    v_max_f32 v200, 0, v200
    v_max_f32 v201, 0, v201
    v_mfma_f32_16x16x32_bf16 v[180:183], a[204:207], v[80:83], 0
    v_mul_f32 v200, v200, v202
    v_mul_f32 v201, v201, v203
    v_mfma_f32_16x16x32_bf16 v[180:183], a[236:239], v[84:87], v[180:183]
    v_cvt_pk_bf16_f32 v200, v200, v201
    v_mfma_f32_16x16x32_bf16 v[180:183], a[12:15], v[88:91], v[180:183]
    ds_write_b32 v21, v200 offset:18432
    v_mfma_f32_16x16x32_bf16 v[180:183], a[44:47], v[92:95], v[180:183]
    v_cvt_pk_bf16_f32 v60, v130, v146
    v_cvt_pk_bf16_f32 v61, v162, v178
    v_mfma_f32_16x16x32_bf16 v[180:183], a[76:79], v[96:99], v[180:183]
    v_max_f32 v216, 0, v216
    v_max_f32 v217, 0, v217
    v_mfma_f32_16x16x32_bf16 v[180:183], a[128:131], v[100:103], v[180:183]
    v_mul_f32 v216, v216, v218
    v_mul_f32 v217, v217, v219
    v_mfma_f32_16x16x32_bf16 v[180:183], a[160:163], v[104:107], v[180:183]
    v_cvt_pk_bf16_f32 v216, v216, v217
    v_mfma_f32_16x16x32_bf16 v[196:199], a[208:211], v[80:83], 0
    ds_write_b32 v21, v216 offset:22528
    v_mfma_f32_16x16x32_bf16 v[196:199], a[240:243], v[84:87], v[196:199]
    v_cvt_pk_bf16_f32 v62, v131, v147
    v_cvt_pk_bf16_f32 v63, v163, v179
    v_mfma_f32_16x16x32_bf16 v[196:199], a[16:19], v[88:91], v[196:199]
    v_max_f32 v232, 0, v232
    v_max_f32 v233, 0, v233
    v_mfma_f32_16x16x32_bf16 v[196:199], a[48:51], v[92:95], v[196:199]
    v_mul_f32 v232, v232, v234
    v_mul_f32 v233, v233, v235
    v_mfma_f32_16x16x32_bf16 v[196:199], a[80:83], v[96:99], v[196:199]
    v_cvt_pk_bf16_f32 v232, v232, v233
    v_mfma_f32_16x16x32_bf16 v[196:199], a[132:135], v[100:103], v[196:199]
    ds_write_b32 v21, v232 offset:26624
    v_mfma_f32_16x16x32_bf16 v[196:199], a[164:167], v[104:107], v[196:199]
    buffer_store_dwordx4 v[60:63], v1, s[24:27], s40 offen offset:1024 sc1
    v_mfma_f32_16x16x32_bf16 v[212:215], a[212:215], v[80:83], 0
    v_cvt_pk_bf16_f32 v56, v192, v208
    v_cvt_pk_bf16_f32 v57, v224, v240
    v_mfma_f32_16x16x32_bf16 v[212:215], a[244:247], v[84:87], v[212:215]
    v_cvt_pk_bf16_f32 v58, v193, v209
    v_cvt_pk_bf16_f32 v59, v225, v241
    v_mfma_f32_16x16x32_bf16 v[212:215], a[20:23], v[88:91], v[212:215]
    v_mfma_f32_16x16x32_bf16 v[212:215], a[52:55], v[92:95], v[212:215]
    v_mfma_f32_16x16x32_bf16 v[212:215], a[84:87], v[96:99], v[212:215]
    s_waitcnt lgkmcnt(0)
    v_mfma_f32_16x16x32_bf16 v[212:215], a[136:139], v[100:103], v[212:215]
    s_barrier
    v_mfma_f32_16x16x32_bf16 v[212:215], a[168:171], v[104:107], v[212:215]
    ds_read_b128 v[24:27], v23 offset:2048
    v_mfma_f32_16x16x32_bf16 v[228:231], a[216:219], v[80:83], 0
    ds_read_b128 v[28:31], v23 offset:6144
    v_mfma_f32_16x16x32_bf16 v[228:231], a[248:251], v[84:87], v[228:231]
    ds_read_b128 v[32:35], v23 offset:10240
    v_mfma_f32_16x16x32_bf16 v[228:231], a[24:27], v[88:91], v[228:231]
    ds_read_b128 v[36:39], v23 offset:14336
    v_mfma_f32_16x16x32_bf16 v[228:231], a[56:59], v[92:95], v[228:231]
    ds_read_b128 v[40:43], v23 offset:18432
    v_mfma_f32_16x16x32_bf16 v[228:231], a[88:91], v[96:99], v[228:231]
    ds_read_b128 v[44:47], v23 offset:22528
    v_mfma_f32_16x16x32_bf16 v[228:231], a[140:143], v[100:103], v[228:231]
    ds_read_b128 v[48:51], v23 offset:26624
    v_mfma_f32_16x16x32_bf16 v[228:231], a[172:175], v[104:107], v[228:231]
    buffer_store_dwordx4 v[56:59], v1, s[24:27], s40 offen offset:2048 sc1
    v_mfma_f32_16x16x32_bf16 v[244:247], a[220:223], v[80:83], 0
    v_cvt_pk_bf16_f32 v60, v194, v210
    v_cvt_pk_bf16_f32 v61, v226, v242
    v_mfma_f32_16x16x32_bf16 v[244:247], a[252:255], v[84:87], v[244:247]
    v_cvt_pk_bf16_f32 v62, v195, v211
    v_cvt_pk_bf16_f32 v63, v227, v243
    v_mfma_f32_16x16x32_bf16 v[244:247], a[28:31], v[88:91], v[244:247]
    v_mfma_f32_16x16x32_bf16 v[244:247], a[60:63], v[92:95], v[244:247]
    v_mfma_f32_16x16x32_bf16 v[244:247], a[92:95], v[96:99], v[244:247]
    v_mfma_f32_16x16x32_bf16 v[244:247], a[144:147], v[100:103], v[244:247]
    buffer_store_dwordx4 v[60:63], v1, s[24:27], s40 offen offset:3072 sc1
    v_mfma_f32_16x16x32_bf16 v[244:247], a[176:179], v[104:107], v[244:247]
    s_waitcnt lgkmcnt(2)
    v_mfma_f32_16x16x32_bf16 v[136:139], a[192:195], v[24:27], 0
    v_max_f32 v140, 0, v140
    v_max_f32 v141, 0, v141
    v_mfma_f32_16x16x32_bf16 v[136:139], a[224:227], v[28:31], v[136:139]
    v_mul_f32 v140, v140, v142
    v_mul_f32 v141, v141, v143
    v_mfma_f32_16x16x32_bf16 v[136:139], a[0:3], v[32:35], v[136:139]
    v_cvt_pk_bf16_f32 v140, v140, v141
    v_mfma_f32_16x16x32_bf16 v[136:139], a[32:35], v[36:39], v[136:139]
    ds_write_b32 v21, v140 offset:3072
    v_mfma_f32_16x16x32_bf16 v[136:139], a[64:67], v[40:43], v[136:139]
    s_waitcnt lgkmcnt(2)
    v_mfma_f32_16x16x32_bf16 v[136:139], a[96:99], v[44:47], v[136:139]
    s_waitcnt lgkmcnt(1)
    v_max_f32 v156, 0, v156
    v_max_f32 v157, 0, v157
    v_mfma_f32_16x16x32_bf16 v[136:139], a[148:151], v[48:51], v[136:139]
    v_mul_f32 v156, v156, v158
    v_mul_f32 v157, v157, v159
    v_mfma_f32_16x16x32_bf16 v[152:155], a[196:199], v[24:27], 0
    v_cvt_pk_bf16_f32 v156, v156, v157
    v_mfma_f32_16x16x32_bf16 v[152:155], a[228:231], v[28:31], v[152:155]
    ds_write_b32 v21, v156 offset:7168
    v_mfma_f32_16x16x32_bf16 v[152:155], a[4:7], v[32:35], v[152:155]
    v_cvt_pk_bf16_f32 v56, v132, v148
    v_cvt_pk_bf16_f32 v57, v164, v180
    v_mfma_f32_16x16x32_bf16 v[152:155], a[36:39], v[36:39], v[152:155]
    v_max_f32 v172, 0, v172
    v_max_f32 v173, 0, v173
    v_mfma_f32_16x16x32_bf16 v[152:155], a[68:71], v[40:43], v[152:155]
    v_mul_f32 v172, v172, v174
    v_mul_f32 v173, v173, v175
    v_mfma_f32_16x16x32_bf16 v[152:155], a[100:103], v[44:47], v[152:155]
    v_cvt_pk_bf16_f32 v172, v172, v173
    v_mfma_f32_16x16x32_bf16 v[152:155], a[152:155], v[48:51], v[152:155]
    ds_write_b32 v21, v172 offset:11264
    v_mfma_f32_16x16x32_bf16 v[168:171], a[200:203], v[24:27], 0
    v_cvt_pk_bf16_f32 v58, v133, v149
    v_cvt_pk_bf16_f32 v59, v165, v181
    v_mfma_f32_16x16x32_bf16 v[168:171], a[232:235], v[28:31], v[168:171]
    v_max_f32 v188, 0, v188
    v_max_f32 v189, 0, v189
    v_mfma_f32_16x16x32_bf16 v[168:171], a[8:11], v[32:35], v[168:171]
    v_mul_f32 v188, v188, v190
    v_mul_f32 v189, v189, v191
    v_mfma_f32_16x16x32_bf16 v[168:171], a[40:43], v[36:39], v[168:171]
    v_cvt_pk_bf16_f32 v188, v188, v189
    v_mfma_f32_16x16x32_bf16 v[168:171], a[72:75], v[40:43], v[168:171]
    ds_write_b32 v21, v188 offset:15360
    v_mfma_f32_16x16x32_bf16 v[168:171], a[104:107], v[44:47], v[168:171]
    buffer_store_dwordx4 v[56:59], v1, s[24:27], s41 offen offset:0 sc1
    v_mfma_f32_16x16x32_bf16 v[168:171], a[156:159], v[48:51], v[168:171]
    v_max_f32 v204, 0, v204
    v_max_f32 v205, 0, v205
    v_mfma_f32_16x16x32_bf16 v[184:187], a[204:207], v[24:27], 0
    v_mul_f32 v204, v204, v206
    v_mul_f32 v205, v205, v207
    v_mfma_f32_16x16x32_bf16 v[184:187], a[236:239], v[28:31], v[184:187]
    v_cvt_pk_bf16_f32 v204, v204, v205
    v_mfma_f32_16x16x32_bf16 v[184:187], a[12:15], v[32:35], v[184:187]
    ds_write_b32 v21, v204 offset:19456
    v_mfma_f32_16x16x32_bf16 v[184:187], a[44:47], v[36:39], v[184:187]
    v_cvt_pk_bf16_f32 v60, v134, v150
    v_cvt_pk_bf16_f32 v61, v166, v182
    v_mfma_f32_16x16x32_bf16 v[184:187], a[76:79], v[40:43], v[184:187]
    v_max_f32 v220, 0, v220
    v_max_f32 v221, 0, v221
    v_mfma_f32_16x16x32_bf16 v[184:187], a[128:131], v[44:47], v[184:187]
    v_mul_f32 v220, v220, v222
    v_mul_f32 v221, v221, v223
    v_mfma_f32_16x16x32_bf16 v[184:187], a[160:163], v[48:51], v[184:187]
    v_cvt_pk_bf16_f32 v220, v220, v221
    v_mfma_f32_16x16x32_bf16 v[200:203], a[208:211], v[24:27], 0
    ds_write_b32 v21, v220 offset:23552
    v_mfma_f32_16x16x32_bf16 v[200:203], a[240:243], v[28:31], v[200:203]
    v_cvt_pk_bf16_f32 v62, v135, v151
    v_cvt_pk_bf16_f32 v63, v167, v183
    v_mfma_f32_16x16x32_bf16 v[200:203], a[16:19], v[32:35], v[200:203]
    v_max_f32 v236, 0, v236
    v_max_f32 v237, 0, v237
    v_mfma_f32_16x16x32_bf16 v[200:203], a[48:51], v[36:39], v[200:203]
    v_mul_f32 v236, v236, v238
    v_mul_f32 v237, v237, v239
    v_mfma_f32_16x16x32_bf16 v[200:203], a[80:83], v[40:43], v[200:203]
    v_cvt_pk_bf16_f32 v236, v236, v237
    v_mfma_f32_16x16x32_bf16 v[200:203], a[132:135], v[44:47], v[200:203]
    ds_write_b32 v21, v236 offset:27648
    v_mfma_f32_16x16x32_bf16 v[200:203], a[164:167], v[48:51], v[200:203]
    buffer_store_dwordx4 v[60:63], v1, s[24:27], s41 offen offset:1024 sc1
    v_mfma_f32_16x16x32_bf16 v[216:219], a[212:215], v[24:27], 0
    v_cvt_pk_bf16_f32 v56, v196, v212
    v_cvt_pk_bf16_f32 v57, v228, v244
    v_mfma_f32_16x16x32_bf16 v[216:219], a[244:247], v[28:31], v[216:219]
    v_cvt_pk_bf16_f32 v58, v197, v213
    v_cvt_pk_bf16_f32 v59, v229, v245
    v_mfma_f32_16x16x32_bf16 v[216:219], a[20:23], v[32:35], v[216:219]
    v_mfma_f32_16x16x32_bf16 v[216:219], a[52:55], v[36:39], v[216:219]
    v_mfma_f32_16x16x32_bf16 v[216:219], a[84:87], v[40:43], v[216:219]
    s_waitcnt lgkmcnt(0)
    v_mfma_f32_16x16x32_bf16 v[216:219], a[136:139], v[44:47], v[216:219]
    s_barrier
    v_mfma_f32_16x16x32_bf16 v[216:219], a[168:171], v[48:51], v[216:219]
    ds_read_b128 v[80:83], v23 offset:3072
    v_mfma_f32_16x16x32_bf16 v[232:235], a[216:219], v[24:27], 0
    ds_read_b128 v[84:87], v23 offset:7168
    v_mfma_f32_16x16x32_bf16 v[232:235], a[248:251], v[28:31], v[232:235]
    ds_read_b128 v[88:91], v23 offset:11264
    v_mfma_f32_16x16x32_bf16 v[232:235], a[24:27], v[32:35], v[232:235]
    ds_read_b128 v[92:95], v23 offset:15360
    v_mfma_f32_16x16x32_bf16 v[232:235], a[56:59], v[36:39], v[232:235]
    ds_read_b128 v[96:99], v23 offset:19456
    v_mfma_f32_16x16x32_bf16 v[232:235], a[88:91], v[40:43], v[232:235]
    ds_read_b128 v[100:103], v23 offset:23552
    v_mfma_f32_16x16x32_bf16 v[232:235], a[140:143], v[44:47], v[232:235]
    ds_read_b128 v[104:107], v23 offset:27648
    v_mfma_f32_16x16x32_bf16 v[232:235], a[172:175], v[48:51], v[232:235]
    buffer_store_dwordx4 v[56:59], v1, s[24:27], s41 offen offset:2048 sc1
    v_mfma_f32_16x16x32_bf16 v[248:251], a[220:223], v[24:27], 0
    v_cvt_pk_bf16_f32 v60, v198, v214
    v_cvt_pk_bf16_f32 v61, v230, v246
    v_mfma_f32_16x16x32_bf16 v[248:251], a[252:255], v[28:31], v[248:251]
    v_cvt_pk_bf16_f32 v62, v199, v215
    v_cvt_pk_bf16_f32 v63, v231, v247
    v_mfma_f32_16x16x32_bf16 v[248:251], a[28:31], v[32:35], v[248:251]
    v_mfma_f32_16x16x32_bf16 v[248:251], a[60:63], v[36:39], v[248:251]
    v_mfma_f32_16x16x32_bf16 v[248:251], a[92:95], v[40:43], v[248:251]
    v_mfma_f32_16x16x32_bf16 v[248:251], a[144:147], v[44:47], v[248:251]
    buffer_store_dwordx4 v[60:63], v1, s[24:27], s41 offen offset:3072 sc1
    v_mfma_f32_16x16x32_bf16 v[248:251], a[176:179], v[48:51], v[248:251]
    s_waitcnt lgkmcnt(2)
    v_mfma_f32_16x16x32_bf16 v[140:143], a[192:195], v[80:83], 0
    v_mfma_f32_16x16x32_bf16 v[140:143], a[224:227], v[84:87], v[140:143]
    v_mfma_f32_16x16x32_bf16 v[140:143], a[0:3], v[88:91], v[140:143]
    v_mfma_f32_16x16x32_bf16 v[140:143], a[32:35], v[92:95], v[140:143]
    v_mfma_f32_16x16x32_bf16 v[140:143], a[64:67], v[96:99], v[140:143]
    s_waitcnt lgkmcnt(1)
    v_mfma_f32_16x16x32_bf16 v[140:143], a[96:99], v[100:103], v[140:143]
    s_waitcnt lgkmcnt(0)
    v_mfma_f32_16x16x32_bf16 v[140:143], a[148:151], v[104:107], v[140:143]
    v_mfma_f32_16x16x32_bf16 v[156:159], a[196:199], v[80:83], 0
    v_mfma_f32_16x16x32_bf16 v[156:159], a[228:231], v[84:87], v[156:159]
    v_cvt_pk_bf16_f32 v56, v136, v152
    v_cvt_pk_bf16_f32 v57, v168, v184
    v_mfma_f32_16x16x32_bf16 v[156:159], a[4:7], v[88:91], v[156:159]
    v_mfma_f32_16x16x32_bf16 v[156:159], a[36:39], v[92:95], v[156:159]
    v_cvt_pk_bf16_f32 v58, v137, v153
    v_cvt_pk_bf16_f32 v59, v169, v185
    v_mfma_f32_16x16x32_bf16 v[156:159], a[68:71], v[96:99], v[156:159]
    v_mfma_f32_16x16x32_bf16 v[156:159], a[100:103], v[100:103], v[156:159]
    v_mfma_f32_16x16x32_bf16 v[156:159], a[152:155], v[104:107], v[156:159]
    buffer_store_dwordx4 v[56:59], v1, s[24:27], s42 offen offset:0 sc1
    v_mfma_f32_16x16x32_bf16 v[172:175], a[200:203], v[80:83], 0
    v_mfma_f32_16x16x32_bf16 v[172:175], a[232:235], v[84:87], v[172:175]
    v_mfma_f32_16x16x32_bf16 v[172:175], a[8:11], v[88:91], v[172:175]
    v_cvt_pk_bf16_f32 v60, v138, v154
    v_cvt_pk_bf16_f32 v61, v170, v186
    v_mfma_f32_16x16x32_bf16 v[172:175], a[40:43], v[92:95], v[172:175]
    v_mfma_f32_16x16x32_bf16 v[172:175], a[72:75], v[96:99], v[172:175]
    v_cvt_pk_bf16_f32 v62, v139, v155
    v_cvt_pk_bf16_f32 v63, v171, v187
    v_mfma_f32_16x16x32_bf16 v[172:175], a[104:107], v[100:103], v[172:175]
    v_mfma_f32_16x16x32_bf16 v[172:175], a[156:159], v[104:107], v[172:175]
    v_mfma_f32_16x16x32_bf16 v[188:191], a[204:207], v[80:83], 0
    buffer_store_dwordx4 v[60:63], v1, s[24:27], s42 offen offset:1024 sc1
    v_mfma_f32_16x16x32_bf16 v[188:191], a[236:239], v[84:87], v[188:191]
    v_mfma_f32_16x16x32_bf16 v[188:191], a[12:15], v[88:91], v[188:191]
    v_mfma_f32_16x16x32_bf16 v[188:191], a[44:47], v[92:95], v[188:191]
    v_cvt_pk_bf16_f32 v56, v200, v216
    v_cvt_pk_bf16_f32 v57, v232, v248
    v_mfma_f32_16x16x32_bf16 v[188:191], a[76:79], v[96:99], v[188:191]
    v_mfma_f32_16x16x32_bf16 v[188:191], a[128:131], v[100:103], v[188:191]
    v_cvt_pk_bf16_f32 v58, v201, v217
    v_cvt_pk_bf16_f32 v59, v233, v249
    v_mfma_f32_16x16x32_bf16 v[188:191], a[160:163], v[104:107], v[188:191]
    v_mfma_f32_16x16x32_bf16 v[204:207], a[208:211], v[80:83], 0
    v_mfma_f32_16x16x32_bf16 v[204:207], a[240:243], v[84:87], v[204:207]
    buffer_store_dwordx4 v[56:59], v1, s[24:27], s42 offen offset:2048 sc1
    v_mfma_f32_16x16x32_bf16 v[204:207], a[16:19], v[88:91], v[204:207]
    v_mfma_f32_16x16x32_bf16 v[204:207], a[48:51], v[92:95], v[204:207]
    v_mfma_f32_16x16x32_bf16 v[204:207], a[80:83], v[96:99], v[204:207]
    v_cvt_pk_bf16_f32 v60, v202, v218
    v_cvt_pk_bf16_f32 v61, v234, v250
    v_mfma_f32_16x16x32_bf16 v[204:207], a[132:135], v[100:103], v[204:207]
    v_mfma_f32_16x16x32_bf16 v[204:207], a[164:167], v[104:107], v[204:207]
    v_cvt_pk_bf16_f32 v62, v203, v219
    v_cvt_pk_bf16_f32 v63, v235, v251
    v_mfma_f32_16x16x32_bf16 v[220:223], a[212:215], v[80:83], 0
    v_mfma_f32_16x16x32_bf16 v[220:223], a[244:247], v[84:87], v[220:223]
    v_mfma_f32_16x16x32_bf16 v[220:223], a[20:23], v[88:91], v[220:223]
    buffer_store_dwordx4 v[60:63], v1, s[24:27], s42 offen offset:3072 sc1
    v_mfma_f32_16x16x32_bf16 v[220:223], a[52:55], v[92:95], v[220:223]
    v_mfma_f32_16x16x32_bf16 v[220:223], a[84:87], v[96:99], v[220:223]
    v_mfma_f32_16x16x32_bf16 v[220:223], a[136:139], v[100:103], v[220:223]
    v_cvt_pk_bf16_f32 v56, v140, v156
    v_cvt_pk_bf16_f32 v57, v172, v188
    v_mfma_f32_16x16x32_bf16 v[220:223], a[168:171], v[104:107], v[220:223]
    v_mfma_f32_16x16x32_bf16 v[236:239], a[216:219], v[80:83], 0
    v_cvt_pk_bf16_f32 v58, v141, v157
    v_cvt_pk_bf16_f32 v59, v173, v189
    v_mfma_f32_16x16x32_bf16 v[236:239], a[248:251], v[84:87], v[236:239]
    v_mfma_f32_16x16x32_bf16 v[236:239], a[24:27], v[88:91], v[236:239]
    v_mfma_f32_16x16x32_bf16 v[236:239], a[56:59], v[92:95], v[236:239]
    s_mov_b64 exec, s[54:55]
    buffer_store_dwordx4 v[56:59], v1, s[24:27], s43 offen offset:0 sc1
    s_mov_b64 exec, -1
    v_mfma_f32_16x16x32_bf16 v[236:239], a[88:91], v[96:99], v[236:239]
    ds_write_b128 v22, v[56:59] offset:0
    v_mfma_f32_16x16x32_bf16 v[236:239], a[140:143], v[100:103], v[236:239]
    v_mfma_f32_16x16x32_bf16 v[236:239], a[172:175], v[104:107], v[236:239]
    v_cvt_pk_bf16_f32 v60, v142, v158
    v_cvt_pk_bf16_f32 v61, v174, v190
    v_mfma_f32_16x16x32_bf16 v[252:255], a[220:223], v[80:83], 0
    v_mfma_f32_16x16x32_bf16 v[252:255], a[252:255], v[84:87], v[252:255]
    v_cvt_pk_bf16_f32 v62, v143, v159
    v_cvt_pk_bf16_f32 v63, v175, v191
    v_mfma_f32_16x16x32_bf16 v[252:255], a[28:31], v[88:91], v[252:255]
    v_mfma_f32_16x16x32_bf16 v[252:255], a[60:63], v[92:95], v[252:255]
    v_mfma_f32_16x16x32_bf16 v[252:255], a[92:95], v[96:99], v[252:255]
    s_mov_b64 exec, s[54:55]
    buffer_store_dwordx4 v[60:63], v1, s[24:27], s43 offen offset:1024 sc1
    s_mov_b64 exec, -1
    v_mfma_f32_16x16x32_bf16 v[252:255], a[144:147], v[100:103], v[252:255]
    ds_write_b128 v22, v[60:63] offset:1024
    v_mfma_f32_16x16x32_bf16 v[252:255], a[176:179], v[104:107], v[252:255]
    s_nop 7
    v_cvt_pk_bf16_f32 v32, v204, v220
    v_cvt_pk_bf16_f32 v33, v236, v252
    v_cvt_pk_bf16_f32 v34, v205, v221
    v_cvt_pk_bf16_f32 v35, v237, v253
    s_mov_b64 exec, s[54:55]
    buffer_store_dwordx4 v[32:35], v1, s[24:27], s43 offen offset:2048 sc1
    s_mov_b64 exec, -1
    v_cvt_pk_bf16_f32 v36, v206, v222
    v_cvt_pk_bf16_f32 v37, v238, v254
    v_cvt_pk_bf16_f32 v38, v207, v223
    v_cvt_pk_bf16_f32 v39, v239, v255
    s_mov_b64 exec, s[54:55]
    buffer_store_dwordx4 v[36:39], v1, s[24:27], s43 offen offset:3072 sc1
    s_mov_b64 exec, -1
    ds_write_b128 v22, v[32:35] offset:2048
    ds_write_b128 v22, v[36:39] offset:3072
    ds_read_b128 v[208:211], v19 offset:6144
    ds_read_b128 v[212:215], v19 offset:6160
    ds_read_b128 v[216:219], v19 offset:6400
    ds_read_b128 v[220:223], v19 offset:6416
    s_waitcnt lgkmcnt(0)
    ds_read_b128 v[184:187], v15 offset:0
    ds_read_b128 v[188:191], v15 offset:2048
    s_waitcnt lgkmcnt(0)
    v_lshlrev_b32 v192, 16, v184
    v_and_b32 v193, 0xffff0000, v184
    v_lshlrev_b32 v194, 16, v185
    v_and_b32 v195, 0xffff0000, v185
    v_lshlrev_b32 v196, 16, v186
    v_and_b32 v197, 0xffff0000, v186
    v_lshlrev_b32 v198, 16, v187
    v_and_b32 v199, 0xffff0000, v187
    v_lshlrev_b32 v200, 16, v188
    v_and_b32 v201, 0xffff0000, v188
    v_lshlrev_b32 v202, 16, v189
    v_and_b32 v203, 0xffff0000, v189
    v_lshlrev_b32 v204, 16, v190
    v_and_b32 v205, 0xffff0000, v190
    v_lshlrev_b32 v206, 16, v191
    v_and_b32 v207, 0xffff0000, v191
    v_mov_b32 v2, 1
    v_lshl_add_u32 v3, v0, 2, s88
    s_waitcnt vmcnt(0)
    s_mov_b64 exec, 1
    buffer_store_dword v2, v3, s[32:35], s89 offen sc1
    s_mov_b64 exec, -1
    s_mov_b32 s90, 0x40000
    s_mov_b32 s56, 0x7f
L_z_poll:
    buffer_load_dword v5, v14, s[32:35], s89 offen sc1
    s_mov_b64 vcc, 0
    s_sub_u32 s90, s90, 1
    s_cbranch_scc1 L_z_look
    s_waitcnt vmcnt(0)
    v_cmp_ne_u32 vcc, 1, v5
    s_nop 0
L_z_look:
    s_andn2_b32 s57, s56, vcc_lo
    s_cbranch_scc0 L_z_poll
    s_cmp_lg_u32 s57, s56
    s_cbranch_scc1 L_z_poll
    s_bitcmp1_b32 s57, 0
    s_cbranch_scc0 L_z_i0
    buffer_load_dwordx4 v[128:131], v11, s[24:27], s44 offen offset:0 sc1
    buffer_load_dwordx4 v[132:135], v11, s[24:27], s44 offen offset:2048 sc1
L_z_i0:
    s_bitcmp1_b32 s57, 1
    s_cbranch_scc0 L_z_i1
    buffer_load_dwordx4 v[136:139], v11, s[24:27], s45 offen offset:0 sc1
    buffer_load_dwordx4 v[140:143], v11, s[24:27], s45 offen offset:2048 sc1
L_z_i1:
    s_bitcmp1_b32 s57, 2
    s_cbranch_scc0 L_z_i2
    buffer_load_dwordx4 v[144:147], v11, s[24:27], s46 offen offset:0 sc1
    buffer_load_dwordx4 v[148:151], v11, s[24:27], s46 offen offset:2048 sc1
L_z_i2:
    s_bitcmp1_b32 s57, 3
    s_cbranch_scc0 L_z_i3
    buffer_load_dwordx4 v[152:155], v11, s[24:27], s47 offen offset:0 sc1
    buffer_load_dwordx4 v[156:159], v11, s[24:27], s47 offen offset:2048 sc1
L_z_i3:
    s_bitcmp1_b32 s57, 4
    s_cbranch_scc0 L_z_i4
    buffer_load_dwordx4 v[160:163], v11, s[24:27], s48 offen offset:0 sc1
    buffer_load_dwordx4 v[164:167], v11, s[24:27], s48 offen offset:2048 sc1
L_z_i4:
    s_bitcmp1_b32 s57, 5
    s_cbranch_scc0 L_z_i5
    buffer_load_dwordx4 v[168:171], v11, s[24:27], s49 offen offset:0 sc1
    buffer_load_dwordx4 v[172:175], v11, s[24:27], s49 offen offset:2048 sc1
L_z_i5:
    s_bitcmp1_b32 s57, 6
    s_cbranch_scc0 L_z_i6
    buffer_load_dwordx4 v[176:179], v11, s[24:27], s50 offen offset:0 sc1
    buffer_load_dwordx4 v[180:183], v11, s[24:27], s50 offen offset:2048 sc1
L_z_i6:
    s_cmp_eq_u32 s57, 0x7f
    s_cbranch_scc1 L_z_all
    s_waitcnt vmcnt(0)
L_z_all:
    s_bitcmp1_b32 s57, 0
    s_cbranch_scc0 L_z_a0
    s_waitcnt vmcnt(12)
    v_lshlrev_b32 v6, 16, v128
    v_and_b32 v7, 0xffff0000, v128
    v_pk_add_f32 v[192:193], v[192:193], v[6:7]
    v_lshlrev_b32 v8, 16, v129
    v_and_b32 v9, 0xffff0000, v129
    v_pk_add_f32 v[194:195], v[194:195], v[8:9]
    v_lshlrev_b32 v6, 16, v130
    v_and_b32 v7, 0xffff0000, v130
    v_pk_add_f32 v[196:197], v[196:197], v[6:7]
    v_lshlrev_b32 v8, 16, v131
    v_and_b32 v9, 0xffff0000, v131
    v_pk_add_f32 v[198:199], v[198:199], v[8:9]
    v_lshlrev_b32 v6, 16, v132
    v_and_b32 v7, 0xffff0000, v132
    v_pk_add_f32 v[200:201], v[200:201], v[6:7]
    v_lshlrev_b32 v8, 16, v133
    v_and_b32 v9, 0xffff0000, v133
    v_pk_add_f32 v[202:203], v[202:203], v[8:9]
    v_lshlrev_b32 v6, 16, v134
    v_and_b32 v7, 0xffff0000, v134
    v_pk_add_f32 v[204:205], v[204:205], v[6:7]
    v_lshlrev_b32 v8, 16, v135
    v_and_b32 v9, 0xffff0000, v135
    v_pk_add_f32 v[206:207], v[206:207], v[8:9]
L_z_a0:
    s_bitcmp1_b32 s57, 1
    s_cbranch_scc0 L_z_a1
    s_waitcnt vmcnt(10)
    v_lshlrev_b32 v6, 16, v136
    v_and_b32 v7, 0xffff0000, v136
    v_pk_add_f32 v[192:193], v[192:193], v[6:7]
    v_lshlrev_b32 v8, 16, v137
    v_and_b32 v9, 0xffff0000, v137
    v_pk_add_f32 v[194:195], v[194:195], v[8:9]
    v_lshlrev_b32 v6, 16, v138
    v_and_b32 v7, 0xffff0000, v138
    v_pk_add_f32 v[196:197], v[196:197], v[6:7]
    v_lshlrev_b32 v8, 16, v139
    v_and_b32 v9, 0xffff0000, v139
    v_pk_add_f32 v[198:199], v[198:199], v[8:9]
    v_lshlrev_b32 v6, 16, v140
    v_and_b32 v7, 0xffff0000, v140
    v_pk_add_f32 v[200:201], v[200:201], v[6:7]
    v_lshlrev_b32 v8, 16, v141
    v_and_b32 v9, 0xffff0000, v141
    v_pk_add_f32 v[202:203], v[202:203], v[8:9]
    v_lshlrev_b32 v6, 16, v142
    v_and_b32 v7, 0xffff0000, v142
    v_pk_add_f32 v[204:205], v[204:205], v[6:7]
    v_lshlrev_b32 v8, 16, v143
    v_and_b32 v9, 0xffff0000, v143
    v_pk_add_f32 v[206:207], v[206:207], v[8:9]
L_z_a1:
    s_bitcmp1_b32 s57, 2
    s_cbranch_scc0 L_z_a2
    s_waitcnt vmcnt(8)
    v_lshlrev_b32 v6, 16, v144
    v_and_b32 v7, 0xffff0000, v144
    v_pk_add_f32 v[192:193], v[192:193], v[6:7]
    v_lshlrev_b32 v8, 16, v145
    v_and_b32 v9, 0xffff0000, v145
    v_pk_add_f32 v[194:195], v[194:195], v[8:9]
    v_lshlrev_b32 v6, 16, v146
    v_and_b32 v7, 0xffff0000, v146
    v_pk_add_f32 v[196:197], v[196:197], v[6:7]
    v_lshlrev_b32 v8, 16, v147
    v_and_b32 v9, 0xffff0000, v147
    v_pk_add_f32 v[198:199], v[198:199], v[8:9]
    v_lshlrev_b32 v6, 16, v148
    v_and_b32 v7, 0xffff0000, v148
    v_pk_add_f32 v[200:201], v[200:201], v[6:7]
    v_lshlrev_b32 v8, 16, v149
    v_and_b32 v9, 0xffff0000, v149
    v_pk_add_f32 v[202:203], v[202:203], v[8:9]
    v_lshlrev_b32 v6, 16, v150
    v_and_b32 v7, 0xffff0000, v150
    v_pk_add_f32 v[204:205], v[204:205], v[6:7]
    v_lshlrev_b32 v8, 16, v151
    v_and_b32 v9, 0xffff0000, v151
    v_pk_add_f32 v[206:207], v[206:207], v[8:9]
L_z_a2:
    s_bitcmp1_b32 s57, 3
    s_cbranch_scc0 L_z_a3
    s_waitcnt vmcnt(6)
    v_lshlrev_b32 v6, 16, v152
    v_and_b32 v7, 0xffff0000, v152
    v_pk_add_f32 v[192:193], v[192:193], v[6:7]
    v_lshlrev_b32 v8, 16, v153
    v_and_b32 v9, 0xffff0000, v153
    v_pk_add_f32 v[194:195], v[194:195], v[8:9]
    v_lshlrev_b32 v6, 16, v154
    v_and_b32 v7, 0xffff0000, v154
    v_pk_add_f32 v[196:197], v[196:197], v[6:7]
    v_lshlrev_b32 v8, 16, v155
    v_and_b32 v9, 0xffff0000, v155
    v_pk_add_f32 v[198:199], v[198:199], v[8:9]
    v_lshlrev_b32 v6, 16, v156
    v_and_b32 v7, 0xffff0000, v156
    v_pk_add_f32 v[200:201], v[200:201], v[6:7]
    v_lshlrev_b32 v8, 16, v157
    v_and_b32 v9, 0xffff0000, v157
    v_pk_add_f32 v[202:203], v[202:203], v[8:9]
    v_lshlrev_b32 v6, 16, v158
    v_and_b32 v7, 0xffff0000, v158
    v_pk_add_f32 v[204:205], v[204:205], v[6:7]
    v_lshlrev_b32 v8, 16, v159
    v_and_b32 v9, 0xffff0000, v159
    v_pk_add_f32 v[206:207], v[206:207], v[8:9]
L_z_a3:
    s_bitcmp1_b32 s57, 4
    s_cbranch_scc0 L_z_a4
    s_waitcnt vmcnt(4)
    v_lshlrev_b32 v6, 16, v160
    v_and_b32 v7, 0xffff0000, v160
    v_pk_add_f32 v[192:193], v[192:193], v[6:7]
    v_lshlrev_b32 v8, 16, v161
    v_and_b32 v9, 0xffff0000, v161
    v_pk_add_f32 v[194:195], v[194:195], v[8:9]
    v_lshlrev_b32 v6, 16, v162
    v_and_b32 v7, 0xffff0000, v162
    v_pk_add_f32 v[196:197], v[196:197], v[6:7]
    v_lshlrev_b32 v8, 16, v163
    v_and_b32 v9, 0xffff0000, v163
    v_pk_add_f32 v[198:199], v[198:199], v[8:9]
    v_lshlrev_b32 v6, 16, v164
    v_and_b32 v7, 0xffff0000, v164
    v_pk_add_f32 v[200:201], v[200:201], v[6:7]
    s_branch L_ov13
L_pad13:
    s_setpc_b64 s[86:87]
L_ov13:
    v_lshlrev_b32 v8, 16, v165
    v_and_b32 v9, 0xffff0000, v165
    v_pk_add_f32 v[202:203], v[202:203], v[8:9]
    v_lshlrev_b32 v6, 16, v166
    v_and_b32 v7, 0xffff0000, v166
    v_pk_add_f32 v[204:205], v[204:205], v[6:7]
    v_lshlrev_b32 v8, 16, v167
    v_and_b32 v9, 0xffff0000, v167
    v_pk_add_f32 v[206:207], v[206:207], v[8:9]
L_z_a4:
    s_bitcmp1_b32 s57, 5
    s_cbranch_scc0 L_z_a5
    s_waitcnt vmcnt(2)
    v_lshlrev_b32 v6, 16, v168
    v_and_b32 v7, 0xffff0000, v168
    v_pk_add_f32 v[192:193], v[192:193], v[6:7]
    v_lshlrev_b32 v8, 16, v169
    v_and_b32 v9, 0xffff0000, v169
    v_pk_add_f32 v[194:195], v[194:195], v[8:9]
    v_lshlrev_b32 v6, 16, v170
    v_and_b32 v7, 0xffff0000, v170
    v_pk_add_f32 v[196:197], v[196:197], v[6:7]
    v_lshlrev_b32 v8, 16, v171
    v_and_b32 v9, 0xffff0000, v171
    v_pk_add_f32 v[198:199], v[198:199], v[8:9]
    v_lshlrev_b32 v6, 16, v172
    v_and_b32 v7, 0xffff0000, v172
    v_pk_add_f32 v[200:201], v[200:201], v[6:7]
    v_lshlrev_b32 v8, 16, v173
    v_and_b32 v9, 0xffff0000, v173
    v_pk_add_f32 v[202:203], v[202:203], v[8:9]
    v_lshlrev_b32 v6, 16, v174
    v_and_b32 v7, 0xffff0000, v174
    v_pk_add_f32 v[204:205], v[204:205], v[6:7]
    v_lshlrev_b32 v8, 16, v175
    v_and_b32 v9, 0xffff0000, v175
    v_pk_add_f32 v[206:207], v[206:207], v[8:9]
L_z_a5:
    s_bitcmp1_b32 s57, 6
    s_cbranch_scc0 L_z_a6
    s_waitcnt vmcnt(0)
    v_lshlrev_b32 v6, 16, v176
    v_and_b32 v7, 0xffff0000, v176
    v_pk_add_f32 v[192:193], v[192:193], v[6:7]
    v_lshlrev_b32 v8, 16, v177
    v_and_b32 v9, 0xffff0000, v177
    v_pk_add_f32 v[194:195], v[194:195], v[8:9]
    v_lshlrev_b32 v6, 16, v178
    v_and_b32 v7, 0xffff0000, v178
    v_pk_add_f32 v[196:197], v[196:197], v[6:7]
    v_lshlrev_b32 v8, 16, v179
    v_and_b32 v9, 0xffff0000, v179
    v_pk_add_f32 v[198:199], v[198:199], v[8:9]
    v_lshlrev_b32 v6, 16, v180
    v_and_b32 v7, 0xffff0000, v180
    v_pk_add_f32 v[200:201], v[200:201], v[6:7]
    v_lshlrev_b32 v8, 16, v181
    v_and_b32 v9, 0xffff0000, v181
    v_pk_add_f32 v[202:203], v[202:203], v[8:9]
    v_lshlrev_b32 v6, 16, v182
    v_and_b32 v7, 0xffff0000, v182
    v_pk_add_f32 v[204:205], v[204:205], v[6:7]
    v_lshlrev_b32 v8, 16, v183
    v_and_b32 v9, 0xffff0000, v183
    v_pk_add_f32 v[206:207], v[206:207], v[8:9]
L_z_a6:
    s_andn2_b32 s56, s56, s57
    s_cbranch_scc1 L_z_poll
    s_add_u32 s89, s89, 131072
    v_pk_fma_f32 v[192:193], v[192:193], v[208:209], v[64:65]
    v_pk_fma_f32 v[194:195], v[194:195], v[210:211], v[66:67]
    v_pk_fma_f32 v[196:197], v[196:197], v[212:213], v[68:69]
    v_pk_fma_f32 v[198:199], v[198:199], v[214:215], v[70:71]
    v_pk_fma_f32 v[200:201], v[200:201], v[216:217], v[72:73]
    v_pk_fma_f32 v[202:203], v[202:203], v[218:219], v[74:75]
    v_pk_fma_f32 v[204:205], v[204:205], v[220:221], v[76:77]
    v_pk_fma_f32 v[206:207], v[206:207], v[222:223], v[78:79]
    v_cvt_pk_bf16_f32 v128, v192, v193
    v_cvt_pk_bf16_f32 v129, v194, v195
    v_cvt_pk_bf16_f32 v130, v196, v197
    v_cvt_pk_bf16_f32 v131, v198, v199
    v_cvt_pk_bf16_f32 v132, v200, v201
    v_cvt_pk_bf16_f32 v133, v202, v203
    v_cvt_pk_bf16_f32 v134, v204, v205
    v_cvt_pk_bf16_f32 v135, v206, v207
    buffer_store_dwordx4 v[128:131], v18, s[36:39], 0 offen offset:0 nt
    buffer_store_dwordx4 v[132:135], v18, s[36:39], 0 offen offset:128 nt
L_main_done:
    s_endpgm
L_mod_first:
    s_mov_b32 s24, s58
    s_and_b32 s25, s59, 0xffff
    s_mov_b32 s26, 0x400
    s_mov_b32 s27, 0x20000
    s_mov_b32 s28, s60
    s_and_b32 s29, s61, 0xffff
    s_mov_b32 s30, 0x300000
    s_mov_b32 s31, 0x20000
    v_lshrrev_b32 v6, 3, v5
    v_and_b32 v7, 7, v0
    v_lshlrev_b32 v8, 3, v6
    v_mul_u32_u24 v6, 24576, v6
    v_lshl_add_u32 v6, v7, 4, v6
    s_lshr_b32 s86, s2, 4
    s_and_b32 s87, s2, 15
    s_mul_i32 s68, s86, 786432
    s_lshl_b32 s84, s87, 7
    s_add_u32 s68, s68, s84
    s_add_u32 s69, s68, 6144
    s_add_u32 s70, s68, 12288
    s_add_u32 s71, s68, 18432
    s_lshl_b32 s84, s86, 8
    buffer_load_dwordx2 v[96:97], v8, s[24:27], s84 offen
    buffer_load_dwordx4 v[64:67], v6, s[28:31], s68 offen
    buffer_load_dwordx4 v[68:71], v6, s[28:31], s69 offen
    buffer_load_dwordx4 v[72:75], v6, s[28:31], s70 offen
    buffer_load_dwordx4 v[76:79], v6, s[28:31], s71 offen
    s_add_u32 s12, s66, 0x0
    s_addc_u32 s13, s67, 0
    s_and_b32 s13, s13, 0xffff
    s_mov_b32 s14, 0x7080
    s_mov_b32 s15, 0x20000
    s_mov_b32 s76, s64
    s_and_b32 s77, s65, 0xffff
    s_mov_b32 s78, 0x100
    s_mov_b32 s79, 0x20000
    s_lshl_b32 s86, s86, 12
    s_lshl_b32 s87, s87, 8
    s_add_u32 s86, s86, s87
    s_add_u32 s93, s86, 12288
    v_lshrrev_b32 v6, 4, v5
    v_lshlrev_b32 v6, 8, v6
    v_lshl_add_u32 v6, v7, 5, v6
    v_add_u32 v6, 65536, v6
    v_lshlrev_b32 v7, 2, v0
    v_add_u32 v8, 65536, v7
    s_waitcnt vmcnt(4)
    v_lshlrev_b32 v100, 16, v96
    v_and_b32 v101, 0xffff0000, v96
    v_lshlrev_b32 v102, 16, v97
    v_and_b32 v103, 0xffff0000, v97
    v_mul_f32 v116, 0xbfb8aa3b, v100
    v_mul_f32 v117, 0xbfb8aa3b, v101
    v_mul_f32 v118, 0xbfb8aa3b, v102
    v_mul_f32 v119, 0xbfb8aa3b, v103
    v_exp_f32 v116, v116
    v_exp_f32 v117, v117
    v_exp_f32 v118, v118
    v_exp_f32 v119, v119
    s_nop 0
    v_add_f32 v116, 1.0, v116
    v_add_f32 v117, 1.0, v117
    v_add_f32 v118, 1.0, v118
    v_add_f32 v119, 1.0, v119
    v_rcp_f32 v116, v116
    v_rcp_f32 v117, v117
    v_rcp_f32 v118, v118
    v_rcp_f32 v119, v119
    s_nop 0
    v_mul_f32 v100, v100, v116
    v_mul_f32 v101, v101, v117
    v_mul_f32 v102, v102, v118
    v_mul_f32 v103, v103, v119
    v_cvt_pk_bf16_f32 v96, v100, v101
    v_cvt_pk_bf16_f32 v97, v102, v103
    v_lshlrev_b32 v100, 16, v96
    v_and_b32 v101, 0xffff0000, v96
    v_lshlrev_b32 v102, 16, v97
    v_and_b32 v103, 0xffff0000, v97
    s_waitcnt vmcnt(3)
    v_lshlrev_b32 v116, 16, v64
    v_and_b32 v117, 0xffff0000, v64
    v_lshlrev_b32 v118, 16, v65
    v_and_b32 v119, 0xffff0000, v65
    v_lshlrev_b32 v120, 16, v66
    v_and_b32 v121, 0xffff0000, v66
    v_lshlrev_b32 v122, 16, v67
    v_and_b32 v123, 0xffff0000, v67
    v_pk_mul_f32 v[108:109], v[116:117], v[100:101] op_sel:[0,0] op_sel_hi:[1,0]
    v_pk_mul_f32 v[110:111], v[118:119], v[100:101] op_sel:[0,0] op_sel_hi:[1,0]
    v_pk_mul_f32 v[112:113], v[120:121], v[100:101] op_sel:[0,0] op_sel_hi:[1,0]
    v_pk_mul_f32 v[114:115], v[122:123], v[100:101] op_sel:[0,0] op_sel_hi:[1,0]
    s_waitcnt vmcnt(2)
    v_lshlrev_b32 v116, 16, v68
    v_and_b32 v117, 0xffff0000, v68
    v_lshlrev_b32 v118, 16, v69
    v_and_b32 v119, 0xffff0000, v69
    v_lshlrev_b32 v120, 16, v70
    v_and_b32 v121, 0xffff0000, v70
    v_lshlrev_b32 v122, 16, v71
    v_and_b32 v123, 0xffff0000, v71
    v_pk_fma_f32 v[108:109], v[116:117], v[100:101], v[108:109] op_sel:[0,1,0] op_sel_hi:[1,1,1]
    v_pk_fma_f32 v[110:111], v[118:119], v[100:101], v[110:111] op_sel:[0,1,0] op_sel_hi:[1,1,1]
    v_pk_fma_f32 v[112:113], v[120:121], v[100:101], v[112:113] op_sel:[0,1,0] op_sel_hi:[1,1,1]
    v_pk_fma_f32 v[114:115], v[122:123], v[100:101], v[114:115] op_sel:[0,1,0] op_sel_hi:[1,1,1]
    s_waitcnt vmcnt(1)
    v_lshlrev_b32 v116, 16, v72
    v_and_b32 v117, 0xffff0000, v72
    v_lshlrev_b32 v118, 16, v73
    v_and_b32 v119, 0xffff0000, v73
    v_lshlrev_b32 v120, 16, v74
    v_and_b32 v121, 0xffff0000, v74
    v_lshlrev_b32 v122, 16, v75
    v_and_b32 v123, 0xffff0000, v75
    v_pk_fma_f32 v[108:109], v[116:117], v[102:103], v[108:109] op_sel:[0,0,0] op_sel_hi:[1,0,1]
    v_pk_fma_f32 v[110:111], v[118:119], v[102:103], v[110:111] op_sel:[0,0,0] op_sel_hi:[1,0,1]
    v_pk_fma_f32 v[112:113], v[120:121], v[102:103], v[112:113] op_sel:[0,0,0] op_sel_hi:[1,0,1]
    v_pk_fma_f32 v[114:115], v[122:123], v[102:103], v[114:115] op_sel:[0,0,0] op_sel_hi:[1,0,1]
    s_waitcnt vmcnt(0)
    v_lshlrev_b32 v116, 16, v76
    v_and_b32 v117, 0xffff0000, v76
    v_lshlrev_b32 v118, 16, v77
    v_and_b32 v119, 0xffff0000, v77
    v_lshlrev_b32 v120, 16, v78
    v_and_b32 v121, 0xffff0000, v78
    v_lshlrev_b32 v122, 16, v79
    v_and_b32 v123, 0xffff0000, v79
    v_pk_fma_f32 v[108:109], v[116:117], v[102:103], v[108:109] op_sel:[0,1,0] op_sel_hi:[1,1,1]
    v_pk_fma_f32 v[110:111], v[118:119], v[102:103], v[110:111] op_sel:[0,1,0] op_sel_hi:[1,1,1]
    v_pk_fma_f32 v[112:113], v[120:121], v[102:103], v[112:113] op_sel:[0,1,0] op_sel_hi:[1,1,1]
    v_pk_fma_f32 v[114:115], v[122:123], v[102:103], v[114:115] op_sel:[0,1,0] op_sel_hi:[1,1,1]
    s_nop 1
    v_add_f32_dpp v108, v108, v108 row_ror:8 row_mask:0xf bank_mask:0xf
    v_add_f32_dpp v109, v109, v109 row_ror:8 row_mask:0xf bank_mask:0xf
    v_add_f32_dpp v110, v110, v110 row_ror:8 row_mask:0xf bank_mask:0xf
    v_add_f32_dpp v111, v111, v111 row_ror:8 row_mask:0xf bank_mask:0xf
    v_add_f32_dpp v112, v112, v112 row_ror:8 row_mask:0xf bank_mask:0xf
    v_add_f32_dpp v113, v113, v113 row_ror:8 row_mask:0xf bank_mask:0xf
    v_add_f32_dpp v114, v114, v114 row_ror:8 row_mask:0xf bank_mask:0xf
    v_add_f32_dpp v115, v115, v115 row_ror:8 row_mask:0xf bank_mask:0xf
    s_mov_b32 exec_lo, 0x00ff00ff
    s_mov_b32 exec_hi, 0x00ff00ff
    ds_write_b128 v6, v[108:111]
    ds_write_b128 v6, v[112:115] offset:16
    s_mov_b64 exec, -1
    s_waitcnt lgkmcnt(0)
    s_barrier
    s_cmp_lg_u32 s3, 0
    s_cbranch_scc1 L_mod_ann
    ds_read_b32 v64, v8 offset:0
    ds_read_b32 v65, v8 offset:256
    ds_read_b32 v66, v8 offset:512
    ds_read_b32 v67, v8 offset:768
    ds_read_b32 v68, v8 offset:1024
    ds_read_b32 v69, v8 offset:1280
    ds_read_b32 v70, v8 offset:1536
    ds_read_b32 v71, v8 offset:1792
    ds_read_b32 v72, v8 offset:2048
    ds_read_b32 v73, v8 offset:2304
    ds_read_b32 v74, v8 offset:2560
    ds_read_b32 v75, v8 offset:2816
    ds_read_b32 v76, v8 offset:3072
    ds_read_b32 v77, v8 offset:3328
    ds_read_b32 v78, v8 offset:3584
    ds_read_b32 v79, v8 offset:3840
    s_lshr_b32 s86, s2, 4
    s_mul_i32 s86, s86, 64
    s_add_u32 s86, s86, 4
    v_mov_b32 v9, s86
    v_mov_b32 v6, 1
    s_waitcnt lgkmcnt(0)
    v_pk_add_f32 v[64:65], v[64:65], v[72:73]
    v_pk_add_f32 v[66:67], v[66:67], v[74:75]
    v_pk_add_f32 v[68:69], v[68:69], v[76:77]
    v_pk_add_f32 v[70:71], v[70:71], v[78:79]
    v_pk_add_f32 v[64:65], v[64:65], v[68:69]
    v_pk_add_f32 v[66:67], v[66:67], v[70:71]
    v_pk_add_f32 v[64:65], v[64:65], v[66:67]
    v_add_f32 v8, v64, v65
    buffer_store_dword v8, v7, s[12:15], s93 offen sc1
    s_mov_b64 exec, 1
    s_waitcnt vmcnt(0)
    buffer_atomic_add v6, v9, s[76:79], 0 offen
    s_mov_b64 exec, -1
L_mod_ann:
    s_barrier
    s_branch L_mod_first_ret
L_mod_rest:
    v_lshrrev_b32 v6, 4, v0
    v_lshlrev_b32 v6, 7, v6
    v_and_b32 v7, 3, v0
    v_lshl_add_u32 v6, v7, 5, v6
    s_lshl_b32 s86, s3, 9
    s_add_u32 s86, s86, 65536
    v_add_u32 v6, s86, v6
    s_waitcnt vmcnt(25)
    v_lshlrev_b32 v100, 16, v96
    v_and_b32 v101, 0xffff0000, v96
    v_lshlrev_b32 v102, 16, v97
    v_and_b32 v103, 0xffff0000, v97
    v_lshlrev_b32 v104, 16, v98
    v_and_b32 v105, 0xffff0000, v98
    v_lshlrev_b32 v106, 16, v99
    v_and_b32 v107, 0xffff0000, v99
    v_mul_f32 v116, 0xbfb8aa3b, v100
    v_mul_f32 v117, 0xbfb8aa3b, v101
    v_mul_f32 v118, 0xbfb8aa3b, v102
    v_mul_f32 v119, 0xbfb8aa3b, v103
    v_mul_f32 v120, 0xbfb8aa3b, v104
    v_mul_f32 v121, 0xbfb8aa3b, v105
    v_mul_f32 v122, 0xbfb8aa3b, v106
    v_mul_f32 v123, 0xbfb8aa3b, v107
    v_exp_f32 v116, v116
    v_exp_f32 v117, v117
    v_exp_f32 v118, v118
    v_exp_f32 v119, v119
    v_exp_f32 v120, v120
    v_exp_f32 v121, v121
    v_exp_f32 v122, v122
    v_exp_f32 v123, v123
    s_nop 0
    v_add_f32 v116, 1.0, v116
    v_add_f32 v117, 1.0, v117
    v_add_f32 v118, 1.0, v118
    v_add_f32 v119, 1.0, v119
    v_add_f32 v120, 1.0, v120
    v_add_f32 v121, 1.0, v121
    v_add_f32 v122, 1.0, v122
    v_add_f32 v123, 1.0, v123
    v_rcp_f32 v116, v116
    v_rcp_f32 v117, v117
    v_rcp_f32 v118, v118
    v_rcp_f32 v119, v119
    v_rcp_f32 v120, v120
    v_rcp_f32 v121, v121
    v_rcp_f32 v122, v122
    v_rcp_f32 v123, v123
    s_nop 0
    v_mul_f32 v100, v100, v116
    v_mul_f32 v101, v101, v117
    v_mul_f32 v102, v102, v118
    v_mul_f32 v103, v103, v119
    v_mul_f32 v104, v104, v120
    v_mul_f32 v105, v105, v121
    v_mul_f32 v106, v106, v122
    v_mul_f32 v107, v107, v123
    v_cvt_pk_bf16_f32 v96, v100, v101
    v_cvt_pk_bf16_f32 v97, v102, v103
    v_cvt_pk_bf16_f32 v98, v104, v105
    v_cvt_pk_bf16_f32 v99, v106, v107
    v_lshlrev_b32 v100, 16, v96
    v_and_b32 v101, 0xffff0000, v96
    v_lshlrev_b32 v102, 16, v97
    v_and_b32 v103, 0xffff0000, v97
    v_lshlrev_b32 v104, 16, v98
    v_and_b32 v105, 0xffff0000, v98
    v_lshlrev_b32 v106, 16, v99
    v_and_b32 v107, 0xffff0000, v99
    s_waitcnt vmcnt(24)
    v_lshlrev_b32 v116, 16, v64
    v_and_b32 v117, 0xffff0000, v64
    v_lshlrev_b32 v118, 16, v65
    v_and_b32 v119, 0xffff0000, v65
    v_lshlrev_b32 v120, 16, v66
    v_and_b32 v121, 0xffff0000, v66
    v_lshlrev_b32 v122, 16, v67
    v_and_b32 v123, 0xffff0000, v67
    v_pk_mul_f32 v[108:109], v[116:117], v[100:101] op_sel:[0,0] op_sel_hi:[1,0]
    v_pk_mul_f32 v[110:111], v[118:119], v[100:101] op_sel:[0,0] op_sel_hi:[1,0]
    v_pk_mul_f32 v[112:113], v[120:121], v[100:101] op_sel:[0,0] op_sel_hi:[1,0]
    v_pk_mul_f32 v[114:115], v[122:123], v[100:101] op_sel:[0,0] op_sel_hi:[1,0]
    s_waitcnt vmcnt(23)
    v_lshlrev_b32 v116, 16, v68
    v_and_b32 v117, 0xffff0000, v68
    v_lshlrev_b32 v118, 16, v69
    v_and_b32 v119, 0xffff0000, v69
    v_lshlrev_b32 v120, 16, v70
    v_and_b32 v121, 0xffff0000, v70
    v_lshlrev_b32 v122, 16, v71
    v_and_b32 v123, 0xffff0000, v71
    v_pk_fma_f32 v[108:109], v[116:117], v[100:101], v[108:109] op_sel:[0,1,0] op_sel_hi:[1,1,1]
    v_pk_fma_f32 v[110:111], v[118:119], v[100:101], v[110:111] op_sel:[0,1,0] op_sel_hi:[1,1,1]
    v_pk_fma_f32 v[112:113], v[120:121], v[100:101], v[112:113] op_sel:[0,1,0] op_sel_hi:[1,1,1]
    v_pk_fma_f32 v[114:115], v[122:123], v[100:101], v[114:115] op_sel:[0,1,0] op_sel_hi:[1,1,1]
    s_waitcnt vmcnt(22)
    v_lshlrev_b32 v116, 16, v72
    v_and_b32 v117, 0xffff0000, v72
    v_lshlrev_b32 v118, 16, v73
    v_and_b32 v119, 0xffff0000, v73
    v_lshlrev_b32 v120, 16, v74
    v_and_b32 v121, 0xffff0000, v74
    v_lshlrev_b32 v122, 16, v75
    v_and_b32 v123, 0xffff0000, v75
    v_pk_fma_f32 v[108:109], v[116:117], v[102:103], v[108:109] op_sel:[0,0,0] op_sel_hi:[1,0,1]
    v_pk_fma_f32 v[110:111], v[118:119], v[102:103], v[110:111] op_sel:[0,0,0] op_sel_hi:[1,0,1]
    v_pk_fma_f32 v[112:113], v[120:121], v[102:103], v[112:113] op_sel:[0,0,0] op_sel_hi:[1,0,1]
    v_pk_fma_f32 v[114:115], v[122:123], v[102:103], v[114:115] op_sel:[0,0,0] op_sel_hi:[1,0,1]
    s_waitcnt vmcnt(21)
    v_lshlrev_b32 v116, 16, v76
    v_and_b32 v117, 0xffff0000, v76
    v_lshlrev_b32 v118, 16, v77
    v_and_b32 v119, 0xffff0000, v77
    v_lshlrev_b32 v120, 16, v78
    v_and_b32 v121, 0xffff0000, v78
    v_lshlrev_b32 v122, 16, v79
    v_and_b32 v123, 0xffff0000, v79
    v_pk_fma_f32 v[108:109], v[116:117], v[102:103], v[108:109] op_sel:[0,1,0] op_sel_hi:[1,1,1]
    v_pk_fma_f32 v[110:111], v[118:119], v[102:103], v[110:111] op_sel:[0,1,0] op_sel_hi:[1,1,1]
    v_pk_fma_f32 v[112:113], v[120:121], v[102:103], v[112:113] op_sel:[0,1,0] op_sel_hi:[1,1,1]
    v_pk_fma_f32 v[114:115], v[122:123], v[102:103], v[114:115] op_sel:[0,1,0] op_sel_hi:[1,1,1]
    s_waitcnt vmcnt(20)
    v_lshlrev_b32 v116, 16, v80
    v_and_b32 v117, 0xffff0000, v80
    v_lshlrev_b32 v118, 16, v81
    v_and_b32 v119, 0xffff0000, v81
    v_lshlrev_b32 v120, 16, v82
    v_and_b32 v121, 0xffff0000, v82
    v_lshlrev_b32 v122, 16, v83
    v_and_b32 v123, 0xffff0000, v83
    v_pk_fma_f32 v[108:109], v[116:117], v[104:105], v[108:109] op_sel:[0,0,0] op_sel_hi:[1,0,1]
    v_pk_fma_f32 v[110:111], v[118:119], v[104:105], v[110:111] op_sel:[0,0,0] op_sel_hi:[1,0,1]
    v_pk_fma_f32 v[112:113], v[120:121], v[104:105], v[112:113] op_sel:[0,0,0] op_sel_hi:[1,0,1]
    v_pk_fma_f32 v[114:115], v[122:123], v[104:105], v[114:115] op_sel:[0,0,0] op_sel_hi:[1,0,1]
    s_waitcnt vmcnt(19)
    v_lshlrev_b32 v116, 16, v84
    v_and_b32 v117, 0xffff0000, v84
    v_lshlrev_b32 v118, 16, v85
    v_and_b32 v119, 0xffff0000, v85
    v_lshlrev_b32 v120, 16, v86
    v_and_b32 v121, 0xffff0000, v86
    v_lshlrev_b32 v122, 16, v87
    v_and_b32 v123, 0xffff0000, v87
    v_pk_fma_f32 v[108:109], v[116:117], v[104:105], v[108:109] op_sel:[0,1,0] op_sel_hi:[1,1,1]
    v_pk_fma_f32 v[110:111], v[118:119], v[104:105], v[110:111] op_sel:[0,1,0] op_sel_hi:[1,1,1]
    v_pk_fma_f32 v[112:113], v[120:121], v[104:105], v[112:113] op_sel:[0,1,0] op_sel_hi:[1,1,1]
    v_pk_fma_f32 v[114:115], v[122:123], v[104:105], v[114:115] op_sel:[0,1,0] op_sel_hi:[1,1,1]
    s_waitcnt vmcnt(18)
    v_lshlrev_b32 v116, 16, v88
    v_and_b32 v117, 0xffff0000, v88
    v_lshlrev_b32 v118, 16, v89
    v_and_b32 v119, 0xffff0000, v89
    v_lshlrev_b32 v120, 16, v90
    v_and_b32 v121, 0xffff0000, v90
    v_lshlrev_b32 v122, 16, v91
    v_and_b32 v123, 0xffff0000, v91
    v_pk_fma_f32 v[108:109], v[116:117], v[106:107], v[108:109] op_sel:[0,0,0] op_sel_hi:[1,0,1]
    v_pk_fma_f32 v[110:111], v[118:119], v[106:107], v[110:111] op_sel:[0,0,0] op_sel_hi:[1,0,1]
    v_pk_fma_f32 v[112:113], v[120:121], v[106:107], v[112:113] op_sel:[0,0,0] op_sel_hi:[1,0,1]
    v_pk_fma_f32 v[114:115], v[122:123], v[106:107], v[114:115] op_sel:[0,0,0] op_sel_hi:[1,0,1]
    s_waitcnt vmcnt(17)
    v_lshlrev_b32 v116, 16, v92
    v_and_b32 v117, 0xffff0000, v92
    v_lshlrev_b32 v118, 16, v93
    v_and_b32 v119, 0xffff0000, v93
    v_lshlrev_b32 v120, 16, v94
    v_and_b32 v121, 0xffff0000, v94
    v_lshlrev_b32 v122, 16, v95
    v_and_b32 v123, 0xffff0000, v95
    v_pk_fma_f32 v[108:109], v[116:117], v[106:107], v[108:109] op_sel:[0,1,0] op_sel_hi:[1,1,1]
    v_pk_fma_f32 v[110:111], v[118:119], v[106:107], v[110:111] op_sel:[0,1,0] op_sel_hi:[1,1,1]
    v_pk_fma_f32 v[112:113], v[120:121], v[106:107], v[112:113] op_sel:[0,1,0] op_sel_hi:[1,1,1]
    v_pk_fma_f32 v[114:115], v[122:123], v[106:107], v[114:115] op_sel:[0,1,0] op_sel_hi:[1,1,1]
    s_nop 1
    v_add_f32_dpp v108, v108, v108 row_ror:4 row_mask:0xf bank_mask:0xf
    v_add_f32_dpp v109, v109, v109 row_ror:4 row_mask:0xf bank_mask:0xf
    v_add_f32_dpp v110, v110, v110 row_ror:4 row_mask:0xf bank_mask:0xf
    v_add_f32_dpp v111, v111, v111 row_ror:4 row_mask:0xf bank_mask:0xf
    v_add_f32_dpp v112, v112, v112 row_ror:4 row_mask:0xf bank_mask:0xf
    v_add_f32_dpp v113, v113, v113 row_ror:4 row_mask:0xf bank_mask:0xf
    v_add_f32_dpp v114, v114, v114 row_ror:4 row_mask:0xf bank_mask:0xf
    v_add_f32_dpp v115, v115, v115 row_ror:4 row_mask:0xf bank_mask:0xf
    v_add_f32_dpp v108, v108, v108 row_ror:8 row_mask:0xf bank_mask:0xf
    v_add_f32_dpp v109, v109, v109 row_ror:8 row_mask:0xf bank_mask:0xf
    v_add_f32_dpp v110, v110, v110 row_ror:8 row_mask:0xf bank_mask:0xf
    v_add_f32_dpp v111, v111, v111 row_ror:8 row_mask:0xf bank_mask:0xf
    v_add_f32_dpp v112, v112, v112 row_ror:8 row_mask:0xf bank_mask:0xf
    v_add_f32_dpp v113, v113, v113 row_ror:8 row_mask:0xf bank_mask:0xf
    v_add_f32_dpp v114, v114, v114 row_ror:8 row_mask:0xf bank_mask:0xf
    v_add_f32_dpp v115, v115, v115 row_ror:8 row_mask:0xf bank_mask:0xf
    s_mov_b32 exec_lo, 0x000f000f
    s_mov_b32 exec_hi, 0x000f000f
    ds_write_b128 v6, v[108:111]
    ds_write_b128 v6, v[112:115] offset:16
    s_mov_b64 exec, -1
    s_waitcnt lgkmcnt(0)
    s_barrier
    s_cmp_lg_u32 s3, 0
    s_cbranch_scc1 L_mod_end
    v_and_b32 v7, 31, v0
    v_lshlrev_b32 v7, 2, v7
    v_lshrrev_b32 v6, 5, v0
    v_lshl_add_u32 v6, v6, 10, v7
    v_add_u32 v6, 65536, v6
    ds_read_b32 v116, v6 offset:0
    ds_read_b32 v117, v6 offset:128
    ds_read_b32 v118, v6 offset:256
    ds_read_b32 v119, v6 offset:384
    ds_read_b32 v120, v6 offset:512
    ds_read_b32 v121, v6 offset:640
    ds_read_b32 v122, v6 offset:768
    ds_read_b32 v123, v6 offset:896
    s_lshr_b32 s86, s2, 4
    s_cmp_eq_u32 s86, 6
    s_cselect_b32 s87, 1.0, 0
    s_waitcnt lgkmcnt(0)
    v_add_f32 v116, v116, v120
    v_add_f32 v117, v117, v121
    v_add_f32 v118, v118, v122
    v_add_f32 v119, v119, v123
    v_add_f32 v116, v116, v118
    v_add_f32 v117, v117, v119
    v_add_f32 v116, v116, v117
    v_mov_b32 v117, v116
    s_nop 1
    v_permlane32_swap_b32 v116, v117
    s_nop 1
    v_add_f32 v8, v116, v117
    v_cvt_pk_bf16_f32 v8, v8, v8
    v_lshlrev_b32 v8, 16, v8
    v_add_f32 v8, s87, v8
    v_cvt_pk_bf16_f32 v8, v8, v8
    v_lshlrev_b32 v8, 16, v8
    s_lshl_b32 s86, s84, 7
    s_mov_b32 exec_hi, 0
    buffer_store_dword v8, v7, s[12:15], s86 offen sc1
    s_mov_b64 exec, -1
    s_branch L_mod_end
L_pack:
    s_cmp_lg_u32 s3, 0
    s_cbranch_scc1 L_pc_14_0
    s_call_b64 s[86:87], L_pad14
    s_call_b64 s[86:87], L_pad18
L_pc_14_0:
    s_cmp_lg_u32 s3, 1
    s_cbranch_scc1 L_pc_14_1
    s_call_b64 s[86:87], L_pad15
L_pc_14_1:
    s_cmp_lg_u32 s3, 2
    s_cbranch_scc1 L_pc_14_2
    s_call_b64 s[86:87], L_pad16
L_pc_14_2:
    s_cmp_lg_u32 s3, 3
    s_cbranch_scc1 L_pc_14_3
    s_call_b64 s[86:87], L_pad17
L_pc_14_3:
    v_accvgpr_write_b32 a44, v11
    v_accvgpr_write_b32 a45, v18
L_pack_round:
    v_bfe_u32 v20, v1, 4, 4
    v_lshrrev_b32 v11, 8, v1
    v_lshlrev_b32 v18, 3, v20
    v_lshl_add_u32 v21, v11, 12, v18
    s_lshr_b32 s60, s55, 1
    s_and_b32 s61, s55, 1
    s_lshl_b32 s61, s61, 1
    s_lshr_b32 s86, s3, 1
    s_add_u32 s61, s61, s86
    s_and_b32 s62, s3, 1
    s_lshl_b32 s68, s60, 15
    s_lshl_b32 s86, s61, 8
    s_add_u32 s68, s68, s86
    s_lshl_b32 s86, s62, 7
    s_add_u32 s68, s68, s86
    s_add_u32 s69, s68, 16384
    s_mul_i32 s52, s61, 303104
    s_lshl_b32 s86, s61, 2
    s_sub_u32 s86, s60, s86
    s_and_b32 s86, s86, 15
    s_lshl_b32 s86, s86, 13
    s_add_u32 s52, s52, s86
    s_lshl_b32 s86, s62, 12
    s_add_u32 s52, s52, s86
    s_cmp_ge_u32 s55, 24
    s_cselect_b32 s86, 13, 14
    s_cselect_b32 s63, 4, 8
    v_lshlrev_b32 v23, s86, v11
    v_add_u32 v23, v23, v18
    s_lshr_b32 s86, s55, 3
    s_lshl_b32 s86, s86, 6
    s_and_b32 s87, s55, 4
    s_add_u32 s86, s86, s87
    s_mul_i32 s87, s4, 224
    s_add_u32 s86, s86, s87
    s_lshl_b32 s86, s86, 10
    s_and_b32 s87, s55, 3
    s_mul_i32 s53, s87, 303104
    s_lshl_b32 s87, s87, 8
    s_add_u32 s86, s86, s87
    s_lshl_b32 s87, s62, 2
    s_add_u32 s86, s86, s87
    s_lshr_b32 s87, s3, 1
    s_lshl_b32 s87, s87, 7
    s_add_u32 s86, s86, s87
    s_lshr_b32 s87, s55, 2
    s_lshl_b32 s87, s87, 13
    s_add_u32 s53, s53, s87
    s_lshl_b32 s87, s3, 11
    s_add_u32 s53, s53, s87
    s_add_u32 s53, s53, 245760
    s_cmp_ge_u32 s55, 28
    s_cselect_b32 s53, 0x7f000000, s53
    s_cselect_b32 s70, 0x7f000000, s86
    s_lshl_b32 s63, s63, 10
    s_add_u32 s71, s70, s63
    s_lshl_b32 s60, s55, 2
    s_add_u32 s60, s60, s3
    s_mul_i32 s61, s60, 9363
    s_lshr_b32 s61, s61, 16
    s_mul_i32 s62, s61, 7
    s_sub_u32 s62, s60, s62
    v_and_b32 v22, 1, v20
    v_lshrrev_b32 v20, 2, v20
    v_lshl_add_u32 v20, v20, 1, v22
    s_cmp_eq_u32 s62, 6
    s_cselect_b32 s86, 3, 4
    v_lshlrev_b32 v20, s86, v20
    v_mul_u32_u24 v22, 57344, v11
    v_add_u32 v22, v22, v20
    s_lshr_b32 s86, s61, 1
    s_lshl_b32 s86, s86, 6
    s_and_b32 s87, s61, 1
    s_lshl_b32 s87, s87, 3
    s_add_u32 s86, s86, s87
    s_mul_i32 s86, s86, 3584
    s_mul_i32 s87, s4, 448
    s_add_u32 s86, s86, s87
    s_lshr_b32 s87, s62, 1
    s_lshl_b32 s87, s87, 7
    s_add_u32 s86, s86, s87
    s_and_b32 s87, s62, 1
    s_lshl_b32 s87, s87, 3
    s_add_u32 s86, s86, s87
    s_add_u32 s54, s60, 128
    s_lshl_b32 s54, s54, 10
    s_cmp_ge_u32 s60, 112
    s_cselect_b32 s54, 0x7f000000, s54
    s_cselect_b32 s72, 0x7f000000, s86
    s_add_u32 s73, s72, 7168
    s_add_u32 s74, s72, 14336
    s_add_u32 s75, s72, 21504
    v_mfma_f32_16x16x32_bf16 v[24:27], a[128:131], v[112:115], v[60:63]
    s_waitcnt vmcnt(16)
    v_mfma_f32_16x16x32_bf16 v[24:27], a[132:135], v[116:119], v[24:27]
    s_barrier
    v_mfma_f32_16x16x32_bf16 v[24:27], a[136:139], v[120:123], v[24:27]
    s_add_u32 s81, s81, 16384
    v_exp_f32 v32, v32
    v_mfma_f32_16x16x32_bf16 v[24:27], a[140:143], v[124:127], v[24:27]
    s_and_b32 s81, s81, 0x7ffff
    v_exp_f32 v33, v33
    v_mfma_f32_16x16x32_bf16 v[28:31], a[156:159], v[124:127], v[60:63]
    s_add_u32 s82, s82, 32768
    ds_read_b128 a[128:131], v10 offset:0
    v_cvt_pk_bf16_f32 v44, v32, v33
    v_mfma_f32_16x16x32_bf16 v[28:31], a[152:155], v[120:123], v[28:31]
    s_sub_u32 s92, s82, 163840
    ds_read_b128 a[132:135], v10 offset:1024
    v_mfma_f32_16x16x32_bf16 v[28:31], a[148:151], v[116:119], v[28:31]
    s_min_u32 s82, s82, s92
    v_exp_f32 v34, v34
    v_mfma_f32_16x16x32_bf16 v[28:31], a[144:147], v[112:115], v[28:31]
    s_add_u32 m0, s82, 0
    v_exp_f32 v35, v35
    v_mfma_f32_16x16x32_bf16 v[196:199], a[208:211], v[2:5], v[196:199]
    s_add_u32 s92, s81, 2880
    ds_read_b128 a[136:139], v10 offset:2048
    v_cvt_pk_bf16_f32 v45, v34, v35
    v_mfma_f32_16x16x32_bf16 v[196:199], a[240:243], v[6:9], v[196:199]
    v_exp_f32 v36, v36
    v_mfma_f32_16x16x32_bf16 v[212:215], a[244:247], v[6:9], v[212:215]
    v_exp_f32 v37, v37
    v_mfma_f32_16x16x32_bf16 v[212:215], a[212:215], v[2:5], v[212:215]
    ds_read_b128 a[140:143], v10 offset:3072
    v_cvt_pk_bf16_f32 v46, v36, v37
    v_mfma_f32_16x16x32_bf16 v[228:231], a[216:219], v[2:5], v[228:231]
    ds_read_b128 a[156:159], v10 offset:7168
    v_mfma_f32_16x16x32_bf16 v[228:231], a[248:251], v[6:9], v[228:231]
    buffer_load_dwordx4 v15, s[20:23], s92 offen offset:0  lds
    v_mfma_f32_16x16x32_bf16 v[244:247], a[252:255], v[6:9], v[244:247]
    s_add_u32 s92, s81, 1920
    v_exp_f32 v38, v38
    v_mfma_f32_16x16x32_bf16 v[244:247], a[220:223], v[2:5], v[244:247]
    v_exp_f32 v39, v39
    v_smfmac_f32_16x16x64_bf16 a[116:119], a[108:111], v[2:9], v0
    ds_read_b128 a[152:155], v10 offset:6144
    v_cvt_pk_bf16_f32 v47, v38, v39
    v_mfma_f32_16x16x32_bf16 v[32:35], a[160:163], v[112:115], v[60:63]
    ds_read_b128 a[148:151], v10 offset:5120
    v_mfma_f32_16x16x32_bf16 v[32:35], a[164:167], v[116:119], v[32:35]
    buffer_load_dwordx4 v15, s[20:23], s92 offen offset:1024  lds
    v_mfma_f32_16x16x32_bf16 v[32:35], a[168:171], v[120:123], v[32:35]
    s_branch L_ov14
L_pad14:
    s_setpc_b64 s[86:87]
L_ov14:
    s_add_u32 s92, s81, 960
    v_exp_f32 v24, v24
    v_mfma_f32_16x16x32_bf16 v[32:35], a[172:175], v[124:127], v[32:35]
    v_exp_f32 v25, v25
    v_mfma_f32_16x16x32_bf16 v[36:39], a[188:191], v[124:127], v[60:63]
    ds_read_b128 a[144:147], v10 offset:4096
    v_cvt_pk_bf16_f32 v2, v24, v25
    v_mfma_f32_16x16x32_bf16 v[36:39], a[184:187], v[120:123], v[36:39]
    v_exp_f32 v26, v26
    v_mfma_f32_16x16x32_bf16 v[36:39], a[180:183], v[116:119], v[36:39]
    v_exp_f32 v27, v27
    v_mfma_f32_16x16x32_bf16 v[36:39], a[176:179], v[112:115], v[36:39]
    ds_read_b128 a[160:163], v10 offset:8192
    v_cvt_pk_bf16_f32 v3, v26, v27
    v_mfma_f32_16x16x32_bf16 v[136:139], a[192:195], v[40:43], v[136:139]
    v_exp_f32 v28, v28
    v_mfma_f32_16x16x32_bf16 v[136:139], a[224:227], v[44:47], v[136:139]
    v_exp_f32 v29, v29
    v_mfma_f32_16x16x32_bf16 v[152:155], a[228:231], v[44:47], v[152:155]
    ds_read_b128 a[164:167], v10 offset:9216
    v_cvt_pk_bf16_f32 v4, v28, v29
    v_mfma_f32_16x16x32_bf16 v[152:155], a[196:199], v[40:43], v[152:155]
    ds_read_b128 a[168:171], v10 offset:10240
    v_mfma_f32_16x16x32_bf16 v[168:171], a[200:203], v[40:43], v[168:171]
    buffer_load_dwordx4 v15, s[20:23], s92 offen offset:2048  lds
    v_mfma_f32_16x16x32_bf16 v[168:171], a[232:235], v[44:47], v[168:171]
    s_add_u32 s92, s81, 0
    v_exp_f32 v30, v30
    v_mfma_f32_16x16x32_bf16 v[184:187], a[236:239], v[44:47], v[184:187]
    v_exp_f32 v31, v31
    v_mfma_f32_16x16x32_bf16 v[184:187], a[204:207], v[40:43], v[184:187]
    s_waitcnt lgkmcnt(3)
    ds_read_b128 a[172:175], v10 offset:11264
    v_cvt_pk_bf16_f32 v5, v30, v31
    v_mfma_f32_16x16x32_bf16 v[24:27], a[128:131], v[64:67], v[48:51]
    ds_read_b128 a[188:191], v10 offset:15360
    v_mfma_f32_16x16x32_bf16 v[24:27], a[132:135], v[68:71], v[24:27]
    buffer_load_dwordx4 v15, s[20:23], s92 offen offset:3072  lds
    v_mfma_f32_16x16x32_bf16 v[24:27], a[136:139], v[72:75], v[24:27]
    s_add_u32 m0, s82, 16384
    v_exp_f32 v32, v32
    v_mfma_f32_16x16x32_bf16 v[24:27], a[140:143], v[76:79], v[24:27]
    s_add_u32 s92, s81, 2880
    v_exp_f32 v33, v33
    v_mfma_f32_16x16x32_bf16 v[28:31], a[156:159], v[76:79], v[48:51]
    ds_read_b128 a[184:187], v10 offset:14336
    v_cvt_pk_bf16_f32 v6, v32, v33
    v_mfma_f32_16x16x32_bf16 v[28:31], a[152:155], v[72:75], v[28:31]
    v_add_u32 v19, s83, v14
    v_xor_b32 v12, 32, v19
    v_mfma_f32_16x16x32_bf16 v[28:31], a[148:151], v[68:71], v[28:31]
    v_exp_f32 v34, v34
    v_mfma_f32_16x16x32_bf16 v[28:31], a[144:147], v[64:67], v[28:31]
    v_exp_f32 v35, v35
    v_mfma_f32_16x16x32_bf16 v[200:203], a[208:211], v[40:43], v[200:203]
    ds_read_b128 a[180:183], v10 offset:13312
    v_cvt_pk_bf16_f32 v7, v34, v35
    v_mfma_f32_16x16x32_bf16 v[200:203], a[240:243], v[44:47], v[200:203]
    s_add_u32 s83, s83, 32768
    v_exp_f32 v36, v36
    v_mfma_f32_16x16x32_bf16 v[216:219], a[244:247], v[44:47], v[216:219]
    s_sub_u32 s90, s83, 163840
    v_exp_f32 v37, v37
    v_mfma_f32_16x16x32_bf16 v[216:219], a[212:215], v[40:43], v[216:219]
    s_min_u32 s83, s83, s90
    ds_read_b128 a[176:179], v10 offset:12288
    v_cvt_pk_bf16_f32 v8, v36, v37
    v_mfma_f32_16x16x32_bf16 v[232:235], a[216:219], v[40:43], v[232:235]
    v_add_u32 v10, s83, v13
    v_mfma_f32_16x16x32_bf16 v[232:235], a[248:251], v[44:47], v[232:235]
    buffer_load_dwordx4 v15, s[24:27], s92 offen offset:0  lds
    v_mfma_f32_16x16x32_bf16 v[248:251], a[252:255], v[44:47], v[248:251]
    s_add_u32 s92, s81, 1920
    v_exp_f32 v38, v38
    v_mfma_f32_16x16x32_bf16 v[248:251], a[220:223], v[40:43], v[248:251]
    v_exp_f32 v39, v39
    v_smfmac_f32_16x16x64_bf16 a[120:123], a[108:111], v[40:47], v0
    s_waitcnt lgkmcnt(3)
    v_cvt_pk_bf16_f32 v9, v38, v39
    v_mfma_f32_16x16x32_bf16 v[32:35], a[160:163], v[64:67], v[48:51]
    v_exp_f32 v24, v24
    v_mfma_f32_16x16x32_bf16 v[32:35], a[164:167], v[68:71], v[32:35]
    v_exp_f32 v25, v25
    v_mfma_f32_16x16x32_bf16 v[32:35], a[168:171], v[72:75], v[32:35]
    v_exp_f32 v26, v26
    v_mfma_f32_16x16x32_bf16 v[32:35], a[172:175], v[76:79], v[32:35]
    v_exp_f32 v27, v27
    v_mfma_f32_16x16x32_bf16 v[36:39], a[188:191], v[76:79], v[48:51]
    s_waitcnt lgkmcnt(2)
    v_exp_f32 v28, v28
    v_mfma_f32_16x16x32_bf16 v[36:39], a[184:187], v[72:75], v[36:39]
    s_waitcnt lgkmcnt(1)
    v_exp_f32 v29, v29
    v_mfma_f32_16x16x32_bf16 v[36:39], a[180:183], v[68:71], v[36:39]
    s_waitcnt lgkmcnt(0)
    v_exp_f32 v30, v30
    v_mfma_f32_16x16x32_bf16 v[36:39], a[176:179], v[64:67], v[36:39]
    v_exp_f32 v31, v31
    v_mfma_f32_16x16x32_bf16 v[140:143], a[192:195], v[2:5], v[140:143]
    v_cvt_pk_bf16_f32 v40, v24, v25
    v_cvt_pk_bf16_f32 v41, v26, v27
    v_mfma_f32_16x16x32_bf16 v[140:143], a[224:227], v[6:9], v[140:143]
    ds_read_b64_tr_b16 a[192:193], v19 offset:16384
    v_cvt_pk_bf16_f32 v42, v28, v29
    v_mfma_f32_16x16x32_bf16 v[156:159], a[228:231], v[6:9], v[156:159]
    ds_read_b64_tr_b16 a[194:195], v19 offset:20480
    v_mfma_f32_16x16x32_bf16 v[156:159], a[196:199], v[2:5], v[156:159]
    ds_read_b64_tr_b16 a[224:225], v19 offset:24576
    v_cvt_pk_bf16_f32 v43, v30, v31
    v_mfma_f32_16x16x32_bf16 v[172:175], a[200:203], v[2:5], v[172:175]
    ds_read_b64_tr_b16 a[226:227], v19 offset:28672
    v_mfma_f32_16x16x32_bf16 v[172:175], a[232:235], v[6:9], v[172:175]
    ds_read_b64_tr_b16 a[228:229], v12 offset:24576
    s_mov_b64 exec, s[56:57]
    buffer_load_dwordx2 a[16:17], v22, s[44:47], s72 offen offset:0
    s_mov_b64 exec, -1
    v_mfma_f32_16x16x32_bf16 v[188:191], a[236:239], v[6:9], v[188:191]
    ds_read_b64_tr_b16 a[230:231], v12 offset:28672
    v_mfma_f32_16x16x32_bf16 v[188:191], a[204:207], v[2:5], v[188:191]
    ds_read_b64_tr_b16 a[196:197], v12 offset:16384
    v_mfma_f32_16x16x32_bf16 v[24:27], a[128:131], v[80:83], v[52:55]
    ds_read_b64_tr_b16 a[198:199], v12 offset:20480
    v_mfma_f32_16x16x32_bf16 v[24:27], a[132:135], v[84:87], v[24:27]
    ds_read_b64_tr_b16 a[200:201], v19 offset:17408
    s_mov_b64 exec, s[58:59]
    buffer_load_dwordx2 a[16:17], v22, s[48:51], s72 offen offset:0
    s_mov_b64 exec, -1
    v_mfma_f32_16x16x32_bf16 v[24:27], a[136:139], v[88:91], v[24:27]
    v_exp_f32 v32, v32
    v_mfma_f32_16x16x32_bf16 v[24:27], a[140:143], v[92:95], v[24:27]
    v_exp_f32 v33, v33
    v_mfma_f32_16x16x32_bf16 v[28:31], a[156:159], v[92:95], v[52:55]
    ds_read_b64_tr_b16 a[202:203], v19 offset:21504
    v_cvt_pk_bf16_f32 v44, v32, v33
    v_mfma_f32_16x16x32_bf16 v[28:31], a[152:155], v[88:91], v[28:31]
    ds_read_b64_tr_b16 a[232:233], v19 offset:25600
    v_mfma_f32_16x16x32_bf16 v[28:31], a[148:151], v[84:87], v[28:31]
    v_exp_f32 v34, v34
    v_mfma_f32_16x16x32_bf16 v[28:31], a[144:147], v[80:83], v[28:31]
    v_exp_f32 v35, v35
    v_mfma_f32_16x16x32_bf16 v[204:207], a[208:211], v[2:5], v[204:207]
    ds_read_b64_tr_b16 a[234:235], v19 offset:29696
    v_cvt_pk_bf16_f32 v45, v34, v35
    v_mfma_f32_16x16x32_bf16 v[204:207], a[240:243], v[6:9], v[204:207]
    v_exp_f32 v36, v36
    v_mfma_f32_16x16x32_bf16 v[220:223], a[244:247], v[6:9], v[220:223]
    v_exp_f32 v37, v37
    v_mfma_f32_16x16x32_bf16 v[220:223], a[212:215], v[2:5], v[220:223]
    ds_read_b64_tr_b16 a[236:237], v12 offset:25600
    v_cvt_pk_bf16_f32 v46, v36, v37
    v_mfma_f32_16x16x32_bf16 v[236:239], a[216:219], v[2:5], v[236:239]
    ds_read_b64_tr_b16 a[238:239], v12 offset:29696
    v_mfma_f32_16x16x32_bf16 v[236:239], a[248:251], v[6:9], v[236:239]
    ds_read_b64_tr_b16 a[204:205], v12 offset:17408
    s_mov_b64 exec, s[56:57]
    buffer_load_dwordx2 a[18:19], v22, s[44:47], s72 offen offset:3584
    s_mov_b64 exec, -1
    v_mfma_f32_16x16x32_bf16 v[252:255], a[252:255], v[6:9], v[252:255]
    v_exp_f32 v38, v38
    v_mfma_f32_16x16x32_bf16 v[252:255], a[220:223], v[2:5], v[252:255]
    v_exp_f32 v39, v39
    v_smfmac_f32_16x16x64_bf16 a[124:127], a[108:111], v[2:9], v0
    ds_read_b64_tr_b16 a[206:207], v12 offset:21504
    v_cvt_pk_bf16_f32 v47, v38, v39
    v_mfma_f32_16x16x32_bf16 v[32:35], a[160:163], v[80:83], v[52:55]
    ds_read_b64_tr_b16 a[208:209], v19 offset:18432
    v_mfma_f32_16x16x32_bf16 v[32:35], a[164:167], v[84:87], v[32:35]
    ds_read_b64_tr_b16 a[210:211], v19 offset:22528
    s_mov_b64 exec, s[58:59]
    buffer_load_dwordx2 a[18:19], v22, s[48:51], s72 offen offset:3584
    s_mov_b64 exec, -1
    v_mfma_f32_16x16x32_bf16 v[32:35], a[168:171], v[88:91], v[32:35]
    ds_read_b64_tr_b16 a[240:241], v19 offset:26624
    v_exp_f32 v24, v24
    v_mfma_f32_16x16x32_bf16 v[32:35], a[172:175], v[92:95], v[32:35]
    v_exp_f32 v25, v25
    v_mfma_f32_16x16x32_bf16 v[36:39], a[188:191], v[92:95], v[52:55]
    ds_read_b64_tr_b16 a[242:243], v19 offset:30720
    v_cvt_pk_bf16_f32 v2, v24, v25
    v_mfma_f32_16x16x32_bf16 v[36:39], a[184:187], v[88:91], v[36:39]
    v_exp_f32 v26, v26
    v_mfma_f32_16x16x32_bf16 v[36:39], a[180:183], v[84:87], v[36:39]
    v_exp_f32 v27, v27
    v_mfma_f32_16x16x32_bf16 v[36:39], a[176:179], v[80:83], v[36:39]
    s_waitcnt lgkmcnt(4)
    ds_read_b64_tr_b16 a[244:245], v12 offset:26624
    v_cvt_pk_bf16_f32 v3, v26, v27
    v_mfma_f32_16x16x32_bf16 v[128:131], a[192:195], v[40:43], v[128:131]
    v_exp_f32 v28, v28
    v_mfma_f32_16x16x32_bf16 v[128:131], a[224:227], v[44:47], v[128:131]
    v_exp_f32 v29, v29
    v_mfma_f32_16x16x32_bf16 v[144:147], a[228:231], v[44:47], v[144:147]
    ds_read_b64_tr_b16 a[246:247], v12 offset:30720
    v_cvt_pk_bf16_f32 v4, v28, v29
    v_mfma_f32_16x16x32_bf16 v[144:147], a[196:199], v[40:43], v[144:147]
    ds_read_b64_tr_b16 a[212:213], v12 offset:18432
    v_mfma_f32_16x16x32_bf16 v[160:163], a[200:203], v[40:43], v[160:163]
    ds_read_b64_tr_b16 a[214:215], v12 offset:22528
    s_mov_b64 exec, s[56:57]
    buffer_load_dwordx2 a[20:21], v22, s[44:47], s73 offen offset:0
    s_mov_b64 exec, -1
    v_mfma_f32_16x16x32_bf16 v[160:163], a[232:235], v[44:47], v[160:163]
    v_exp_f32 v30, v30
    v_mfma_f32_16x16x32_bf16 v[176:179], a[236:239], v[44:47], v[176:179]
    v_exp_f32 v31, v31
    v_mfma_f32_16x16x32_bf16 v[176:179], a[204:207], v[40:43], v[176:179]
    ds_read_b64_tr_b16 a[216:217], v19 offset:19456
    v_cvt_pk_bf16_f32 v5, v30, v31
    v_smfmac_f32_16x16x64_bf16 a[112:115], a[108:111], v[40:47], v0
    ds_read_b64_tr_b16 a[218:219], v19 offset:23552
    v_mfma_f32_16x16x32_bf16 v[24:27], a[128:131], v[96:99], v[56:59]
    ds_read_b64_tr_b16 a[248:249], v19 offset:27648
    s_mov_b64 exec, s[58:59]
    buffer_load_dwordx2 a[20:21], v22, s[48:51], s73 offen offset:0
    s_mov_b64 exec, -1
    v_mfma_f32_16x16x32_bf16 v[24:27], a[132:135], v[100:103], v[24:27]
    ds_read_b64_tr_b16 a[250:251], v19 offset:31744
    v_mfma_f32_16x16x32_bf16 v[24:27], a[136:139], v[104:107], v[24:27]
    ds_read_b64_tr_b16 a[252:253], v12 offset:27648
    v_mfma_f32_16x16x32_bf16 v[24:27], a[140:143], v[108:111], v[24:27]
    ds_read_b64_tr_b16 a[254:255], v12 offset:31744
    v_mfma_f32_16x16x32_bf16 v[28:31], a[156:159], v[108:111], v[56:59]
    ds_read_b64_tr_b16 a[220:221], v12 offset:19456
    s_mov_b64 exec, s[56:57]
    buffer_load_dwordx2 a[22:23], v22, s[44:47], s73 offen offset:3584
    s_mov_b64 exec, -1
    v_mfma_f32_16x16x32_bf16 v[28:31], a[152:155], v[104:107], v[28:31]
    ds_read_b64_tr_b16 a[222:223], v12 offset:23552
    v_mfma_f32_16x16x32_bf16 v[28:31], a[148:151], v[100:103], v[28:31]
    v_exp_f32 v32, v32
    v_mfma_f32_16x16x32_bf16 v[28:31], a[144:147], v[96:99], v[28:31]
    s_waitcnt lgkmcnt(4)
    v_exp_f32 v33, v33
    v_mfma_f32_16x16x32_bf16 v[192:195], a[208:211], v[40:43], v[192:195]
    v_exp_f32 v34, v34
    v_mfma_f32_16x16x32_bf16 v[192:195], a[240:243], v[44:47], v[192:195]
    v_exp_f32 v35, v35
    v_mfma_f32_16x16x32_bf16 v[208:211], a[244:247], v[44:47], v[208:211]
    v_cvt_pk_bf16_f32 v6, v32, v33
    v_cvt_pk_bf16_f32 v7, v34, v35
    v_mfma_f32_16x16x32_bf16 v[208:211], a[212:215], v[40:43], v[208:211]
    v_exp_f32 v36, v36
    v_mfma_f32_16x16x32_bf16 v[224:227], a[216:219], v[40:43], v[224:227]
    v_exp_f32 v37, v37
    v_mfma_f32_16x16x32_bf16 v[224:227], a[248:251], v[44:47], v[224:227]
    s_waitcnt lgkmcnt(2)
    v_exp_f32 v38, v38
    v_mfma_f32_16x16x32_bf16 v[240:243], a[252:255], v[44:47], v[240:243]
    s_waitcnt lgkmcnt(0)
    v_exp_f32 v39, v39
    v_mfma_f32_16x16x32_bf16 v[240:243], a[220:223], v[40:43], v[240:243]
    v_cvt_pk_bf16_f32 v8, v36, v37
    v_cvt_pk_bf16_f32 v9, v38, v39
    v_mfma_f32_16x16x32_bf16 v[32:35], a[160:163], v[96:99], v[56:59]
    v_exp_f32 v24, v24
    v_mfma_f32_16x16x32_bf16 v[32:35], a[164:167], v[100:103], v[32:35]
    v_exp_f32 v25, v25
    v_mfma_f32_16x16x32_bf16 v[32:35], a[168:171], v[104:107], v[32:35]
    v_cvt_pk_bf16_f32 v40, v24, v25
    v_mfma_f32_16x16x32_bf16 v[32:35], a[172:175], v[108:111], v[32:35]
    buffer_load_dwordx4 v15, s[24:27], s92 offen offset:1024  lds
    v_mfma_f32_16x16x32_bf16 v[36:39], a[188:191], v[108:111], v[56:59]
    s_add_u32 s92, s81, 960
    v_exp_f32 v26, v26
    v_mfma_f32_16x16x32_bf16 v[36:39], a[184:187], v[104:107], v[36:39]
    v_exp_f32 v27, v27
    v_mfma_f32_16x16x32_bf16 v[36:39], a[180:183], v[100:103], v[36:39]
    v_cvt_pk_bf16_f32 v41, v26, v27
    v_mfma_f32_16x16x32_bf16 v[36:39], a[176:179], v[96:99], v[36:39]
    buffer_load_dwordx4 v15, s[24:27], s92 offen offset:2048  lds
    v_mfma_f32_16x16x32_bf16 v[132:135], a[192:195], v[2:5], v[132:135]
    s_add_u32 s92, s81, 0
    v_exp_f32 v28, v28
    v_mfma_f32_16x16x32_bf16 v[132:135], a[224:227], v[6:9], v[132:135]
    v_exp_f32 v29, v29
    v_mfma_f32_16x16x32_bf16 v[148:151], a[228:231], v[6:9], v[148:151]
    v_cvt_pk_bf16_f32 v42, v28, v29
    v_mfma_f32_16x16x32_bf16 v[148:151], a[196:199], v[2:5], v[148:151]
    buffer_load_dwordx4 v15, s[24:27], s92 offen offset:3072  lds
    v_mfma_f32_16x16x32_bf16 v[164:167], a[200:203], v[2:5], v[164:167]
    v_exp_f32 v30, v30
    v_mfma_f32_16x16x32_bf16 v[164:167], a[232:235], v[6:9], v[164:167]
    v_exp_f32 v31, v31
    v_mfma_f32_16x16x32_bf16 v[180:183], a[236:239], v[6:9], v[180:183]
    v_cvt_pk_bf16_f32 v43, v30, v31
    v_mfma_f32_16x16x32_bf16 v[180:183], a[204:207], v[2:5], v[180:183]
    s_mov_b64 exec, s[58:59]
    buffer_load_dwordx2 a[22:23], v22, s[48:51], s73 offen offset:3584
    s_mov_b64 exec, -1
    v_mfma_f32_16x16x32_bf16 v[24:27], a[128:131], v[112:115], v[60:63]
    s_waitcnt vmcnt(24)
    v_mfma_f32_16x16x32_bf16 v[24:27], a[132:135], v[116:119], v[24:27]
    s_barrier
    v_mfma_f32_16x16x32_bf16 v[24:27], a[136:139], v[120:123], v[24:27]
    s_add_u32 s81, s81, 16384
    v_exp_f32 v32, v32
    v_mfma_f32_16x16x32_bf16 v[24:27], a[140:143], v[124:127], v[24:27]
    s_and_b32 s81, s81, 0x7ffff
    v_exp_f32 v33, v33
    v_mfma_f32_16x16x32_bf16 v[28:31], a[156:159], v[124:127], v[60:63]
    s_add_u32 s82, s82, 32768
    ds_read_b128 a[128:131], v10 offset:0
    v_cvt_pk_bf16_f32 v44, v32, v33
    v_mfma_f32_16x16x32_bf16 v[28:31], a[152:155], v[120:123], v[28:31]
    s_sub_u32 s92, s82, 163840
    ds_read_b128 a[132:135], v10 offset:1024
    v_mfma_f32_16x16x32_bf16 v[28:31], a[148:151], v[116:119], v[28:31]
    s_min_u32 s82, s82, s92
    v_exp_f32 v34, v34
    v_mfma_f32_16x16x32_bf16 v[28:31], a[144:147], v[112:115], v[28:31]
    s_add_u32 m0, s82, 0
    v_exp_f32 v35, v35
    v_mfma_f32_16x16x32_bf16 v[196:199], a[208:211], v[2:5], v[196:199]
    s_add_u32 s92, s81, 2880
    ds_read_b128 a[136:139], v10 offset:2048
    v_cvt_pk_bf16_f32 v45, v34, v35
    v_mfma_f32_16x16x32_bf16 v[196:199], a[240:243], v[6:9], v[196:199]
    v_exp_f32 v36, v36
    v_mfma_f32_16x16x32_bf16 v[212:215], a[244:247], v[6:9], v[212:215]
    v_exp_f32 v37, v37
    v_mfma_f32_16x16x32_bf16 v[212:215], a[212:215], v[2:5], v[212:215]
    ds_read_b128 a[140:143], v10 offset:3072
    v_cvt_pk_bf16_f32 v46, v36, v37
    v_mfma_f32_16x16x32_bf16 v[228:231], a[216:219], v[2:5], v[228:231]
    ds_read_b128 a[156:159], v10 offset:7168
    v_mfma_f32_16x16x32_bf16 v[228:231], a[248:251], v[6:9], v[228:231]
    buffer_load_dwordx4 v15, s[20:23], s92 offen offset:0  lds
    v_mfma_f32_16x16x32_bf16 v[244:247], a[252:255], v[6:9], v[244:247]
    s_add_u32 s92, s81, 1920
    v_exp_f32 v38, v38
    v_mfma_f32_16x16x32_bf16 v[244:247], a[220:223], v[2:5], v[244:247]
    v_exp_f32 v39, v39
    v_smfmac_f32_16x16x64_bf16 a[116:119], a[108:111], v[2:9], v0
    ds_read_b128 a[152:155], v10 offset:6144
    v_cvt_pk_bf16_f32 v47, v38, v39
    v_mfma_f32_16x16x32_bf16 v[32:35], a[160:163], v[112:115], v[60:63]
    ds_read_b128 a[148:151], v10 offset:5120
    v_mfma_f32_16x16x32_bf16 v[32:35], a[164:167], v[116:119], v[32:35]
    buffer_load_dwordx4 v15, s[20:23], s92 offen offset:1024  lds
    v_mfma_f32_16x16x32_bf16 v[32:35], a[168:171], v[120:123], v[32:35]
    s_add_u32 s92, s81, 960
    v_exp_f32 v24, v24
    v_mfma_f32_16x16x32_bf16 v[32:35], a[172:175], v[124:127], v[32:35]
    v_exp_f32 v25, v25
    v_mfma_f32_16x16x32_bf16 v[36:39], a[188:191], v[124:127], v[60:63]
    ds_read_b128 a[144:147], v10 offset:4096
    v_cvt_pk_bf16_f32 v2, v24, v25
    v_mfma_f32_16x16x32_bf16 v[36:39], a[184:187], v[120:123], v[36:39]
    v_exp_f32 v26, v26
    v_mfma_f32_16x16x32_bf16 v[36:39], a[180:183], v[116:119], v[36:39]
    v_exp_f32 v27, v27
    v_mfma_f32_16x16x32_bf16 v[36:39], a[176:179], v[112:115], v[36:39]
    ds_read_b128 a[160:163], v10 offset:8192
    v_cvt_pk_bf16_f32 v3, v26, v27
    v_mfma_f32_16x16x32_bf16 v[136:139], a[192:195], v[40:43], v[136:139]
    v_exp_f32 v28, v28
    v_mfma_f32_16x16x32_bf16 v[136:139], a[224:227], v[44:47], v[136:139]
    v_exp_f32 v29, v29
    v_mfma_f32_16x16x32_bf16 v[152:155], a[228:231], v[44:47], v[152:155]
    ds_read_b128 a[164:167], v10 offset:9216
    v_cvt_pk_bf16_f32 v4, v28, v29
    v_mfma_f32_16x16x32_bf16 v[152:155], a[196:199], v[40:43], v[152:155]
    ds_read_b128 a[168:171], v10 offset:10240
    v_mfma_f32_16x16x32_bf16 v[168:171], a[200:203], v[40:43], v[168:171]
    buffer_load_dwordx4 v15, s[20:23], s92 offen offset:2048  lds
    v_mfma_f32_16x16x32_bf16 v[168:171], a[232:235], v[44:47], v[168:171]
    s_add_u32 s92, s81, 0
    v_exp_f32 v30, v30
    v_mfma_f32_16x16x32_bf16 v[184:187], a[236:239], v[44:47], v[184:187]
    v_exp_f32 v31, v31
    v_mfma_f32_16x16x32_bf16 v[184:187], a[204:207], v[40:43], v[184:187]
    s_waitcnt lgkmcnt(3)
    ds_read_b128 a[172:175], v10 offset:11264
    v_cvt_pk_bf16_f32 v5, v30, v31
    v_mfma_f32_16x16x32_bf16 v[24:27], a[128:131], v[64:67], v[48:51]
    ds_read_b128 a[188:191], v10 offset:15360
    v_mfma_f32_16x16x32_bf16 v[24:27], a[132:135], v[68:71], v[24:27]
    buffer_load_dwordx4 v15, s[20:23], s92 offen offset:3072  lds
    v_mfma_f32_16x16x32_bf16 v[24:27], a[136:139], v[72:75], v[24:27]
    s_add_u32 m0, s82, 16384
    v_exp_f32 v32, v32
    v_mfma_f32_16x16x32_bf16 v[24:27], a[140:143], v[76:79], v[24:27]
    s_add_u32 s92, s81, 2880
    v_exp_f32 v33, v33
    v_mfma_f32_16x16x32_bf16 v[28:31], a[156:159], v[76:79], v[48:51]
    ds_read_b128 a[184:187], v10 offset:14336
    v_cvt_pk_bf16_f32 v6, v32, v33
    v_mfma_f32_16x16x32_bf16 v[28:31], a[152:155], v[72:75], v[28:31]
    v_add_u32 v19, s83, v14
    v_xor_b32 v12, 32, v19
    v_mfma_f32_16x16x32_bf16 v[28:31], a[148:151], v[68:71], v[28:31]
    v_exp_f32 v34, v34
    v_mfma_f32_16x16x32_bf16 v[28:31], a[144:147], v[64:67], v[28:31]
    v_exp_f32 v35, v35
    v_mfma_f32_16x16x32_bf16 v[200:203], a[208:211], v[40:43], v[200:203]
    ds_read_b128 a[180:183], v10 offset:13312
    v_cvt_pk_bf16_f32 v7, v34, v35
    v_mfma_f32_16x16x32_bf16 v[200:203], a[240:243], v[44:47], v[200:203]
    s_add_u32 s83, s83, 32768
    v_exp_f32 v36, v36
    v_mfma_f32_16x16x32_bf16 v[216:219], a[244:247], v[44:47], v[216:219]
    s_sub_u32 s90, s83, 163840
    v_exp_f32 v37, v37
    v_mfma_f32_16x16x32_bf16 v[216:219], a[212:215], v[40:43], v[216:219]
    s_min_u32 s83, s83, s90
    ds_read_b128 a[176:179], v10 offset:12288
    v_cvt_pk_bf16_f32 v8, v36, v37
    v_mfma_f32_16x16x32_bf16 v[232:235], a[216:219], v[40:43], v[232:235]
    v_add_u32 v10, s83, v13
    v_mfma_f32_16x16x32_bf16 v[232:235], a[248:251], v[44:47], v[232:235]
    buffer_load_dwordx4 v15, s[24:27], s92 offen offset:0  lds
    v_mfma_f32_16x16x32_bf16 v[248:251], a[252:255], v[44:47], v[248:251]
    s_add_u32 s92, s81, 1920
    v_exp_f32 v38, v38
    v_mfma_f32_16x16x32_bf16 v[248:251], a[220:223], v[40:43], v[248:251]
    v_exp_f32 v39, v39
    v_smfmac_f32_16x16x64_bf16 a[120:123], a[108:111], v[40:47], v0
    s_waitcnt lgkmcnt(3)
    v_cvt_pk_bf16_f32 v9, v38, v39
    v_mfma_f32_16x16x32_bf16 v[32:35], a[160:163], v[64:67], v[48:51]
    v_exp_f32 v24, v24
    v_mfma_f32_16x16x32_bf16 v[32:35], a[164:167], v[68:71], v[32:35]
    v_exp_f32 v25, v25
    v_mfma_f32_16x16x32_bf16 v[32:35], a[168:171], v[72:75], v[32:35]
    v_exp_f32 v26, v26
    v_mfma_f32_16x16x32_bf16 v[32:35], a[172:175], v[76:79], v[32:35]
    v_exp_f32 v27, v27
    v_mfma_f32_16x16x32_bf16 v[36:39], a[188:191], v[76:79], v[48:51]
    s_waitcnt lgkmcnt(2)
    v_exp_f32 v28, v28
    v_mfma_f32_16x16x32_bf16 v[36:39], a[184:187], v[72:75], v[36:39]
    s_waitcnt lgkmcnt(1)
    v_exp_f32 v29, v29
    v_mfma_f32_16x16x32_bf16 v[36:39], a[180:183], v[68:71], v[36:39]
    s_waitcnt lgkmcnt(0)
    v_exp_f32 v30, v30
    v_mfma_f32_16x16x32_bf16 v[36:39], a[176:179], v[64:67], v[36:39]
    v_exp_f32 v31, v31
    v_mfma_f32_16x16x32_bf16 v[140:143], a[192:195], v[2:5], v[140:143]
    v_cvt_pk_bf16_f32 v40, v24, v25
    v_cvt_pk_bf16_f32 v41, v26, v27
    v_mfma_f32_16x16x32_bf16 v[140:143], a[224:227], v[6:9], v[140:143]
    ds_read_b64_tr_b16 a[192:193], v19 offset:16384
    v_cvt_pk_bf16_f32 v42, v28, v29
    v_mfma_f32_16x16x32_bf16 v[156:159], a[228:231], v[6:9], v[156:159]
    ds_read_b64_tr_b16 a[194:195], v19 offset:20480
    v_mfma_f32_16x16x32_bf16 v[156:159], a[196:199], v[2:5], v[156:159]
    ds_read_b64_tr_b16 a[224:225], v19 offset:24576
    v_cvt_pk_bf16_f32 v43, v30, v31
    v_mfma_f32_16x16x32_bf16 v[172:175], a[200:203], v[2:5], v[172:175]
    ds_read_b64_tr_b16 a[226:227], v19 offset:28672
    v_mfma_f32_16x16x32_bf16 v[172:175], a[232:235], v[6:9], v[172:175]
    ds_read_b64_tr_b16 a[228:229], v12 offset:24576
    s_mov_b64 exec, s[56:57]
    buffer_load_dwordx2 a[24:25], v22, s[44:47], s74 offen offset:0
    s_mov_b64 exec, -1
    v_mfma_f32_16x16x32_bf16 v[188:191], a[236:239], v[6:9], v[188:191]
    ds_read_b64_tr_b16 a[230:231], v12 offset:28672
    v_mfma_f32_16x16x32_bf16 v[188:191], a[204:207], v[2:5], v[188:191]
    ds_read_b64_tr_b16 a[196:197], v12 offset:16384
    v_mfma_f32_16x16x32_bf16 v[24:27], a[128:131], v[80:83], v[52:55]
    ds_read_b64_tr_b16 a[198:199], v12 offset:20480
    v_mfma_f32_16x16x32_bf16 v[24:27], a[132:135], v[84:87], v[24:27]
    ds_read_b64_tr_b16 a[200:201], v19 offset:17408
    s_mov_b64 exec, s[58:59]
    buffer_load_dwordx2 a[24:25], v22, s[48:51], s74 offen offset:0
    s_mov_b64 exec, -1
    v_mfma_f32_16x16x32_bf16 v[24:27], a[136:139], v[88:91], v[24:27]
    v_exp_f32 v32, v32
    v_mfma_f32_16x16x32_bf16 v[24:27], a[140:143], v[92:95], v[24:27]
    v_exp_f32 v33, v33
    v_mfma_f32_16x16x32_bf16 v[28:31], a[156:159], v[92:95], v[52:55]
    ds_read_b64_tr_b16 a[202:203], v19 offset:21504
    v_cvt_pk_bf16_f32 v44, v32, v33
    v_mfma_f32_16x16x32_bf16 v[28:31], a[152:155], v[88:91], v[28:31]
    ds_read_b64_tr_b16 a[232:233], v19 offset:25600
    v_mfma_f32_16x16x32_bf16 v[28:31], a[148:151], v[84:87], v[28:31]
    v_exp_f32 v34, v34
    v_mfma_f32_16x16x32_bf16 v[28:31], a[144:147], v[80:83], v[28:31]
    v_exp_f32 v35, v35
    v_mfma_f32_16x16x32_bf16 v[204:207], a[208:211], v[2:5], v[204:207]
    ds_read_b64_tr_b16 a[234:235], v19 offset:29696
    v_cvt_pk_bf16_f32 v45, v34, v35
    v_mfma_f32_16x16x32_bf16 v[204:207], a[240:243], v[6:9], v[204:207]
    v_exp_f32 v36, v36
    v_mfma_f32_16x16x32_bf16 v[220:223], a[244:247], v[6:9], v[220:223]
    v_exp_f32 v37, v37
    v_mfma_f32_16x16x32_bf16 v[220:223], a[212:215], v[2:5], v[220:223]
    ds_read_b64_tr_b16 a[236:237], v12 offset:25600
    v_cvt_pk_bf16_f32 v46, v36, v37
    v_mfma_f32_16x16x32_bf16 v[236:239], a[216:219], v[2:5], v[236:239]
    ds_read_b64_tr_b16 a[238:239], v12 offset:29696
    v_mfma_f32_16x16x32_bf16 v[236:239], a[248:251], v[6:9], v[236:239]
    ds_read_b64_tr_b16 a[204:205], v12 offset:17408
    s_mov_b64 exec, s[56:57]
    buffer_load_dwordx2 a[26:27], v22, s[44:47], s74 offen offset:3584
    s_mov_b64 exec, -1
    v_mfma_f32_16x16x32_bf16 v[252:255], a[252:255], v[6:9], v[252:255]
    v_exp_f32 v38, v38
    v_mfma_f32_16x16x32_bf16 v[252:255], a[220:223], v[2:5], v[252:255]
    v_exp_f32 v39, v39
    v_smfmac_f32_16x16x64_bf16 a[124:127], a[108:111], v[2:9], v0
    ds_read_b64_tr_b16 a[206:207], v12 offset:21504
    v_cvt_pk_bf16_f32 v47, v38, v39
    v_mfma_f32_16x16x32_bf16 v[32:35], a[160:163], v[80:83], v[52:55]
    ds_read_b64_tr_b16 a[208:209], v19 offset:18432
    v_mfma_f32_16x16x32_bf16 v[32:35], a[164:167], v[84:87], v[32:35]
    ds_read_b64_tr_b16 a[210:211], v19 offset:22528
    s_mov_b64 exec, s[58:59]
    buffer_load_dwordx2 a[26:27], v22, s[48:51], s74 offen offset:3584
    s_mov_b64 exec, -1
    v_mfma_f32_16x16x32_bf16 v[32:35], a[168:171], v[88:91], v[32:35]
    ds_read_b64_tr_b16 a[240:241], v19 offset:26624
    v_exp_f32 v24, v24
    v_mfma_f32_16x16x32_bf16 v[32:35], a[172:175], v[92:95], v[32:35]
    v_exp_f32 v25, v25
    v_mfma_f32_16x16x32_bf16 v[36:39], a[188:191], v[92:95], v[52:55]
    ds_read_b64_tr_b16 a[242:243], v19 offset:30720
    v_cvt_pk_bf16_f32 v2, v24, v25
    v_mfma_f32_16x16x32_bf16 v[36:39], a[184:187], v[88:91], v[36:39]
    v_exp_f32 v26, v26
    v_mfma_f32_16x16x32_bf16 v[36:39], a[180:183], v[84:87], v[36:39]
    v_exp_f32 v27, v27
    v_mfma_f32_16x16x32_bf16 v[36:39], a[176:179], v[80:83], v[36:39]
    s_waitcnt lgkmcnt(4)
    ds_read_b64_tr_b16 a[244:245], v12 offset:26624
    v_cvt_pk_bf16_f32 v3, v26, v27
    v_mfma_f32_16x16x32_bf16 v[128:131], a[192:195], v[40:43], v[128:131]
    v_exp_f32 v28, v28
    v_mfma_f32_16x16x32_bf16 v[128:131], a[224:227], v[44:47], v[128:131]
    v_exp_f32 v29, v29
    v_mfma_f32_16x16x32_bf16 v[144:147], a[228:231], v[44:47], v[144:147]
    ds_read_b64_tr_b16 a[246:247], v12 offset:30720
    v_cvt_pk_bf16_f32 v4, v28, v29
    v_mfma_f32_16x16x32_bf16 v[144:147], a[196:199], v[40:43], v[144:147]
    ds_read_b64_tr_b16 a[212:213], v12 offset:18432
    v_mfma_f32_16x16x32_bf16 v[160:163], a[200:203], v[40:43], v[160:163]
    ds_read_b64_tr_b16 a[214:215], v12 offset:22528
    s_mov_b64 exec, s[56:57]
    buffer_load_dwordx2 a[28:29], v22, s[44:47], s75 offen offset:0
    s_mov_b64 exec, -1
    v_mfma_f32_16x16x32_bf16 v[160:163], a[232:235], v[44:47], v[160:163]
    v_exp_f32 v30, v30
    v_mfma_f32_16x16x32_bf16 v[176:179], a[236:239], v[44:47], v[176:179]
    v_exp_f32 v31, v31
    v_mfma_f32_16x16x32_bf16 v[176:179], a[204:207], v[40:43], v[176:179]
    ds_read_b64_tr_b16 a[216:217], v19 offset:19456
    v_cvt_pk_bf16_f32 v5, v30, v31
    v_smfmac_f32_16x16x64_bf16 a[112:115], a[108:111], v[40:47], v0
    ds_read_b64_tr_b16 a[218:219], v19 offset:23552
    v_mfma_f32_16x16x32_bf16 v[24:27], a[128:131], v[96:99], v[56:59]
    ds_read_b64_tr_b16 a[248:249], v19 offset:27648
    s_mov_b64 exec, s[58:59]
    buffer_load_dwordx2 a[28:29], v22, s[48:51], s75 offen offset:0
    s_mov_b64 exec, -1
    v_mfma_f32_16x16x32_bf16 v[24:27], a[132:135], v[100:103], v[24:27]
    ds_read_b64_tr_b16 a[250:251], v19 offset:31744
    v_mfma_f32_16x16x32_bf16 v[24:27], a[136:139], v[104:107], v[24:27]
    ds_read_b64_tr_b16 a[252:253], v12 offset:27648
    v_mfma_f32_16x16x32_bf16 v[24:27], a[140:143], v[108:111], v[24:27]
    ds_read_b64_tr_b16 a[254:255], v12 offset:31744
    v_mfma_f32_16x16x32_bf16 v[28:31], a[156:159], v[108:111], v[56:59]
    ds_read_b64_tr_b16 a[220:221], v12 offset:19456
    s_mov_b64 exec, s[56:57]
    buffer_load_dwordx2 a[30:31], v22, s[44:47], s75 offen offset:3584
    s_mov_b64 exec, -1
    v_mfma_f32_16x16x32_bf16 v[28:31], a[152:155], v[104:107], v[28:31]
    ds_read_b64_tr_b16 a[222:223], v12 offset:23552
    v_mfma_f32_16x16x32_bf16 v[28:31], a[148:151], v[100:103], v[28:31]
    v_exp_f32 v32, v32
    v_mfma_f32_16x16x32_bf16 v[28:31], a[144:147], v[96:99], v[28:31]
    s_waitcnt lgkmcnt(4)
    v_exp_f32 v33, v33
    v_mfma_f32_16x16x32_bf16 v[192:195], a[208:211], v[40:43], v[192:195]
    v_exp_f32 v34, v34
    v_mfma_f32_16x16x32_bf16 v[192:195], a[240:243], v[44:47], v[192:195]
    v_exp_f32 v35, v35
    v_mfma_f32_16x16x32_bf16 v[208:211], a[244:247], v[44:47], v[208:211]
    v_cvt_pk_bf16_f32 v6, v32, v33
    v_cvt_pk_bf16_f32 v7, v34, v35
    v_mfma_f32_16x16x32_bf16 v[208:211], a[212:215], v[40:43], v[208:211]
    v_exp_f32 v36, v36
    v_mfma_f32_16x16x32_bf16 v[224:227], a[216:219], v[40:43], v[224:227]
    v_exp_f32 v37, v37
    v_mfma_f32_16x16x32_bf16 v[224:227], a[248:251], v[44:47], v[224:227]
    s_waitcnt lgkmcnt(2)
    v_exp_f32 v38, v38
    v_mfma_f32_16x16x32_bf16 v[240:243], a[252:255], v[44:47], v[240:243]
    s_waitcnt lgkmcnt(0)
    v_exp_f32 v39, v39
    v_mfma_f32_16x16x32_bf16 v[240:243], a[220:223], v[40:43], v[240:243]
    v_cvt_pk_bf16_f32 v8, v36, v37
    v_cvt_pk_bf16_f32 v9, v38, v39
    v_mfma_f32_16x16x32_bf16 v[32:35], a[160:163], v[96:99], v[56:59]
    v_exp_f32 v24, v24
    v_mfma_f32_16x16x32_bf16 v[32:35], a[164:167], v[100:103], v[32:35]
    v_exp_f32 v25, v25
    v_mfma_f32_16x16x32_bf16 v[32:35], a[168:171], v[104:107], v[32:35]
    v_cvt_pk_bf16_f32 v40, v24, v25
    v_mfma_f32_16x16x32_bf16 v[32:35], a[172:175], v[108:111], v[32:35]
    s_branch L_ov15
L_pad15:
    s_setpc_b64 s[86:87]
L_ov15:
    buffer_load_dwordx4 v15, s[24:27], s92 offen offset:1024  lds
    v_mfma_f32_16x16x32_bf16 v[36:39], a[188:191], v[108:111], v[56:59]
    s_add_u32 s92, s81, 960
    v_exp_f32 v26, v26
    v_mfma_f32_16x16x32_bf16 v[36:39], a[184:187], v[104:107], v[36:39]
    v_exp_f32 v27, v27
    v_mfma_f32_16x16x32_bf16 v[36:39], a[180:183], v[100:103], v[36:39]
    v_cvt_pk_bf16_f32 v41, v26, v27
    v_mfma_f32_16x16x32_bf16 v[36:39], a[176:179], v[96:99], v[36:39]
    buffer_load_dwordx4 v15, s[24:27], s92 offen offset:2048  lds
    v_mfma_f32_16x16x32_bf16 v[132:135], a[192:195], v[2:5], v[132:135]
    s_add_u32 s92, s81, 0
    v_exp_f32 v28, v28
    v_mfma_f32_16x16x32_bf16 v[132:135], a[224:227], v[6:9], v[132:135]
    v_exp_f32 v29, v29
    v_mfma_f32_16x16x32_bf16 v[148:151], a[228:231], v[6:9], v[148:151]
    v_cvt_pk_bf16_f32 v42, v28, v29
    v_mfma_f32_16x16x32_bf16 v[148:151], a[196:199], v[2:5], v[148:151]
    buffer_load_dwordx4 v15, s[24:27], s92 offen offset:3072  lds
    v_mfma_f32_16x16x32_bf16 v[164:167], a[200:203], v[2:5], v[164:167]
    v_exp_f32 v30, v30
    v_mfma_f32_16x16x32_bf16 v[164:167], a[232:235], v[6:9], v[164:167]
    v_exp_f32 v31, v31
    v_mfma_f32_16x16x32_bf16 v[180:183], a[236:239], v[6:9], v[180:183]
    v_cvt_pk_bf16_f32 v43, v30, v31
    v_mfma_f32_16x16x32_bf16 v[180:183], a[204:207], v[2:5], v[180:183]
    s_mov_b64 exec, s[58:59]
    buffer_load_dwordx2 a[30:31], v22, s[48:51], s75 offen offset:3584
    s_mov_b64 exec, -1
    v_mfma_f32_16x16x32_bf16 v[24:27], a[128:131], v[112:115], v[60:63]
    s_waitcnt vmcnt(32)
    v_mfma_f32_16x16x32_bf16 v[24:27], a[132:135], v[116:119], v[24:27]
    s_barrier
    v_mfma_f32_16x16x32_bf16 v[24:27], a[136:139], v[120:123], v[24:27]
    s_add_u32 s81, s81, 16384
    v_exp_f32 v32, v32
    v_mfma_f32_16x16x32_bf16 v[24:27], a[140:143], v[124:127], v[24:27]
    s_and_b32 s81, s81, 0x7ffff
    v_exp_f32 v33, v33
    v_mfma_f32_16x16x32_bf16 v[28:31], a[156:159], v[124:127], v[60:63]
    s_add_u32 s82, s82, 32768
    ds_read_b128 a[128:131], v10 offset:0
    v_cvt_pk_bf16_f32 v44, v32, v33
    v_mfma_f32_16x16x32_bf16 v[28:31], a[152:155], v[120:123], v[28:31]
    s_sub_u32 s92, s82, 163840
    ds_read_b128 a[132:135], v10 offset:1024
    v_mfma_f32_16x16x32_bf16 v[28:31], a[148:151], v[116:119], v[28:31]
    s_min_u32 s82, s82, s92
    v_exp_f32 v34, v34
    v_mfma_f32_16x16x32_bf16 v[28:31], a[144:147], v[112:115], v[28:31]
    s_add_u32 m0, s82, 0
    v_exp_f32 v35, v35
    v_mfma_f32_16x16x32_bf16 v[196:199], a[208:211], v[2:5], v[196:199]
    s_add_u32 s92, s81, 2880
    ds_read_b128 a[136:139], v10 offset:2048
    v_cvt_pk_bf16_f32 v45, v34, v35
    v_mfma_f32_16x16x32_bf16 v[196:199], a[240:243], v[6:9], v[196:199]
    v_exp_f32 v36, v36
    v_mfma_f32_16x16x32_bf16 v[212:215], a[244:247], v[6:9], v[212:215]
    v_exp_f32 v37, v37
    v_mfma_f32_16x16x32_bf16 v[212:215], a[212:215], v[2:5], v[212:215]
    ds_read_b128 a[140:143], v10 offset:3072
    v_cvt_pk_bf16_f32 v46, v36, v37
    v_mfma_f32_16x16x32_bf16 v[228:231], a[216:219], v[2:5], v[228:231]
    ds_read_b128 a[156:159], v10 offset:7168
    v_mfma_f32_16x16x32_bf16 v[228:231], a[248:251], v[6:9], v[228:231]
    buffer_load_dwordx4 v15, s[20:23], s92 offen offset:0  lds
    v_mfma_f32_16x16x32_bf16 v[244:247], a[252:255], v[6:9], v[244:247]
    s_add_u32 s92, s81, 1920
    v_exp_f32 v38, v38
    v_mfma_f32_16x16x32_bf16 v[244:247], a[220:223], v[2:5], v[244:247]
    v_exp_f32 v39, v39
    v_smfmac_f32_16x16x64_bf16 a[116:119], a[108:111], v[2:9], v0
    ds_read_b128 a[152:155], v10 offset:6144
    v_cvt_pk_bf16_f32 v47, v38, v39
    v_mfma_f32_16x16x32_bf16 v[32:35], a[160:163], v[112:115], v[60:63]
    ds_read_b128 a[148:151], v10 offset:5120
    v_mfma_f32_16x16x32_bf16 v[32:35], a[164:167], v[116:119], v[32:35]
    buffer_load_dwordx4 v15, s[20:23], s92 offen offset:1024  lds
    v_mfma_f32_16x16x32_bf16 v[32:35], a[168:171], v[120:123], v[32:35]
    s_add_u32 s92, s81, 960
    v_exp_f32 v24, v24
    v_mfma_f32_16x16x32_bf16 v[32:35], a[172:175], v[124:127], v[32:35]
    v_exp_f32 v25, v25
    v_mfma_f32_16x16x32_bf16 v[36:39], a[188:191], v[124:127], v[60:63]
    ds_read_b128 a[144:147], v10 offset:4096
    v_cvt_pk_bf16_f32 v2, v24, v25
    v_mfma_f32_16x16x32_bf16 v[36:39], a[184:187], v[120:123], v[36:39]
    v_exp_f32 v26, v26
    v_mfma_f32_16x16x32_bf16 v[36:39], a[180:183], v[116:119], v[36:39]
    v_exp_f32 v27, v27
    v_mfma_f32_16x16x32_bf16 v[36:39], a[176:179], v[112:115], v[36:39]
    ds_read_b128 a[160:163], v10 offset:8192
    v_cvt_pk_bf16_f32 v3, v26, v27
    v_mfma_f32_16x16x32_bf16 v[136:139], a[192:195], v[40:43], v[136:139]
    v_exp_f32 v28, v28
    v_mfma_f32_16x16x32_bf16 v[136:139], a[224:227], v[44:47], v[136:139]
    v_exp_f32 v29, v29
    v_mfma_f32_16x16x32_bf16 v[152:155], a[228:231], v[44:47], v[152:155]
    ds_read_b128 a[164:167], v10 offset:9216
    v_cvt_pk_bf16_f32 v4, v28, v29
    v_mfma_f32_16x16x32_bf16 v[152:155], a[196:199], v[40:43], v[152:155]
    ds_read_b128 a[168:171], v10 offset:10240
    v_mfma_f32_16x16x32_bf16 v[168:171], a[200:203], v[40:43], v[168:171]
    buffer_load_dwordx4 v15, s[20:23], s92 offen offset:2048  lds
    v_mfma_f32_16x16x32_bf16 v[168:171], a[232:235], v[44:47], v[168:171]
    s_add_u32 s92, s81, 0
    v_exp_f32 v30, v30
    v_mfma_f32_16x16x32_bf16 v[184:187], a[236:239], v[44:47], v[184:187]
    v_exp_f32 v31, v31
    v_mfma_f32_16x16x32_bf16 v[184:187], a[204:207], v[40:43], v[184:187]
    s_waitcnt lgkmcnt(3)
    ds_read_b128 a[172:175], v10 offset:11264
    v_cvt_pk_bf16_f32 v5, v30, v31
    v_mfma_f32_16x16x32_bf16 v[24:27], a[128:131], v[64:67], v[48:51]
    ds_read_b128 a[188:191], v10 offset:15360
    v_mfma_f32_16x16x32_bf16 v[24:27], a[132:135], v[68:71], v[24:27]
    buffer_load_dwordx4 v15, s[20:23], s92 offen offset:3072  lds
    v_mfma_f32_16x16x32_bf16 v[24:27], a[136:139], v[72:75], v[24:27]
    s_add_u32 m0, s82, 16384
    v_exp_f32 v32, v32
    v_mfma_f32_16x16x32_bf16 v[24:27], a[140:143], v[76:79], v[24:27]
    s_add_u32 s92, s81, 2880
    v_exp_f32 v33, v33
    v_mfma_f32_16x16x32_bf16 v[28:31], a[156:159], v[76:79], v[48:51]
    ds_read_b128 a[184:187], v10 offset:14336
    v_cvt_pk_bf16_f32 v6, v32, v33
    v_mfma_f32_16x16x32_bf16 v[28:31], a[152:155], v[72:75], v[28:31]
    v_add_u32 v19, s83, v14
    v_xor_b32 v12, 32, v19
    v_mfma_f32_16x16x32_bf16 v[28:31], a[148:151], v[68:71], v[28:31]
    v_exp_f32 v34, v34
    v_mfma_f32_16x16x32_bf16 v[28:31], a[144:147], v[64:67], v[28:31]
    v_exp_f32 v35, v35
    v_mfma_f32_16x16x32_bf16 v[200:203], a[208:211], v[40:43], v[200:203]
    ds_read_b128 a[180:183], v10 offset:13312
    v_cvt_pk_bf16_f32 v7, v34, v35
    v_mfma_f32_16x16x32_bf16 v[200:203], a[240:243], v[44:47], v[200:203]
    s_add_u32 s83, s83, 32768
    v_exp_f32 v36, v36
    v_mfma_f32_16x16x32_bf16 v[216:219], a[244:247], v[44:47], v[216:219]
    s_sub_u32 s90, s83, 163840
    v_exp_f32 v37, v37
    v_mfma_f32_16x16x32_bf16 v[216:219], a[212:215], v[40:43], v[216:219]
    s_min_u32 s83, s83, s90
    ds_read_b128 a[176:179], v10 offset:12288
    v_cvt_pk_bf16_f32 v8, v36, v37
    v_mfma_f32_16x16x32_bf16 v[232:235], a[216:219], v[40:43], v[232:235]
    v_add_u32 v10, s83, v13
    v_mfma_f32_16x16x32_bf16 v[232:235], a[248:251], v[44:47], v[232:235]
    buffer_load_dwordx4 v15, s[24:27], s92 offen offset:0  lds
    v_mfma_f32_16x16x32_bf16 v[248:251], a[252:255], v[44:47], v[248:251]
    s_add_u32 s92, s81, 1920
    v_exp_f32 v38, v38
    v_mfma_f32_16x16x32_bf16 v[248:251], a[220:223], v[40:43], v[248:251]
    v_exp_f32 v39, v39
    v_smfmac_f32_16x16x64_bf16 a[120:123], a[108:111], v[40:47], v0
    s_waitcnt lgkmcnt(3)
    v_cvt_pk_bf16_f32 v9, v38, v39
    v_mfma_f32_16x16x32_bf16 v[32:35], a[160:163], v[64:67], v[48:51]
    v_exp_f32 v24, v24
    v_mfma_f32_16x16x32_bf16 v[32:35], a[164:167], v[68:71], v[32:35]
    v_exp_f32 v25, v25
    v_mfma_f32_16x16x32_bf16 v[32:35], a[168:171], v[72:75], v[32:35]
    v_exp_f32 v26, v26
    v_mfma_f32_16x16x32_bf16 v[32:35], a[172:175], v[76:79], v[32:35]
    v_exp_f32 v27, v27
    v_mfma_f32_16x16x32_bf16 v[36:39], a[188:191], v[76:79], v[48:51]
    s_waitcnt lgkmcnt(2)
    v_exp_f32 v28, v28
    v_mfma_f32_16x16x32_bf16 v[36:39], a[184:187], v[72:75], v[36:39]
    s_waitcnt lgkmcnt(1)
    v_exp_f32 v29, v29
    v_mfma_f32_16x16x32_bf16 v[36:39], a[180:183], v[68:71], v[36:39]
    s_waitcnt lgkmcnt(0)
    v_exp_f32 v30, v30
    v_mfma_f32_16x16x32_bf16 v[36:39], a[176:179], v[64:67], v[36:39]
    v_exp_f32 v31, v31
    v_mfma_f32_16x16x32_bf16 v[140:143], a[192:195], v[2:5], v[140:143]
    v_cvt_pk_bf16_f32 v40, v24, v25
    v_cvt_pk_bf16_f32 v41, v26, v27
    v_mfma_f32_16x16x32_bf16 v[140:143], a[224:227], v[6:9], v[140:143]
    ds_read_b64_tr_b16 a[192:193], v19 offset:16384
    v_cvt_pk_bf16_f32 v42, v28, v29
    v_mfma_f32_16x16x32_bf16 v[156:159], a[228:231], v[6:9], v[156:159]
    ds_read_b64_tr_b16 a[194:195], v19 offset:20480
    v_mfma_f32_16x16x32_bf16 v[156:159], a[196:199], v[2:5], v[156:159]
    ds_read_b64_tr_b16 a[224:225], v19 offset:24576
    v_cvt_pk_bf16_f32 v43, v30, v31
    v_mfma_f32_16x16x32_bf16 v[172:175], a[200:203], v[2:5], v[172:175]
    ds_read_b64_tr_b16 a[226:227], v19 offset:28672
    v_mfma_f32_16x16x32_bf16 v[172:175], a[232:235], v[6:9], v[172:175]
    ds_read_b64_tr_b16 a[228:229], v12 offset:24576
    buffer_load_dwordx2 a[0:1], v21, s[28:31], s68 offen offset:0
    v_mfma_f32_16x16x32_bf16 v[188:191], a[236:239], v[6:9], v[188:191]
    ds_read_b64_tr_b16 a[230:231], v12 offset:28672
    v_mfma_f32_16x16x32_bf16 v[188:191], a[204:207], v[2:5], v[188:191]
    ds_read_b64_tr_b16 a[196:197], v12 offset:16384
    v_mfma_f32_16x16x32_bf16 v[24:27], a[128:131], v[80:83], v[52:55]
    ds_read_b64_tr_b16 a[198:199], v12 offset:20480
    v_mfma_f32_16x16x32_bf16 v[24:27], a[132:135], v[84:87], v[24:27]
    ds_read_b64_tr_b16 a[200:201], v19 offset:17408
    buffer_load_dwordx2 a[2:3], v21, s[28:31], s68 offen offset:1024
    v_mfma_f32_16x16x32_bf16 v[24:27], a[136:139], v[88:91], v[24:27]
    v_exp_f32 v32, v32
    v_mfma_f32_16x16x32_bf16 v[24:27], a[140:143], v[92:95], v[24:27]
    v_exp_f32 v33, v33
    v_mfma_f32_16x16x32_bf16 v[28:31], a[156:159], v[92:95], v[52:55]
    ds_read_b64_tr_b16 a[202:203], v19 offset:21504
    v_cvt_pk_bf16_f32 v44, v32, v33
    v_mfma_f32_16x16x32_bf16 v[28:31], a[152:155], v[88:91], v[28:31]
    ds_read_b64_tr_b16 a[232:233], v19 offset:25600
    v_mfma_f32_16x16x32_bf16 v[28:31], a[148:151], v[84:87], v[28:31]
    v_exp_f32 v34, v34
    v_mfma_f32_16x16x32_bf16 v[28:31], a[144:147], v[80:83], v[28:31]
    v_exp_f32 v35, v35
    v_mfma_f32_16x16x32_bf16 v[204:207], a[208:211], v[2:5], v[204:207]
    ds_read_b64_tr_b16 a[234:235], v19 offset:29696
    v_cvt_pk_bf16_f32 v45, v34, v35
    v_mfma_f32_16x16x32_bf16 v[204:207], a[240:243], v[6:9], v[204:207]
    v_exp_f32 v36, v36
    v_mfma_f32_16x16x32_bf16 v[220:223], a[244:247], v[6:9], v[220:223]
    v_exp_f32 v37, v37
    v_mfma_f32_16x16x32_bf16 v[220:223], a[212:215], v[2:5], v[220:223]
    ds_read_b64_tr_b16 a[236:237], v12 offset:25600
    v_cvt_pk_bf16_f32 v46, v36, v37
    v_mfma_f32_16x16x32_bf16 v[236:239], a[216:219], v[2:5], v[236:239]
    ds_read_b64_tr_b16 a[238:239], v12 offset:29696
    v_mfma_f32_16x16x32_bf16 v[236:239], a[248:251], v[6:9], v[236:239]
    ds_read_b64_tr_b16 a[204:205], v12 offset:17408
    buffer_load_dwordx2 a[4:5], v21, s[28:31], s68 offen offset:2048
    v_mfma_f32_16x16x32_bf16 v[252:255], a[252:255], v[6:9], v[252:255]
    v_exp_f32 v38, v38
    v_mfma_f32_16x16x32_bf16 v[252:255], a[220:223], v[2:5], v[252:255]
    v_exp_f32 v39, v39
    v_smfmac_f32_16x16x64_bf16 a[124:127], a[108:111], v[2:9], v0
    ds_read_b64_tr_b16 a[206:207], v12 offset:21504
    v_cvt_pk_bf16_f32 v47, v38, v39
    v_mfma_f32_16x16x32_bf16 v[32:35], a[160:163], v[80:83], v[52:55]
    ds_read_b64_tr_b16 a[208:209], v19 offset:18432
    v_mfma_f32_16x16x32_bf16 v[32:35], a[164:167], v[84:87], v[32:35]
    ds_read_b64_tr_b16 a[210:211], v19 offset:22528
    buffer_load_dwordx2 a[6:7], v21, s[28:31], s68 offen offset:3072
    v_mfma_f32_16x16x32_bf16 v[32:35], a[168:171], v[88:91], v[32:35]
    ds_read_b64_tr_b16 a[240:241], v19 offset:26624
    v_exp_f32 v24, v24
    v_mfma_f32_16x16x32_bf16 v[32:35], a[172:175], v[92:95], v[32:35]
    v_exp_f32 v25, v25
    v_mfma_f32_16x16x32_bf16 v[36:39], a[188:191], v[92:95], v[52:55]
    ds_read_b64_tr_b16 a[242:243], v19 offset:30720
    v_cvt_pk_bf16_f32 v2, v24, v25
    v_mfma_f32_16x16x32_bf16 v[36:39], a[184:187], v[88:91], v[36:39]
    v_exp_f32 v26, v26
    v_mfma_f32_16x16x32_bf16 v[36:39], a[180:183], v[84:87], v[36:39]
    v_exp_f32 v27, v27
    v_mfma_f32_16x16x32_bf16 v[36:39], a[176:179], v[80:83], v[36:39]
    s_waitcnt lgkmcnt(4)
    ds_read_b64_tr_b16 a[244:245], v12 offset:26624
    v_cvt_pk_bf16_f32 v3, v26, v27
    v_mfma_f32_16x16x32_bf16 v[128:131], a[192:195], v[40:43], v[128:131]
    v_exp_f32 v28, v28
    v_mfma_f32_16x16x32_bf16 v[128:131], a[224:227], v[44:47], v[128:131]
    v_exp_f32 v29, v29
    v_mfma_f32_16x16x32_bf16 v[144:147], a[228:231], v[44:47], v[144:147]
    ds_read_b64_tr_b16 a[246:247], v12 offset:30720
    v_cvt_pk_bf16_f32 v4, v28, v29
    v_mfma_f32_16x16x32_bf16 v[144:147], a[196:199], v[40:43], v[144:147]
    ds_read_b64_tr_b16 a[212:213], v12 offset:18432
    v_mfma_f32_16x16x32_bf16 v[160:163], a[200:203], v[40:43], v[160:163]
    ds_read_b64_tr_b16 a[214:215], v12 offset:22528
    buffer_load_dwordx2 a[8:9], v21, s[28:31], s69 offen offset:0
    v_mfma_f32_16x16x32_bf16 v[160:163], a[232:235], v[44:47], v[160:163]
    v_exp_f32 v30, v30
    v_mfma_f32_16x16x32_bf16 v[176:179], a[236:239], v[44:47], v[176:179]
    v_exp_f32 v31, v31
    v_mfma_f32_16x16x32_bf16 v[176:179], a[204:207], v[40:43], v[176:179]
    ds_read_b64_tr_b16 a[216:217], v19 offset:19456
    v_cvt_pk_bf16_f32 v5, v30, v31
    v_smfmac_f32_16x16x64_bf16 a[112:115], a[108:111], v[40:47], v0
    ds_read_b64_tr_b16 a[218:219], v19 offset:23552
    v_mfma_f32_16x16x32_bf16 v[24:27], a[128:131], v[96:99], v[56:59]
    ds_read_b64_tr_b16 a[248:249], v19 offset:27648
    buffer_load_dwordx2 a[10:11], v21, s[28:31], s69 offen offset:1024
    v_mfma_f32_16x16x32_bf16 v[24:27], a[132:135], v[100:103], v[24:27]
    ds_read_b64_tr_b16 a[250:251], v19 offset:31744
    v_mfma_f32_16x16x32_bf16 v[24:27], a[136:139], v[104:107], v[24:27]
    ds_read_b64_tr_b16 a[252:253], v12 offset:27648
    v_mfma_f32_16x16x32_bf16 v[24:27], a[140:143], v[108:111], v[24:27]
    ds_read_b64_tr_b16 a[254:255], v12 offset:31744
    v_mfma_f32_16x16x32_bf16 v[28:31], a[156:159], v[108:111], v[56:59]
    ds_read_b64_tr_b16 a[220:221], v12 offset:19456
    buffer_load_dwordx2 a[12:13], v21, s[28:31], s69 offen offset:2048
    v_mfma_f32_16x16x32_bf16 v[28:31], a[152:155], v[104:107], v[28:31]
    ds_read_b64_tr_b16 a[222:223], v12 offset:23552
    v_mfma_f32_16x16x32_bf16 v[28:31], a[148:151], v[100:103], v[28:31]
    v_exp_f32 v32, v32
    v_mfma_f32_16x16x32_bf16 v[28:31], a[144:147], v[96:99], v[28:31]
    s_waitcnt lgkmcnt(4)
    v_exp_f32 v33, v33
    v_mfma_f32_16x16x32_bf16 v[192:195], a[208:211], v[40:43], v[192:195]
    v_exp_f32 v34, v34
    v_mfma_f32_16x16x32_bf16 v[192:195], a[240:243], v[44:47], v[192:195]
    v_exp_f32 v35, v35
    v_mfma_f32_16x16x32_bf16 v[208:211], a[244:247], v[44:47], v[208:211]
    v_cvt_pk_bf16_f32 v6, v32, v33
    v_cvt_pk_bf16_f32 v7, v34, v35
    v_mfma_f32_16x16x32_bf16 v[208:211], a[212:215], v[40:43], v[208:211]
    v_exp_f32 v36, v36
    v_mfma_f32_16x16x32_bf16 v[224:227], a[216:219], v[40:43], v[224:227]
    v_exp_f32 v37, v37
    v_mfma_f32_16x16x32_bf16 v[224:227], a[248:251], v[44:47], v[224:227]
    s_waitcnt lgkmcnt(2)
    v_exp_f32 v38, v38
    v_mfma_f32_16x16x32_bf16 v[240:243], a[252:255], v[44:47], v[240:243]
    s_waitcnt lgkmcnt(0)
    v_exp_f32 v39, v39
    v_mfma_f32_16x16x32_bf16 v[240:243], a[220:223], v[40:43], v[240:243]
    v_cvt_pk_bf16_f32 v8, v36, v37
    v_cvt_pk_bf16_f32 v9, v38, v39
    v_mfma_f32_16x16x32_bf16 v[32:35], a[160:163], v[96:99], v[56:59]
    v_exp_f32 v24, v24
    v_mfma_f32_16x16x32_bf16 v[32:35], a[164:167], v[100:103], v[32:35]
    v_exp_f32 v25, v25
    v_mfma_f32_16x16x32_bf16 v[32:35], a[168:171], v[104:107], v[32:35]
    v_cvt_pk_bf16_f32 v40, v24, v25
    v_mfma_f32_16x16x32_bf16 v[32:35], a[172:175], v[108:111], v[32:35]
    buffer_load_dwordx4 v15, s[24:27], s92 offen offset:1024  lds
    v_mfma_f32_16x16x32_bf16 v[36:39], a[188:191], v[108:111], v[56:59]
    s_add_u32 s92, s81, 960
    v_exp_f32 v26, v26
    v_mfma_f32_16x16x32_bf16 v[36:39], a[184:187], v[104:107], v[36:39]
    v_exp_f32 v27, v27
    v_mfma_f32_16x16x32_bf16 v[36:39], a[180:183], v[100:103], v[36:39]
    v_cvt_pk_bf16_f32 v41, v26, v27
    v_mfma_f32_16x16x32_bf16 v[36:39], a[176:179], v[96:99], v[36:39]
    buffer_load_dwordx4 v15, s[24:27], s92 offen offset:2048  lds
    v_mfma_f32_16x16x32_bf16 v[132:135], a[192:195], v[2:5], v[132:135]
    s_add_u32 s92, s81, 0
    v_exp_f32 v28, v28
    v_mfma_f32_16x16x32_bf16 v[132:135], a[224:227], v[6:9], v[132:135]
    v_exp_f32 v29, v29
    v_mfma_f32_16x16x32_bf16 v[148:151], a[228:231], v[6:9], v[148:151]
    v_cvt_pk_bf16_f32 v42, v28, v29
    v_mfma_f32_16x16x32_bf16 v[148:151], a[196:199], v[2:5], v[148:151]
    buffer_load_dwordx4 v15, s[24:27], s92 offen offset:3072  lds
    v_mfma_f32_16x16x32_bf16 v[164:167], a[200:203], v[2:5], v[164:167]
    v_exp_f32 v30, v30
    v_mfma_f32_16x16x32_bf16 v[164:167], a[232:235], v[6:9], v[164:167]
    v_exp_f32 v31, v31
    v_mfma_f32_16x16x32_bf16 v[180:183], a[236:239], v[6:9], v[180:183]
    v_cvt_pk_bf16_f32 v43, v30, v31
    v_mfma_f32_16x16x32_bf16 v[180:183], a[204:207], v[2:5], v[180:183]
    buffer_load_dwordx2 a[14:15], v21, s[28:31], s69 offen offset:3072
    v_mfma_f32_16x16x32_bf16 v[24:27], a[128:131], v[112:115], v[60:63]
    s_waitcnt vmcnt(33)
    v_mfma_f32_16x16x32_bf16 v[24:27], a[132:135], v[116:119], v[24:27]
    s_barrier
    v_mfma_f32_16x16x32_bf16 v[24:27], a[136:139], v[120:123], v[24:27]
    s_add_u32 s81, s81, 16384
    v_exp_f32 v32, v32
    v_mfma_f32_16x16x32_bf16 v[24:27], a[140:143], v[124:127], v[24:27]
    s_and_b32 s81, s81, 0x7ffff
    v_exp_f32 v33, v33
    v_mfma_f32_16x16x32_bf16 v[28:31], a[156:159], v[124:127], v[60:63]
    s_add_u32 s82, s82, 32768
    ds_read_b128 a[128:131], v10 offset:0
    v_cvt_pk_bf16_f32 v44, v32, v33
    v_mfma_f32_16x16x32_bf16 v[28:31], a[152:155], v[120:123], v[28:31]
    s_sub_u32 s92, s82, 163840
    ds_read_b128 a[132:135], v10 offset:1024
    v_mfma_f32_16x16x32_bf16 v[28:31], a[148:151], v[116:119], v[28:31]
    s_min_u32 s82, s82, s92
    v_exp_f32 v34, v34
    v_mfma_f32_16x16x32_bf16 v[28:31], a[144:147], v[112:115], v[28:31]
    s_add_u32 m0, s82, 0
    v_exp_f32 v35, v35
    v_mfma_f32_16x16x32_bf16 v[196:199], a[208:211], v[2:5], v[196:199]
    s_add_u32 s92, s81, 2880
    ds_read_b128 a[136:139], v10 offset:2048
    v_cvt_pk_bf16_f32 v45, v34, v35
    v_mfma_f32_16x16x32_bf16 v[196:199], a[240:243], v[6:9], v[196:199]
    v_exp_f32 v36, v36
    v_mfma_f32_16x16x32_bf16 v[212:215], a[244:247], v[6:9], v[212:215]
    v_exp_f32 v37, v37
    v_mfma_f32_16x16x32_bf16 v[212:215], a[212:215], v[2:5], v[212:215]
    ds_read_b128 a[140:143], v10 offset:3072
    v_cvt_pk_bf16_f32 v46, v36, v37
    v_mfma_f32_16x16x32_bf16 v[228:231], a[216:219], v[2:5], v[228:231]
    ds_read_b128 a[156:159], v10 offset:7168
    v_mfma_f32_16x16x32_bf16 v[228:231], a[248:251], v[6:9], v[228:231]
    buffer_load_dwordx4 v15, s[20:23], s92 offen offset:0  lds
    v_mfma_f32_16x16x32_bf16 v[244:247], a[252:255], v[6:9], v[244:247]
    s_add_u32 s92, s81, 1920
    v_exp_f32 v38, v38
    v_mfma_f32_16x16x32_bf16 v[244:247], a[220:223], v[2:5], v[244:247]
    v_exp_f32 v39, v39
    v_smfmac_f32_16x16x64_bf16 a[116:119], a[108:111], v[2:9], v0
    ds_read_b128 a[152:155], v10 offset:6144
    v_cvt_pk_bf16_f32 v47, v38, v39
    v_mfma_f32_16x16x32_bf16 v[32:35], a[160:163], v[112:115], v[60:63]
    ds_read_b128 a[148:151], v10 offset:5120
    v_mfma_f32_16x16x32_bf16 v[32:35], a[164:167], v[116:119], v[32:35]
    buffer_load_dwordx4 v15, s[20:23], s92 offen offset:1024  lds
    v_mfma_f32_16x16x32_bf16 v[32:35], a[168:171], v[120:123], v[32:35]
    s_add_u32 s92, s81, 960
    v_exp_f32 v24, v24
    v_mfma_f32_16x16x32_bf16 v[32:35], a[172:175], v[124:127], v[32:35]
    v_exp_f32 v25, v25
    v_mfma_f32_16x16x32_bf16 v[36:39], a[188:191], v[124:127], v[60:63]
    ds_read_b128 a[144:147], v10 offset:4096
    v_cvt_pk_bf16_f32 v2, v24, v25
    v_mfma_f32_16x16x32_bf16 v[36:39], a[184:187], v[120:123], v[36:39]
    v_exp_f32 v26, v26
    v_mfma_f32_16x16x32_bf16 v[36:39], a[180:183], v[116:119], v[36:39]
    v_exp_f32 v27, v27
    v_mfma_f32_16x16x32_bf16 v[36:39], a[176:179], v[112:115], v[36:39]
    ds_read_b128 a[160:163], v10 offset:8192
    v_cvt_pk_bf16_f32 v3, v26, v27
    v_mfma_f32_16x16x32_bf16 v[136:139], a[192:195], v[40:43], v[136:139]
    v_exp_f32 v28, v28
    v_mfma_f32_16x16x32_bf16 v[136:139], a[224:227], v[44:47], v[136:139]
    v_exp_f32 v29, v29
    v_mfma_f32_16x16x32_bf16 v[152:155], a[228:231], v[44:47], v[152:155]
    ds_read_b128 a[164:167], v10 offset:9216
    v_cvt_pk_bf16_f32 v4, v28, v29
    v_mfma_f32_16x16x32_bf16 v[152:155], a[196:199], v[40:43], v[152:155]
    ds_read_b128 a[168:171], v10 offset:10240
    v_mfma_f32_16x16x32_bf16 v[168:171], a[200:203], v[40:43], v[168:171]
    buffer_load_dwordx4 v15, s[20:23], s92 offen offset:2048  lds
    v_mfma_f32_16x16x32_bf16 v[168:171], a[232:235], v[44:47], v[168:171]
    s_add_u32 s92, s81, 0
    v_exp_f32 v30, v30
    v_mfma_f32_16x16x32_bf16 v[184:187], a[236:239], v[44:47], v[184:187]
    v_exp_f32 v31, v31
    v_mfma_f32_16x16x32_bf16 v[184:187], a[204:207], v[40:43], v[184:187]
    s_waitcnt lgkmcnt(3)
    ds_read_b128 a[172:175], v10 offset:11264
    v_cvt_pk_bf16_f32 v5, v30, v31
    v_mfma_f32_16x16x32_bf16 v[24:27], a[128:131], v[64:67], v[48:51]
    ds_read_b128 a[188:191], v10 offset:15360
    v_mfma_f32_16x16x32_bf16 v[24:27], a[132:135], v[68:71], v[24:27]
    buffer_load_dwordx4 v15, s[20:23], s92 offen offset:3072  lds
    v_mfma_f32_16x16x32_bf16 v[24:27], a[136:139], v[72:75], v[24:27]
    s_add_u32 m0, s82, 16384
    v_exp_f32 v32, v32
    v_mfma_f32_16x16x32_bf16 v[24:27], a[140:143], v[76:79], v[24:27]
    s_add_u32 s92, s81, 2880
    v_exp_f32 v33, v33
    v_mfma_f32_16x16x32_bf16 v[28:31], a[156:159], v[76:79], v[48:51]
    ds_read_b128 a[184:187], v10 offset:14336
    v_cvt_pk_bf16_f32 v6, v32, v33
    v_mfma_f32_16x16x32_bf16 v[28:31], a[152:155], v[72:75], v[28:31]
    v_add_u32 v19, s83, v14
    v_xor_b32 v12, 32, v19
    v_mfma_f32_16x16x32_bf16 v[28:31], a[148:151], v[68:71], v[28:31]
    v_exp_f32 v34, v34
    v_mfma_f32_16x16x32_bf16 v[28:31], a[144:147], v[64:67], v[28:31]
    v_exp_f32 v35, v35
    v_mfma_f32_16x16x32_bf16 v[200:203], a[208:211], v[40:43], v[200:203]
    ds_read_b128 a[180:183], v10 offset:13312
    v_cvt_pk_bf16_f32 v7, v34, v35
    v_mfma_f32_16x16x32_bf16 v[200:203], a[240:243], v[44:47], v[200:203]
    s_add_u32 s83, s83, 32768
    v_exp_f32 v36, v36
    v_mfma_f32_16x16x32_bf16 v[216:219], a[244:247], v[44:47], v[216:219]
    s_sub_u32 s90, s83, 163840
    v_exp_f32 v37, v37
    v_mfma_f32_16x16x32_bf16 v[216:219], a[212:215], v[40:43], v[216:219]
    s_min_u32 s83, s83, s90
    ds_read_b128 a[176:179], v10 offset:12288
    v_cvt_pk_bf16_f32 v8, v36, v37
    v_mfma_f32_16x16x32_bf16 v[232:235], a[216:219], v[40:43], v[232:235]
    v_add_u32 v10, s83, v13
    v_mfma_f32_16x16x32_bf16 v[232:235], a[248:251], v[44:47], v[232:235]
    buffer_load_dwordx4 v15, s[24:27], s92 offen offset:0  lds
    v_mfma_f32_16x16x32_bf16 v[248:251], a[252:255], v[44:47], v[248:251]
    s_add_u32 s92, s81, 1920
    v_exp_f32 v38, v38
    v_mfma_f32_16x16x32_bf16 v[248:251], a[220:223], v[40:43], v[248:251]
    v_exp_f32 v39, v39
    v_smfmac_f32_16x16x64_bf16 a[120:123], a[108:111], v[40:47], v0
    s_waitcnt lgkmcnt(3)
    v_cvt_pk_bf16_f32 v9, v38, v39
    v_mfma_f32_16x16x32_bf16 v[32:35], a[160:163], v[64:67], v[48:51]
    v_exp_f32 v24, v24
    v_mfma_f32_16x16x32_bf16 v[32:35], a[164:167], v[68:71], v[32:35]
    v_exp_f32 v25, v25
    v_mfma_f32_16x16x32_bf16 v[32:35], a[168:171], v[72:75], v[32:35]
    v_exp_f32 v26, v26
    v_mfma_f32_16x16x32_bf16 v[32:35], a[172:175], v[76:79], v[32:35]
    v_exp_f32 v27, v27
    v_mfma_f32_16x16x32_bf16 v[36:39], a[188:191], v[76:79], v[48:51]
    s_waitcnt lgkmcnt(2)
    v_exp_f32 v28, v28
    v_mfma_f32_16x16x32_bf16 v[36:39], a[184:187], v[72:75], v[36:39]
    s_waitcnt lgkmcnt(1)
    v_exp_f32 v29, v29
    v_mfma_f32_16x16x32_bf16 v[36:39], a[180:183], v[68:71], v[36:39]
    s_waitcnt lgkmcnt(0)
    v_exp_f32 v30, v30
    v_mfma_f32_16x16x32_bf16 v[36:39], a[176:179], v[64:67], v[36:39]
    v_exp_f32 v31, v31
    v_mfma_f32_16x16x32_bf16 v[140:143], a[192:195], v[2:5], v[140:143]
    v_cvt_pk_bf16_f32 v40, v24, v25
    v_cvt_pk_bf16_f32 v41, v26, v27
    v_mfma_f32_16x16x32_bf16 v[140:143], a[224:227], v[6:9], v[140:143]
    ds_read_b64_tr_b16 a[192:193], v19 offset:16384
    v_cvt_pk_bf16_f32 v42, v28, v29
    v_mfma_f32_16x16x32_bf16 v[156:159], a[228:231], v[6:9], v[156:159]
    ds_read_b64_tr_b16 a[194:195], v19 offset:20480
    v_mfma_f32_16x16x32_bf16 v[156:159], a[196:199], v[2:5], v[156:159]
    ds_read_b64_tr_b16 a[224:225], v19 offset:24576
    v_cvt_pk_bf16_f32 v43, v30, v31
    v_mfma_f32_16x16x32_bf16 v[172:175], a[200:203], v[2:5], v[172:175]
    ds_read_b64_tr_b16 a[226:227], v19 offset:28672
    v_mfma_f32_16x16x32_bf16 v[172:175], a[232:235], v[6:9], v[172:175]
    ds_read_b64_tr_b16 a[228:229], v12 offset:24576
    buffer_load_dword a32, v23, s[40:43], s70 offen offset:0
    v_mfma_f32_16x16x32_bf16 v[188:191], a[236:239], v[6:9], v[188:191]
    ds_read_b64_tr_b16 a[230:231], v12 offset:28672
    v_mfma_f32_16x16x32_bf16 v[188:191], a[204:207], v[2:5], v[188:191]
    ds_read_b64_tr_b16 a[196:197], v12 offset:16384
    v_mfma_f32_16x16x32_bf16 v[24:27], a[128:131], v[80:83], v[52:55]
    ds_read_b64_tr_b16 a[198:199], v12 offset:20480
    v_mfma_f32_16x16x32_bf16 v[24:27], a[132:135], v[84:87], v[24:27]
    ds_read_b64_tr_b16 a[200:201], v19 offset:17408
    buffer_load_dword a33, v23, s[40:43], s71 offen offset:0
    v_mfma_f32_16x16x32_bf16 v[24:27], a[136:139], v[88:91], v[24:27]
    v_exp_f32 v32, v32
    v_mfma_f32_16x16x32_bf16 v[24:27], a[140:143], v[92:95], v[24:27]
    v_exp_f32 v33, v33
    v_mfma_f32_16x16x32_bf16 v[28:31], a[156:159], v[92:95], v[52:55]
    ds_read_b64_tr_b16 a[202:203], v19 offset:21504
    v_cvt_pk_bf16_f32 v44, v32, v33
    v_mfma_f32_16x16x32_bf16 v[28:31], a[152:155], v[88:91], v[28:31]
    ds_read_b64_tr_b16 a[232:233], v19 offset:25600
    v_mfma_f32_16x16x32_bf16 v[28:31], a[148:151], v[84:87], v[28:31]
    v_exp_f32 v34, v34
    v_mfma_f32_16x16x32_bf16 v[28:31], a[144:147], v[80:83], v[28:31]
    v_exp_f32 v35, v35
    v_mfma_f32_16x16x32_bf16 v[204:207], a[208:211], v[2:5], v[204:207]
    ds_read_b64_tr_b16 a[234:235], v19 offset:29696
    v_cvt_pk_bf16_f32 v45, v34, v35
    v_mfma_f32_16x16x32_bf16 v[204:207], a[240:243], v[6:9], v[204:207]
    v_exp_f32 v36, v36
    v_mfma_f32_16x16x32_bf16 v[220:223], a[244:247], v[6:9], v[220:223]
    v_exp_f32 v37, v37
    v_mfma_f32_16x16x32_bf16 v[220:223], a[212:215], v[2:5], v[220:223]
    ds_read_b64_tr_b16 a[236:237], v12 offset:25600
    v_cvt_pk_bf16_f32 v46, v36, v37
    v_mfma_f32_16x16x32_bf16 v[236:239], a[216:219], v[2:5], v[236:239]
    ds_read_b64_tr_b16 a[238:239], v12 offset:29696
    v_mfma_f32_16x16x32_bf16 v[236:239], a[248:251], v[6:9], v[236:239]
    ds_read_b64_tr_b16 a[204:205], v12 offset:17408
    buffer_load_dword a34, v23, s[40:43], s70 offen offset:1024
    v_mfma_f32_16x16x32_bf16 v[252:255], a[252:255], v[6:9], v[252:255]
    v_exp_f32 v38, v38
    v_mfma_f32_16x16x32_bf16 v[252:255], a[220:223], v[2:5], v[252:255]
    v_exp_f32 v39, v39
    v_smfmac_f32_16x16x64_bf16 a[124:127], a[108:111], v[2:9], v0
    ds_read_b64_tr_b16 a[206:207], v12 offset:21504
    v_cvt_pk_bf16_f32 v47, v38, v39
    v_mfma_f32_16x16x32_bf16 v[32:35], a[160:163], v[80:83], v[52:55]
    ds_read_b64_tr_b16 a[208:209], v19 offset:18432
    v_mfma_f32_16x16x32_bf16 v[32:35], a[164:167], v[84:87], v[32:35]
    ds_read_b64_tr_b16 a[210:211], v19 offset:22528
    buffer_load_dword a35, v23, s[40:43], s71 offen offset:1024
    v_mfma_f32_16x16x32_bf16 v[32:35], a[168:171], v[88:91], v[32:35]
    ds_read_b64_tr_b16 a[240:241], v19 offset:26624
    v_exp_f32 v24, v24
    v_mfma_f32_16x16x32_bf16 v[32:35], a[172:175], v[92:95], v[32:35]
    v_exp_f32 v25, v25
    v_mfma_f32_16x16x32_bf16 v[36:39], a[188:191], v[92:95], v[52:55]
    ds_read_b64_tr_b16 a[242:243], v19 offset:30720
    v_cvt_pk_bf16_f32 v2, v24, v25
    v_mfma_f32_16x16x32_bf16 v[36:39], a[184:187], v[88:91], v[36:39]
    v_exp_f32 v26, v26
    v_mfma_f32_16x16x32_bf16 v[36:39], a[180:183], v[84:87], v[36:39]
    v_exp_f32 v27, v27
    v_mfma_f32_16x16x32_bf16 v[36:39], a[176:179], v[80:83], v[36:39]
    s_waitcnt lgkmcnt(4)
    ds_read_b64_tr_b16 a[244:245], v12 offset:26624
    v_cvt_pk_bf16_f32 v3, v26, v27
    v_mfma_f32_16x16x32_bf16 v[128:131], a[192:195], v[40:43], v[128:131]
    v_exp_f32 v28, v28
    v_mfma_f32_16x16x32_bf16 v[128:131], a[224:227], v[44:47], v[128:131]
    v_exp_f32 v29, v29
    v_mfma_f32_16x16x32_bf16 v[144:147], a[228:231], v[44:47], v[144:147]
    s_branch L_ov16
L_pad16:
    s_setpc_b64 s[86:87]
L_ov16:
    ds_read_b64_tr_b16 a[246:247], v12 offset:30720
    v_cvt_pk_bf16_f32 v4, v28, v29
    v_mfma_f32_16x16x32_bf16 v[144:147], a[196:199], v[40:43], v[144:147]
    ds_read_b64_tr_b16 a[212:213], v12 offset:18432
    v_mfma_f32_16x16x32_bf16 v[160:163], a[200:203], v[40:43], v[160:163]
    ds_read_b64_tr_b16 a[214:215], v12 offset:22528
    buffer_load_dword a36, v23, s[40:43], s70 offen offset:2048
    v_mfma_f32_16x16x32_bf16 v[160:163], a[232:235], v[44:47], v[160:163]
    v_exp_f32 v30, v30
    v_mfma_f32_16x16x32_bf16 v[176:179], a[236:239], v[44:47], v[176:179]
    v_exp_f32 v31, v31
    v_mfma_f32_16x16x32_bf16 v[176:179], a[204:207], v[40:43], v[176:179]
    ds_read_b64_tr_b16 a[216:217], v19 offset:19456
    v_cvt_pk_bf16_f32 v5, v30, v31
    v_smfmac_f32_16x16x64_bf16 a[112:115], a[108:111], v[40:47], v0
    ds_read_b64_tr_b16 a[218:219], v19 offset:23552
    v_mfma_f32_16x16x32_bf16 v[24:27], a[128:131], v[96:99], v[56:59]
    ds_read_b64_tr_b16 a[248:249], v19 offset:27648
    buffer_load_dword a37, v23, s[40:43], s71 offen offset:2048
    v_mfma_f32_16x16x32_bf16 v[24:27], a[132:135], v[100:103], v[24:27]
    ds_read_b64_tr_b16 a[250:251], v19 offset:31744
    v_mfma_f32_16x16x32_bf16 v[24:27], a[136:139], v[104:107], v[24:27]
    ds_read_b64_tr_b16 a[252:253], v12 offset:27648
    v_mfma_f32_16x16x32_bf16 v[24:27], a[140:143], v[108:111], v[24:27]
    ds_read_b64_tr_b16 a[254:255], v12 offset:31744
    v_mfma_f32_16x16x32_bf16 v[28:31], a[156:159], v[108:111], v[56:59]
    ds_read_b64_tr_b16 a[220:221], v12 offset:19456
    buffer_load_dword a38, v23, s[40:43], s70 offen offset:3072
    v_mfma_f32_16x16x32_bf16 v[28:31], a[152:155], v[104:107], v[28:31]
    ds_read_b64_tr_b16 a[222:223], v12 offset:23552
    v_mfma_f32_16x16x32_bf16 v[28:31], a[148:151], v[100:103], v[28:31]
    v_exp_f32 v32, v32
    v_mfma_f32_16x16x32_bf16 v[28:31], a[144:147], v[96:99], v[28:31]
    s_waitcnt lgkmcnt(4)
    v_exp_f32 v33, v33
    v_mfma_f32_16x16x32_bf16 v[192:195], a[208:211], v[40:43], v[192:195]
    v_exp_f32 v34, v34
    v_mfma_f32_16x16x32_bf16 v[192:195], a[240:243], v[44:47], v[192:195]
    v_exp_f32 v35, v35
    v_mfma_f32_16x16x32_bf16 v[208:211], a[244:247], v[44:47], v[208:211]
    v_cvt_pk_bf16_f32 v6, v32, v33
    v_cvt_pk_bf16_f32 v7, v34, v35
    v_mfma_f32_16x16x32_bf16 v[208:211], a[212:215], v[40:43], v[208:211]
    v_exp_f32 v36, v36
    v_mfma_f32_16x16x32_bf16 v[224:227], a[216:219], v[40:43], v[224:227]
    v_exp_f32 v37, v37
    v_mfma_f32_16x16x32_bf16 v[224:227], a[248:251], v[44:47], v[224:227]
    s_waitcnt lgkmcnt(2)
    v_exp_f32 v38, v38
    v_mfma_f32_16x16x32_bf16 v[240:243], a[252:255], v[44:47], v[240:243]
    s_waitcnt lgkmcnt(0)
    v_exp_f32 v39, v39
    v_mfma_f32_16x16x32_bf16 v[240:243], a[220:223], v[40:43], v[240:243]
    v_cvt_pk_bf16_f32 v8, v36, v37
    v_cvt_pk_bf16_f32 v9, v38, v39
    v_mfma_f32_16x16x32_bf16 v[32:35], a[160:163], v[96:99], v[56:59]
    v_exp_f32 v24, v24
    v_mfma_f32_16x16x32_bf16 v[32:35], a[164:167], v[100:103], v[32:35]
    v_exp_f32 v25, v25
    v_mfma_f32_16x16x32_bf16 v[32:35], a[168:171], v[104:107], v[32:35]
    v_cvt_pk_bf16_f32 v40, v24, v25
    v_mfma_f32_16x16x32_bf16 v[32:35], a[172:175], v[108:111], v[32:35]
    buffer_load_dwordx4 v15, s[24:27], s92 offen offset:1024  lds
    v_mfma_f32_16x16x32_bf16 v[36:39], a[188:191], v[108:111], v[56:59]
    s_add_u32 s92, s81, 960
    v_exp_f32 v26, v26
    v_mfma_f32_16x16x32_bf16 v[36:39], a[184:187], v[104:107], v[36:39]
    v_exp_f32 v27, v27
    v_mfma_f32_16x16x32_bf16 v[36:39], a[180:183], v[100:103], v[36:39]
    v_cvt_pk_bf16_f32 v41, v26, v27
    v_mfma_f32_16x16x32_bf16 v[36:39], a[176:179], v[96:99], v[36:39]
    buffer_load_dwordx4 v15, s[24:27], s92 offen offset:2048  lds
    v_mfma_f32_16x16x32_bf16 v[132:135], a[192:195], v[2:5], v[132:135]
    s_add_u32 s92, s81, 0
    v_exp_f32 v28, v28
    v_mfma_f32_16x16x32_bf16 v[132:135], a[224:227], v[6:9], v[132:135]
    v_exp_f32 v29, v29
    v_mfma_f32_16x16x32_bf16 v[148:151], a[228:231], v[6:9], v[148:151]
    v_cvt_pk_bf16_f32 v42, v28, v29
    v_mfma_f32_16x16x32_bf16 v[148:151], a[196:199], v[2:5], v[148:151]
    buffer_load_dwordx4 v15, s[24:27], s92 offen offset:3072  lds
    v_mfma_f32_16x16x32_bf16 v[164:167], a[200:203], v[2:5], v[164:167]
    v_exp_f32 v30, v30
    v_mfma_f32_16x16x32_bf16 v[164:167], a[232:235], v[6:9], v[164:167]
    v_exp_f32 v31, v31
    v_mfma_f32_16x16x32_bf16 v[180:183], a[236:239], v[6:9], v[180:183]
    v_cvt_pk_bf16_f32 v43, v30, v31
    v_mfma_f32_16x16x32_bf16 v[180:183], a[204:207], v[2:5], v[180:183]
    buffer_load_dword a39, v23, s[40:43], s71 offen offset:3072
    s_waitcnt vmcnt(32)
    v_mfma_f32_16x16x32_bf16 v[24:27], a[128:131], v[112:115], v[60:63]
    s_waitcnt vmcnt(33)
    v_accvgpr_read_b32 v11, a16
    v_accvgpr_read_b32 v18, a18
    v_mfma_f32_16x16x32_bf16 v[24:27], a[132:135], v[116:119], v[24:27]
    s_barrier
    v_perm_b32 v20, v18, v11, s96
    v_accvgpr_read_b32 v11, a20
    v_mfma_f32_16x16x32_bf16 v[24:27], a[136:139], v[120:123], v[24:27]
    s_add_u32 s81, s81, 16384
    v_exp_f32 v32, v32
    v_mfma_f32_16x16x32_bf16 v[24:27], a[140:143], v[124:127], v[24:27]
    s_and_b32 s81, s81, 0x7ffff
    v_exp_f32 v33, v33
    v_mfma_f32_16x16x32_bf16 v[28:31], a[156:159], v[124:127], v[60:63]
    s_add_u32 s82, s82, 32768
    ds_read_b128 a[128:131], v10 offset:0
    v_cvt_pk_bf16_f32 v44, v32, v33
    v_mfma_f32_16x16x32_bf16 v[28:31], a[152:155], v[120:123], v[28:31]
    s_sub_u32 s92, s82, 163840
    ds_read_b128 a[132:135], v10 offset:1024
    v_accvgpr_read_b32 v18, a22
    v_perm_b32 v21, v18, v11, s96
    v_accvgpr_read_b32 v11, a24
    v_mfma_f32_16x16x32_bf16 v[28:31], a[148:151], v[116:119], v[28:31]
    s_min_u32 s82, s82, s92
    v_exp_f32 v34, v34
    v_mfma_f32_16x16x32_bf16 v[28:31], a[144:147], v[112:115], v[28:31]
    s_add_u32 m0, s82, 0
    v_exp_f32 v35, v35
    v_mfma_f32_16x16x32_bf16 v[196:199], a[208:211], v[2:5], v[196:199]
    s_add_u32 s92, s81, 2880
    ds_read_b128 a[136:139], v10 offset:2048
    v_cvt_pk_bf16_f32 v45, v34, v35
    v_mfma_f32_16x16x32_bf16 v[196:199], a[240:243], v[6:9], v[196:199]
    v_exp_f32 v36, v36
    v_mfma_f32_16x16x32_bf16 v[212:215], a[244:247], v[6:9], v[212:215]
    v_exp_f32 v37, v37
    v_mfma_f32_16x16x32_bf16 v[212:215], a[212:215], v[2:5], v[212:215]
    ds_read_b128 a[140:143], v10 offset:3072
    v_cvt_pk_bf16_f32 v46, v36, v37
    v_mfma_f32_16x16x32_bf16 v[228:231], a[216:219], v[2:5], v[228:231]
    ds_read_b128 a[156:159], v10 offset:7168
    v_mfma_f32_16x16x32_bf16 v[228:231], a[248:251], v[6:9], v[228:231]
    buffer_load_dwordx4 v15, s[20:23], s92 offen offset:0  lds
    v_mfma_f32_16x16x32_bf16 v[244:247], a[252:255], v[6:9], v[244:247]
    s_add_u32 s92, s81, 1920
    v_exp_f32 v38, v38
    v_mfma_f32_16x16x32_bf16 v[244:247], a[220:223], v[2:5], v[244:247]
    v_exp_f32 v39, v39
    v_smfmac_f32_16x16x64_bf16 a[116:119], a[108:111], v[2:9], v0
    ds_read_b128 a[152:155], v10 offset:6144
    v_cvt_pk_bf16_f32 v47, v38, v39
    v_mfma_f32_16x16x32_bf16 v[32:35], a[160:163], v[112:115], v[60:63]
    ds_read_b128 a[148:151], v10 offset:5120
    v_mfma_f32_16x16x32_bf16 v[32:35], a[164:167], v[116:119], v[32:35]
    buffer_load_dwordx4 v15, s[20:23], s92 offen offset:1024  lds
    v_mfma_f32_16x16x32_bf16 v[32:35], a[168:171], v[120:123], v[32:35]
    s_add_u32 s92, s81, 960
    v_exp_f32 v24, v24
    v_mfma_f32_16x16x32_bf16 v[32:35], a[172:175], v[124:127], v[32:35]
    v_exp_f32 v25, v25
    v_mfma_f32_16x16x32_bf16 v[36:39], a[188:191], v[124:127], v[60:63]
    ds_read_b128 a[144:147], v10 offset:4096
    v_cvt_pk_bf16_f32 v2, v24, v25
    v_mfma_f32_16x16x32_bf16 v[36:39], a[184:187], v[120:123], v[36:39]
    v_exp_f32 v26, v26
    v_mfma_f32_16x16x32_bf16 v[36:39], a[180:183], v[116:119], v[36:39]
    v_exp_f32 v27, v27
    v_mfma_f32_16x16x32_bf16 v[36:39], a[176:179], v[112:115], v[36:39]
    ds_read_b128 a[160:163], v10 offset:8192
    v_cvt_pk_bf16_f32 v3, v26, v27
    v_mfma_f32_16x16x32_bf16 v[136:139], a[192:195], v[40:43], v[136:139]
    v_exp_f32 v28, v28
    v_mfma_f32_16x16x32_bf16 v[136:139], a[224:227], v[44:47], v[136:139]
    v_exp_f32 v29, v29
    v_mfma_f32_16x16x32_bf16 v[152:155], a[228:231], v[44:47], v[152:155]
    ds_read_b128 a[164:167], v10 offset:9216
    v_cvt_pk_bf16_f32 v4, v28, v29
    v_mfma_f32_16x16x32_bf16 v[152:155], a[196:199], v[40:43], v[152:155]
    ds_read_b128 a[168:171], v10 offset:10240
    v_mfma_f32_16x16x32_bf16 v[168:171], a[200:203], v[40:43], v[168:171]
    buffer_load_dwordx4 v15, s[20:23], s92 offen offset:2048  lds
    v_mfma_f32_16x16x32_bf16 v[168:171], a[232:235], v[44:47], v[168:171]
    s_add_u32 s92, s81, 0
    v_exp_f32 v30, v30
    v_mfma_f32_16x16x32_bf16 v[184:187], a[236:239], v[44:47], v[184:187]
    v_exp_f32 v31, v31
    v_mfma_f32_16x16x32_bf16 v[184:187], a[204:207], v[40:43], v[184:187]
    s_waitcnt lgkmcnt(3)
    ds_read_b128 a[172:175], v10 offset:11264
    v_cvt_pk_bf16_f32 v5, v30, v31
    v_mfma_f32_16x16x32_bf16 v[24:27], a[128:131], v[64:67], v[48:51]
    ds_read_b128 a[188:191], v10 offset:15360
    v_mfma_f32_16x16x32_bf16 v[24:27], a[132:135], v[68:71], v[24:27]
    buffer_load_dwordx4 v15, s[20:23], s92 offen offset:3072  lds
    v_mfma_f32_16x16x32_bf16 v[24:27], a[136:139], v[72:75], v[24:27]
    s_add_u32 m0, s82, 16384
    v_exp_f32 v32, v32
    v_mfma_f32_16x16x32_bf16 v[24:27], a[140:143], v[76:79], v[24:27]
    s_add_u32 s92, s81, 2880
    v_exp_f32 v33, v33
    v_mfma_f32_16x16x32_bf16 v[28:31], a[156:159], v[76:79], v[48:51]
    ds_read_b128 a[184:187], v10 offset:14336
    v_cvt_pk_bf16_f32 v6, v32, v33
    v_mfma_f32_16x16x32_bf16 v[28:31], a[152:155], v[72:75], v[28:31]
    v_add_u32 v19, s83, v14
    v_xor_b32 v12, 32, v19
    v_mfma_f32_16x16x32_bf16 v[28:31], a[148:151], v[68:71], v[28:31]
    v_exp_f32 v34, v34
    v_mfma_f32_16x16x32_bf16 v[28:31], a[144:147], v[64:67], v[28:31]
    v_exp_f32 v35, v35
    v_mfma_f32_16x16x32_bf16 v[200:203], a[208:211], v[40:43], v[200:203]
    ds_read_b128 a[180:183], v10 offset:13312
    v_cvt_pk_bf16_f32 v7, v34, v35
    v_mfma_f32_16x16x32_bf16 v[200:203], a[240:243], v[44:47], v[200:203]
    s_add_u32 s83, s83, 32768
    v_exp_f32 v36, v36
    v_mfma_f32_16x16x32_bf16 v[216:219], a[244:247], v[44:47], v[216:219]
    s_sub_u32 s90, s83, 163840
    v_exp_f32 v37, v37
    v_mfma_f32_16x16x32_bf16 v[216:219], a[212:215], v[40:43], v[216:219]
    s_min_u32 s83, s83, s90
    ds_read_b128 a[176:179], v10 offset:12288
    v_cvt_pk_bf16_f32 v8, v36, v37
    v_mfma_f32_16x16x32_bf16 v[232:235], a[216:219], v[40:43], v[232:235]
    v_add_u32 v10, s83, v13
    v_mfma_f32_16x16x32_bf16 v[232:235], a[248:251], v[44:47], v[232:235]
    buffer_load_dwordx4 v15, s[24:27], s92 offen offset:0  lds
    v_mfma_f32_16x16x32_bf16 v[248:251], a[252:255], v[44:47], v[248:251]
    s_add_u32 s92, s81, 1920
    v_exp_f32 v38, v38
    v_mfma_f32_16x16x32_bf16 v[248:251], a[220:223], v[40:43], v[248:251]
    v_exp_f32 v39, v39
    v_smfmac_f32_16x16x64_bf16 a[120:123], a[108:111], v[40:47], v0
    s_waitcnt lgkmcnt(3)
    v_cvt_pk_bf16_f32 v9, v38, v39
    v_mfma_f32_16x16x32_bf16 v[32:35], a[160:163], v[64:67], v[48:51]
    v_exp_f32 v24, v24
    v_mfma_f32_16x16x32_bf16 v[32:35], a[164:167], v[68:71], v[32:35]
    v_exp_f32 v25, v25
    v_mfma_f32_16x16x32_bf16 v[32:35], a[168:171], v[72:75], v[32:35]
    v_exp_f32 v26, v26
    v_mfma_f32_16x16x32_bf16 v[32:35], a[172:175], v[76:79], v[32:35]
    v_exp_f32 v27, v27
    v_mfma_f32_16x16x32_bf16 v[36:39], a[188:191], v[76:79], v[48:51]
    s_waitcnt lgkmcnt(2)
    v_exp_f32 v28, v28
    v_mfma_f32_16x16x32_bf16 v[36:39], a[184:187], v[72:75], v[36:39]
    s_waitcnt lgkmcnt(1)
    v_exp_f32 v29, v29
    v_mfma_f32_16x16x32_bf16 v[36:39], a[180:183], v[68:71], v[36:39]
    s_waitcnt lgkmcnt(0)
    v_exp_f32 v30, v30
    v_mfma_f32_16x16x32_bf16 v[36:39], a[176:179], v[64:67], v[36:39]
    v_exp_f32 v31, v31
    v_mfma_f32_16x16x32_bf16 v[140:143], a[192:195], v[2:5], v[140:143]
    v_cvt_pk_bf16_f32 v40, v24, v25
    v_cvt_pk_bf16_f32 v41, v26, v27
    v_mfma_f32_16x16x32_bf16 v[140:143], a[224:227], v[6:9], v[140:143]
    ds_read_b64_tr_b16 a[192:193], v19 offset:16384
    v_cvt_pk_bf16_f32 v42, v28, v29
    v_mfma_f32_16x16x32_bf16 v[156:159], a[228:231], v[6:9], v[156:159]
    ds_read_b64_tr_b16 a[194:195], v19 offset:20480
    v_accvgpr_read_b32 v18, a26
    v_perm_b32 v22, v18, v11, s96
    v_accvgpr_read_b32 v11, a28
    v_mfma_f32_16x16x32_bf16 v[156:159], a[196:199], v[2:5], v[156:159]
    ds_read_b64_tr_b16 a[224:225], v19 offset:24576
    v_cvt_pk_bf16_f32 v43, v30, v31
    v_mfma_f32_16x16x32_bf16 v[172:175], a[200:203], v[2:5], v[172:175]
    ds_read_b64_tr_b16 a[226:227], v19 offset:28672
    v_accvgpr_read_b32 v18, a30
    v_perm_b32 v23, v18, v11, s96
    v_mfma_f32_16x16x32_bf16 v[172:175], a[232:235], v[6:9], v[172:175]
    ds_read_b64_tr_b16 a[228:229], v12 offset:24576
    buffer_store_dwordx4 v[20:23], v1, s[16:19], s54 offen offset:0 sc1
    s_add_u32 s54, s54, 303104
    v_mfma_f32_16x16x32_bf16 v[188:191], a[236:239], v[6:9], v[188:191]
    ds_read_b64_tr_b16 a[230:231], v12 offset:28672
    v_accvgpr_read_b32 v11, a16
    v_accvgpr_read_b32 v18, a18
    v_perm_b32 v20, v18, v11, s97
    v_mfma_f32_16x16x32_bf16 v[188:191], a[204:207], v[2:5], v[188:191]
    ds_read_b64_tr_b16 a[196:197], v12 offset:16384
    v_accvgpr_read_b32 v11, a20
    v_accvgpr_read_b32 v18, a22
    v_perm_b32 v21, v18, v11, s97
    v_mfma_f32_16x16x32_bf16 v[24:27], a[128:131], v[80:83], v[52:55]
    ds_read_b64_tr_b16 a[198:199], v12 offset:20480
    v_accvgpr_read_b32 v11, a24
    v_accvgpr_read_b32 v18, a26
    v_perm_b32 v22, v18, v11, s97
    v_mfma_f32_16x16x32_bf16 v[24:27], a[132:135], v[84:87], v[24:27]
    ds_read_b64_tr_b16 a[200:201], v19 offset:17408
    v_accvgpr_read_b32 v11, a28
    v_accvgpr_read_b32 v18, a30
    v_perm_b32 v23, v18, v11, s97
    v_mfma_f32_16x16x32_bf16 v[24:27], a[136:139], v[88:91], v[24:27]
    v_exp_f32 v32, v32
    v_mfma_f32_16x16x32_bf16 v[24:27], a[140:143], v[92:95], v[24:27]
    v_exp_f32 v33, v33
    v_mfma_f32_16x16x32_bf16 v[28:31], a[156:159], v[92:95], v[52:55]
    ds_read_b64_tr_b16 a[202:203], v19 offset:21504
    v_cvt_pk_bf16_f32 v44, v32, v33
    v_mfma_f32_16x16x32_bf16 v[28:31], a[152:155], v[88:91], v[28:31]
    ds_read_b64_tr_b16 a[232:233], v19 offset:25600
    v_mfma_f32_16x16x32_bf16 v[28:31], a[148:151], v[84:87], v[28:31]
    v_exp_f32 v34, v34
    v_mfma_f32_16x16x32_bf16 v[28:31], a[144:147], v[80:83], v[28:31]
    v_exp_f32 v35, v35
    v_mfma_f32_16x16x32_bf16 v[204:207], a[208:211], v[2:5], v[204:207]
    ds_read_b64_tr_b16 a[234:235], v19 offset:29696
    v_cvt_pk_bf16_f32 v45, v34, v35
    v_mfma_f32_16x16x32_bf16 v[204:207], a[240:243], v[6:9], v[204:207]
    v_exp_f32 v36, v36
    v_mfma_f32_16x16x32_bf16 v[220:223], a[244:247], v[6:9], v[220:223]
    v_exp_f32 v37, v37
    v_mfma_f32_16x16x32_bf16 v[220:223], a[212:215], v[2:5], v[220:223]
    ds_read_b64_tr_b16 a[236:237], v12 offset:25600
    v_cvt_pk_bf16_f32 v46, v36, v37
    v_mfma_f32_16x16x32_bf16 v[236:239], a[216:219], v[2:5], v[236:239]
    ds_read_b64_tr_b16 a[238:239], v12 offset:29696
    v_mfma_f32_16x16x32_bf16 v[236:239], a[248:251], v[6:9], v[236:239]
    ds_read_b64_tr_b16 a[204:205], v12 offset:17408
    buffer_store_dwordx4 v[20:23], v1, s[16:19], s54 offen offset:0 sc1
    s_add_u32 s54, s54, 303104
    v_mfma_f32_16x16x32_bf16 v[252:255], a[252:255], v[6:9], v[252:255]
    v_exp_f32 v38, v38
    v_mfma_f32_16x16x32_bf16 v[252:255], a[220:223], v[2:5], v[252:255]
    v_exp_f32 v39, v39
    v_smfmac_f32_16x16x64_bf16 a[124:127], a[108:111], v[2:9], v0
    ds_read_b64_tr_b16 a[206:207], v12 offset:21504
    v_cvt_pk_bf16_f32 v47, v38, v39
    v_mfma_f32_16x16x32_bf16 v[32:35], a[160:163], v[80:83], v[52:55]
    ds_read_b64_tr_b16 a[208:209], v19 offset:18432
    v_accvgpr_read_b32 v11, a17
    v_accvgpr_read_b32 v18, a19
    v_perm_b32 v20, v18, v11, s96
    v_mfma_f32_16x16x32_bf16 v[32:35], a[164:167], v[84:87], v[32:35]
    ds_read_b64_tr_b16 a[210:211], v19 offset:22528
    v_accvgpr_read_b32 v11, a21
    v_accvgpr_read_b32 v18, a23
    v_perm_b32 v21, v18, v11, s96
    v_mfma_f32_16x16x32_bf16 v[32:35], a[168:171], v[88:91], v[32:35]
    ds_read_b64_tr_b16 a[240:241], v19 offset:26624
    v_exp_f32 v24, v24
    v_mfma_f32_16x16x32_bf16 v[32:35], a[172:175], v[92:95], v[32:35]
    v_exp_f32 v25, v25
    v_mfma_f32_16x16x32_bf16 v[36:39], a[188:191], v[92:95], v[52:55]
    ds_read_b64_tr_b16 a[242:243], v19 offset:30720
    v_cvt_pk_bf16_f32 v2, v24, v25
    v_mfma_f32_16x16x32_bf16 v[36:39], a[184:187], v[88:91], v[36:39]
    v_exp_f32 v26, v26
    v_mfma_f32_16x16x32_bf16 v[36:39], a[180:183], v[84:87], v[36:39]
    v_exp_f32 v27, v27
    v_mfma_f32_16x16x32_bf16 v[36:39], a[176:179], v[80:83], v[36:39]
    s_waitcnt lgkmcnt(4)
    ds_read_b64_tr_b16 a[244:245], v12 offset:26624
    v_cvt_pk_bf16_f32 v3, v26, v27
    v_mfma_f32_16x16x32_bf16 v[128:131], a[192:195], v[40:43], v[128:131]
    v_exp_f32 v28, v28
    v_mfma_f32_16x16x32_bf16 v[128:131], a[224:227], v[44:47], v[128:131]
    v_exp_f32 v29, v29
    v_mfma_f32_16x16x32_bf16 v[144:147], a[228:231], v[44:47], v[144:147]
    ds_read_b64_tr_b16 a[246:247], v12 offset:30720
    v_cvt_pk_bf16_f32 v4, v28, v29
    v_mfma_f32_16x16x32_bf16 v[144:147], a[196:199], v[40:43], v[144:147]
    ds_read_b64_tr_b16 a[212:213], v12 offset:18432
    v_accvgpr_read_b32 v11, a25
    v_accvgpr_read_b32 v18, a27
    v_perm_b32 v22, v18, v11, s96
    v_mfma_f32_16x16x32_bf16 v[160:163], a[200:203], v[40:43], v[160:163]
    ds_read_b64_tr_b16 a[214:215], v12 offset:22528
    v_accvgpr_read_b32 v11, a29
    v_accvgpr_read_b32 v18, a31
    v_perm_b32 v23, v18, v11, s96
    v_mfma_f32_16x16x32_bf16 v[160:163], a[232:235], v[44:47], v[160:163]
    v_exp_f32 v30, v30
    v_mfma_f32_16x16x32_bf16 v[176:179], a[236:239], v[44:47], v[176:179]
    v_exp_f32 v31, v31
    v_mfma_f32_16x16x32_bf16 v[176:179], a[204:207], v[40:43], v[176:179]
    ds_read_b64_tr_b16 a[216:217], v19 offset:19456
    v_cvt_pk_bf16_f32 v5, v30, v31
    v_smfmac_f32_16x16x64_bf16 a[112:115], a[108:111], v[40:47], v0
    ds_read_b64_tr_b16 a[218:219], v19 offset:23552
    v_mfma_f32_16x16x32_bf16 v[24:27], a[128:131], v[96:99], v[56:59]
    ds_read_b64_tr_b16 a[248:249], v19 offset:27648
    buffer_store_dwordx4 v[20:23], v1, s[16:19], s54 offen offset:0 sc1
    s_add_u32 s54, s54, 303104
    v_mfma_f32_16x16x32_bf16 v[24:27], a[132:135], v[100:103], v[24:27]
    ds_read_b64_tr_b16 a[250:251], v19 offset:31744
    v_accvgpr_read_b32 v11, a17
    v_accvgpr_read_b32 v18, a19
    v_perm_b32 v20, v18, v11, s97
    v_mfma_f32_16x16x32_bf16 v[24:27], a[136:139], v[104:107], v[24:27]
    ds_read_b64_tr_b16 a[252:253], v12 offset:27648
    v_accvgpr_read_b32 v11, a21
    v_accvgpr_read_b32 v18, a23
    v_perm_b32 v21, v18, v11, s97
    v_mfma_f32_16x16x32_bf16 v[24:27], a[140:143], v[108:111], v[24:27]
    ds_read_b64_tr_b16 a[254:255], v12 offset:31744
    v_accvgpr_read_b32 v11, a25
    v_accvgpr_read_b32 v18, a27
    v_perm_b32 v22, v18, v11, s97
    v_mfma_f32_16x16x32_bf16 v[28:31], a[156:159], v[108:111], v[56:59]
    ds_read_b64_tr_b16 a[220:221], v12 offset:19456
    v_accvgpr_read_b32 v11, a29
    v_accvgpr_read_b32 v18, a31
    v_perm_b32 v23, v18, v11, s97
    v_mfma_f32_16x16x32_bf16 v[28:31], a[152:155], v[104:107], v[28:31]
    ds_read_b64_tr_b16 a[222:223], v12 offset:23552
    v_mfma_f32_16x16x32_bf16 v[28:31], a[148:151], v[100:103], v[28:31]
    v_exp_f32 v32, v32
    v_mfma_f32_16x16x32_bf16 v[28:31], a[144:147], v[96:99], v[28:31]
    s_waitcnt lgkmcnt(4)
    v_exp_f32 v33, v33
    v_mfma_f32_16x16x32_bf16 v[192:195], a[208:211], v[40:43], v[192:195]
    v_exp_f32 v34, v34
    v_mfma_f32_16x16x32_bf16 v[192:195], a[240:243], v[44:47], v[192:195]
    v_exp_f32 v35, v35
    v_mfma_f32_16x16x32_bf16 v[208:211], a[244:247], v[44:47], v[208:211]
    v_cvt_pk_bf16_f32 v6, v32, v33
    v_cvt_pk_bf16_f32 v7, v34, v35
    v_mfma_f32_16x16x32_bf16 v[208:211], a[212:215], v[40:43], v[208:211]
    v_exp_f32 v36, v36
    v_mfma_f32_16x16x32_bf16 v[224:227], a[216:219], v[40:43], v[224:227]
    v_exp_f32 v37, v37
    v_mfma_f32_16x16x32_bf16 v[224:227], a[248:251], v[44:47], v[224:227]
    s_waitcnt lgkmcnt(2)
    v_exp_f32 v38, v38
    v_mfma_f32_16x16x32_bf16 v[240:243], a[252:255], v[44:47], v[240:243]
    s_waitcnt lgkmcnt(0)
    v_exp_f32 v39, v39
    v_mfma_f32_16x16x32_bf16 v[240:243], a[220:223], v[40:43], v[240:243]
    v_cvt_pk_bf16_f32 v8, v36, v37
    v_cvt_pk_bf16_f32 v9, v38, v39
    v_mfma_f32_16x16x32_bf16 v[32:35], a[160:163], v[96:99], v[56:59]
    v_exp_f32 v24, v24
    v_mfma_f32_16x16x32_bf16 v[32:35], a[164:167], v[100:103], v[32:35]
    v_exp_f32 v25, v25
    v_mfma_f32_16x16x32_bf16 v[32:35], a[168:171], v[104:107], v[32:35]
    v_cvt_pk_bf16_f32 v40, v24, v25
    v_mfma_f32_16x16x32_bf16 v[32:35], a[172:175], v[108:111], v[32:35]
    buffer_load_dwordx4 v15, s[24:27], s92 offen offset:1024  lds
    v_mfma_f32_16x16x32_bf16 v[36:39], a[188:191], v[108:111], v[56:59]
    s_add_u32 s92, s81, 960
    v_exp_f32 v26, v26
    v_mfma_f32_16x16x32_bf16 v[36:39], a[184:187], v[104:107], v[36:39]
    v_exp_f32 v27, v27
    v_mfma_f32_16x16x32_bf16 v[36:39], a[180:183], v[100:103], v[36:39]
    v_cvt_pk_bf16_f32 v41, v26, v27
    v_mfma_f32_16x16x32_bf16 v[36:39], a[176:179], v[96:99], v[36:39]
    buffer_load_dwordx4 v15, s[24:27], s92 offen offset:2048  lds
    v_mfma_f32_16x16x32_bf16 v[132:135], a[192:195], v[2:5], v[132:135]
    s_add_u32 s92, s81, 0
    v_exp_f32 v28, v28
    v_mfma_f32_16x16x32_bf16 v[132:135], a[224:227], v[6:9], v[132:135]
    v_exp_f32 v29, v29
    v_mfma_f32_16x16x32_bf16 v[148:151], a[228:231], v[6:9], v[148:151]
    v_cvt_pk_bf16_f32 v42, v28, v29
    v_mfma_f32_16x16x32_bf16 v[148:151], a[196:199], v[2:5], v[148:151]
    buffer_load_dwordx4 v15, s[24:27], s92 offen offset:3072  lds
    v_mfma_f32_16x16x32_bf16 v[164:167], a[200:203], v[2:5], v[164:167]
    v_exp_f32 v30, v30
    v_mfma_f32_16x16x32_bf16 v[164:167], a[232:235], v[6:9], v[164:167]
    v_exp_f32 v31, v31
    v_mfma_f32_16x16x32_bf16 v[180:183], a[236:239], v[6:9], v[180:183]
    v_cvt_pk_bf16_f32 v43, v30, v31
    v_mfma_f32_16x16x32_bf16 v[180:183], a[204:207], v[2:5], v[180:183]
    buffer_store_dwordx4 v[20:23], v1, s[16:19], s54 offen offset:0 sc1
    s_add_u32 s54, s54, 303104
    s_waitcnt vmcnt(12)
    v_mfma_f32_16x16x32_bf16 v[24:27], a[128:131], v[112:115], v[60:63]
    s_waitcnt vmcnt(29)
    v_accvgpr_read_b32 v11, a0
    v_accvgpr_read_b32 v18, a2
    v_mfma_f32_16x16x32_bf16 v[24:27], a[132:135], v[116:119], v[24:27]
    s_barrier
    v_perm_b32 v20, v18, v11, s96
    v_accvgpr_read_b32 v11, a4
    v_mfma_f32_16x16x32_bf16 v[24:27], a[136:139], v[120:123], v[24:27]
    s_add_u32 s81, s81, 16384
    v_exp_f32 v32, v32
    v_mfma_f32_16x16x32_bf16 v[24:27], a[140:143], v[124:127], v[24:27]
    s_and_b32 s81, s81, 0x7ffff
    v_exp_f32 v33, v33
    v_mfma_f32_16x16x32_bf16 v[28:31], a[156:159], v[124:127], v[60:63]
    s_add_u32 s82, s82, 32768
    ds_read_b128 a[128:131], v10 offset:0
    v_cvt_pk_bf16_f32 v44, v32, v33
    v_mfma_f32_16x16x32_bf16 v[28:31], a[152:155], v[120:123], v[28:31]
    s_sub_u32 s92, s82, 163840
    ds_read_b128 a[132:135], v10 offset:1024
    v_accvgpr_read_b32 v18, a6
    v_perm_b32 v21, v18, v11, s96
    v_accvgpr_read_b32 v11, a8
    v_mfma_f32_16x16x32_bf16 v[28:31], a[148:151], v[116:119], v[28:31]
    s_min_u32 s82, s82, s92
    v_exp_f32 v34, v34
    v_mfma_f32_16x16x32_bf16 v[28:31], a[144:147], v[112:115], v[28:31]
    s_add_u32 m0, s82, 0
    v_exp_f32 v35, v35
    v_mfma_f32_16x16x32_bf16 v[196:199], a[208:211], v[2:5], v[196:199]
    s_add_u32 s92, s81, 2880
    ds_read_b128 a[136:139], v10 offset:2048
    v_cvt_pk_bf16_f32 v45, v34, v35
    v_mfma_f32_16x16x32_bf16 v[196:199], a[240:243], v[6:9], v[196:199]
    v_exp_f32 v36, v36
    v_mfma_f32_16x16x32_bf16 v[212:215], a[244:247], v[6:9], v[212:215]
    v_exp_f32 v37, v37
    v_mfma_f32_16x16x32_bf16 v[212:215], a[212:215], v[2:5], v[212:215]
    ds_read_b128 a[140:143], v10 offset:3072
    v_cvt_pk_bf16_f32 v46, v36, v37
    v_mfma_f32_16x16x32_bf16 v[228:231], a[216:219], v[2:5], v[228:231]
    ds_read_b128 a[156:159], v10 offset:7168
    v_mfma_f32_16x16x32_bf16 v[228:231], a[248:251], v[6:9], v[228:231]
    buffer_load_dwordx4 v15, s[20:23], s92 offen offset:0  lds
    v_mfma_f32_16x16x32_bf16 v[244:247], a[252:255], v[6:9], v[244:247]
    s_add_u32 s92, s81, 1920
    v_exp_f32 v38, v38
    v_mfma_f32_16x16x32_bf16 v[244:247], a[220:223], v[2:5], v[244:247]
    v_exp_f32 v39, v39
    v_smfmac_f32_16x16x64_bf16 a[116:119], a[108:111], v[2:9], v0
    ds_read_b128 a[152:155], v10 offset:6144
    v_cvt_pk_bf16_f32 v47, v38, v39
    v_mfma_f32_16x16x32_bf16 v[32:35], a[160:163], v[112:115], v[60:63]
    ds_read_b128 a[148:151], v10 offset:5120
    v_mfma_f32_16x16x32_bf16 v[32:35], a[164:167], v[116:119], v[32:35]
    buffer_load_dwordx4 v15, s[20:23], s92 offen offset:1024  lds
    v_mfma_f32_16x16x32_bf16 v[32:35], a[168:171], v[120:123], v[32:35]
    s_add_u32 s92, s81, 960
    v_exp_f32 v24, v24
    v_mfma_f32_16x16x32_bf16 v[32:35], a[172:175], v[124:127], v[32:35]
    v_exp_f32 v25, v25
    v_mfma_f32_16x16x32_bf16 v[36:39], a[188:191], v[124:127], v[60:63]
    ds_read_b128 a[144:147], v10 offset:4096
    v_cvt_pk_bf16_f32 v2, v24, v25
    v_mfma_f32_16x16x32_bf16 v[36:39], a[184:187], v[120:123], v[36:39]
    v_exp_f32 v26, v26
    v_mfma_f32_16x16x32_bf16 v[36:39], a[180:183], v[116:119], v[36:39]
    v_exp_f32 v27, v27
    v_mfma_f32_16x16x32_bf16 v[36:39], a[176:179], v[112:115], v[36:39]
    ds_read_b128 a[160:163], v10 offset:8192
    v_cvt_pk_bf16_f32 v3, v26, v27
    v_mfma_f32_16x16x32_bf16 v[136:139], a[192:195], v[40:43], v[136:139]
    v_exp_f32 v28, v28
    v_mfma_f32_16x16x32_bf16 v[136:139], a[224:227], v[44:47], v[136:139]
    v_exp_f32 v29, v29
    v_mfma_f32_16x16x32_bf16 v[152:155], a[228:231], v[44:47], v[152:155]
    ds_read_b128 a[164:167], v10 offset:9216
    v_cvt_pk_bf16_f32 v4, v28, v29
    v_mfma_f32_16x16x32_bf16 v[152:155], a[196:199], v[40:43], v[152:155]
    ds_read_b128 a[168:171], v10 offset:10240
    v_mfma_f32_16x16x32_bf16 v[168:171], a[200:203], v[40:43], v[168:171]
    buffer_load_dwordx4 v15, s[20:23], s92 offen offset:2048  lds
    v_mfma_f32_16x16x32_bf16 v[168:171], a[232:235], v[44:47], v[168:171]
    s_add_u32 s92, s81, 0
    v_exp_f32 v30, v30
    v_mfma_f32_16x16x32_bf16 v[184:187], a[236:239], v[44:47], v[184:187]
    v_exp_f32 v31, v31
    v_mfma_f32_16x16x32_bf16 v[184:187], a[204:207], v[40:43], v[184:187]
    s_waitcnt lgkmcnt(3)
    ds_read_b128 a[172:175], v10 offset:11264
    v_cvt_pk_bf16_f32 v5, v30, v31
    v_mfma_f32_16x16x32_bf16 v[24:27], a[128:131], v[64:67], v[48:51]
    ds_read_b128 a[188:191], v10 offset:15360
    v_mfma_f32_16x16x32_bf16 v[24:27], a[132:135], v[68:71], v[24:27]
    buffer_load_dwordx4 v15, s[20:23], s92 offen offset:3072  lds
    v_mfma_f32_16x16x32_bf16 v[24:27], a[136:139], v[72:75], v[24:27]
    s_add_u32 m0, s82, 16384
    v_exp_f32 v32, v32
    v_mfma_f32_16x16x32_bf16 v[24:27], a[140:143], v[76:79], v[24:27]
    s_add_u32 s92, s81, 2880
    v_exp_f32 v33, v33
    v_mfma_f32_16x16x32_bf16 v[28:31], a[156:159], v[76:79], v[48:51]
    ds_read_b128 a[184:187], v10 offset:14336
    v_cvt_pk_bf16_f32 v6, v32, v33
    v_mfma_f32_16x16x32_bf16 v[28:31], a[152:155], v[72:75], v[28:31]
    v_add_u32 v19, s83, v14
    v_xor_b32 v12, 32, v19
    v_mfma_f32_16x16x32_bf16 v[28:31], a[148:151], v[68:71], v[28:31]
    v_exp_f32 v34, v34
    v_mfma_f32_16x16x32_bf16 v[28:31], a[144:147], v[64:67], v[28:31]
    v_exp_f32 v35, v35
    v_mfma_f32_16x16x32_bf16 v[200:203], a[208:211], v[40:43], v[200:203]
    ds_read_b128 a[180:183], v10 offset:13312
    v_cvt_pk_bf16_f32 v7, v34, v35
    v_mfma_f32_16x16x32_bf16 v[200:203], a[240:243], v[44:47], v[200:203]
    s_branch L_ov17
L_pad17:
    s_setpc_b64 s[86:87]
L_ov17:
    s_add_u32 s83, s83, 32768
    v_exp_f32 v36, v36
    v_mfma_f32_16x16x32_bf16 v[216:219], a[244:247], v[44:47], v[216:219]
    s_sub_u32 s90, s83, 163840
    v_exp_f32 v37, v37
    v_mfma_f32_16x16x32_bf16 v[216:219], a[212:215], v[40:43], v[216:219]
    s_min_u32 s83, s83, s90
    ds_read_b128 a[176:179], v10 offset:12288
    v_cvt_pk_bf16_f32 v8, v36, v37
    v_mfma_f32_16x16x32_bf16 v[232:235], a[216:219], v[40:43], v[232:235]
    v_add_u32 v10, s83, v13
    v_mfma_f32_16x16x32_bf16 v[232:235], a[248:251], v[44:47], v[232:235]
    buffer_load_dwordx4 v15, s[24:27], s92 offen offset:0  lds
    v_mfma_f32_16x16x32_bf16 v[248:251], a[252:255], v[44:47], v[248:251]
    s_add_u32 s92, s81, 1920
    v_exp_f32 v38, v38
    v_mfma_f32_16x16x32_bf16 v[248:251], a[220:223], v[40:43], v[248:251]
    v_exp_f32 v39, v39
    v_smfmac_f32_16x16x64_bf16 a[120:123], a[108:111], v[40:47], v0
    s_waitcnt lgkmcnt(3)
    v_cvt_pk_bf16_f32 v9, v38, v39
    v_mfma_f32_16x16x32_bf16 v[32:35], a[160:163], v[64:67], v[48:51]
    v_exp_f32 v24, v24
    v_mfma_f32_16x16x32_bf16 v[32:35], a[164:167], v[68:71], v[32:35]
    v_exp_f32 v25, v25
    v_mfma_f32_16x16x32_bf16 v[32:35], a[168:171], v[72:75], v[32:35]
    v_exp_f32 v26, v26
    v_mfma_f32_16x16x32_bf16 v[32:35], a[172:175], v[76:79], v[32:35]
    v_exp_f32 v27, v27
    v_mfma_f32_16x16x32_bf16 v[36:39], a[188:191], v[76:79], v[48:51]
    s_waitcnt lgkmcnt(2)
    v_exp_f32 v28, v28
    v_mfma_f32_16x16x32_bf16 v[36:39], a[184:187], v[72:75], v[36:39]
    s_waitcnt lgkmcnt(1)
    v_exp_f32 v29, v29
    v_mfma_f32_16x16x32_bf16 v[36:39], a[180:183], v[68:71], v[36:39]
    s_waitcnt lgkmcnt(0)
    v_exp_f32 v30, v30
    v_mfma_f32_16x16x32_bf16 v[36:39], a[176:179], v[64:67], v[36:39]
    v_exp_f32 v31, v31
    v_mfma_f32_16x16x32_bf16 v[140:143], a[192:195], v[2:5], v[140:143]
    v_cvt_pk_bf16_f32 v40, v24, v25
    v_cvt_pk_bf16_f32 v41, v26, v27
    v_mfma_f32_16x16x32_bf16 v[140:143], a[224:227], v[6:9], v[140:143]
    ds_read_b64_tr_b16 a[192:193], v19 offset:16384
    v_cvt_pk_bf16_f32 v42, v28, v29
    v_mfma_f32_16x16x32_bf16 v[156:159], a[228:231], v[6:9], v[156:159]
    ds_read_b64_tr_b16 a[194:195], v19 offset:20480
    v_accvgpr_read_b32 v18, a10
    v_perm_b32 v22, v18, v11, s96
    v_accvgpr_read_b32 v11, a12
    v_mfma_f32_16x16x32_bf16 v[156:159], a[196:199], v[2:5], v[156:159]
    ds_read_b64_tr_b16 a[224:225], v19 offset:24576
    v_cvt_pk_bf16_f32 v43, v30, v31
    v_mfma_f32_16x16x32_bf16 v[172:175], a[200:203], v[2:5], v[172:175]
    ds_read_b64_tr_b16 a[226:227], v19 offset:28672
    v_accvgpr_read_b32 v18, a14
    v_perm_b32 v23, v18, v11, s96
    v_mfma_f32_16x16x32_bf16 v[172:175], a[232:235], v[6:9], v[172:175]
    ds_read_b64_tr_b16 a[228:229], v12 offset:24576
    buffer_store_dwordx4 v[20:23], v1, s[16:19], s52 offen offset:0 sc1
    v_mfma_f32_16x16x32_bf16 v[188:191], a[236:239], v[6:9], v[188:191]
    ds_read_b64_tr_b16 a[230:231], v12 offset:28672
    v_accvgpr_read_b32 v11, a0
    v_accvgpr_read_b32 v18, a2
    v_perm_b32 v20, v18, v11, s97
    v_mfma_f32_16x16x32_bf16 v[188:191], a[204:207], v[2:5], v[188:191]
    ds_read_b64_tr_b16 a[196:197], v12 offset:16384
    v_accvgpr_read_b32 v11, a4
    v_accvgpr_read_b32 v18, a6
    v_perm_b32 v21, v18, v11, s97
    v_mfma_f32_16x16x32_bf16 v[24:27], a[128:131], v[80:83], v[52:55]
    ds_read_b64_tr_b16 a[198:199], v12 offset:20480
    v_accvgpr_read_b32 v11, a8
    v_accvgpr_read_b32 v18, a10
    v_perm_b32 v22, v18, v11, s97
    v_mfma_f32_16x16x32_bf16 v[24:27], a[132:135], v[84:87], v[24:27]
    ds_read_b64_tr_b16 a[200:201], v19 offset:17408
    v_accvgpr_read_b32 v11, a12
    v_accvgpr_read_b32 v18, a14
    v_perm_b32 v23, v18, v11, s97
    v_mfma_f32_16x16x32_bf16 v[24:27], a[136:139], v[88:91], v[24:27]
    v_exp_f32 v32, v32
    v_mfma_f32_16x16x32_bf16 v[24:27], a[140:143], v[92:95], v[24:27]
    v_exp_f32 v33, v33
    v_mfma_f32_16x16x32_bf16 v[28:31], a[156:159], v[92:95], v[52:55]
    ds_read_b64_tr_b16 a[202:203], v19 offset:21504
    v_cvt_pk_bf16_f32 v44, v32, v33
    v_mfma_f32_16x16x32_bf16 v[28:31], a[152:155], v[88:91], v[28:31]
    ds_read_b64_tr_b16 a[232:233], v19 offset:25600
    v_mfma_f32_16x16x32_bf16 v[28:31], a[148:151], v[84:87], v[28:31]
    v_exp_f32 v34, v34
    v_mfma_f32_16x16x32_bf16 v[28:31], a[144:147], v[80:83], v[28:31]
    v_exp_f32 v35, v35
    v_mfma_f32_16x16x32_bf16 v[204:207], a[208:211], v[2:5], v[204:207]
    ds_read_b64_tr_b16 a[234:235], v19 offset:29696
    v_cvt_pk_bf16_f32 v45, v34, v35
    v_mfma_f32_16x16x32_bf16 v[204:207], a[240:243], v[6:9], v[204:207]
    v_exp_f32 v36, v36
    v_mfma_f32_16x16x32_bf16 v[220:223], a[244:247], v[6:9], v[220:223]
    v_exp_f32 v37, v37
    v_mfma_f32_16x16x32_bf16 v[220:223], a[212:215], v[2:5], v[220:223]
    ds_read_b64_tr_b16 a[236:237], v12 offset:25600
    v_cvt_pk_bf16_f32 v46, v36, v37
    v_mfma_f32_16x16x32_bf16 v[236:239], a[216:219], v[2:5], v[236:239]
    ds_read_b64_tr_b16 a[238:239], v12 offset:29696
    v_mfma_f32_16x16x32_bf16 v[236:239], a[248:251], v[6:9], v[236:239]
    ds_read_b64_tr_b16 a[204:205], v12 offset:17408
    buffer_store_dwordx4 v[20:23], v1, s[16:19], s52 offen offset:1024 sc1
    v_mfma_f32_16x16x32_bf16 v[252:255], a[252:255], v[6:9], v[252:255]
    v_exp_f32 v38, v38
    v_mfma_f32_16x16x32_bf16 v[252:255], a[220:223], v[2:5], v[252:255]
    v_exp_f32 v39, v39
    v_smfmac_f32_16x16x64_bf16 a[124:127], a[108:111], v[2:9], v0
    ds_read_b64_tr_b16 a[206:207], v12 offset:21504
    v_cvt_pk_bf16_f32 v47, v38, v39
    v_mfma_f32_16x16x32_bf16 v[32:35], a[160:163], v[80:83], v[52:55]
    ds_read_b64_tr_b16 a[208:209], v19 offset:18432
    v_accvgpr_read_b32 v11, a1
    v_accvgpr_read_b32 v18, a3
    v_perm_b32 v20, v18, v11, s96
    v_mfma_f32_16x16x32_bf16 v[32:35], a[164:167], v[84:87], v[32:35]
    ds_read_b64_tr_b16 a[210:211], v19 offset:22528
    v_accvgpr_read_b32 v11, a5
    v_accvgpr_read_b32 v18, a7
    v_perm_b32 v21, v18, v11, s96
    v_mfma_f32_16x16x32_bf16 v[32:35], a[168:171], v[88:91], v[32:35]
    ds_read_b64_tr_b16 a[240:241], v19 offset:26624
    v_exp_f32 v24, v24
    v_mfma_f32_16x16x32_bf16 v[32:35], a[172:175], v[92:95], v[32:35]
    v_exp_f32 v25, v25
    v_mfma_f32_16x16x32_bf16 v[36:39], a[188:191], v[92:95], v[52:55]
    ds_read_b64_tr_b16 a[242:243], v19 offset:30720
    v_cvt_pk_bf16_f32 v2, v24, v25
    v_mfma_f32_16x16x32_bf16 v[36:39], a[184:187], v[88:91], v[36:39]
    v_exp_f32 v26, v26
    v_mfma_f32_16x16x32_bf16 v[36:39], a[180:183], v[84:87], v[36:39]
    v_exp_f32 v27, v27
    v_mfma_f32_16x16x32_bf16 v[36:39], a[176:179], v[80:83], v[36:39]
    s_waitcnt lgkmcnt(4)
    ds_read_b64_tr_b16 a[244:245], v12 offset:26624
    v_cvt_pk_bf16_f32 v3, v26, v27
    v_mfma_f32_16x16x32_bf16 v[128:131], a[192:195], v[40:43], v[128:131]
    v_exp_f32 v28, v28
    v_mfma_f32_16x16x32_bf16 v[128:131], a[224:227], v[44:47], v[128:131]
    v_exp_f32 v29, v29
    v_mfma_f32_16x16x32_bf16 v[144:147], a[228:231], v[44:47], v[144:147]
    ds_read_b64_tr_b16 a[246:247], v12 offset:30720
    v_cvt_pk_bf16_f32 v4, v28, v29
    v_mfma_f32_16x16x32_bf16 v[144:147], a[196:199], v[40:43], v[144:147]
    ds_read_b64_tr_b16 a[212:213], v12 offset:18432
    v_accvgpr_read_b32 v11, a9
    v_accvgpr_read_b32 v18, a11
    v_perm_b32 v22, v18, v11, s96
    v_mfma_f32_16x16x32_bf16 v[160:163], a[200:203], v[40:43], v[160:163]
    ds_read_b64_tr_b16 a[214:215], v12 offset:22528
    v_accvgpr_read_b32 v11, a13
    v_accvgpr_read_b32 v18, a15
    v_perm_b32 v23, v18, v11, s96
    v_mfma_f32_16x16x32_bf16 v[160:163], a[232:235], v[44:47], v[160:163]
    v_exp_f32 v30, v30
    v_mfma_f32_16x16x32_bf16 v[176:179], a[236:239], v[44:47], v[176:179]
    v_exp_f32 v31, v31
    v_mfma_f32_16x16x32_bf16 v[176:179], a[204:207], v[40:43], v[176:179]
    ds_read_b64_tr_b16 a[216:217], v19 offset:19456
    v_cvt_pk_bf16_f32 v5, v30, v31
    v_smfmac_f32_16x16x64_bf16 a[112:115], a[108:111], v[40:47], v0
    ds_read_b64_tr_b16 a[218:219], v19 offset:23552
    v_mfma_f32_16x16x32_bf16 v[24:27], a[128:131], v[96:99], v[56:59]
    ds_read_b64_tr_b16 a[248:249], v19 offset:27648
    buffer_store_dwordx4 v[20:23], v1, s[16:19], s52 offen offset:2048 sc1
    v_mfma_f32_16x16x32_bf16 v[24:27], a[132:135], v[100:103], v[24:27]
    ds_read_b64_tr_b16 a[250:251], v19 offset:31744
    v_accvgpr_read_b32 v11, a1
    v_accvgpr_read_b32 v18, a3
    v_perm_b32 v20, v18, v11, s97
    v_mfma_f32_16x16x32_bf16 v[24:27], a[136:139], v[104:107], v[24:27]
    ds_read_b64_tr_b16 a[252:253], v12 offset:27648
    v_accvgpr_read_b32 v11, a5
    v_accvgpr_read_b32 v18, a7
    v_perm_b32 v21, v18, v11, s97
    v_mfma_f32_16x16x32_bf16 v[24:27], a[140:143], v[108:111], v[24:27]
    ds_read_b64_tr_b16 a[254:255], v12 offset:31744
    v_accvgpr_read_b32 v11, a9
    v_accvgpr_read_b32 v18, a11
    v_perm_b32 v22, v18, v11, s97
    v_mfma_f32_16x16x32_bf16 v[28:31], a[156:159], v[108:111], v[56:59]
    ds_read_b64_tr_b16 a[220:221], v12 offset:19456
    v_accvgpr_read_b32 v11, a13
    v_accvgpr_read_b32 v18, a15
    v_perm_b32 v23, v18, v11, s97
    v_mfma_f32_16x16x32_bf16 v[28:31], a[152:155], v[104:107], v[28:31]
    ds_read_b64_tr_b16 a[222:223], v12 offset:23552
    v_mfma_f32_16x16x32_bf16 v[28:31], a[148:151], v[100:103], v[28:31]
    v_exp_f32 v32, v32
    v_mfma_f32_16x16x32_bf16 v[28:31], a[144:147], v[96:99], v[28:31]
    s_waitcnt lgkmcnt(4)
    v_exp_f32 v33, v33
    v_mfma_f32_16x16x32_bf16 v[192:195], a[208:211], v[40:43], v[192:195]
    v_exp_f32 v34, v34
    v_mfma_f32_16x16x32_bf16 v[192:195], a[240:243], v[44:47], v[192:195]
    v_exp_f32 v35, v35
    v_mfma_f32_16x16x32_bf16 v[208:211], a[244:247], v[44:47], v[208:211]
    v_cvt_pk_bf16_f32 v6, v32, v33
    v_cvt_pk_bf16_f32 v7, v34, v35
    v_mfma_f32_16x16x32_bf16 v[208:211], a[212:215], v[40:43], v[208:211]
    v_exp_f32 v36, v36
    v_mfma_f32_16x16x32_bf16 v[224:227], a[216:219], v[40:43], v[224:227]
    v_exp_f32 v37, v37
    v_mfma_f32_16x16x32_bf16 v[224:227], a[248:251], v[44:47], v[224:227]
    s_waitcnt lgkmcnt(2)
    v_exp_f32 v38, v38
    v_mfma_f32_16x16x32_bf16 v[240:243], a[252:255], v[44:47], v[240:243]
    s_waitcnt lgkmcnt(0)
    v_exp_f32 v39, v39
    v_mfma_f32_16x16x32_bf16 v[240:243], a[220:223], v[40:43], v[240:243]
    v_cvt_pk_bf16_f32 v8, v36, v37
    v_cvt_pk_bf16_f32 v9, v38, v39
    v_mfma_f32_16x16x32_bf16 v[32:35], a[160:163], v[96:99], v[56:59]
    v_exp_f32 v24, v24
    v_mfma_f32_16x16x32_bf16 v[32:35], a[164:167], v[100:103], v[32:35]
    v_exp_f32 v25, v25
    v_mfma_f32_16x16x32_bf16 v[32:35], a[168:171], v[104:107], v[32:35]
    v_cvt_pk_bf16_f32 v40, v24, v25
    v_mfma_f32_16x16x32_bf16 v[32:35], a[172:175], v[108:111], v[32:35]
    buffer_load_dwordx4 v15, s[24:27], s92 offen offset:1024  lds
    v_mfma_f32_16x16x32_bf16 v[36:39], a[188:191], v[108:111], v[56:59]
    s_add_u32 s92, s81, 960
    v_exp_f32 v26, v26
    v_mfma_f32_16x16x32_bf16 v[36:39], a[184:187], v[104:107], v[36:39]
    v_exp_f32 v27, v27
    v_mfma_f32_16x16x32_bf16 v[36:39], a[180:183], v[100:103], v[36:39]
    v_cvt_pk_bf16_f32 v41, v26, v27
    v_mfma_f32_16x16x32_bf16 v[36:39], a[176:179], v[96:99], v[36:39]
    buffer_load_dwordx4 v15, s[24:27], s92 offen offset:2048  lds
    v_mfma_f32_16x16x32_bf16 v[132:135], a[192:195], v[2:5], v[132:135]
    s_add_u32 s92, s81, 0
    v_exp_f32 v28, v28
    v_mfma_f32_16x16x32_bf16 v[132:135], a[224:227], v[6:9], v[132:135]
    v_exp_f32 v29, v29
    v_mfma_f32_16x16x32_bf16 v[148:151], a[228:231], v[6:9], v[148:151]
    v_cvt_pk_bf16_f32 v42, v28, v29
    v_mfma_f32_16x16x32_bf16 v[148:151], a[196:199], v[2:5], v[148:151]
    buffer_load_dwordx4 v15, s[24:27], s92 offen offset:3072  lds
    v_mfma_f32_16x16x32_bf16 v[164:167], a[200:203], v[2:5], v[164:167]
    v_exp_f32 v30, v30
    v_mfma_f32_16x16x32_bf16 v[164:167], a[232:235], v[6:9], v[164:167]
    v_exp_f32 v31, v31
    v_mfma_f32_16x16x32_bf16 v[180:183], a[236:239], v[6:9], v[180:183]
    v_cvt_pk_bf16_f32 v43, v30, v31
    v_mfma_f32_16x16x32_bf16 v[180:183], a[204:207], v[2:5], v[180:183]
    buffer_store_dwordx4 v[20:23], v1, s[16:19], s52 offen offset:3072 sc1
    v_mfma_f32_16x16x32_bf16 v[24:27], a[128:131], v[112:115], v[60:63]
    s_waitcnt vmcnt(25)
    v_accvgpr_read_b32 v11, a32
    v_accvgpr_read_b32 v18, a33
    v_mfma_f32_16x16x32_bf16 v[24:27], a[132:135], v[116:119], v[24:27]
    s_barrier
    v_perm_b32 v20, v18, v11, s96
    v_accvgpr_read_b32 v11, a34
    v_mfma_f32_16x16x32_bf16 v[24:27], a[136:139], v[120:123], v[24:27]
    s_add_u32 s81, s81, 16384
    v_exp_f32 v32, v32
    v_mfma_f32_16x16x32_bf16 v[24:27], a[140:143], v[124:127], v[24:27]
    s_and_b32 s81, s81, 0x7ffff
    v_exp_f32 v33, v33
    v_mfma_f32_16x16x32_bf16 v[28:31], a[156:159], v[124:127], v[60:63]
    s_add_u32 s82, s82, 32768
    ds_read_b128 a[128:131], v10 offset:0
    v_cvt_pk_bf16_f32 v44, v32, v33
    v_mfma_f32_16x16x32_bf16 v[28:31], a[152:155], v[120:123], v[28:31]
    s_sub_u32 s92, s82, 163840
    ds_read_b128 a[132:135], v10 offset:1024
    v_accvgpr_read_b32 v18, a35
    v_perm_b32 v21, v18, v11, s96
    v_accvgpr_read_b32 v11, a36
    v_mfma_f32_16x16x32_bf16 v[28:31], a[148:151], v[116:119], v[28:31]
    s_min_u32 s82, s82, s92
    v_exp_f32 v34, v34
    v_mfma_f32_16x16x32_bf16 v[28:31], a[144:147], v[112:115], v[28:31]
    s_add_u32 m0, s82, 0
    v_exp_f32 v35, v35
    v_mfma_f32_16x16x32_bf16 v[196:199], a[208:211], v[2:5], v[196:199]
    s_add_u32 s92, s81, 2880
    ds_read_b128 a[136:139], v10 offset:2048
    v_cvt_pk_bf16_f32 v45, v34, v35
    v_mfma_f32_16x16x32_bf16 v[196:199], a[240:243], v[6:9], v[196:199]
    v_exp_f32 v36, v36
    v_mfma_f32_16x16x32_bf16 v[212:215], a[244:247], v[6:9], v[212:215]
    v_exp_f32 v37, v37
    v_mfma_f32_16x16x32_bf16 v[212:215], a[212:215], v[2:5], v[212:215]
    ds_read_b128 a[140:143], v10 offset:3072
    v_cvt_pk_bf16_f32 v46, v36, v37
    v_mfma_f32_16x16x32_bf16 v[228:231], a[216:219], v[2:5], v[228:231]
    ds_read_b128 a[156:159], v10 offset:7168
    v_mfma_f32_16x16x32_bf16 v[228:231], a[248:251], v[6:9], v[228:231]
    buffer_load_dwordx4 v15, s[20:23], s92 offen offset:0  lds
    v_mfma_f32_16x16x32_bf16 v[244:247], a[252:255], v[6:9], v[244:247]
    s_add_u32 s92, s81, 1920
    v_exp_f32 v38, v38
    v_mfma_f32_16x16x32_bf16 v[244:247], a[220:223], v[2:5], v[244:247]
    v_exp_f32 v39, v39
    v_smfmac_f32_16x16x64_bf16 a[116:119], a[108:111], v[2:9], v0
    ds_read_b128 a[152:155], v10 offset:6144
    v_cvt_pk_bf16_f32 v47, v38, v39
    v_mfma_f32_16x16x32_bf16 v[32:35], a[160:163], v[112:115], v[60:63]
    ds_read_b128 a[148:151], v10 offset:5120
    v_mfma_f32_16x16x32_bf16 v[32:35], a[164:167], v[116:119], v[32:35]
    buffer_load_dwordx4 v15, s[20:23], s92 offen offset:1024  lds
    v_mfma_f32_16x16x32_bf16 v[32:35], a[168:171], v[120:123], v[32:35]
    s_add_u32 s92, s81, 960
    v_exp_f32 v24, v24
    v_mfma_f32_16x16x32_bf16 v[32:35], a[172:175], v[124:127], v[32:35]
    v_exp_f32 v25, v25
    v_mfma_f32_16x16x32_bf16 v[36:39], a[188:191], v[124:127], v[60:63]
    ds_read_b128 a[144:147], v10 offset:4096
    v_cvt_pk_bf16_f32 v2, v24, v25
    v_mfma_f32_16x16x32_bf16 v[36:39], a[184:187], v[120:123], v[36:39]
    v_exp_f32 v26, v26
    v_mfma_f32_16x16x32_bf16 v[36:39], a[180:183], v[116:119], v[36:39]
    v_exp_f32 v27, v27
    v_mfma_f32_16x16x32_bf16 v[36:39], a[176:179], v[112:115], v[36:39]
    ds_read_b128 a[160:163], v10 offset:8192
    v_cvt_pk_bf16_f32 v3, v26, v27
    v_mfma_f32_16x16x32_bf16 v[136:139], a[192:195], v[40:43], v[136:139]
    v_exp_f32 v28, v28
    v_mfma_f32_16x16x32_bf16 v[136:139], a[224:227], v[44:47], v[136:139]
    v_exp_f32 v29, v29
    v_mfma_f32_16x16x32_bf16 v[152:155], a[228:231], v[44:47], v[152:155]
    ds_read_b128 a[164:167], v10 offset:9216
    v_cvt_pk_bf16_f32 v4, v28, v29
    v_mfma_f32_16x16x32_bf16 v[152:155], a[196:199], v[40:43], v[152:155]
    ds_read_b128 a[168:171], v10 offset:10240
    v_mfma_f32_16x16x32_bf16 v[168:171], a[200:203], v[40:43], v[168:171]
    buffer_load_dwordx4 v15, s[20:23], s92 offen offset:2048  lds
    v_mfma_f32_16x16x32_bf16 v[168:171], a[232:235], v[44:47], v[168:171]
    s_add_u32 s92, s81, 0
    v_exp_f32 v30, v30
    v_mfma_f32_16x16x32_bf16 v[184:187], a[236:239], v[44:47], v[184:187]
    v_exp_f32 v31, v31
    v_mfma_f32_16x16x32_bf16 v[184:187], a[204:207], v[40:43], v[184:187]
    s_waitcnt lgkmcnt(3)
    ds_read_b128 a[172:175], v10 offset:11264
    v_cvt_pk_bf16_f32 v5, v30, v31
    v_mfma_f32_16x16x32_bf16 v[24:27], a[128:131], v[64:67], v[48:51]
    ds_read_b128 a[188:191], v10 offset:15360
    v_mfma_f32_16x16x32_bf16 v[24:27], a[132:135], v[68:71], v[24:27]
    buffer_load_dwordx4 v15, s[20:23], s92 offen offset:3072  lds
    v_mfma_f32_16x16x32_bf16 v[24:27], a[136:139], v[72:75], v[24:27]
    s_add_u32 m0, s82, 16384
    v_exp_f32 v32, v32
    v_mfma_f32_16x16x32_bf16 v[24:27], a[140:143], v[76:79], v[24:27]
    s_add_u32 s92, s81, 2880
    v_exp_f32 v33, v33
    v_mfma_f32_16x16x32_bf16 v[28:31], a[156:159], v[76:79], v[48:51]
    ds_read_b128 a[184:187], v10 offset:14336
    v_cvt_pk_bf16_f32 v6, v32, v33
    v_mfma_f32_16x16x32_bf16 v[28:31], a[152:155], v[72:75], v[28:31]
    v_add_u32 v19, s83, v14
    v_xor_b32 v12, 32, v19
    v_mfma_f32_16x16x32_bf16 v[28:31], a[148:151], v[68:71], v[28:31]
    v_exp_f32 v34, v34
    v_mfma_f32_16x16x32_bf16 v[28:31], a[144:147], v[64:67], v[28:31]
    v_exp_f32 v35, v35
    v_mfma_f32_16x16x32_bf16 v[200:203], a[208:211], v[40:43], v[200:203]
    ds_read_b128 a[180:183], v10 offset:13312
    v_cvt_pk_bf16_f32 v7, v34, v35
    v_mfma_f32_16x16x32_bf16 v[200:203], a[240:243], v[44:47], v[200:203]
    s_add_u32 s83, s83, 32768
    v_exp_f32 v36, v36
    v_mfma_f32_16x16x32_bf16 v[216:219], a[244:247], v[44:47], v[216:219]
    s_sub_u32 s90, s83, 163840
    v_exp_f32 v37, v37
    v_mfma_f32_16x16x32_bf16 v[216:219], a[212:215], v[40:43], v[216:219]
    s_min_u32 s83, s83, s90
    ds_read_b128 a[176:179], v10 offset:12288
    v_cvt_pk_bf16_f32 v8, v36, v37
    v_mfma_f32_16x16x32_bf16 v[232:235], a[216:219], v[40:43], v[232:235]
    v_add_u32 v10, s83, v13
    v_mfma_f32_16x16x32_bf16 v[232:235], a[248:251], v[44:47], v[232:235]
    buffer_load_dwordx4 v15, s[24:27], s92 offen offset:0  lds
    v_mfma_f32_16x16x32_bf16 v[248:251], a[252:255], v[44:47], v[248:251]
    s_add_u32 s92, s81, 1920
    v_exp_f32 v38, v38
    v_mfma_f32_16x16x32_bf16 v[248:251], a[220:223], v[40:43], v[248:251]
    v_exp_f32 v39, v39
    v_smfmac_f32_16x16x64_bf16 a[120:123], a[108:111], v[40:47], v0
    s_waitcnt lgkmcnt(3)
    v_cvt_pk_bf16_f32 v9, v38, v39
    v_mfma_f32_16x16x32_bf16 v[32:35], a[160:163], v[64:67], v[48:51]
    v_exp_f32 v24, v24
    v_mfma_f32_16x16x32_bf16 v[32:35], a[164:167], v[68:71], v[32:35]
    v_exp_f32 v25, v25
    v_mfma_f32_16x16x32_bf16 v[32:35], a[168:171], v[72:75], v[32:35]
    v_exp_f32 v26, v26
    v_mfma_f32_16x16x32_bf16 v[32:35], a[172:175], v[76:79], v[32:35]
    v_exp_f32 v27, v27
    v_mfma_f32_16x16x32_bf16 v[36:39], a[188:191], v[76:79], v[48:51]
    s_waitcnt lgkmcnt(2)
    v_exp_f32 v28, v28
    v_mfma_f32_16x16x32_bf16 v[36:39], a[184:187], v[72:75], v[36:39]
    s_waitcnt lgkmcnt(1)
    v_exp_f32 v29, v29
    v_mfma_f32_16x16x32_bf16 v[36:39], a[180:183], v[68:71], v[36:39]
    s_waitcnt lgkmcnt(0)
    v_exp_f32 v30, v30
    v_mfma_f32_16x16x32_bf16 v[36:39], a[176:179], v[64:67], v[36:39]
    v_exp_f32 v31, v31
    v_mfma_f32_16x16x32_bf16 v[140:143], a[192:195], v[2:5], v[140:143]
    v_cvt_pk_bf16_f32 v40, v24, v25
    v_cvt_pk_bf16_f32 v41, v26, v27
    v_mfma_f32_16x16x32_bf16 v[140:143], a[224:227], v[6:9], v[140:143]
    ds_read_b64_tr_b16 a[192:193], v19 offset:16384
    v_cvt_pk_bf16_f32 v42, v28, v29
    v_mfma_f32_16x16x32_bf16 v[156:159], a[228:231], v[6:9], v[156:159]
    ds_read_b64_tr_b16 a[194:195], v19 offset:20480
    v_accvgpr_read_b32 v18, a37
    v_perm_b32 v22, v18, v11, s96
    v_accvgpr_read_b32 v11, a38
    v_mfma_f32_16x16x32_bf16 v[156:159], a[196:199], v[2:5], v[156:159]
    ds_read_b64_tr_b16 a[224:225], v19 offset:24576
    v_cvt_pk_bf16_f32 v43, v30, v31
    v_mfma_f32_16x16x32_bf16 v[172:175], a[200:203], v[2:5], v[172:175]
    ds_read_b64_tr_b16 a[226:227], v19 offset:28672
    v_accvgpr_read_b32 v18, a39
    v_perm_b32 v23, v18, v11, s96
    v_mfma_f32_16x16x32_bf16 v[172:175], a[232:235], v[6:9], v[172:175]
    ds_read_b64_tr_b16 a[228:229], v12 offset:24576
    buffer_store_dwordx4 v[20:23], v1, s[16:19], s53 offen offset:0 sc1
    v_mfma_f32_16x16x32_bf16 v[188:191], a[236:239], v[6:9], v[188:191]
    ds_read_b64_tr_b16 a[230:231], v12 offset:28672
    v_accvgpr_read_b32 v11, a32
    v_accvgpr_read_b32 v18, a33
    v_perm_b32 v20, v18, v11, s97
    v_mfma_f32_16x16x32_bf16 v[188:191], a[204:207], v[2:5], v[188:191]
    ds_read_b64_tr_b16 a[196:197], v12 offset:16384
    v_accvgpr_read_b32 v11, a34
    v_accvgpr_read_b32 v18, a35
    v_perm_b32 v21, v18, v11, s97
    v_mfma_f32_16x16x32_bf16 v[24:27], a[128:131], v[80:83], v[52:55]
    ds_read_b64_tr_b16 a[198:199], v12 offset:20480
    v_accvgpr_read_b32 v11, a36
    v_accvgpr_read_b32 v18, a37
    v_perm_b32 v22, v18, v11, s97
    v_mfma_f32_16x16x32_bf16 v[24:27], a[132:135], v[84:87], v[24:27]
    ds_read_b64_tr_b16 a[200:201], v19 offset:17408
    v_accvgpr_read_b32 v11, a38
    v_accvgpr_read_b32 v18, a39
    v_perm_b32 v23, v18, v11, s97
    v_mfma_f32_16x16x32_bf16 v[24:27], a[136:139], v[88:91], v[24:27]
    v_exp_f32 v32, v32
    v_mfma_f32_16x16x32_bf16 v[24:27], a[140:143], v[92:95], v[24:27]
    v_exp_f32 v33, v33
    v_mfma_f32_16x16x32_bf16 v[28:31], a[156:159], v[92:95], v[52:55]
    ds_read_b64_tr_b16 a[202:203], v19 offset:21504
    v_cvt_pk_bf16_f32 v44, v32, v33
    v_mfma_f32_16x16x32_bf16 v[28:31], a[152:155], v[88:91], v[28:31]
    ds_read_b64_tr_b16 a[232:233], v19 offset:25600
    v_mfma_f32_16x16x32_bf16 v[28:31], a[148:151], v[84:87], v[28:31]
    v_exp_f32 v34, v34
    v_mfma_f32_16x16x32_bf16 v[28:31], a[144:147], v[80:83], v[28:31]
    v_exp_f32 v35, v35
    v_mfma_f32_16x16x32_bf16 v[204:207], a[208:211], v[2:5], v[204:207]
    ds_read_b64_tr_b16 a[234:235], v19 offset:29696
    v_cvt_pk_bf16_f32 v45, v34, v35
    v_mfma_f32_16x16x32_bf16 v[204:207], a[240:243], v[6:9], v[204:207]
    v_exp_f32 v36, v36
    v_mfma_f32_16x16x32_bf16 v[220:223], a[244:247], v[6:9], v[220:223]
    v_exp_f32 v37, v37
    v_mfma_f32_16x16x32_bf16 v[220:223], a[212:215], v[2:5], v[220:223]
    ds_read_b64_tr_b16 a[236:237], v12 offset:25600
    v_cvt_pk_bf16_f32 v46, v36, v37
    v_mfma_f32_16x16x32_bf16 v[236:239], a[216:219], v[2:5], v[236:239]
    ds_read_b64_tr_b16 a[238:239], v12 offset:29696
    v_mfma_f32_16x16x32_bf16 v[236:239], a[248:251], v[6:9], v[236:239]
    ds_read_b64_tr_b16 a[204:205], v12 offset:17408
    buffer_store_dwordx4 v[20:23], v1, s[16:19], s53 offen offset:1024 sc1
    v_mfma_f32_16x16x32_bf16 v[252:255], a[252:255], v[6:9], v[252:255]
    v_exp_f32 v38, v38
    v_mfma_f32_16x16x32_bf16 v[252:255], a[220:223], v[2:5], v[252:255]
    v_exp_f32 v39, v39
    v_smfmac_f32_16x16x64_bf16 a[124:127], a[108:111], v[2:9], v0
    ds_read_b64_tr_b16 a[206:207], v12 offset:21504
    v_cvt_pk_bf16_f32 v47, v38, v39
    v_mfma_f32_16x16x32_bf16 v[32:35], a[160:163], v[80:83], v[52:55]
    ds_read_b64_tr_b16 a[208:209], v19 offset:18432
    v_mfma_f32_16x16x32_bf16 v[32:35], a[164:167], v[84:87], v[32:35]
    ds_read_b64_tr_b16 a[210:211], v19 offset:22528
    v_mfma_f32_16x16x32_bf16 v[32:35], a[168:171], v[88:91], v[32:35]
    ds_read_b64_tr_b16 a[240:241], v19 offset:26624
    v_exp_f32 v24, v24
    v_mfma_f32_16x16x32_bf16 v[32:35], a[172:175], v[92:95], v[32:35]
    v_exp_f32 v25, v25
    v_mfma_f32_16x16x32_bf16 v[36:39], a[188:191], v[92:95], v[52:55]
    ds_read_b64_tr_b16 a[242:243], v19 offset:30720
    v_cvt_pk_bf16_f32 v2, v24, v25
    v_mfma_f32_16x16x32_bf16 v[36:39], a[184:187], v[88:91], v[36:39]
    v_exp_f32 v26, v26
    v_mfma_f32_16x16x32_bf16 v[36:39], a[180:183], v[84:87], v[36:39]
    v_exp_f32 v27, v27
    v_mfma_f32_16x16x32_bf16 v[36:39], a[176:179], v[80:83], v[36:39]
    s_waitcnt lgkmcnt(4)
    ds_read_b64_tr_b16 a[244:245], v12 offset:26624
    v_cvt_pk_bf16_f32 v3, v26, v27
    v_mfma_f32_16x16x32_bf16 v[128:131], a[192:195], v[40:43], v[128:131]
    v_exp_f32 v28, v28
    v_mfma_f32_16x16x32_bf16 v[128:131], a[224:227], v[44:47], v[128:131]
    v_exp_f32 v29, v29
    v_mfma_f32_16x16x32_bf16 v[144:147], a[228:231], v[44:47], v[144:147]
    ds_read_b64_tr_b16 a[246:247], v12 offset:30720
    v_cvt_pk_bf16_f32 v4, v28, v29
    v_mfma_f32_16x16x32_bf16 v[144:147], a[196:199], v[40:43], v[144:147]
    ds_read_b64_tr_b16 a[212:213], v12 offset:18432
    v_mfma_f32_16x16x32_bf16 v[160:163], a[200:203], v[40:43], v[160:163]
    ds_read_b64_tr_b16 a[214:215], v12 offset:22528
    v_mfma_f32_16x16x32_bf16 v[160:163], a[232:235], v[44:47], v[160:163]
    v_exp_f32 v30, v30
    v_mfma_f32_16x16x32_bf16 v[176:179], a[236:239], v[44:47], v[176:179]
    v_exp_f32 v31, v31
    v_mfma_f32_16x16x32_bf16 v[176:179], a[204:207], v[40:43], v[176:179]
    ds_read_b64_tr_b16 a[216:217], v19 offset:19456
    v_cvt_pk_bf16_f32 v5, v30, v31
    v_smfmac_f32_16x16x64_bf16 a[112:115], a[108:111], v[40:47], v0
    ds_read_b64_tr_b16 a[218:219], v19 offset:23552
    v_mfma_f32_16x16x32_bf16 v[24:27], a[128:131], v[96:99], v[56:59]
    ds_read_b64_tr_b16 a[248:249], v19 offset:27648
    v_mfma_f32_16x16x32_bf16 v[24:27], a[132:135], v[100:103], v[24:27]
    ds_read_b64_tr_b16 a[250:251], v19 offset:31744
    v_mfma_f32_16x16x32_bf16 v[24:27], a[136:139], v[104:107], v[24:27]
    ds_read_b64_tr_b16 a[252:253], v12 offset:27648
    v_mfma_f32_16x16x32_bf16 v[24:27], a[140:143], v[108:111], v[24:27]
    ds_read_b64_tr_b16 a[254:255], v12 offset:31744
    v_mfma_f32_16x16x32_bf16 v[28:31], a[156:159], v[108:111], v[56:59]
    ds_read_b64_tr_b16 a[220:221], v12 offset:19456
    v_mfma_f32_16x16x32_bf16 v[28:31], a[152:155], v[104:107], v[28:31]
    ds_read_b64_tr_b16 a[222:223], v12 offset:23552
    v_mfma_f32_16x16x32_bf16 v[28:31], a[148:151], v[100:103], v[28:31]
    v_exp_f32 v32, v32
    v_mfma_f32_16x16x32_bf16 v[28:31], a[144:147], v[96:99], v[28:31]
    s_waitcnt lgkmcnt(4)
    v_exp_f32 v33, v33
    v_mfma_f32_16x16x32_bf16 v[192:195], a[208:211], v[40:43], v[192:195]
    v_exp_f32 v34, v34
    v_mfma_f32_16x16x32_bf16 v[192:195], a[240:243], v[44:47], v[192:195]
    v_exp_f32 v35, v35
    v_mfma_f32_16x16x32_bf16 v[208:211], a[244:247], v[44:47], v[208:211]
    v_cvt_pk_bf16_f32 v6, v32, v33
    v_cvt_pk_bf16_f32 v7, v34, v35
    v_mfma_f32_16x16x32_bf16 v[208:211], a[212:215], v[40:43], v[208:211]
    v_exp_f32 v36, v36
    v_mfma_f32_16x16x32_bf16 v[224:227], a[216:219], v[40:43], v[224:227]
    v_exp_f32 v37, v37
    v_mfma_f32_16x16x32_bf16 v[224:227], a[248:251], v[44:47], v[224:227]
    s_waitcnt lgkmcnt(2)
    v_exp_f32 v38, v38
    v_mfma_f32_16x16x32_bf16 v[240:243], a[252:255], v[44:47], v[240:243]
    s_waitcnt lgkmcnt(0)
    v_exp_f32 v39, v39
    v_mfma_f32_16x16x32_bf16 v[240:243], a[220:223], v[40:43], v[240:243]
    v_cvt_pk_bf16_f32 v8, v36, v37
    v_cvt_pk_bf16_f32 v9, v38, v39
    v_mfma_f32_16x16x32_bf16 v[32:35], a[160:163], v[96:99], v[56:59]
    v_exp_f32 v24, v24
    v_mfma_f32_16x16x32_bf16 v[32:35], a[164:167], v[100:103], v[32:35]
    v_exp_f32 v25, v25
    v_mfma_f32_16x16x32_bf16 v[32:35], a[168:171], v[104:107], v[32:35]
    v_cvt_pk_bf16_f32 v40, v24, v25
    v_mfma_f32_16x16x32_bf16 v[32:35], a[172:175], v[108:111], v[32:35]
    buffer_load_dwordx4 v15, s[24:27], s92 offen offset:1024  lds
    v_mfma_f32_16x16x32_bf16 v[36:39], a[188:191], v[108:111], v[56:59]
    s_add_u32 s92, s81, 960
    v_exp_f32 v26, v26
    v_mfma_f32_16x16x32_bf16 v[36:39], a[184:187], v[104:107], v[36:39]
    v_exp_f32 v27, v27
    v_mfma_f32_16x16x32_bf16 v[36:39], a[180:183], v[100:103], v[36:39]
    v_cvt_pk_bf16_f32 v41, v26, v27
    v_mfma_f32_16x16x32_bf16 v[36:39], a[176:179], v[96:99], v[36:39]
    s_branch L_ov18
L_pad18:
    s_setpc_b64 s[86:87]
L_ov18:
    buffer_load_dwordx4 v15, s[24:27], s92 offen offset:2048  lds
    v_mfma_f32_16x16x32_bf16 v[132:135], a[192:195], v[2:5], v[132:135]
    s_add_u32 s92, s81, 0
    v_exp_f32 v28, v28
    v_mfma_f32_16x16x32_bf16 v[132:135], a[224:227], v[6:9], v[132:135]
    v_exp_f32 v29, v29
    v_mfma_f32_16x16x32_bf16 v[148:151], a[228:231], v[6:9], v[148:151]
    v_cvt_pk_bf16_f32 v42, v28, v29
    v_mfma_f32_16x16x32_bf16 v[148:151], a[196:199], v[2:5], v[148:151]
    buffer_load_dwordx4 v15, s[24:27], s92 offen offset:3072  lds
    v_mfma_f32_16x16x32_bf16 v[164:167], a[200:203], v[2:5], v[164:167]
    v_exp_f32 v30, v30
    v_mfma_f32_16x16x32_bf16 v[164:167], a[232:235], v[6:9], v[164:167]
    v_exp_f32 v31, v31
    v_mfma_f32_16x16x32_bf16 v[180:183], a[236:239], v[6:9], v[180:183]
    v_cvt_pk_bf16_f32 v43, v30, v31
    v_mfma_f32_16x16x32_bf16 v[180:183], a[204:207], v[2:5], v[180:183]
    s_add_u32 s55, s55, 16
    s_cmp_lt_u32 s55, 32
    s_cbranch_scc1 L_pack_round
    v_accvgpr_read_b32 v11, a44
    v_accvgpr_read_b32 v18, a45
    s_waitcnt vmcnt(3)
    s_mov_b32 s84, 13
    s_branch L_packed
L_pack_end:
L_arr_wait:
    s_mov_b32 s90, 0x40000
L_arr2:
    s_sleep 24
    buffer_load_dword v20, v21, s[76:79], 0 offen sc1
    s_sub_u32 s90, s90, 1
    s_cbranch_scc1 L_arr2x
    s_waitcnt vmcnt(0)
    v_cmp_gt_u32 vcc, 0x20, v20
    s_nop 1
    s_cbranch_vccnz L_arr2
L_arr2x:
    s_branch L_arr_ok
L_code_end:
L_main_slow:
    s_waitcnt lgkmcnt(0)
    s_nop 15
    s_mov_b32 s85, 1
    s_mov_b32 s84, 32
    v_mov_b32 v128, 0
    v_mov_b32 v129, 0
    v_mov_b32 v130, 0
    v_mov_b32 v131, 0
    v_mov_b32 v132, 0
    v_mov_b32 v133, 0
    v_mov_b32 v134, 0
    v_mov_b32 v135, 0
    v_mov_b32 v136, 0
    v_mov_b32 v137, 0
    v_mov_b32 v138, 0
    v_mov_b32 v139, 0
    v_mov_b32 v140, 0
    v_mov_b32 v141, 0
    v_mov_b32 v142, 0
    v_mov_b32 v143, 0
    v_mov_b32 v144, 0
    v_mov_b32 v145, 0
    v_mov_b32 v146, 0
    v_mov_b32 v147, 0
    v_mov_b32 v148, 0
    v_mov_b32 v149, 0
    v_mov_b32 v150, 0
    v_mov_b32 v151, 0
    v_mov_b32 v152, 0
    v_mov_b32 v153, 0
    v_mov_b32 v154, 0
    v_mov_b32 v155, 0
    v_mov_b32 v156, 0
    v_mov_b32 v157, 0
    v_mov_b32 v158, 0
    v_mov_b32 v159, 0
    v_mov_b32 v160, 0
    v_mov_b32 v161, 0
    v_mov_b32 v162, 0
    v_mov_b32 v163, 0
    v_mov_b32 v164, 0
    v_mov_b32 v165, 0
    v_mov_b32 v166, 0
    v_mov_b32 v167, 0
    v_mov_b32 v168, 0
    v_mov_b32 v169, 0
    v_mov_b32 v170, 0
    v_mov_b32 v171, 0
    v_mov_b32 v172, 0
    v_mov_b32 v173, 0
    v_mov_b32 v174, 0
    v_mov_b32 v175, 0
    v_mov_b32 v176, 0
    v_mov_b32 v177, 0
    v_mov_b32 v178, 0
    v_mov_b32 v179, 0
    v_mov_b32 v180, 0
    v_mov_b32 v181, 0
    v_mov_b32 v182, 0
    v_mov_b32 v183, 0
    v_mov_b32 v184, 0
    v_mov_b32 v185, 0
    v_mov_b32 v186, 0
    v_mov_b32 v187, 0
    v_mov_b32 v188, 0
    v_mov_b32 v189, 0
    v_mov_b32 v190, 0
    v_mov_b32 v191, 0
    v_mov_b32 v192, 0
    v_mov_b32 v193, 0
    v_mov_b32 v194, 0
    v_mov_b32 v195, 0
    v_mov_b32 v196, 0
    v_mov_b32 v197, 0
    v_mov_b32 v198, 0
    v_mov_b32 v199, 0
    v_mov_b32 v200, 0
    v_mov_b32 v201, 0
    v_mov_b32 v202, 0
    v_mov_b32 v203, 0
    v_mov_b32 v204, 0
    v_mov_b32 v205, 0
    v_mov_b32 v206, 0
    v_mov_b32 v207, 0
    v_mov_b32 v208, 0
    v_mov_b32 v209, 0
    v_mov_b32 v210, 0
    v_mov_b32 v211, 0
    v_mov_b32 v212, 0
    v_mov_b32 v213, 0
    v_mov_b32 v214, 0
    v_mov_b32 v215, 0
    v_mov_b32 v216, 0
    v_mov_b32 v217, 0
    v_mov_b32 v218, 0
    v_mov_b32 v219, 0
    v_mov_b32 v220, 0
    v_mov_b32 v221, 0
    v_mov_b32 v222, 0
    v_mov_b32 v223, 0
    v_mov_b32 v224, 0
    v_mov_b32 v225, 0
    v_mov_b32 v226, 0
    v_mov_b32 v227, 0
    v_mov_b32 v228, 0
    v_mov_b32 v229, 0
    v_mov_b32 v230, 0
    v_mov_b32 v231, 0
    v_mov_b32 v232, 0
    v_mov_b32 v233, 0
    v_mov_b32 v234, 0
    v_mov_b32 v235, 0
    v_mov_b32 v236, 0
    v_mov_b32 v237, 0
    v_mov_b32 v238, 0
    v_mov_b32 v239, 0
    v_mov_b32 v240, 0
    v_mov_b32 v241, 0
    v_mov_b32 v242, 0
    v_mov_b32 v243, 0
    v_mov_b32 v244, 0
    v_mov_b32 v245, 0
    v_mov_b32 v246, 0
    v_mov_b32 v247, 0
    v_mov_b32 v248, 0
    v_mov_b32 v249, 0
    v_mov_b32 v250, 0
    v_mov_b32 v251, 0
    v_mov_b32 v252, 0
    v_mov_b32 v253, 0
    v_mov_b32 v254, 0
    v_mov_b32 v255, 0
    v_mov_b32 v60, 0
    v_mov_b32 v48, 0xff800000
    v_mov_b32 v61, 0
    v_mov_b32 v49, 0xff800000
    v_mov_b32 v62, 0
    v_mov_b32 v50, 0xff800000
    v_mov_b32 v63, 0
    v_mov_b32 v51, 0xff800000
    v_mov_b32 v10, v13
    v_mov_b32 v19, v14
    v_xor_b32 v12, 32, v14
    s_waitcnt vmcnt(0)
L_main_slow_loop:
    s_barrier
    s_sub_u32 s82, s91, 32768
    s_add_u32 s81, s81, 16384
    s_nop 0
    s_and_b32 s81, s81, 0x7ffff
    s_nop 0
    s_add_u32 s82, s82, 32768
    s_nop 0
    s_sub_u32 s92, s82, 163840
    s_nop 0
    s_min_u32 s82, s82, s92
    s_nop 0
    s_add_u32 m0, s82, 0
    s_nop 0
    s_add_u32 s92, s81, 2880
    s_nop 0
    buffer_load_dwordx4 v15, s[20:23], s92 offen offset:0  lds
    s_add_u32 s92, s81, 1920
    s_nop 0
    buffer_load_dwordx4 v15, s[20:23], s92 offen offset:1024  lds
    s_add_u32 s92, s81, 960
    s_nop 0
    buffer_load_dwordx4 v15, s[20:23], s92 offen offset:2048  lds
    s_add_u32 s92, s81, 0
    s_nop 0
    buffer_load_dwordx4 v15, s[20:23], s92 offen offset:3072  lds
    s_add_u32 m0, s82, 16384
    s_nop 0
    s_add_u32 s92, s81, 2880
    s_nop 0
    buffer_load_dwordx4 v15, s[24:27], s92 offen offset:0  lds
    s_add_u32 s92, s81, 1920
    s_nop 0
    buffer_load_dwordx4 v15, s[24:27], s92 offen offset:1024  lds
    s_add_u32 s92, s81, 960
    s_nop 0
    buffer_load_dwordx4 v15, s[24:27], s92 offen offset:2048  lds
    s_add_u32 s92, s81, 0
    s_nop 0
    buffer_load_dwordx4 v15, s[24:27], s92 offen offset:3072  lds
    s_waitcnt vmcnt(0)
    s_barrier
    ds_read_b128 a[128:131], v10 offset:0
    ds_read_b128 a[132:135], v10 offset:1024
    ds_read_b128 a[136:139], v10 offset:2048
    ds_read_b128 a[140:143], v10 offset:3072
    ds_read_b128 a[144:147], v10 offset:4096
    ds_read_b128 a[148:151], v10 offset:5120
    ds_read_b128 a[152:155], v10 offset:6144
    ds_read_b128 a[156:159], v10 offset:7168
    s_waitcnt lgkmcnt(0)
    ds_read_b64_tr_b16 a[192:193], v19 offset:16384
    ds_read_b64_tr_b16 a[196:197], v12 offset:16384
    ds_read_b64_tr_b16 a[200:201], v19 offset:17408
    ds_read_b64_tr_b16 a[204:205], v12 offset:17408
    ds_read_b64_tr_b16 a[208:209], v19 offset:18432
    ds_read_b64_tr_b16 a[212:213], v12 offset:18432
    ds_read_b64_tr_b16 a[216:217], v19 offset:19456
    ds_read_b64_tr_b16 a[220:221], v12 offset:19456
    s_waitcnt lgkmcnt(0)
    ds_read_b64_tr_b16 a[194:195], v19 offset:20480
    ds_read_b64_tr_b16 a[198:199], v12 offset:20480
    ds_read_b64_tr_b16 a[202:203], v19 offset:21504
    ds_read_b64_tr_b16 a[206:207], v12 offset:21504
    ds_read_b64_tr_b16 a[210:211], v19 offset:22528
    ds_read_b64_tr_b16 a[214:215], v12 offset:22528
    ds_read_b64_tr_b16 a[218:219], v19 offset:23552
    ds_read_b64_tr_b16 a[222:223], v12 offset:23552
    s_waitcnt lgkmcnt(0)
    v_mfma_f32_16x16x32_bf16 v[24:27], a[128:131], v[64:67], 0
    v_mfma_f32_16x16x32_bf16 v[24:27], a[132:135], v[68:71], v[24:27]
    v_mfma_f32_16x16x32_bf16 v[24:27], a[136:139], v[72:75], v[24:27]
    v_mfma_f32_16x16x32_bf16 v[24:27], a[140:143], v[76:79], v[24:27]
    v_mfma_f32_16x16x32_bf16 v[28:31], a[156:159], v[76:79], 0
    v_mfma_f32_16x16x32_bf16 v[28:31], a[152:155], v[72:75], v[28:31]
    v_mfma_f32_16x16x32_bf16 v[28:31], a[148:151], v[68:71], v[28:31]
    v_mfma_f32_16x16x32_bf16 v[28:31], a[144:147], v[64:67], v[28:31]
    s_nop 9
    v_max3_f32 v2, v24, v25, v26
    v_max3_f32 v2, v2, v27, v28
    v_max3_f32 v2, v2, v29, v30
    v_max_f32 v2, v2, v31
    v_mov_b32 v3, v2
    s_nop 1
    v_permlane16_swap_b32 v2, v3
    s_nop 1
    v_max_f32 v2, v2, v3
    v_mov_b32 v3, v2
    s_nop 1
    v_permlane32_swap_b32 v2, v3
    s_nop 1
    v_max_f32 v2, v2, v3
    v_max_f32 v2, v2, v48
    v_sub_f32 v4, v48, v2
    v_exp_f32 v4, v4
    v_mov_b32 v48, v2
    v_mul_f32 v60, v60, v4
    v_mul_f32 v128, v128, v4
    v_mul_f32 v129, v129, v4
    v_mul_f32 v130, v130, v4
    v_mul_f32 v131, v131, v4
    v_mul_f32 v144, v144, v4
    v_mul_f32 v145, v145, v4
    v_mul_f32 v146, v146, v4
    v_mul_f32 v147, v147, v4
    v_mul_f32 v160, v160, v4
    v_mul_f32 v161, v161, v4
    v_mul_f32 v162, v162, v4
    v_mul_f32 v163, v163, v4
    v_mul_f32 v176, v176, v4
    v_mul_f32 v177, v177, v4
    v_mul_f32 v178, v178, v4
    v_mul_f32 v179, v179, v4
    v_mul_f32 v192, v192, v4
    v_mul_f32 v193, v193, v4
    v_mul_f32 v194, v194, v4
    v_mul_f32 v195, v195, v4
    v_mul_f32 v208, v208, v4
    v_mul_f32 v209, v209, v4
    v_mul_f32 v210, v210, v4
    v_mul_f32 v211, v211, v4
    v_mul_f32 v224, v224, v4
    v_mul_f32 v225, v225, v4
    v_mul_f32 v226, v226, v4
    v_mul_f32 v227, v227, v4
    v_mul_f32 v240, v240, v4
    v_mul_f32 v241, v241, v4
    v_mul_f32 v242, v242, v4
    v_mul_f32 v243, v243, v4
    v_sub_f32 v24, v24, v2
    v_sub_f32 v25, v25, v2
    v_sub_f32 v26, v26, v2
    v_sub_f32 v27, v27, v2
    v_sub_f32 v28, v28, v2
    v_sub_f32 v29, v29, v2
    v_sub_f32 v30, v30, v2
    v_sub_f32 v31, v31, v2
    v_exp_f32 v24, v24
    v_exp_f32 v25, v25
    v_exp_f32 v26, v26
    v_exp_f32 v27, v27
    v_exp_f32 v28, v28
    v_exp_f32 v29, v29
    v_exp_f32 v30, v30
    v_exp_f32 v31, v31
    s_nop 0
    v_add_f32 v60, v60, v24
    v_add_f32 v60, v60, v25
    v_add_f32 v60, v60, v26
    v_add_f32 v60, v60, v27
    v_add_f32 v60, v60, v28
    v_add_f32 v60, v60, v29
    v_add_f32 v60, v60, v30
    v_add_f32 v60, v60, v31
    v_cvt_pk_bf16_f32 v40, v24, v25
    v_cvt_pk_bf16_f32 v41, v26, v27
    v_cvt_pk_bf16_f32 v42, v28, v29
    v_cvt_pk_bf16_f32 v43, v30, v31
    s_nop 1
    v_mfma_f32_16x16x32_bf16 v[128:131], a[192:195], v[40:43], v[128:131]
    v_mfma_f32_16x16x32_bf16 v[144:147], a[196:199], v[40:43], v[144:147]
    v_mfma_f32_16x16x32_bf16 v[160:163], a[200:203], v[40:43], v[160:163]
    v_mfma_f32_16x16x32_bf16 v[176:179], a[204:207], v[40:43], v[176:179]
    v_mfma_f32_16x16x32_bf16 v[192:195], a[208:211], v[40:43], v[192:195]
    v_mfma_f32_16x16x32_bf16 v[208:211], a[212:215], v[40:43], v[208:211]
    v_mfma_f32_16x16x32_bf16 v[224:227], a[216:219], v[40:43], v[224:227]
    v_mfma_f32_16x16x32_bf16 v[240:243], a[220:223], v[40:43], v[240:243]
    v_mfma_f32_16x16x32_bf16 v[24:27], a[128:131], v[80:83], 0
    v_mfma_f32_16x16x32_bf16 v[24:27], a[132:135], v[84:87], v[24:27]
    v_mfma_f32_16x16x32_bf16 v[24:27], a[136:139], v[88:91], v[24:27]
    v_mfma_f32_16x16x32_bf16 v[24:27], a[140:143], v[92:95], v[24:27]
    v_mfma_f32_16x16x32_bf16 v[28:31], a[156:159], v[92:95], 0
    v_mfma_f32_16x16x32_bf16 v[28:31], a[152:155], v[88:91], v[28:31]
    v_mfma_f32_16x16x32_bf16 v[28:31], a[148:151], v[84:87], v[28:31]
    v_mfma_f32_16x16x32_bf16 v[28:31], a[144:147], v[80:83], v[28:31]
    s_nop 9
    v_max3_f32 v2, v24, v25, v26
    v_max3_f32 v2, v2, v27, v28
    v_max3_f32 v2, v2, v29, v30
    v_max_f32 v2, v2, v31
    v_mov_b32 v3, v2
    s_nop 1
    v_permlane16_swap_b32 v2, v3
    s_nop 1
    v_max_f32 v2, v2, v3
    v_mov_b32 v3, v2
    s_nop 1
    v_permlane32_swap_b32 v2, v3
    s_nop 1
    v_max_f32 v2, v2, v3
    v_max_f32 v2, v2, v49
    v_sub_f32 v4, v49, v2
    v_exp_f32 v4, v4
    v_mov_b32 v49, v2
    v_mul_f32 v61, v61, v4
    v_mul_f32 v132, v132, v4
    v_mul_f32 v133, v133, v4
    v_mul_f32 v134, v134, v4
    v_mul_f32 v135, v135, v4
    v_mul_f32 v148, v148, v4
    v_mul_f32 v149, v149, v4
    v_mul_f32 v150, v150, v4
    v_mul_f32 v151, v151, v4
    v_mul_f32 v164, v164, v4
    v_mul_f32 v165, v165, v4
    v_mul_f32 v166, v166, v4
    v_mul_f32 v167, v167, v4
    v_mul_f32 v180, v180, v4
    v_mul_f32 v181, v181, v4
    v_mul_f32 v182, v182, v4
    v_mul_f32 v183, v183, v4
    v_mul_f32 v196, v196, v4
    v_mul_f32 v197, v197, v4
    v_mul_f32 v198, v198, v4
    v_mul_f32 v199, v199, v4
    v_mul_f32 v212, v212, v4
    v_mul_f32 v213, v213, v4
    v_mul_f32 v214, v214, v4
    v_mul_f32 v215, v215, v4
    v_mul_f32 v228, v228, v4
    v_mul_f32 v229, v229, v4
    v_mul_f32 v230, v230, v4
    v_mul_f32 v231, v231, v4
    v_mul_f32 v244, v244, v4
    v_mul_f32 v245, v245, v4
    v_mul_f32 v246, v246, v4
    v_mul_f32 v247, v247, v4
    v_sub_f32 v24, v24, v2
    v_sub_f32 v25, v25, v2
    v_sub_f32 v26, v26, v2
    v_sub_f32 v27, v27, v2
    v_sub_f32 v28, v28, v2
    v_sub_f32 v29, v29, v2
    v_sub_f32 v30, v30, v2
    v_sub_f32 v31, v31, v2
    v_exp_f32 v24, v24
    v_exp_f32 v25, v25
    v_exp_f32 v26, v26
    v_exp_f32 v27, v27
    v_exp_f32 v28, v28
    v_exp_f32 v29, v29
    v_exp_f32 v30, v30
    v_exp_f32 v31, v31
    s_nop 0
    v_add_f32 v61, v61, v24
    v_add_f32 v61, v61, v25
    v_add_f32 v61, v61, v26
    v_add_f32 v61, v61, v27
    v_add_f32 v61, v61, v28
    v_add_f32 v61, v61, v29
    v_add_f32 v61, v61, v30
    v_add_f32 v61, v61, v31
    v_cvt_pk_bf16_f32 v40, v24, v25
    v_cvt_pk_bf16_f32 v41, v26, v27
    v_cvt_pk_bf16_f32 v42, v28, v29
    v_cvt_pk_bf16_f32 v43, v30, v31
    s_nop 1
    v_mfma_f32_16x16x32_bf16 v[132:135], a[192:195], v[40:43], v[132:135]
    v_mfma_f32_16x16x32_bf16 v[148:151], a[196:199], v[40:43], v[148:151]
    v_mfma_f32_16x16x32_bf16 v[164:167], a[200:203], v[40:43], v[164:167]
    v_mfma_f32_16x16x32_bf16 v[180:183], a[204:207], v[40:43], v[180:183]
    v_mfma_f32_16x16x32_bf16 v[196:199], a[208:211], v[40:43], v[196:199]
    v_mfma_f32_16x16x32_bf16 v[212:215], a[212:215], v[40:43], v[212:215]
    v_mfma_f32_16x16x32_bf16 v[228:231], a[216:219], v[40:43], v[228:231]
    v_mfma_f32_16x16x32_bf16 v[244:247], a[220:223], v[40:43], v[244:247]
    v_mfma_f32_16x16x32_bf16 v[24:27], a[128:131], v[96:99], 0
    v_mfma_f32_16x16x32_bf16 v[24:27], a[132:135], v[100:103], v[24:27]
    v_mfma_f32_16x16x32_bf16 v[24:27], a[136:139], v[104:107], v[24:27]
    v_mfma_f32_16x16x32_bf16 v[24:27], a[140:143], v[108:111], v[24:27]
    v_mfma_f32_16x16x32_bf16 v[28:31], a[156:159], v[108:111], 0
    v_mfma_f32_16x16x32_bf16 v[28:31], a[152:155], v[104:107], v[28:31]
    v_mfma_f32_16x16x32_bf16 v[28:31], a[148:151], v[100:103], v[28:31]
    v_mfma_f32_16x16x32_bf16 v[28:31], a[144:147], v[96:99], v[28:31]
    s_nop 9
    v_max3_f32 v2, v24, v25, v26
    v_max3_f32 v2, v2, v27, v28
    v_max3_f32 v2, v2, v29, v30
    v_max_f32 v2, v2, v31
    v_mov_b32 v3, v2
    s_nop 1
    v_permlane16_swap_b32 v2, v3
    s_nop 1
    v_max_f32 v2, v2, v3
    v_mov_b32 v3, v2
    s_nop 1
    v_permlane32_swap_b32 v2, v3
    s_nop 1
    v_max_f32 v2, v2, v3
    v_max_f32 v2, v2, v50
    v_sub_f32 v4, v50, v2
    v_exp_f32 v4, v4
    v_mov_b32 v50, v2
    v_mul_f32 v62, v62, v4
    v_mul_f32 v136, v136, v4
    v_mul_f32 v137, v137, v4
    v_mul_f32 v138, v138, v4
    v_mul_f32 v139, v139, v4
    v_mul_f32 v152, v152, v4
    v_mul_f32 v153, v153, v4
    v_mul_f32 v154, v154, v4
    v_mul_f32 v155, v155, v4
    v_mul_f32 v168, v168, v4
    v_mul_f32 v169, v169, v4
    v_mul_f32 v170, v170, v4
    v_mul_f32 v171, v171, v4
    v_mul_f32 v184, v184, v4
    v_mul_f32 v185, v185, v4
    v_mul_f32 v186, v186, v4
    v_mul_f32 v187, v187, v4
    v_mul_f32 v200, v200, v4
    v_mul_f32 v201, v201, v4
    v_mul_f32 v202, v202, v4
    v_mul_f32 v203, v203, v4
    v_mul_f32 v216, v216, v4
    v_mul_f32 v217, v217, v4
    v_mul_f32 v218, v218, v4
    v_mul_f32 v219, v219, v4
    v_mul_f32 v232, v232, v4
    v_mul_f32 v233, v233, v4
    v_mul_f32 v234, v234, v4
    v_mul_f32 v235, v235, v4
    v_mul_f32 v248, v248, v4
    v_mul_f32 v249, v249, v4
    v_mul_f32 v250, v250, v4
    v_mul_f32 v251, v251, v4
    v_sub_f32 v24, v24, v2
    v_sub_f32 v25, v25, v2
    v_sub_f32 v26, v26, v2
    v_sub_f32 v27, v27, v2
    v_sub_f32 v28, v28, v2
    v_sub_f32 v29, v29, v2
    v_sub_f32 v30, v30, v2
    v_sub_f32 v31, v31, v2
    v_exp_f32 v24, v24
    v_exp_f32 v25, v25
    v_exp_f32 v26, v26
    v_exp_f32 v27, v27
    v_exp_f32 v28, v28
    v_exp_f32 v29, v29
    v_exp_f32 v30, v30
    v_exp_f32 v31, v31
    s_nop 0
    v_add_f32 v62, v62, v24
    v_add_f32 v62, v62, v25
    v_add_f32 v62, v62, v26
    v_add_f32 v62, v62, v27
    v_add_f32 v62, v62, v28
    v_add_f32 v62, v62, v29
    v_add_f32 v62, v62, v30
    v_add_f32 v62, v62, v31
    v_cvt_pk_bf16_f32 v40, v24, v25
    v_cvt_pk_bf16_f32 v41, v26, v27
    v_cvt_pk_bf16_f32 v42, v28, v29
    v_cvt_pk_bf16_f32 v43, v30, v31
    s_nop 1
    v_mfma_f32_16x16x32_bf16 v[136:139], a[192:195], v[40:43], v[136:139]
    v_mfma_f32_16x16x32_bf16 v[152:155], a[196:199], v[40:43], v[152:155]
    v_mfma_f32_16x16x32_bf16 v[168:171], a[200:203], v[40:43], v[168:171]
    v_mfma_f32_16x16x32_bf16 v[184:187], a[204:207], v[40:43], v[184:187]
    v_mfma_f32_16x16x32_bf16 v[200:203], a[208:211], v[40:43], v[200:203]
    v_mfma_f32_16x16x32_bf16 v[216:219], a[212:215], v[40:43], v[216:219]
    v_mfma_f32_16x16x32_bf16 v[232:235], a[216:219], v[40:43], v[232:235]
    v_mfma_f32_16x16x32_bf16 v[248:251], a[220:223], v[40:43], v[248:251]
    v_mfma_f32_16x16x32_bf16 v[24:27], a[128:131], v[112:115], 0
    v_mfma_f32_16x16x32_bf16 v[24:27], a[132:135], v[116:119], v[24:27]
    v_mfma_f32_16x16x32_bf16 v[24:27], a[136:139], v[120:123], v[24:27]
    v_mfma_f32_16x16x32_bf16 v[24:27], a[140:143], v[124:127], v[24:27]
    v_mfma_f32_16x16x32_bf16 v[28:31], a[156:159], v[124:127], 0
    v_mfma_f32_16x16x32_bf16 v[28:31], a[152:155], v[120:123], v[28:31]
    v_mfma_f32_16x16x32_bf16 v[28:31], a[148:151], v[116:119], v[28:31]
    v_mfma_f32_16x16x32_bf16 v[28:31], a[144:147], v[112:115], v[28:31]
    s_nop 9
    v_max3_f32 v2, v24, v25, v26
    v_max3_f32 v2, v2, v27, v28
    v_max3_f32 v2, v2, v29, v30
    v_max_f32 v2, v2, v31
    v_mov_b32 v3, v2
    s_nop 1
    v_permlane16_swap_b32 v2, v3
    s_nop 1
    v_max_f32 v2, v2, v3
    v_mov_b32 v3, v2
    s_nop 1
    v_permlane32_swap_b32 v2, v3
    s_nop 1
    v_max_f32 v2, v2, v3
    v_max_f32 v2, v2, v51
    v_sub_f32 v4, v51, v2
    v_exp_f32 v4, v4
    v_mov_b32 v51, v2
    v_mul_f32 v63, v63, v4
    v_mul_f32 v140, v140, v4
    v_mul_f32 v141, v141, v4
    v_mul_f32 v142, v142, v4
    v_mul_f32 v143, v143, v4
    v_mul_f32 v156, v156, v4
    v_mul_f32 v157, v157, v4
    v_mul_f32 v158, v158, v4
    v_mul_f32 v159, v159, v4
    v_mul_f32 v172, v172, v4
    v_mul_f32 v173, v173, v4
    v_mul_f32 v174, v174, v4
    v_mul_f32 v175, v175, v4
    v_mul_f32 v188, v188, v4
    v_mul_f32 v189, v189, v4
    v_mul_f32 v190, v190, v4
    v_mul_f32 v191, v191, v4
    v_mul_f32 v204, v204, v4
    v_mul_f32 v205, v205, v4
    v_mul_f32 v206, v206, v4
    v_mul_f32 v207, v207, v4
    v_mul_f32 v220, v220, v4
    v_mul_f32 v221, v221, v4
    v_mul_f32 v222, v222, v4
    v_mul_f32 v223, v223, v4
    v_mul_f32 v236, v236, v4
    v_mul_f32 v237, v237, v4
    v_mul_f32 v238, v238, v4
    v_mul_f32 v239, v239, v4
    v_mul_f32 v252, v252, v4
    v_mul_f32 v253, v253, v4
    v_mul_f32 v254, v254, v4
    v_mul_f32 v255, v255, v4
    v_sub_f32 v24, v24, v2
    v_sub_f32 v25, v25, v2
    v_sub_f32 v26, v26, v2
    v_sub_f32 v27, v27, v2
    v_sub_f32 v28, v28, v2
    v_sub_f32 v29, v29, v2
    v_sub_f32 v30, v30, v2
    v_sub_f32 v31, v31, v2
    v_exp_f32 v24, v24
    v_exp_f32 v25, v25
    v_exp_f32 v26, v26
    v_exp_f32 v27, v27
    v_exp_f32 v28, v28
    v_exp_f32 v29, v29
    v_exp_f32 v30, v30
    v_exp_f32 v31, v31
    s_nop 0
    v_add_f32 v63, v63, v24
    v_add_f32 v63, v63, v25
    v_add_f32 v63, v63, v26
    v_add_f32 v63, v63, v27
    v_add_f32 v63, v63, v28
    v_add_f32 v63, v63, v29
    v_add_f32 v63, v63, v30
    v_add_f32 v63, v63, v31
    v_cvt_pk_bf16_f32 v40, v24, v25
    v_cvt_pk_bf16_f32 v41, v26, v27
    v_cvt_pk_bf16_f32 v42, v28, v29
    v_cvt_pk_bf16_f32 v43, v30, v31
    s_nop 1
    v_mfma_f32_16x16x32_bf16 v[140:143], a[192:195], v[40:43], v[140:143]
    v_mfma_f32_16x16x32_bf16 v[156:159], a[196:199], v[40:43], v[156:159]
    v_mfma_f32_16x16x32_bf16 v[172:175], a[200:203], v[40:43], v[172:175]
    v_mfma_f32_16x16x32_bf16 v[188:191], a[204:207], v[40:43], v[188:191]
    v_mfma_f32_16x16x32_bf16 v[204:207], a[208:211], v[40:43], v[204:207]
    v_mfma_f32_16x16x32_bf16 v[220:223], a[212:215], v[40:43], v[220:223]
    v_mfma_f32_16x16x32_bf16 v[236:239], a[216:219], v[40:43], v[236:239]
    v_mfma_f32_16x16x32_bf16 v[252:255], a[220:223], v[40:43], v[252:255]
    ds_read_b128 a[160:163], v10 offset:8192
    ds_read_b128 a[164:167], v10 offset:9216
    ds_read_b128 a[168:171], v10 offset:10240
    ds_read_b128 a[172:175], v10 offset:11264
    ds_read_b128 a[176:179], v10 offset:12288
    ds_read_b128 a[180:183], v10 offset:13312
    ds_read_b128 a[184:187], v10 offset:14336
    ds_read_b128 a[188:191], v10 offset:15360
    s_waitcnt lgkmcnt(0)
    ds_read_b64_tr_b16 a[224:225], v19 offset:24576
    ds_read_b64_tr_b16 a[228:229], v12 offset:24576
    ds_read_b64_tr_b16 a[232:233], v19 offset:25600
    ds_read_b64_tr_b16 a[236:237], v12 offset:25600
    ds_read_b64_tr_b16 a[240:241], v19 offset:26624
    ds_read_b64_tr_b16 a[244:245], v12 offset:26624
    ds_read_b64_tr_b16 a[248:249], v19 offset:27648
    ds_read_b64_tr_b16 a[252:253], v12 offset:27648
    s_waitcnt lgkmcnt(0)
    ds_read_b64_tr_b16 a[226:227], v19 offset:28672
    ds_read_b64_tr_b16 a[230:231], v12 offset:28672
    ds_read_b64_tr_b16 a[234:235], v19 offset:29696
    ds_read_b64_tr_b16 a[238:239], v12 offset:29696
    ds_read_b64_tr_b16 a[242:243], v19 offset:30720
    ds_read_b64_tr_b16 a[246:247], v12 offset:30720
    ds_read_b64_tr_b16 a[250:251], v19 offset:31744
    ds_read_b64_tr_b16 a[254:255], v12 offset:31744
    s_waitcnt lgkmcnt(0)
    v_mfma_f32_16x16x32_bf16 v[32:35], a[160:163], v[64:67], 0
    v_mfma_f32_16x16x32_bf16 v[32:35], a[164:167], v[68:71], v[32:35]
    v_mfma_f32_16x16x32_bf16 v[32:35], a[168:171], v[72:75], v[32:35]
    v_mfma_f32_16x16x32_bf16 v[32:35], a[172:175], v[76:79], v[32:35]
    v_mfma_f32_16x16x32_bf16 v[36:39], a[188:191], v[76:79], 0
    v_mfma_f32_16x16x32_bf16 v[36:39], a[184:187], v[72:75], v[36:39]
    v_mfma_f32_16x16x32_bf16 v[36:39], a[180:183], v[68:71], v[36:39]
    v_mfma_f32_16x16x32_bf16 v[36:39], a[176:179], v[64:67], v[36:39]
    s_nop 9
    v_max3_f32 v2, v32, v33, v34
    v_max3_f32 v2, v2, v35, v36
    v_max3_f32 v2, v2, v37, v38
    v_max_f32 v2, v2, v39
    v_mov_b32 v3, v2
    s_nop 1
    v_permlane16_swap_b32 v2, v3
    s_nop 1
    v_max_f32 v2, v2, v3
    v_mov_b32 v3, v2
    s_nop 1
    v_permlane32_swap_b32 v2, v3
    s_nop 1
    v_max_f32 v2, v2, v3
    v_max_f32 v2, v2, v48
    v_sub_f32 v4, v48, v2
    v_exp_f32 v4, v4
    v_mov_b32 v48, v2
    v_mul_f32 v60, v60, v4
    v_mul_f32 v128, v128, v4
    v_mul_f32 v129, v129, v4
    v_mul_f32 v130, v130, v4
    v_mul_f32 v131, v131, v4
    v_mul_f32 v144, v144, v4
    v_mul_f32 v145, v145, v4
    v_mul_f32 v146, v146, v4
    v_mul_f32 v147, v147, v4
    v_mul_f32 v160, v160, v4
    v_mul_f32 v161, v161, v4
    v_mul_f32 v162, v162, v4
    v_mul_f32 v163, v163, v4
    v_mul_f32 v176, v176, v4
    v_mul_f32 v177, v177, v4
    v_mul_f32 v178, v178, v4
    v_mul_f32 v179, v179, v4
    v_mul_f32 v192, v192, v4
    v_mul_f32 v193, v193, v4
    v_mul_f32 v194, v194, v4
    v_mul_f32 v195, v195, v4
    v_mul_f32 v208, v208, v4
    v_mul_f32 v209, v209, v4
    v_mul_f32 v210, v210, v4
    v_mul_f32 v211, v211, v4
    v_mul_f32 v224, v224, v4
    v_mul_f32 v225, v225, v4
    v_mul_f32 v226, v226, v4
    v_mul_f32 v227, v227, v4
    v_mul_f32 v240, v240, v4
    v_mul_f32 v241, v241, v4
    v_mul_f32 v242, v242, v4
    v_mul_f32 v243, v243, v4
    v_sub_f32 v32, v32, v2
    v_sub_f32 v33, v33, v2
    v_sub_f32 v34, v34, v2
    v_sub_f32 v35, v35, v2
    v_sub_f32 v36, v36, v2
    v_sub_f32 v37, v37, v2
    v_sub_f32 v38, v38, v2
    v_sub_f32 v39, v39, v2
    v_exp_f32 v32, v32
    v_exp_f32 v33, v33
    v_exp_f32 v34, v34
    v_exp_f32 v35, v35
    v_exp_f32 v36, v36
    v_exp_f32 v37, v37
    v_exp_f32 v38, v38
    v_exp_f32 v39, v39
    s_nop 0
    v_add_f32 v60, v60, v32
    v_add_f32 v60, v60, v33
    v_add_f32 v60, v60, v34
    v_add_f32 v60, v60, v35
    v_add_f32 v60, v60, v36
    v_add_f32 v60, v60, v37
    v_add_f32 v60, v60, v38
    v_add_f32 v60, v60, v39
    v_cvt_pk_bf16_f32 v44, v32, v33
    v_cvt_pk_bf16_f32 v45, v34, v35
    v_cvt_pk_bf16_f32 v46, v36, v37
    v_cvt_pk_bf16_f32 v47, v38, v39
    s_nop 1
    v_mfma_f32_16x16x32_bf16 v[128:131], a[224:227], v[44:47], v[128:131]
    v_mfma_f32_16x16x32_bf16 v[144:147], a[228:231], v[44:47], v[144:147]
    v_mfma_f32_16x16x32_bf16 v[160:163], a[232:235], v[44:47], v[160:163]
    v_mfma_f32_16x16x32_bf16 v[176:179], a[236:239], v[44:47], v[176:179]
    v_mfma_f32_16x16x32_bf16 v[192:195], a[240:243], v[44:47], v[192:195]
    v_mfma_f32_16x16x32_bf16 v[208:211], a[244:247], v[44:47], v[208:211]
    v_mfma_f32_16x16x32_bf16 v[224:227], a[248:251], v[44:47], v[224:227]
    v_mfma_f32_16x16x32_bf16 v[240:243], a[252:255], v[44:47], v[240:243]
    v_mfma_f32_16x16x32_bf16 v[32:35], a[160:163], v[80:83], 0
    v_mfma_f32_16x16x32_bf16 v[32:35], a[164:167], v[84:87], v[32:35]
    v_mfma_f32_16x16x32_bf16 v[32:35], a[168:171], v[88:91], v[32:35]
    v_mfma_f32_16x16x32_bf16 v[32:35], a[172:175], v[92:95], v[32:35]
    v_mfma_f32_16x16x32_bf16 v[36:39], a[188:191], v[92:95], 0
    v_mfma_f32_16x16x32_bf16 v[36:39], a[184:187], v[88:91], v[36:39]
    v_mfma_f32_16x16x32_bf16 v[36:39], a[180:183], v[84:87], v[36:39]
    v_mfma_f32_16x16x32_bf16 v[36:39], a[176:179], v[80:83], v[36:39]
    s_nop 9
    v_max3_f32 v2, v32, v33, v34
    v_max3_f32 v2, v2, v35, v36
    v_max3_f32 v2, v2, v37, v38
    v_max_f32 v2, v2, v39
    v_mov_b32 v3, v2
    s_nop 1
    v_permlane16_swap_b32 v2, v3
    s_nop 1
    v_max_f32 v2, v2, v3
    v_mov_b32 v3, v2
    s_nop 1
    v_permlane32_swap_b32 v2, v3
    s_nop 1
    v_max_f32 v2, v2, v3
    v_max_f32 v2, v2, v49
    v_sub_f32 v4, v49, v2
    v_exp_f32 v4, v4
    v_mov_b32 v49, v2
    v_mul_f32 v61, v61, v4
    v_mul_f32 v132, v132, v4
    v_mul_f32 v133, v133, v4
    v_mul_f32 v134, v134, v4
    v_mul_f32 v135, v135, v4
    v_mul_f32 v148, v148, v4
    v_mul_f32 v149, v149, v4
    v_mul_f32 v150, v150, v4
    v_mul_f32 v151, v151, v4
    v_mul_f32 v164, v164, v4
    v_mul_f32 v165, v165, v4
    v_mul_f32 v166, v166, v4
    v_mul_f32 v167, v167, v4
    v_mul_f32 v180, v180, v4
    v_mul_f32 v181, v181, v4
    v_mul_f32 v182, v182, v4
    v_mul_f32 v183, v183, v4
    v_mul_f32 v196, v196, v4
    v_mul_f32 v197, v197, v4
    v_mul_f32 v198, v198, v4
    v_mul_f32 v199, v199, v4
    v_mul_f32 v212, v212, v4
    v_mul_f32 v213, v213, v4
    v_mul_f32 v214, v214, v4
    v_mul_f32 v215, v215, v4
    v_mul_f32 v228, v228, v4
    v_mul_f32 v229, v229, v4
    v_mul_f32 v230, v230, v4
    v_mul_f32 v231, v231, v4
    v_mul_f32 v244, v244, v4
    v_mul_f32 v245, v245, v4
    v_mul_f32 v246, v246, v4
    v_mul_f32 v247, v247, v4
    v_sub_f32 v32, v32, v2
    v_sub_f32 v33, v33, v2
    v_sub_f32 v34, v34, v2
    v_sub_f32 v35, v35, v2
    v_sub_f32 v36, v36, v2
    v_sub_f32 v37, v37, v2
    v_sub_f32 v38, v38, v2
    v_sub_f32 v39, v39, v2
    v_exp_f32 v32, v32
    v_exp_f32 v33, v33
    v_exp_f32 v34, v34
    v_exp_f32 v35, v35
    v_exp_f32 v36, v36
    v_exp_f32 v37, v37
    v_exp_f32 v38, v38
    v_exp_f32 v39, v39
    s_nop 0
    v_add_f32 v61, v61, v32
    v_add_f32 v61, v61, v33
    v_add_f32 v61, v61, v34
    v_add_f32 v61, v61, v35
    v_add_f32 v61, v61, v36
    v_add_f32 v61, v61, v37
    v_add_f32 v61, v61, v38
    v_add_f32 v61, v61, v39
    v_cvt_pk_bf16_f32 v44, v32, v33
    v_cvt_pk_bf16_f32 v45, v34, v35
    v_cvt_pk_bf16_f32 v46, v36, v37
    v_cvt_pk_bf16_f32 v47, v38, v39
    s_nop 1
    v_mfma_f32_16x16x32_bf16 v[132:135], a[224:227], v[44:47], v[132:135]
    v_mfma_f32_16x16x32_bf16 v[148:151], a[228:231], v[44:47], v[148:151]
    v_mfma_f32_16x16x32_bf16 v[164:167], a[232:235], v[44:47], v[164:167]
    v_mfma_f32_16x16x32_bf16 v[180:183], a[236:239], v[44:47], v[180:183]
    v_mfma_f32_16x16x32_bf16 v[196:199], a[240:243], v[44:47], v[196:199]
    v_mfma_f32_16x16x32_bf16 v[212:215], a[244:247], v[44:47], v[212:215]
    v_mfma_f32_16x16x32_bf16 v[228:231], a[248:251], v[44:47], v[228:231]
    v_mfma_f32_16x16x32_bf16 v[244:247], a[252:255], v[44:47], v[244:247]
    v_mfma_f32_16x16x32_bf16 v[32:35], a[160:163], v[96:99], 0
    v_mfma_f32_16x16x32_bf16 v[32:35], a[164:167], v[100:103], v[32:35]
    v_mfma_f32_16x16x32_bf16 v[32:35], a[168:171], v[104:107], v[32:35]
    v_mfma_f32_16x16x32_bf16 v[32:35], a[172:175], v[108:111], v[32:35]
    v_mfma_f32_16x16x32_bf16 v[36:39], a[188:191], v[108:111], 0
    v_mfma_f32_16x16x32_bf16 v[36:39], a[184:187], v[104:107], v[36:39]
    v_mfma_f32_16x16x32_bf16 v[36:39], a[180:183], v[100:103], v[36:39]
    v_mfma_f32_16x16x32_bf16 v[36:39], a[176:179], v[96:99], v[36:39]
    s_nop 9
    v_max3_f32 v2, v32, v33, v34
    v_max3_f32 v2, v2, v35, v36
    v_max3_f32 v2, v2, v37, v38
    v_max_f32 v2, v2, v39
    v_mov_b32 v3, v2
    s_nop 1
    v_permlane16_swap_b32 v2, v3
    s_nop 1
    v_max_f32 v2, v2, v3
    v_mov_b32 v3, v2
    s_nop 1
    v_permlane32_swap_b32 v2, v3
    s_nop 1
    v_max_f32 v2, v2, v3
    v_max_f32 v2, v2, v50
    v_sub_f32 v4, v50, v2
    v_exp_f32 v4, v4
    v_mov_b32 v50, v2
    v_mul_f32 v62, v62, v4
    v_mul_f32 v136, v136, v4
    v_mul_f32 v137, v137, v4
    v_mul_f32 v138, v138, v4
    v_mul_f32 v139, v139, v4
    v_mul_f32 v152, v152, v4
    v_mul_f32 v153, v153, v4
    v_mul_f32 v154, v154, v4
    v_mul_f32 v155, v155, v4
    v_mul_f32 v168, v168, v4
    v_mul_f32 v169, v169, v4
    v_mul_f32 v170, v170, v4
    v_mul_f32 v171, v171, v4
    v_mul_f32 v184, v184, v4
    v_mul_f32 v185, v185, v4
    v_mul_f32 v186, v186, v4
    v_mul_f32 v187, v187, v4
    v_mul_f32 v200, v200, v4
    v_mul_f32 v201, v201, v4
    v_mul_f32 v202, v202, v4
    v_mul_f32 v203, v203, v4
    v_mul_f32 v216, v216, v4
    v_mul_f32 v217, v217, v4
    v_mul_f32 v218, v218, v4
    v_mul_f32 v219, v219, v4
    v_mul_f32 v232, v232, v4
    v_mul_f32 v233, v233, v4
    v_mul_f32 v234, v234, v4
    v_mul_f32 v235, v235, v4
    v_mul_f32 v248, v248, v4
    v_mul_f32 v249, v249, v4
    v_mul_f32 v250, v250, v4
    v_mul_f32 v251, v251, v4
    v_sub_f32 v32, v32, v2
    v_sub_f32 v33, v33, v2
    v_sub_f32 v34, v34, v2
    v_sub_f32 v35, v35, v2
    v_sub_f32 v36, v36, v2
    v_sub_f32 v37, v37, v2
    v_sub_f32 v38, v38, v2
    v_sub_f32 v39, v39, v2
    v_exp_f32 v32, v32
    v_exp_f32 v33, v33
    v_exp_f32 v34, v34
    v_exp_f32 v35, v35
    v_exp_f32 v36, v36
    v_exp_f32 v37, v37
    v_exp_f32 v38, v38
    v_exp_f32 v39, v39
    s_nop 0
    v_add_f32 v62, v62, v32
    v_add_f32 v62, v62, v33
    v_add_f32 v62, v62, v34
    v_add_f32 v62, v62, v35
    v_add_f32 v62, v62, v36
    v_add_f32 v62, v62, v37
    v_add_f32 v62, v62, v38
    v_add_f32 v62, v62, v39
    v_cvt_pk_bf16_f32 v44, v32, v33
    v_cvt_pk_bf16_f32 v45, v34, v35
    v_cvt_pk_bf16_f32 v46, v36, v37
    v_cvt_pk_bf16_f32 v47, v38, v39
    s_nop 1
    v_mfma_f32_16x16x32_bf16 v[136:139], a[224:227], v[44:47], v[136:139]
    v_mfma_f32_16x16x32_bf16 v[152:155], a[228:231], v[44:47], v[152:155]
    v_mfma_f32_16x16x32_bf16 v[168:171], a[232:235], v[44:47], v[168:171]
    v_mfma_f32_16x16x32_bf16 v[184:187], a[236:239], v[44:47], v[184:187]
    v_mfma_f32_16x16x32_bf16 v[200:203], a[240:243], v[44:47], v[200:203]
    v_mfma_f32_16x16x32_bf16 v[216:219], a[244:247], v[44:47], v[216:219]
    v_mfma_f32_16x16x32_bf16 v[232:235], a[248:251], v[44:47], v[232:235]
    v_mfma_f32_16x16x32_bf16 v[248:251], a[252:255], v[44:47], v[248:251]
    v_mfma_f32_16x16x32_bf16 v[32:35], a[160:163], v[112:115], 0
    v_mfma_f32_16x16x32_bf16 v[32:35], a[164:167], v[116:119], v[32:35]
    v_mfma_f32_16x16x32_bf16 v[32:35], a[168:171], v[120:123], v[32:35]
    v_mfma_f32_16x16x32_bf16 v[32:35], a[172:175], v[124:127], v[32:35]
    v_mfma_f32_16x16x32_bf16 v[36:39], a[188:191], v[124:127], 0
    v_mfma_f32_16x16x32_bf16 v[36:39], a[184:187], v[120:123], v[36:39]
    v_mfma_f32_16x16x32_bf16 v[36:39], a[180:183], v[116:119], v[36:39]
    v_mfma_f32_16x16x32_bf16 v[36:39], a[176:179], v[112:115], v[36:39]
    s_nop 9
    v_max3_f32 v2, v32, v33, v34
    v_max3_f32 v2, v2, v35, v36
    v_max3_f32 v2, v2, v37, v38
    v_max_f32 v2, v2, v39
    v_mov_b32 v3, v2
    s_nop 1
    v_permlane16_swap_b32 v2, v3
    s_nop 1
    v_max_f32 v2, v2, v3
    v_mov_b32 v3, v2
    s_nop 1
    v_permlane32_swap_b32 v2, v3
    s_nop 1
    v_max_f32 v2, v2, v3
    v_max_f32 v2, v2, v51
    v_sub_f32 v4, v51, v2
    v_exp_f32 v4, v4
    v_mov_b32 v51, v2
    v_mul_f32 v63, v63, v4
    v_mul_f32 v140, v140, v4
    v_mul_f32 v141, v141, v4
    v_mul_f32 v142, v142, v4
    v_mul_f32 v143, v143, v4
    v_mul_f32 v156, v156, v4
    v_mul_f32 v157, v157, v4
    v_mul_f32 v158, v158, v4
    v_mul_f32 v159, v159, v4
    v_mul_f32 v172, v172, v4
    v_mul_f32 v173, v173, v4
    v_mul_f32 v174, v174, v4
    v_mul_f32 v175, v175, v4
    v_mul_f32 v188, v188, v4
    v_mul_f32 v189, v189, v4
    v_mul_f32 v190, v190, v4
    v_mul_f32 v191, v191, v4
    v_mul_f32 v204, v204, v4
    v_mul_f32 v205, v205, v4
    v_mul_f32 v206, v206, v4
    v_mul_f32 v207, v207, v4
    v_mul_f32 v220, v220, v4
    v_mul_f32 v221, v221, v4
    v_mul_f32 v222, v222, v4
    v_mul_f32 v223, v223, v4
    v_mul_f32 v236, v236, v4
    v_mul_f32 v237, v237, v4
    v_mul_f32 v238, v238, v4
    v_mul_f32 v239, v239, v4
    v_mul_f32 v252, v252, v4
    v_mul_f32 v253, v253, v4
    v_mul_f32 v254, v254, v4
    v_mul_f32 v255, v255, v4
    v_sub_f32 v32, v32, v2
    v_sub_f32 v33, v33, v2
    v_sub_f32 v34, v34, v2
    v_sub_f32 v35, v35, v2
    v_sub_f32 v36, v36, v2
    v_sub_f32 v37, v37, v2
    v_sub_f32 v38, v38, v2
    v_sub_f32 v39, v39, v2
    v_exp_f32 v32, v32
    v_exp_f32 v33, v33
    v_exp_f32 v34, v34
    v_exp_f32 v35, v35
    v_exp_f32 v36, v36
    v_exp_f32 v37, v37
    v_exp_f32 v38, v38
    v_exp_f32 v39, v39
    s_nop 0
    v_add_f32 v63, v63, v32
    v_add_f32 v63, v63, v33
    v_add_f32 v63, v63, v34
    v_add_f32 v63, v63, v35
    v_add_f32 v63, v63, v36
    v_add_f32 v63, v63, v37
    v_add_f32 v63, v63, v38
    v_add_f32 v63, v63, v39
    v_cvt_pk_bf16_f32 v44, v32, v33
    v_cvt_pk_bf16_f32 v45, v34, v35
    v_cvt_pk_bf16_f32 v46, v36, v37
    v_cvt_pk_bf16_f32 v47, v38, v39
    s_nop 1
    v_mfma_f32_16x16x32_bf16 v[140:143], a[224:227], v[44:47], v[140:143]
    v_mfma_f32_16x16x32_bf16 v[156:159], a[228:231], v[44:47], v[156:159]
    v_mfma_f32_16x16x32_bf16 v[172:175], a[232:235], v[44:47], v[172:175]
    v_mfma_f32_16x16x32_bf16 v[188:191], a[236:239], v[44:47], v[188:191]
    v_mfma_f32_16x16x32_bf16 v[204:207], a[240:243], v[44:47], v[204:207]
    v_mfma_f32_16x16x32_bf16 v[220:223], a[244:247], v[44:47], v[220:223]
    v_mfma_f32_16x16x32_bf16 v[236:239], a[248:251], v[44:47], v[236:239]
    v_mfma_f32_16x16x32_bf16 v[252:255], a[252:255], v[44:47], v[252:255]
    s_sub_u32 s84, s84, 1
    s_cmp_lg_u32 s84, 0
    s_cbranch_scc1 L_main_slow_loop
    s_nop 7
    v_mov_b32 v2, v60
    v_mov_b32 v3, v61
    v_mov_b32 v4, v62
    v_mov_b32 v5, v63
    s_nop 1
    v_permlane16_swap_b32 v60, v2
    v_permlane16_swap_b32 v61, v3
    v_permlane16_swap_b32 v62, v4
    v_permlane16_swap_b32 v63, v5
    s_nop 1
    v_add_f32 v60, v60, v2
    v_add_f32 v61, v61, v3
    v_add_f32 v62, v62, v4
    v_add_f32 v63, v63, v5
    v_mov_b32 v2, v60
    v_mov_b32 v3, v61
    v_mov_b32 v4, v62
    v_mov_b32 v5, v63
    s_nop 1
    v_permlane32_swap_b32 v60, v2
    v_permlane32_swap_b32 v61, v3
    v_permlane32_swap_b32 v62, v4
    v_permlane32_swap_b32 v63, v5
    s_nop 1
    v_add_f32 v60, v60, v2
    v_add_f32 v61, v61, v3
    v_add_f32 v62, v62, v4
    v_add_f32 v63, v63, v5
    s_mul_i32 s80, s3, 303104
    s_add_u32 s80, s80, 24576
    buffer_load_dwordx4 a[128:131], v1, s[16:19], s80 offen offset:3072 sc1
    s_add_u32 s80, s80, 4096
    buffer_load_dwordx4 a[132:135], v1, s[16:19], s80 offen offset:0 sc1
    buffer_load_dwordx4 a[136:139], v1, s[16:19], s80 offen offset:1024 sc1
    buffer_load_dwordx4 a[140:143], v1, s[16:19], s80 offen offset:2048 sc1
    buffer_load_dwordx4 a[144:147], v1, s[16:19], s80 offen offset:3072 sc1
    s_add_u32 s80, s80, 4096
    buffer_load_dwordx4 a[148:151], v1, s[16:19], s80 offen offset:0 sc1
    buffer_load_dwordx4 a[152:155], v1, s[16:19], s80 offen offset:1024 sc1
    buffer_load_dwordx4 a[156:159], v1, s[16:19], s80 offen offset:2048 sc1
    buffer_load_dwordx4 a[160:163], v1, s[16:19], s80 offen offset:3072 sc1
    s_add_u32 s80, s80, 4096
    buffer_load_dwordx4 a[164:167], v1, s[16:19], s80 offen offset:0 sc1
    s_waitcnt vmcnt(0)
    s_barrier
    s_branch L_main_norm
.section .rodata,"a"
.p2align 6
.amdhsa_kernel adaLN_cond__gqa_block_cached__glu_gated_reglu__prompt_kernel
  .amdhsa_next_free_vgpr 512
  .amdhsa_next_free_sgpr 102
  .amdhsa_accum_offset 256
  .amdhsa_group_segment_fixed_size 0
  .amdhsa_kernarg_size 112
  .amdhsa_user_sgpr_count 2
  .amdhsa_user_sgpr_kernarg_segment_ptr 1
  .amdhsa_system_sgpr_workgroup_id_x 1
.end_amdhsa_kernel
```
